```python
import torch

def _softmax(x, axis=-1):
    return torch.softmax(x, dim=axis)
def _gelu(x):
    return torch.nn.functional.gelu(x, approximate="tanh")
def _silu(x):
    return torch.nn.functional.silu(x)
def _sigmoid(x):
    return torch.sigmoid(x)
def _layernorm(x, axis=-1, eps=1e-5):
    m = x.mean(dim=axis, keepdim=True)
    v = x.var(dim=axis, keepdim=True, unbiased=False)
    return (x - m) / torch.sqrt(v + eps)
def _scatter_add(tgt, idx, src, axis=0):
    return tgt.clone().index_add_(axis, idx, src)
def _segment_sum(src, seg, n):
    out = torch.zeros((n,) + src.shape[1:], dtype=src.dtype)
    return out.index_add_(0, seg, src)
def _pad(x, pw):
    flat = tuple(v for pair in reversed(pw) for v in pair)
    return torch.nn.functional.pad(x, flat)

kernel_name = 'gated_mix__sliding_block__mixer_channel_mlp__prompt'

def setup_inputs():

    _w = (lambda a: (lambda t: t.to(torch.bfloat16) if t.is_floating_point() else t)(torch.as_tensor(a)))
    def _A_setup():
        B, S, D = 1, 2048, 576
        return {
            "x": _w((lambda *s: torch.randn(*s, dtype=torch.bfloat16) * 0.05)(B, S, D)),
            "wqkv": _w((lambda *s: torch.randn(*s, dtype=torch.bfloat16) * 0.8)(D, 3 * D)),
            "wo": _w((lambda *s: torch.randn(*s, dtype=torch.bfloat16) * 0.05)(D, D)),
        }
    _A_in = _A_setup()

    def _B_setup():
        B, S, D, F = 1, 2048, 576, 4608
        return {
            "x": _w((lambda *s: torch.randn(*s, dtype=torch.bfloat16) * 0.05)(B, S, D)),
            "w1": _w((lambda *s: torch.randn(*s, dtype=torch.bfloat16) * 3.2)(D, F) * (D ** -0.5)),
            "b1": _w((lambda *s: torch.randn(*s, dtype=torch.bfloat16) * 1.6)(F)),
            "w2": _w((lambda *s: torch.randn(*s, dtype=torch.bfloat16) * 0.1)(F, D) * (F ** -0.5)),
            "b2": _w((lambda *s: torch.randn(*s, dtype=torch.bfloat16) * 0.2)(D)),
        }
    _B_in = _B_setup()

    return {
        "A_x": _A_in["x"],
        "A_wqkv": _A_in["wqkv"],
        "A_wo": _A_in["wo"],
        "B_x": _B_in["x"],
        "B_w1": _B_in["w1"],
        "B_b1": _B_in["b1"],
        "B_w2": _B_in["w2"],
        "B_b2": _B_in["b2"],
        "gate_w": _w((lambda *s: torch.randn(*s, dtype=torch.bfloat16) * 0.05)(576) * 16.0),
    }

def reference(A_x, A_wqkv, A_wo, B_x, B_w1, B_b1, B_w2, B_b2, gate_w):
    def _A_ref(x, wqkv, wo):
        B, S, D = x.shape
        H = 32; Dh = D // H; W = 256
        qkv = (lambda x, *d: x.permute(*d))((x @ wqkv).reshape(B, S, 3, H, Dh), 2, 0, 3, 1, 4)
        q, k, v = qkv[0], qkv[1], qkv[2]
        scores = torch.einsum("bhqd,bhkd->bhqk", q, k) * (Dh ** -0.5)
        idx = torch.arange(S)
        mask = (idx[:, None] - idx[None, :] >= 0) & (idx[:, None] - idx[None, :] < W)
        scores = torch.where(mask[None, None], scores, -1e9)
        p = _softmax(scores, axis=-1)
        o = torch.einsum("bhqk,bhkd->bhqd", p, v)
        return (lambda x, *d: x.permute(*d))(o, 0, 2, 1, 3).reshape(B, S, D) @ wo

    def _B_ref(x, w1, b1, w2, b2):
        y = _layernorm(x, axis=-1)
        h = _gelu(torch.einsum("bsd,df->bsf", y, w1) + b1)
        return torch.einsum("bsf,fd->bsd", h, w2) + b2

    x = A_x
    g = _sigmoid((x * gate_w).sum(-1, keepdims=True))
    a = _A_ref(x, A_wqkv, A_wo)
    b = _B_ref(x, B_w1, B_b1, B_w2, B_b2)
    return g * a + (1 - g) * b
```

```asm
; @launch grid=(256,1,1) block=(512,1,1) lds=163840
.amdgcn_target "amdgcn-amd-amdhsa--gfx950"
.text
.p2align 8
.globl gated_mix__sliding_block__mixer_channel_mlp__prompt_kernel
.type gated_mix__sliding_block__mixer_channel_mlp__prompt_kernel,@function
gated_mix__sliding_block__mixer_channel_mlp__prompt_kernel:
mk_kernel:
    s_cmp_ge_u32 s2, 256
    s_cbranch_scc1 mk_end
    s_load_dwordx4 s[4:7], s[0:1], 0
    s_load_dwordx4 s[88:91], s[0:1], 32
    s_load_dwordx2 s[12:13], s[0:1], 64
    s_load_dwordx4 s[8:11], s[0:1], 80
    s_load_dwordx4 s[92:95], s[0:1], 48
    s_load_dwordx2 s[98:99], s[0:1], 72
    s_load_dwordx2 s[96:97], s[0:1], 16
    v_and_b32 v246, 63, v0
    v_lshrrev_b32 v228, 6, v0
    s_nop 0
    v_readfirstlane_b32 s32, v228
    s_and_b32 s40, s2, 7
    s_lshr_b32 s39, s2, 3
    s_and_b32 s35, s40, 3
    s_lshr_b32 s40, s40, 2
    s_lshl_b32 s40, s40, 3
    s_and_b32 s36, s39, 7
    s_add_u32 s36, s36, s40
    s_lshr_b32 s37, s39, 3
    v_lshrrev_b32 v228, 3, v246
    v_and_b32 v229, 7, v246
    v_lshrrev_b32 v230, 1, v228
    v_xor_b32 v229, v229, v230
    v_mul_u32_u24 v228, 1152, v228
    v_lshl_add_u32 v208, v229, 4, v228
    v_xor_b32 v209, 64, v208
    s_lshl_b32 s40, s36, 3
    s_add_u32 s40, s40, s32
    s_mul_i32 s44, s40, 18432
    s_lshl_b32 s45, s32, 11
    s_lshl_b32 s47, s32, 10
    v_lshrrev_b32 v241, 5, v246
    v_bfe_u32 v228, v246, 2, 2
    v_and_b32 v231, 3, v246
    v_bfe_u32 v230, v246, 4, 1
    v_lshl_add_u32 v229, v241, 2, v228
    v_lshlrev_b32 v240, 6, v230
    v_lshl_add_u32 v240, v231, 4, v240
    s_cmp_eq_u32 s37, 3
    s_movk_i32 s41, 9216
    s_cselect_b32 s41, 3456, s41
    v_mul_lo_u32 v229, s41, v229
    v_add_u32 v240, v240, v229
    s_mul_i32 s46, s32, s41
    s_lshl_b32 s46, s46, 3
    s_waitcnt lgkmcnt(0)
    s_mov_b32 s16, s4
    s_and_b32 s17, s5, 0xffff
    s_mov_b32 s18, 0x240000
    s_mov_b32 s19, 0x20000
    s_add_u32 m0, s45, 90112
    s_add_u32 s41, s44, 0
    buffer_load_dwordx4 v208, s[16:19], s41 offen lds
    s_add_u32 m0, s45, 91136
    s_add_u32 s41, s44, 9216
    buffer_load_dwordx4 v209, s[16:19], s41 offen lds
    s_mov_b32 s28, s10
    s_and_b32 s29, s11, 0xffff
    s_mov_b32 s30, 0x2d6a000
    s_mov_b32 s31, 0x20000
    s_and_b32 s33, s32, 3
    s_lshr_b32 s34, s32, 2
    s_lshl_b32 s38, s36, 2
    s_add_u32 s43, s38, s35
    s_lshl_b32 s43, s43, 2
    s_add_u32 s43, s43, s37
    s_add_u32 s38, s38, s33
    s_lshr_b32 s14, s43, 2
    s_lshl_b32 s14, s14, 5
    s_add_u32 s14, s14, s37
    s_lshl_b32 s14, s14, 2
    s_add_u32 s14, s14, 0x2d60000
    s_cmp_eq_u32 s32, 0
    s_cselect_b32 s40, s14, 0x40000000
    v_mov_b32 v243, 0
    s_mov_b64 exec, 1
    buffer_store_dword v243, off, s[28:31], s40 sc1
    s_mov_b64 exec, -1
    s_lshl_b32 s40, s36, 2
    s_add_u32 s40, s40, s37
    s_lshl_b32 s40, s40, 2
    s_add_u32 s40, s40, s33
    s_lshl_b32 s40, s40, 5
    s_add_u32 s40, s40, s35
    s_lshl_b32 s40, s40, 2
    s_add_u32 s40, s40, 0x2d62000
    s_lshl_b32 s41, s33, 4
    s_add_u32 s41, s41, s14
    s_add_u32 s41, s41, 64
    s_cmp_eq_u32 s34, 1
    s_cselect_b32 s40, s40, s41
    s_mov_b64 exec, 1
    buffer_store_dword v243, off, s[28:31], s40 sc1
    s_mov_b64 exec, -1
    s_cmp_eq_u32 s37, 3
    s_cbranch_scc1 p1_qkv
    s_mov_b32 s20, s88
    s_and_b32 s21, s89, 0xffff
    s_mov_b32 s22, 0x510000
    s_mov_b32 s23, 0x20000
    s_mul_i32 s51, s35, 3
    s_add_u32 s51, s51, s37
    s_mul_i32 s50, s51, 768
    s_add_u32 s46, s46, s50
    s_mov_b32 s24, s90
    s_and_b32 s25, s91, 0xffff
    s_mov_b32 s26, 0x2400
    s_mov_b32 s27, 0x20000
    s_add_u32 m0, s47, 8192
    s_add_u32 s40, s46, 0
    buffer_load_dwordx4 v240, s[20:23], s40 offen lds
    v_lshlrev_b32 v243, 1, v0
    buffer_load_ushort v244, v243, s[24:27], s50 offen
    s_mov_b32 s24, s12
    s_and_b32 s25, s13, 0xffff
    s_mov_b32 s26, 0x480
    s_mov_b32 s27, 0x20000
    s_mov_b32 s4, s8
    s_and_b32 s5, s9, 0xffff
    s_mov_b32 s6, 0x100
    s_mov_b32 s7, 0x20000
    s_lshl_b32 s40, s32, 8
    s_add_u32 s40, s40, 161792
    s_cmp_lt_u32 s32, 5
    s_cselect_b32 m0, s40, 163840
    v_lshlrev_b32 v242, 2, v0
    buffer_load_dword v242, s[24:27], 0 offen lds
    s_mul_i32 s54, s36, 331776
    s_add_u32 s54, s54, s50
    v_min_u32 v248, 35, v246
    v_mul_u32_u24 v248, 9216, v248
    s_lshl_b32 s40, s43, 3
    s_add_u32 s40, s40, s32
    s_mul_i32 s40, s40, 1152
    v_min_u32 v251, 8, v246
    v_lshlrev_b32 v251, 7, v251
    buffer_load_dword v247, v251, s[16:19], s40 offen
    s_lshl_b32 s40, s32, 7
    s_add_u32 s40, s40, s54
    s_cmp_lt_u32 s32, 6
    s_cselect_b32 s40, s40, 0x40000000
    buffer_load_dword v247, v248, s[20:23], s40 offen offset:0
    s_add_u32 m0, s45, 106496
    s_add_u32 s41, s44, 128
    buffer_load_dwordx4 v208, s[16:19], s41 offen lds
    s_add_u32 m0, s45, 107520
    s_add_u32 s41, s44, 9344
    buffer_load_dwordx4 v209, s[16:19], s41 offen lds
    s_add_u32 m0, s47, 16384
    s_add_u32 s40, s46, 589824
    buffer_load_dwordx4 v240, s[20:23], s40 offen lds
    s_add_u32 m0, s45, 122880
    s_add_u32 s41, s44, 256
    buffer_load_dwordx4 v208, s[16:19], s41 offen lds
    s_add_u32 m0, s45, 123904
    s_add_u32 s41, s44, 9472
    buffer_load_dwordx4 v209, s[16:19], s41 offen lds
    s_add_u32 m0, s47, 24576
    s_add_u32 s40, s46, 1179648
    buffer_load_dwordx4 v240, s[20:23], s40 offen lds
    s_lshl_b32 s40, s34, 1
    s_xor_b32 s40, s40, s33
    s_lshr_b32 s41, s40, 1
    s_and_b32 s40, s40, 1
    v_lshlrev_b32 v229, 6, v228
    v_lshl_add_u32 v229, v231, 3, v229
    v_lshl_add_u32 v229, v230, 5, v229
    v_lshl_add_u32 v229, v241, 11, v229
    s_lshl_b32 s42, s34, 8
    s_lshl_b32 s12, s41, 12
    s_add_u32 s42, s42, s12
    s_lshl_b32 s12, s40, 10
    s_add_u32 s42, s42, s12
    v_add_u32 v232, s42, v229
    v_xor_b32 v234, 1024, v232
    v_xor_b32 v236, 4096, v232
    v_xor_b32 v238, 5120, v232
    v_add_u32 v233, 0x10000, v232
    v_add_u32 v235, 0x10000, v234
    v_add_u32 v237, 0x10000, v236
    v_add_u32 v239, 0x10000, v238
    s_lshl_b32 s41, s41, 6
    s_lshl_b32 s40, s40, 4
    s_add_u32 s40, s40, s41
    v_and_b32 v228, 31, v246
    v_bfe_u32 v229, v228, 1, 3
    v_lshlrev_b32 v230, 1, v241
    v_xor_b32 v229, v229, v230
    v_lshlrev_b32 v229, 4, v229
    v_lshl_add_u32 v229, v228, 7, v229
    v_xor_b32 v229, s40, v229
    s_lshl_b32 s41, s33, 12
    s_add_u32 s41, s41, 90112
    v_add_u32 v204, s41, v229
    v_xor_b32 v205, 16, v204
    v_xor_b32 v206, 64, v204
    v_xor_b32 v207, 80, v204
    s_add_u32 s40, s40, 161792
    v_lshl_add_u32 v210, v241, 5, s40
    v_xor_b32 v211, 16, v210
    v_lshlrev_b32 v242, 4, v246
    s_mov_b32 s52, 0x3f803f80
    v_mov_b32 v216, 0
    v_mov_b32 v217, 0
    v_mov_b32 v218, 0
    v_mov_b32 v230, 0
    v_mov_b32 v231, 0
    v_mov_b32 v229, 163328
    ds_write_b64 v229, v[230:231]
    ds_write_b64 v229, v[230:231] offset:8
    ds_write_b64 v229, v[230:231] offset:16
    s_and_b32 s40, s36, 7
    s_mul_i32 s40, s40, 72
    s_add_u32 s40, s40, s32
    v_min_u32 v251, 8, v246
    v_add_u32 v251, s40, v251
    v_mul_u32_u24 v251, 9216, v251
    s_getpc_b64 s[100:101]
here_1:
    s_sub_u32 s100, s100, here_1-mk_kernel
    s_subb_u32 s101, s101, 0
    s_mul_i32 s40, s39, 3072
    s_mul_i32 s41, s32, 384
    s_add_u32 s40, s40, s41
    v_min_u32 v252, 2, v246
    v_lshl_add_u32 v252, v252, 7, s40
    s_mov_b32 s40, all_code_end-mk_kernel-4
    v_min_u32 v252, s40, v252
    global_load_dword v247, v252, s[100:101]
    s_mul_i32 s48, s38, 288
    s_mul_i32 s40, s51, 24
    s_add_u32 s48, s48, s40
    s_lshl_b32 s40, s34, 1
    s_add_u32 s48, s48, s40
    s_lshl_b32 s48, s48, 10
    v_and_b32 v228, 31, v246
    s_lshl_b32 s41, s34, 10
    s_add_u32 s41, s41, 155648
    v_lshl_add_u32 v249, v228, 5, s41
    v_lshl_add_u32 v241, v241, 4, v249
    s_lshl_b32 s41, s33, 3
    v_add_u32 v249, s41, v249
    s_lshl_b32 s41, s34, 7
    s_add_u32 s41, s41, 159744
    v_lshl_add_u32 v250, v228, 2, s41
    s_cmp_lt_u32 s33, 2
    s_cselect_b32 s53, -1, 0
    v_and_b32 v228, 23, v246
    v_cmp_eq_u32 vcc, 0, v228
    v_cmp_eq_u32 s[12:13], 20, v228
    s_nop 3
    s_or_b64 vcc, vcc, s[12:13]
    v_mov_b32 v228, s52
    v_cndmask_b32_e64 v224, 0, v228, vcc
    v_cndmask_b32_e64 v225, 0, v228, vcc
    v_cndmask_b32_e64 v226, 0, v228, vcc
    v_cndmask_b32_e64 v227, 0, v228, vcc
    v_lshlrev_b32 v230, 2, v0
    v_add_u32 v230, 159744, v230
    s_waitcnt vmcnt(10)
    v_lshlrev_b32 v244, 16, v244
    ds_write_b32 v230, v244
    s_waitcnt vmcnt(9) lgkmcnt(0)
    s_barrier
    ds_read_b128 v[4:7], v204 offset:0
    ds_read_b128 v[8:11], v205 offset:0
    ds_read_b128 v[12:15], v206 offset:0
    ds_read_b128 v[16:19], v207 offset:0
    ds_read_b64_tr_b16 v[180:181], v232 offset:8192
    ds_read_b64_tr_b16 v[182:183], v232 offset:8704
    ds_read_b64_tr_b16 v[184:185], v234 offset:8192
    ds_read_b64_tr_b16 v[186:187], v234 offset:8704
    ds_read_b64_tr_b16 v[188:189], v236 offset:8192
    ds_read_b64_tr_b16 v[190:191], v236 offset:8704
    ds_read_b64_tr_b16 v[192:193], v238 offset:8192
    ds_read_b64_tr_b16 v[194:195], v238 offset:8704
    ds_read_b128 v[164:167], v210 offset:0
    ds_read_b128 v[168:171], v211 offset:0
    s_add_u32 m0, s45, 139264
    s_add_u32 s41, s44, 384
    buffer_load_dwordx4 v208, s[16:19], s41 offen lds
    s_add_u32 m0, s45, 140288
    s_add_u32 s41, s44, 9600
    buffer_load_dwordx4 v209, s[16:19], s41 offen lds
    s_add_u32 m0, s47, 32768
    s_add_u32 s40, s46, 1769472
    buffer_load_dwordx4 v240, s[20:23], s40 offen lds
    s_waitcnt vmcnt(7) lgkmcnt(0)
    s_barrier
    ds_read_b128 v[20:23], v204 offset:16384
    ds_read_b128 v[24:27], v205 offset:16384
    ds_read_b128 v[28:31], v206 offset:16384
    ds_read_b128 v[32:35], v207 offset:16384
    ds_read_b64_tr_b16 v[196:197], v232 offset:16384
    ds_read_b64_tr_b16 v[198:199], v232 offset:16896
    ds_read_b64_tr_b16 v[200:201], v234 offset:16384
    ds_read_b64_tr_b16 v[202:203], v234 offset:16896
    ds_read_b64_tr_b16 v[212:213], v236 offset:16384
    ds_read_b64_tr_b16 v[214:215], v236 offset:16896
    ds_read_b64_tr_b16 v[228:229], v238 offset:16384
    ds_read_b64_tr_b16 v[230:231], v238 offset:16896
    ds_read_b128 v[172:175], v210 offset:128
    ds_read_b128 v[176:179], v211 offset:128
    v_mfma_f32_16x16x32_bf16 v[220:223], v[224:227], v[180:183], 0
    s_add_u32 m0, s45, 90112
    v_mfma_f32_32x32x16_bf16 v[148:163], v[180:183], v[4:7], 0
    s_add_u32 s41, s44, 512
    buffer_load_dwordx4 v208, s[16:19], s41 offen lds
    s_add_u32 m0, s45, 91136
    v_mfma_f32_32x32x16_bf16 v[148:163], v[184:187], v[8:11], v[148:163]
    s_add_u32 s41, s44, 9728
    buffer_load_dwordx4 v209, s[16:19], s41 offen lds
    s_add_u32 m0, s47, 40960
    v_mfma_f32_32x32x16_bf16 v[148:163], v[188:191], v[12:15], v[148:163]
    s_add_u32 s40, s46, 2359296
    buffer_load_dwordx4 v240, s[20:23], s40 offen lds
    v_mfma_f32_32x32x16_bf16 v[148:163], v[192:195], v[16:19], v[148:163]
    v_dot2_f32_bf16 v216, v4, s52, v216
    v_dot2_f32_bf16 v217, v4, v4, v217
    v_dot2_f32_bf16 v218, v4, v164, v218
    v_dot2_f32_bf16 v216, v5, s52, v216
    v_dot2_f32_bf16 v217, v5, v5, v217
    v_dot2_f32_bf16 v218, v5, v165, v218
    v_dot2_f32_bf16 v216, v6, s52, v216
    v_dot2_f32_bf16 v217, v6, v6, v217
    v_dot2_f32_bf16 v218, v6, v166, v218
    v_dot2_f32_bf16 v216, v7, s52, v216
    v_dot2_f32_bf16 v217, v7, v7, v217
    v_dot2_f32_bf16 v218, v7, v167, v218
    v_dot2_f32_bf16 v216, v8, s52, v216
    v_dot2_f32_bf16 v217, v8, v8, v217
    v_dot2_f32_bf16 v218, v8, v168, v218
    v_dot2_f32_bf16 v216, v9, s52, v216
    v_dot2_f32_bf16 v217, v9, v9, v217
    v_dot2_f32_bf16 v218, v9, v169, v218
    v_dot2_f32_bf16 v216, v10, s52, v216
    v_dot2_f32_bf16 v217, v10, v10, v217
    v_dot2_f32_bf16 v218, v10, v170, v218
    v_dot2_f32_bf16 v216, v11, s52, v216
    v_dot2_f32_bf16 v217, v11, v11, v217
    v_dot2_f32_bf16 v218, v11, v171, v218
    s_waitcnt vmcnt(7) lgkmcnt(0)
    s_barrier
    ds_read_b128 v[36:39], v204 offset:32768
    ds_read_b128 v[40:43], v205 offset:32768
    ds_read_b128 v[44:47], v206 offset:32768
    ds_read_b128 v[48:51], v207 offset:32768
    ds_read_b64_tr_b16 v[180:181], v232 offset:24576
    ds_read_b64_tr_b16 v[182:183], v232 offset:25088
    ds_read_b64_tr_b16 v[184:185], v234 offset:24576
    ds_read_b64_tr_b16 v[186:187], v234 offset:25088
    ds_read_b64_tr_b16 v[188:189], v236 offset:24576
    ds_read_b64_tr_b16 v[190:191], v236 offset:25088
    ds_read_b64_tr_b16 v[192:193], v238 offset:24576
    ds_read_b64_tr_b16 v[194:195], v238 offset:25088
    ds_read_b128 v[164:167], v210 offset:256
    ds_read_b128 v[168:171], v211 offset:256
    v_mfma_f32_16x16x32_bf16 v[220:223], v[224:227], v[196:199], v[220:223]
    s_add_u32 m0, s45, 106496
    v_mfma_f32_32x32x16_bf16 v[148:163], v[196:199], v[20:23], v[148:163]
    s_add_u32 s41, s44, 640
    buffer_load_dwordx4 v208, s[16:19], s41 offen lds
    s_add_u32 m0, s45, 107520
    v_mfma_f32_32x32x16_bf16 v[148:163], v[200:203], v[24:27], v[148:163]
    s_add_u32 s41, s44, 9856
    buffer_load_dwordx4 v209, s[16:19], s41 offen lds
    s_add_u32 m0, s47, 49152
    v_mfma_f32_32x32x16_bf16 v[148:163], v[212:215], v[28:31], v[148:163]
    s_add_u32 s40, s46, 2949120
    buffer_load_dwordx4 v240, s[20:23], s40 offen lds
    v_mfma_f32_32x32x16_bf16 v[148:163], v[228:231], v[32:35], v[148:163]
    v_dot2_f32_bf16 v216, v20, s52, v216
    v_dot2_f32_bf16 v217, v20, v20, v217
    v_dot2_f32_bf16 v218, v20, v172, v218
    v_dot2_f32_bf16 v216, v21, s52, v216
    v_dot2_f32_bf16 v217, v21, v21, v217
    v_dot2_f32_bf16 v218, v21, v173, v218
    v_dot2_f32_bf16 v216, v22, s52, v216
    v_dot2_f32_bf16 v217, v22, v22, v217
    v_dot2_f32_bf16 v218, v22, v174, v218
    v_dot2_f32_bf16 v216, v23, s52, v216
    v_dot2_f32_bf16 v217, v23, v23, v217
    v_dot2_f32_bf16 v218, v23, v175, v218
    v_dot2_f32_bf16 v216, v24, s52, v216
    v_dot2_f32_bf16 v217, v24, v24, v217
    v_dot2_f32_bf16 v218, v24, v176, v218
    v_dot2_f32_bf16 v216, v25, s52, v216
    v_dot2_f32_bf16 v217, v25, v25, v217
    v_dot2_f32_bf16 v218, v25, v177, v218
    v_dot2_f32_bf16 v216, v26, s52, v216
    v_dot2_f32_bf16 v217, v26, v26, v217
    v_dot2_f32_bf16 v218, v26, v178, v218
    v_dot2_f32_bf16 v216, v27, s52, v216
    v_dot2_f32_bf16 v217, v27, v27, v217
    v_dot2_f32_bf16 v218, v27, v179, v218
    s_waitcnt vmcnt(6) lgkmcnt(0)
    s_barrier
    ds_read_b128 v[52:55], v204 offset:49152
    ds_read_b128 v[56:59], v205 offset:49152
    ds_read_b128 v[60:63], v206 offset:49152
    ds_read_b128 v[64:67], v207 offset:49152
    ds_read_b64_tr_b16 v[196:197], v232 offset:32768
    ds_read_b64_tr_b16 v[198:199], v232 offset:33280
    ds_read_b64_tr_b16 v[200:201], v234 offset:32768
    ds_read_b64_tr_b16 v[202:203], v234 offset:33280
    ds_read_b64_tr_b16 v[212:213], v236 offset:32768
    ds_read_b64_tr_b16 v[214:215], v236 offset:33280
    ds_read_b64_tr_b16 v[228:229], v238 offset:32768
    ds_read_b64_tr_b16 v[230:231], v238 offset:33280
    ds_read_b128 v[172:175], v210 offset:384
    ds_read_b128 v[176:179], v211 offset:384
    v_mfma_f32_16x16x32_bf16 v[220:223], v[224:227], v[180:183], v[220:223]
    s_add_u32 m0, s45, 122880
    v_mfma_f32_32x32x16_bf16 v[148:163], v[180:183], v[36:39], v[148:163]
    s_add_u32 s41, s44, 768
    buffer_load_dwordx4 v208, s[16:19], s41 offen lds
    s_add_u32 m0, s45, 123904
    v_mfma_f32_32x32x16_bf16 v[148:163], v[184:187], v[40:43], v[148:163]
    s_add_u32 s41, s44, 9984
    buffer_load_dwordx4 v209, s[16:19], s41 offen lds
    s_add_u32 m0, s47, 57344
    v_mfma_f32_32x32x16_bf16 v[148:163], v[188:191], v[44:47], v[148:163]
    s_add_u32 s40, s46, 3538944
    buffer_load_dwordx4 v240, s[20:23], s40 offen lds
    v_mfma_f32_32x32x16_bf16 v[148:163], v[192:195], v[48:51], v[148:163]
    v_dot2_f32_bf16 v216, v36, s52, v216
    v_dot2_f32_bf16 v217, v36, v36, v217
    v_dot2_f32_bf16 v218, v36, v164, v218
    v_dot2_f32_bf16 v216, v37, s52, v216
    v_dot2_f32_bf16 v217, v37, v37, v217
    v_dot2_f32_bf16 v218, v37, v165, v218
    v_dot2_f32_bf16 v216, v38, s52, v216
    v_dot2_f32_bf16 v217, v38, v38, v217
    v_dot2_f32_bf16 v218, v38, v166, v218
    v_dot2_f32_bf16 v216, v39, s52, v216
    v_dot2_f32_bf16 v217, v39, v39, v217
    v_dot2_f32_bf16 v218, v39, v167, v218
    v_dot2_f32_bf16 v216, v40, s52, v216
    v_dot2_f32_bf16 v217, v40, v40, v217
    v_dot2_f32_bf16 v218, v40, v168, v218
    v_dot2_f32_bf16 v216, v41, s52, v216
    v_dot2_f32_bf16 v217, v41, v41, v217
    v_dot2_f32_bf16 v218, v41, v169, v218
    v_dot2_f32_bf16 v216, v42, s52, v216
    v_dot2_f32_bf16 v217, v42, v42, v217
    v_dot2_f32_bf16 v218, v42, v170, v218
    v_dot2_f32_bf16 v216, v43, s52, v216
    v_dot2_f32_bf16 v217, v43, v43, v217
    v_dot2_f32_bf16 v218, v43, v171, v218
    s_waitcnt vmcnt(6) lgkmcnt(0)
    s_barrier
    ds_read_b128 v[68:71], v204 offset:0
    ds_read_b128 v[72:75], v205 offset:0
    ds_read_b128 v[76:79], v206 offset:0
    ds_read_b128 v[80:83], v207 offset:0
    ds_read_b64_tr_b16 v[180:181], v232 offset:40960
    ds_read_b64_tr_b16 v[182:183], v232 offset:41472
    ds_read_b64_tr_b16 v[184:185], v234 offset:40960
    ds_read_b64_tr_b16 v[186:187], v234 offset:41472
    ds_read_b64_tr_b16 v[188:189], v236 offset:40960
    ds_read_b64_tr_b16 v[190:191], v236 offset:41472
    ds_read_b64_tr_b16 v[192:193], v238 offset:40960
    ds_read_b64_tr_b16 v[194:195], v238 offset:41472
    ds_read_b128 v[164:167], v210 offset:512
    ds_read_b128 v[168:171], v211 offset:512
    v_mfma_f32_16x16x32_bf16 v[220:223], v[224:227], v[196:199], v[220:223]
    s_add_u32 m0, s45, 139264
    v_mfma_f32_32x32x16_bf16 v[148:163], v[196:199], v[52:55], v[148:163]
    s_add_u32 s41, s44, 896
    buffer_load_dwordx4 v208, s[16:19], s41 offen lds
    s_add_u32 m0, s45, 140288
    v_mfma_f32_32x32x16_bf16 v[148:163], v[200:203], v[56:59], v[148:163]
    s_add_u32 s41, s44, 10112
    buffer_load_dwordx4 v209, s[16:19], s41 offen lds
    s_add_u32 m0, s47, 65536
    v_mfma_f32_32x32x16_bf16 v[148:163], v[212:215], v[60:63], v[148:163]
    s_add_u32 s40, s46, 4128768
    buffer_load_dwordx4 v240, s[20:23], s40 offen lds
    v_mfma_f32_32x32x16_bf16 v[148:163], v[228:231], v[64:67], v[148:163]
    v_dot2_f32_bf16 v216, v52, s52, v216
    v_dot2_f32_bf16 v217, v52, v52, v217
    v_dot2_f32_bf16 v218, v52, v172, v218
    v_dot2_f32_bf16 v216, v53, s52, v216
    v_dot2_f32_bf16 v217, v53, v53, v217
    v_dot2_f32_bf16 v218, v53, v173, v218
    v_dot2_f32_bf16 v216, v54, s52, v216
    v_dot2_f32_bf16 v217, v54, v54, v217
    v_dot2_f32_bf16 v218, v54, v174, v218
    v_dot2_f32_bf16 v216, v55, s52, v216
    v_dot2_f32_bf16 v217, v55, v55, v217
    v_dot2_f32_bf16 v218, v55, v175, v218
    v_dot2_f32_bf16 v216, v56, s52, v216
    v_dot2_f32_bf16 v217, v56, v56, v217
    v_dot2_f32_bf16 v218, v56, v176, v218
    v_dot2_f32_bf16 v216, v57, s52, v216
    v_dot2_f32_bf16 v217, v57, v57, v217
    v_dot2_f32_bf16 v218, v57, v177, v218
    v_dot2_f32_bf16 v216, v58, s52, v216
    v_dot2_f32_bf16 v217, v58, v58, v217
    v_dot2_f32_bf16 v218, v58, v178, v218
    v_dot2_f32_bf16 v216, v59, s52, v216
    v_dot2_f32_bf16 v217, v59, v59, v217
    v_dot2_f32_bf16 v218, v59, v179, v218
    s_waitcnt vmcnt(6) lgkmcnt(0)
    s_barrier
    ds_read_b128 v[84:87], v204 offset:16384
    ds_read_b128 v[88:91], v205 offset:16384
    ds_read_b128 v[92:95], v206 offset:16384
    ds_read_b128 v[96:99], v207 offset:16384
    ds_read_b64_tr_b16 v[196:197], v232 offset:49152
    ds_read_b64_tr_b16 v[198:199], v232 offset:49664
    ds_read_b64_tr_b16 v[200:201], v234 offset:49152
    ds_read_b64_tr_b16 v[202:203], v234 offset:49664
    ds_read_b64_tr_b16 v[212:213], v236 offset:49152
    ds_read_b64_tr_b16 v[214:215], v236 offset:49664
    ds_read_b64_tr_b16 v[228:229], v238 offset:49152
    ds_read_b64_tr_b16 v[230:231], v238 offset:49664
    ds_read_b128 v[172:175], v210 offset:640
    ds_read_b128 v[176:179], v211 offset:640
    v_mfma_f32_16x16x32_bf16 v[220:223], v[224:227], v[180:183], v[220:223]
    s_add_u32 m0, s45, 90112
    v_mfma_f32_32x32x16_bf16 v[148:163], v[180:183], v[68:71], v[148:163]
    s_add_u32 s41, s44, 1024
    buffer_load_dwordx4 v208, s[16:19], s41 offen lds
    s_add_u32 m0, s45, 91136
    v_mfma_f32_32x32x16_bf16 v[148:163], v[184:187], v[72:75], v[148:163]
    s_add_u32 s41, s44, 10240
    buffer_load_dwordx4 v209, s[16:19], s41 offen lds
    s_add_u32 m0, s47, 73728
    v_mfma_f32_32x32x16_bf16 v[148:163], v[188:191], v[76:79], v[148:163]
    s_add_u32 s40, s46, 4718592
    buffer_load_dwordx4 v240, s[20:23], s40 offen lds
    v_mfma_f32_32x32x16_bf16 v[148:163], v[192:195], v[80:83], v[148:163]
    v_dot2_f32_bf16 v216, v68, s52, v216
    v_dot2_f32_bf16 v217, v68, v68, v217
    v_dot2_f32_bf16 v218, v68, v164, v218
    v_dot2_f32_bf16 v216, v69, s52, v216
    v_dot2_f32_bf16 v217, v69, v69, v217
    v_dot2_f32_bf16 v218, v69, v165, v218
    v_dot2_f32_bf16 v216, v70, s52, v216
    v_dot2_f32_bf16 v217, v70, v70, v217
    v_dot2_f32_bf16 v218, v70, v166, v218
    v_dot2_f32_bf16 v216, v71, s52, v216
    v_dot2_f32_bf16 v217, v71, v71, v217
    v_dot2_f32_bf16 v218, v71, v167, v218
    v_dot2_f32_bf16 v216, v72, s52, v216
    v_dot2_f32_bf16 v217, v72, v72, v217
    v_dot2_f32_bf16 v218, v72, v168, v218
    v_dot2_f32_bf16 v216, v73, s52, v216
    v_dot2_f32_bf16 v217, v73, v73, v217
    v_dot2_f32_bf16 v218, v73, v169, v218
    v_dot2_f32_bf16 v216, v74, s52, v216
    v_dot2_f32_bf16 v217, v74, v74, v217
    v_dot2_f32_bf16 v218, v74, v170, v218
    v_dot2_f32_bf16 v216, v75, s52, v216
    v_dot2_f32_bf16 v217, v75, v75, v217
    v_dot2_f32_bf16 v218, v75, v171, v218
    s_waitcnt vmcnt(6) lgkmcnt(0)
    s_barrier
    ds_read_b128 v[100:103], v204 offset:32768
    ds_read_b128 v[104:107], v205 offset:32768
    ds_read_b128 v[108:111], v206 offset:32768
    ds_read_b128 v[112:115], v207 offset:32768
    ds_read_b64_tr_b16 v[180:181], v232 offset:57344
    ds_read_b64_tr_b16 v[182:183], v232 offset:57856
    ds_read_b64_tr_b16 v[184:185], v234 offset:57344
    ds_read_b64_tr_b16 v[186:187], v234 offset:57856
    ds_read_b64_tr_b16 v[188:189], v236 offset:57344
    ds_read_b64_tr_b16 v[190:191], v236 offset:57856
    ds_read_b64_tr_b16 v[192:193], v238 offset:57344
    ds_read_b64_tr_b16 v[194:195], v238 offset:57856
    ds_read_b128 v[164:167], v210 offset:768
    ds_read_b128 v[168:171], v211 offset:768
    v_mfma_f32_16x16x32_bf16 v[220:223], v[224:227], v[196:199], v[220:223]
    s_add_u32 m0, s47, 0
    v_mfma_f32_32x32x16_bf16 v[148:163], v[196:199], v[84:87], v[148:163]
    s_add_u32 s40, s46, 128
    buffer_load_dwordx4 v240, s[20:23], s40 offen lds
    s_add_u32 m0, s47, 81920
    v_mfma_f32_32x32x16_bf16 v[148:163], v[200:203], v[88:91], v[148:163]
    s_add_u32 s40, s46, 589952
    buffer_load_dwordx4 v240, s[20:23], s40 offen lds
    s_add_u32 m0, s47, 8192
    v_mfma_f32_32x32x16_bf16 v[148:163], v[212:215], v[92:95], v[148:163]
    s_add_u32 s40, s46, 1179776
    buffer_load_dwordx4 v240, s[20:23], s40 offen lds
    v_mfma_f32_32x32x16_bf16 v[148:163], v[228:231], v[96:99], v[148:163]
    v_dot2_f32_bf16 v216, v84, s52, v216
    v_dot2_f32_bf16 v217, v84, v84, v217
    v_dot2_f32_bf16 v218, v84, v172, v218
    v_dot2_f32_bf16 v216, v85, s52, v216
    v_dot2_f32_bf16 v217, v85, v85, v217
    v_dot2_f32_bf16 v218, v85, v173, v218
    v_dot2_f32_bf16 v216, v86, s52, v216
    v_dot2_f32_bf16 v217, v86, v86, v217
    v_dot2_f32_bf16 v218, v86, v174, v218
    v_dot2_f32_bf16 v216, v87, s52, v216
    v_dot2_f32_bf16 v217, v87, v87, v217
    v_dot2_f32_bf16 v218, v87, v175, v218
    v_dot2_f32_bf16 v216, v88, s52, v216
    v_dot2_f32_bf16 v217, v88, v88, v217
    v_dot2_f32_bf16 v218, v88, v176, v218
    v_dot2_f32_bf16 v216, v89, s52, v216
    v_dot2_f32_bf16 v217, v89, v89, v217
    v_dot2_f32_bf16 v218, v89, v177, v218
    v_dot2_f32_bf16 v216, v90, s52, v216
    v_dot2_f32_bf16 v217, v90, v90, v217
    v_dot2_f32_bf16 v218, v90, v178, v218
    v_dot2_f32_bf16 v216, v91, s52, v216
    v_dot2_f32_bf16 v217, v91, v91, v217
    v_dot2_f32_bf16 v218, v91, v179, v218
    s_waitcnt vmcnt(6) lgkmcnt(0)
    s_barrier
    ds_read_b128 v[116:119], v204 offset:49152
    ds_read_b128 v[120:123], v205 offset:49152
    ds_read_b128 v[124:127], v206 offset:49152
    ds_read_b128 v[128:131], v207 offset:49152
    ds_read_b64_tr_b16 v[196:197], v233 offset:0
    ds_read_b64_tr_b16 v[198:199], v233 offset:512
    ds_read_b64_tr_b16 v[200:201], v235 offset:0
    ds_read_b64_tr_b16 v[202:203], v235 offset:512
    ds_read_b64_tr_b16 v[212:213], v237 offset:0
    ds_read_b64_tr_b16 v[214:215], v237 offset:512
    ds_read_b64_tr_b16 v[228:229], v239 offset:0
    ds_read_b64_tr_b16 v[230:231], v239 offset:512
    ds_read_b128 v[172:175], v210 offset:896
    ds_read_b128 v[176:179], v211 offset:896
    v_mfma_f32_16x16x32_bf16 v[220:223], v[224:227], v[180:183], v[220:223]
    s_add_u32 m0, s47, 16384
    v_mfma_f32_32x32x16_bf16 v[148:163], v[180:183], v[100:103], v[148:163]
    s_add_u32 s40, s46, 1769600
    buffer_load_dwordx4 v240, s[20:23], s40 offen lds
    s_add_u32 m0, s47, 24576
    v_mfma_f32_32x32x16_bf16 v[148:163], v[184:187], v[104:107], v[148:163]
    s_add_u32 s40, s46, 2359424
    buffer_load_dwordx4 v240, s[20:23], s40 offen lds
    s_add_u32 m0, s47, 32768
    v_mfma_f32_32x32x16_bf16 v[148:163], v[188:191], v[108:111], v[148:163]
    s_add_u32 s40, s46, 2949248
    buffer_load_dwordx4 v240, s[20:23], s40 offen lds
    v_mfma_f32_32x32x16_bf16 v[148:163], v[192:195], v[112:115], v[148:163]
    v_dot2_f32_bf16 v216, v100, s52, v216
    v_dot2_f32_bf16 v217, v100, v100, v217
    v_dot2_f32_bf16 v218, v100, v164, v218
    v_dot2_f32_bf16 v216, v101, s52, v216
    v_dot2_f32_bf16 v217, v101, v101, v217
    v_dot2_f32_bf16 v218, v101, v165, v218
    v_dot2_f32_bf16 v216, v102, s52, v216
    v_dot2_f32_bf16 v217, v102, v102, v217
    v_dot2_f32_bf16 v218, v102, v166, v218
    v_dot2_f32_bf16 v216, v103, s52, v216
    v_dot2_f32_bf16 v217, v103, v103, v217
    v_dot2_f32_bf16 v218, v103, v167, v218
    v_dot2_f32_bf16 v216, v104, s52, v216
    v_dot2_f32_bf16 v217, v104, v104, v217
    v_dot2_f32_bf16 v218, v104, v168, v218
    v_dot2_f32_bf16 v216, v105, s52, v216
    v_dot2_f32_bf16 v217, v105, v105, v217
    v_dot2_f32_bf16 v218, v105, v169, v218
    v_dot2_f32_bf16 v216, v106, s52, v216
    v_dot2_f32_bf16 v217, v106, v106, v217
    v_dot2_f32_bf16 v218, v106, v170, v218
    v_dot2_f32_bf16 v216, v107, s52, v216
    v_dot2_f32_bf16 v217, v107, v107, v217
    v_dot2_f32_bf16 v218, v107, v171, v218
    s_waitcnt vmcnt(6) lgkmcnt(0)
    s_barrier
    ds_read_b128 v[132:135], v204 offset:0
    ds_read_b128 v[136:139], v205 offset:0
    ds_read_b128 v[140:143], v206 offset:0
    ds_read_b128 v[144:147], v207 offset:0
    ds_read_b64_tr_b16 v[180:181], v233 offset:8192
    ds_read_b64_tr_b16 v[182:183], v233 offset:8704
    ds_read_b64_tr_b16 v[184:185], v235 offset:8192
    ds_read_b64_tr_b16 v[186:187], v235 offset:8704
    ds_read_b64_tr_b16 v[188:189], v237 offset:8192
    ds_read_b64_tr_b16 v[190:191], v237 offset:8704
    ds_read_b64_tr_b16 v[192:193], v239 offset:8192
    ds_read_b64_tr_b16 v[194:195], v239 offset:8704
    ds_read_b128 v[164:167], v210 offset:1024
    ds_read_b128 v[168:171], v211 offset:1024
    v_mfma_f32_16x16x32_bf16 v[220:223], v[224:227], v[196:199], v[220:223]
    s_add_u32 m0, s47, 40960
    v_mfma_f32_32x32x16_bf16 v[148:163], v[196:199], v[116:119], v[148:163]
    s_add_u32 s40, s46, 3539072
    buffer_load_dwordx4 v240, s[20:23], s40 offen lds
    s_add_u32 m0, s47, 49152
    v_mfma_f32_32x32x16_bf16 v[148:163], v[200:203], v[120:123], v[148:163]
    s_add_u32 s40, s46, 4128896
    buffer_load_dwordx4 v240, s[20:23], s40 offen lds
    s_add_u32 m0, s47, 57344
    v_mfma_f32_32x32x16_bf16 v[148:163], v[212:215], v[124:127], v[148:163]
    s_add_u32 s40, s46, 4718720
    buffer_load_dwordx4 v240, s[20:23], s40 offen lds
    v_mfma_f32_32x32x16_bf16 v[148:163], v[228:231], v[128:131], v[148:163]
    buffer_load_dword v247, v251, s[20:23], s46 offen offset:256
    v_dot2_f32_bf16 v216, v116, s52, v216
    v_dot2_f32_bf16 v217, v116, v116, v217
    v_dot2_f32_bf16 v218, v116, v172, v218
    v_dot2_f32_bf16 v216, v117, s52, v216
    v_dot2_f32_bf16 v217, v117, v117, v217
    v_dot2_f32_bf16 v218, v117, v173, v218
    v_dot2_f32_bf16 v216, v118, s52, v216
    v_dot2_f32_bf16 v217, v118, v118, v217
    v_dot2_f32_bf16 v218, v118, v174, v218
    v_dot2_f32_bf16 v216, v119, s52, v216
    v_dot2_f32_bf16 v217, v119, v119, v217
    v_dot2_f32_bf16 v218, v119, v175, v218
    v_dot2_f32_bf16 v216, v120, s52, v216
    v_dot2_f32_bf16 v217, v120, v120, v217
    v_dot2_f32_bf16 v218, v120, v176, v218
    v_dot2_f32_bf16 v216, v121, s52, v216
    v_dot2_f32_bf16 v217, v121, v121, v217
    v_dot2_f32_bf16 v218, v121, v177, v218
    v_dot2_f32_bf16 v216, v122, s52, v216
    v_dot2_f32_bf16 v217, v122, v122, v217
    v_dot2_f32_bf16 v218, v122, v178, v218
    v_dot2_f32_bf16 v216, v123, s52, v216
    v_dot2_f32_bf16 v217, v123, v123, v217
    v_dot2_f32_bf16 v218, v123, v179, v218
    s_waitcnt lgkmcnt(8)
    v_mfma_f32_16x16x32_bf16 v[220:223], v[224:227], v[180:183], v[220:223]
    v_mfma_f32_32x32x16_bf16 v[148:163], v[180:183], v[132:135], v[148:163]
    s_waitcnt lgkmcnt(6)
    v_mfma_f32_32x32x16_bf16 v[148:163], v[184:187], v[136:139], v[148:163]
    s_waitcnt lgkmcnt(4)
    v_mfma_f32_32x32x16_bf16 v[148:163], v[188:191], v[140:143], v[148:163]
    s_waitcnt lgkmcnt(2)
    v_mfma_f32_32x32x16_bf16 v[148:163], v[192:195], v[144:147], v[148:163]
    v_dot2_f32_bf16 v216, v132, s52, v216
    v_dot2_f32_bf16 v217, v132, v132, v217
    s_waitcnt lgkmcnt(1)
    v_dot2_f32_bf16 v218, v132, v164, v218
    v_dot2_f32_bf16 v216, v133, s52, v216
    v_dot2_f32_bf16 v217, v133, v133, v217
    v_dot2_f32_bf16 v218, v133, v165, v218
    v_dot2_f32_bf16 v216, v134, s52, v216
    v_dot2_f32_bf16 v217, v134, v134, v217
    v_dot2_f32_bf16 v218, v134, v166, v218
    v_dot2_f32_bf16 v216, v135, s52, v216
    v_dot2_f32_bf16 v217, v135, v135, v217
    v_dot2_f32_bf16 v218, v135, v167, v218
    v_dot2_f32_bf16 v216, v136, s52, v216
    v_dot2_f32_bf16 v217, v136, v136, v217
    s_waitcnt lgkmcnt(0)
    v_dot2_f32_bf16 v218, v136, v168, v218
    v_dot2_f32_bf16 v216, v137, s52, v216
    v_dot2_f32_bf16 v217, v137, v137, v217
    v_dot2_f32_bf16 v218, v137, v169, v218
    v_dot2_f32_bf16 v216, v138, s52, v216
    v_dot2_f32_bf16 v217, v138, v138, v217
    v_dot2_f32_bf16 v218, v138, v170, v218
    v_dot2_f32_bf16 v216, v139, s52, v216
    v_dot2_f32_bf16 v217, v139, v139, v217
    v_dot2_f32_bf16 v218, v139, v171, v218
    s_lshl_b32 s40, s32, 10
    s_add_u32 s40, s40, 147456
    v_add_u32 v243, s40, v242
    ds_write_b96 v243, v[216:218]
    v_xor_b32 v243, 4096, v243
    ds_read_b32 v231, v250 offset:0
    v_cvt_pk_bf16_f32 v228, v220, v220
    s_waitcnt lgkmcnt(0)
    v_and_b32 v231, s53, v231
    v_and_b32 v229, 0xffff0000, v228
    v_sub_f32 v229, v220, v229
    v_cvt_pk_bf16_f32 v229, v229, v231
    ds_write_b64 v249, v[228:229] offset:0
    s_waitcnt vmcnt(4) lgkmcnt(0)
    s_barrier
    s_cmp_lg_u32 s32, 0
    s_cbranch_scc1 ws_2
    s_mov_b64 exec, 1
    v_mov_b32 v228, 1
    buffer_store_byte v228, off, s[4:7], s43 sc1
    s_mov_b64 exec, -1
ws_2:
    ds_read_b64_tr_b16 v[180:181], v232 offset:0
    ds_read_b64_tr_b16 v[182:183], v232 offset:512
    ds_read_b64_tr_b16 v[184:185], v234 offset:0
    ds_read_b64_tr_b16 v[186:187], v234 offset:512
    ds_read_b64_tr_b16 v[188:189], v236 offset:0
    ds_read_b64_tr_b16 v[190:191], v236 offset:512
    ds_read_b64_tr_b16 v[192:193], v238 offset:0
    ds_read_b64_tr_b16 v[194:195], v238 offset:512
    ds_read_b64_tr_b16 v[196:197], v233 offset:16384
    ds_read_b64_tr_b16 v[198:199], v233 offset:16896
    ds_read_b64_tr_b16 v[200:201], v235 offset:16384
    ds_read_b64_tr_b16 v[202:203], v235 offset:16896
    s_waitcnt lgkmcnt(10)
    v_mfma_f32_16x16x32_bf16 v[220:223], v[224:227], v[180:183], 0
    ds_read_b128 v[212:215], v241 offset:0
    ds_read_b96 v[228:230], v243
    s_waitcnt lgkmcnt(0)
    v_add_f32 v216, v216, v228
    v_mfma_f32_32x32x16_bf16 v[164:179], v[180:183], v[4:7], 0
    v_add_f32 v217, v217, v229
    v_add_f32 v218, v218, v230
    v_mov_b32 v228, v216
    s_add_u32 m0, s47, 65536
    s_add_u32 s40, s46, 256
    buffer_load_dwordx4 v240, s[20:23], s40 offen lds
    v_mov_b32 v229, v217
    v_mov_b32 v230, v218
    ds_read_b64_tr_b16 v[180:181], v237 offset:16384
    ds_read_b64_tr_b16 v[182:183], v237 offset:16896
    v_mfma_f32_32x32x16_bf16 v[164:179], v[184:187], v[8:11], v[164:179]
    v_permlane32_swap_b32 v216, v228
    v_permlane32_swap_b32 v217, v229
    v_permlane32_swap_b32 v218, v230
    v_add_f32 v228, v216, v228
    s_add_u32 m0, s47, 73728
    s_add_u32 s40, s46, 590080
    buffer_load_dwordx4 v240, s[20:23], s40 offen lds
    v_add_f32 v229, v217, v229
    ds_read_b64_tr_b16 v[184:185], v239 offset:16384
    ds_read_b64_tr_b16 v[186:187], v239 offset:16896
    v_mfma_f32_32x32x16_bf16 v[164:179], v[188:191], v[12:15], v[164:179]
    v_add_f32 v230, v218, v230
    v_mul_f32 v230, 0xbfb8aa3b, v230
    v_mul_f32 v228, 0xbae38e39, v228
    v_exp_f32 v230, v230
    v_mul_f32 v229, 0x3ae38e39, v229
    s_add_u32 m0, s47, 90112
    ds_read_b64_tr_b16 v[188:189], v232 offset:8192
    ds_read_b64_tr_b16 v[190:191], v232 offset:8704
    v_mfma_f32_32x32x16_bf16 v[164:179], v[192:195], v[16:19], v[164:179]
    s_add_u32 s40, s46, 1179904
    buffer_load_dwordx4 v240, s[20:23], s40 offen lds
    v_add_f32 v230, 1.0, v230
    v_fma_f32 v229, -v228, v228, v229
    v_rcp_f32 v255, v230
    v_max_f32 v229, 0, v229
    ds_read_b64_tr_b16 v[192:193], v234 offset:8192
    ds_read_b64_tr_b16 v[194:195], v234 offset:8704
    v_mfma_f32_16x16x32_bf16 v[220:223], v[224:227], v[196:199], v[220:223]
    v_add_f32 v229, 0x3727c5ac, v229
    v_mfma_f32_32x32x16_bf16 v[164:179], v[196:199], v[20:23], v[164:179]
    v_rsq_f32 v231, v229
    s_add_u32 m0, s47, 98304
    s_add_u32 s40, s46, 1769728
    buffer_load_dwordx4 v240, s[20:23], s40 offen lds
    v_cvt_pk_bf16_f32 v230, v228, v228
    v_mul_f32 v245, v229, v231
    v_mul_f32 v243, 0xc0135761, v231
    v_mul_f32 v244, v231, v231
    ds_read_b64_tr_b16 v[196:197], v236 offset:8192
    ds_read_b64_tr_b16 v[198:199], v236 offset:8704
    v_mfma_f32_32x32x16_bf16 v[164:179], v[200:203], v[24:27], v[164:179]
    v_and_b32 v230, 0xffff0000, v230
    v_mul_f32 v244, v244, v231
    s_add_u32 m0, s47, 106496
    s_add_u32 s40, s46, 2359552
    buffer_load_dwordx4 v240, s[20:23], s40 offen lds
    v_sub_f32 v228, v228, v230
    v_mul_f32 v244, 0xbdd2d3e8, v244
    v_cvt_pk_bf16_f32 v216, v230, v228
    ds_read_b64_tr_b16 v[200:201], v238 offset:8192
    ds_read_b64_tr_b16 v[202:203], v238 offset:8704
    s_waitcnt lgkmcnt(10)
    v_mfma_f32_32x32x16_bf16 v[164:179], v[180:183], v[28:31], v[164:179]
    v_cmp_gt_u32 vcc, 32, v246
    v_mov_b32 v218, v216
    s_nop 0
    v_cndmask_b32_e64 v229, 0, v245, vcc
    s_add_u32 m0, s47, 114688
    s_add_u32 s40, s46, 2949376
    buffer_load_dwordx4 v240, s[20:23], s40 offen lds
    v_cvt_pk_bf16_f32 v217, v230, v229
    v_and_b32 v231, 0xffff0000, v217
    ds_read_b64_tr_b16 v[180:181], v232 offset:16384
    ds_read_b64_tr_b16 v[182:183], v232 offset:16896
    s_waitcnt lgkmcnt(10)
    v_mfma_f32_32x32x16_bf16 v[164:179], v[184:187], v[32:35], v[164:179]
    v_sub_f32 v231, v229, v231
    v_cvt_pk_bf16_f32 v219, v230, v231
    s_nop 1
    v_mfma_f32_32x32x16_bf16 v[148:163], v[212:215], v[216:219], v[148:163]
    s_nop 11
    v_mul_f32 v204, v148, v148
    v_mul_f32 v205, v149, v149
    ds_read_b64_tr_b16 v[184:185], v234 offset:16384
    ds_read_b64_tr_b16 v[186:187], v234 offset:16896
    s_waitcnt lgkmcnt(10)
    v_mfma_f32_16x16x32_bf16 v[220:223], v[224:227], v[188:191], v[220:223]
    v_mul_f32 v206, v150, v150
    v_mul_f32 v207, v151, v151
    v_mfma_f32_32x32x16_bf16 v[164:179], v[188:191], v[36:39], v[164:179]
    v_mul_f32 v208, v152, v152
    v_mul_f32 v209, v153, v153
    v_mul_f32 v210, v154, v154
    v_mul_f32 v211, v155, v155
    v_fma_f32 v204, v204, v244, v243
    v_fma_f32 v205, v205, v244, v243
    ds_read_b64_tr_b16 v[188:189], v236 offset:16384
    ds_read_b64_tr_b16 v[190:191], v236 offset:16896
    s_waitcnt lgkmcnt(10)
    v_mfma_f32_32x32x16_bf16 v[164:179], v[192:195], v[40:43], v[164:179]
    v_fma_f32 v206, v206, v244, v243
    v_fma_f32 v207, v207, v244, v243
    v_fma_f32 v208, v208, v244, v243
    ds_read_b64_tr_b16 v[192:193], v238 offset:16384
    ds_read_b64_tr_b16 v[194:195], v238 offset:16896
    s_waitcnt lgkmcnt(10)
    v_mfma_f32_32x32x16_bf16 v[164:179], v[196:199], v[44:47], v[164:179]
    ds_read_b64_tr_b16 v[196:197], v232 offset:24576
    ds_read_b64_tr_b16 v[198:199], v232 offset:25088
    s_waitcnt lgkmcnt(10)
    v_mfma_f32_32x32x16_bf16 v[164:179], v[200:203], v[48:51], v[164:179]
    s_waitcnt vmcnt(7)
    s_barrier
    ds_read_b64_tr_b16 v[200:201], v234 offset:24576
    ds_read_b64_tr_b16 v[202:203], v234 offset:25088
    s_waitcnt lgkmcnt(10)
    v_mfma_f32_16x16x32_bf16 v[220:223], v[224:227], v[180:183], v[220:223]
    v_fma_f32 v209, v209, v244, v243
    v_fma_f32 v210, v210, v244, v243
    v_mfma_f32_32x32x16_bf16 v[164:179], v[180:183], v[52:55], v[164:179]
    v_fma_f32 v211, v211, v244, v243
    v_mul_f32 v204, v204, v148
    v_mul_f32 v205, v205, v149
    v_mul_f32 v206, v206, v150
    v_mul_f32 v207, v207, v151
    v_mul_f32 v208, v208, v152
    v_mul_f32 v209, v209, v153
    ds_read_b64_tr_b16 v[180:181], v236 offset:24576
    ds_read_b64_tr_b16 v[182:183], v236 offset:25088
    s_waitcnt lgkmcnt(10)
    v_mfma_f32_32x32x16_bf16 v[164:179], v[184:187], v[56:59], v[164:179]
    v_mul_f32 v210, v210, v154
    s_add_u32 m0, s47, 122880
    s_add_u32 s40, s46, 3539200
    buffer_load_dwordx4 v240, s[20:23], s40 offen lds
    v_mul_f32 v211, v211, v155
    v_exp_f32 v204, v204
    v_exp_f32 v205, v205
    ds_read_b64_tr_b16 v[184:185], v238 offset:24576
    ds_read_b64_tr_b16 v[186:187], v238 offset:25088
    s_waitcnt lgkmcnt(10)
    v_mfma_f32_32x32x16_bf16 v[164:179], v[188:191], v[60:63], v[164:179]
    v_exp_f32 v206, v206
    v_exp_f32 v207, v207
    v_exp_f32 v208, v208
    ds_read_b64_tr_b16 v[188:189], v232 offset:32768
    ds_read_b64_tr_b16 v[190:191], v232 offset:33280
    s_waitcnt lgkmcnt(10)
    v_mfma_f32_32x32x16_bf16 v[164:179], v[192:195], v[64:67], v[164:179]
    v_exp_f32 v209, v209
    v_exp_f32 v210, v210
    v_exp_f32 v211, v211
    v_fma_f32 v204, v204, v245, v245
    s_add_u32 m0, s47, 131072
    s_add_u32 s40, s46, 4129024
    ds_read_b64_tr_b16 v[192:193], v234 offset:32768
    ds_read_b64_tr_b16 v[194:195], v234 offset:33280
    s_waitcnt lgkmcnt(10)
    v_mfma_f32_16x16x32_bf16 v[220:223], v[224:227], v[196:199], v[220:223]
    buffer_load_dwordx4 v240, s[20:23], s40 offen lds
    v_fma_f32 v205, v205, v245, v245
    v_fma_f32 v206, v206, v245, v245
    v_mfma_f32_32x32x16_bf16 v[164:179], v[196:199], v[68:71], v[164:179]
    v_fma_f32 v207, v207, v245, v245
    v_fma_f32 v208, v208, v245, v245
    v_fma_f32 v209, v209, v245, v245
    v_fma_f32 v210, v210, v245, v245
    v_fma_f32 v211, v211, v245, v245
    ds_read_b64_tr_b16 v[196:197], v236 offset:32768
    ds_read_b64_tr_b16 v[198:199], v236 offset:33280
    s_waitcnt lgkmcnt(10)
    v_mfma_f32_32x32x16_bf16 v[164:179], v[200:203], v[72:75], v[164:179]
    v_rcp_f32 v204, v204
    v_rcp_f32 v205, v205
    v_rcp_f32 v206, v206
    s_add_u32 m0, s47, 139264
    s_add_u32 s40, s46, 4718848
    buffer_load_dwordx4 v240, s[20:23], s40 offen lds
    ds_read_b64_tr_b16 v[200:201], v238 offset:32768
    ds_read_b64_tr_b16 v[202:203], v238 offset:33280
    s_waitcnt lgkmcnt(10)
    v_mfma_f32_32x32x16_bf16 v[164:179], v[180:183], v[76:79], v[164:179]
    v_rcp_f32 v207, v207
    v_rcp_f32 v208, v208
    v_rcp_f32 v209, v209
    v_rcp_f32 v210, v210
    ds_read_b64_tr_b16 v[180:181], v232 offset:40960
    ds_read_b64_tr_b16 v[182:183], v232 offset:41472
    s_waitcnt lgkmcnt(10)
    v_mfma_f32_32x32x16_bf16 v[164:179], v[184:187], v[80:83], v[164:179]
    v_rcp_f32 v211, v211
    v_mul_f32 v148, v148, v204
    v_mul_f32 v149, v149, v205
    v_mul_f32 v150, v150, v206
    v_mul_f32 v151, v151, v207
    v_mul_f32 v152, v152, v208
    ds_read_b64_tr_b16 v[184:185], v234 offset:40960
    ds_read_b64_tr_b16 v[186:187], v234 offset:41472
    s_waitcnt lgkmcnt(10)
    v_mfma_f32_16x16x32_bf16 v[220:223], v[224:227], v[188:191], v[220:223]
    v_mul_f32 v153, v153, v209
    v_mul_f32 v154, v154, v210
    v_mfma_f32_32x32x16_bf16 v[164:179], v[188:191], v[84:87], v[164:179]
    v_mul_f32 v155, v155, v211
    v_cvt_pk_bf16_f32 v148, v148, v149
    v_cvt_pk_bf16_f32 v149, v150, v151
    v_cvt_pk_bf16_f32 v150, v152, v153
    v_cvt_pk_bf16_f32 v151, v154, v155
    buffer_store_dwordx4 v[148:151], v242, s[28:31], s48 offen offset:0 sc1
    v_mul_f32 v204, v156, v156
    v_mul_f32 v205, v157, v157
    ds_read_b64_tr_b16 v[188:189], v236 offset:40960
    ds_read_b64_tr_b16 v[190:191], v236 offset:41472
    s_waitcnt lgkmcnt(10)
    v_mfma_f32_32x32x16_bf16 v[164:179], v[192:195], v[88:91], v[164:179]
    v_mul_f32 v206, v158, v158
    v_mul_f32 v207, v159, v159
    v_mul_f32 v208, v160, v160
    v_mul_f32 v209, v161, v161
    ds_read_b64_tr_b16 v[192:193], v238 offset:40960
    ds_read_b64_tr_b16 v[194:195], v238 offset:41472
    s_waitcnt lgkmcnt(10)
    v_mfma_f32_32x32x16_bf16 v[164:179], v[196:199], v[92:95], v[164:179]
    ds_read_b64_tr_b16 v[196:197], v232 offset:49152
    ds_read_b64_tr_b16 v[198:199], v232 offset:49664
    s_waitcnt lgkmcnt(10)
    v_mfma_f32_32x32x16_bf16 v[164:179], v[200:203], v[96:99], v[164:179]
    s_waitcnt vmcnt(7)
    s_barrier
    ds_read_b64_tr_b16 v[200:201], v234 offset:49152
    ds_read_b64_tr_b16 v[202:203], v234 offset:49664
    s_waitcnt lgkmcnt(10)
    v_mfma_f32_16x16x32_bf16 v[220:223], v[224:227], v[180:183], v[220:223]
    v_mul_f32 v210, v162, v162
    v_mul_f32 v211, v163, v163
    v_mfma_f32_32x32x16_bf16 v[164:179], v[180:183], v[100:103], v[164:179]
    v_fma_f32 v204, v204, v244, v243
    v_fma_f32 v205, v205, v244, v243
    v_fma_f32 v206, v206, v244, v243
    v_fma_f32 v207, v207, v244, v243
    v_fma_f32 v208, v208, v244, v243
    v_fma_f32 v209, v209, v244, v243
    v_fma_f32 v210, v210, v244, v243
    ds_read_b64_tr_b16 v[180:181], v236 offset:49152
    ds_read_b64_tr_b16 v[182:183], v236 offset:49664
    s_waitcnt lgkmcnt(10)
    v_mfma_f32_32x32x16_bf16 v[164:179], v[184:187], v[104:107], v[164:179]
    v_fma_f32 v211, v211, v244, v243
    v_mul_f32 v204, v204, v156
    v_mul_f32 v205, v205, v157
    v_mul_f32 v206, v206, v158
    v_mul_f32 v207, v207, v159
    v_mul_f32 v208, v208, v160
    ds_read_b64_tr_b16 v[184:185], v238 offset:49152
    ds_read_b64_tr_b16 v[186:187], v238 offset:49664
    s_waitcnt lgkmcnt(10)
    v_mfma_f32_32x32x16_bf16 v[164:179], v[188:191], v[108:111], v[164:179]
    v_mul_f32 v209, v209, v161
    v_mul_f32 v210, v210, v162
    v_mul_f32 v211, v211, v163
    v_exp_f32 v204, v204
    v_exp_f32 v205, v205
    ds_read_b32 v231, v250 offset:256
    ds_read_b64_tr_b16 v[188:189], v232 offset:57344
    ds_read_b64_tr_b16 v[190:191], v232 offset:57856
    s_waitcnt lgkmcnt(11)
    v_mfma_f32_32x32x16_bf16 v[164:179], v[192:195], v[112:115], v[164:179]
    v_exp_f32 v206, v206
    v_exp_f32 v207, v207
    v_exp_f32 v208, v208
    ds_read_b64_tr_b16 v[192:193], v234 offset:57344
    ds_read_b64_tr_b16 v[194:195], v234 offset:57856
    s_waitcnt lgkmcnt(11)
    v_mfma_f32_16x16x32_bf16 v[220:223], v[224:227], v[196:199], v[220:223]
    v_exp_f32 v209, v209
    v_mfma_f32_32x32x16_bf16 v[164:179], v[196:199], v[116:119], v[164:179]
    v_exp_f32 v210, v210
    v_exp_f32 v211, v211
    v_fma_f32 v204, v204, v245, v245
    v_fma_f32 v205, v205, v245, v245
    v_fma_f32 v206, v206, v245, v245
    ds_read_b64_tr_b16 v[196:197], v236 offset:57344
    ds_read_b64_tr_b16 v[198:199], v236 offset:57856
    s_waitcnt lgkmcnt(11)
    v_mfma_f32_32x32x16_bf16 v[164:179], v[200:203], v[120:123], v[164:179]
    v_fma_f32 v207, v207, v245, v245
    v_fma_f32 v208, v208, v245, v245
    v_fma_f32 v209, v209, v245, v245
    v_fma_f32 v210, v210, v245, v245
    v_fma_f32 v211, v211, v245, v245
    v_rcp_f32 v204, v204
    ds_read_b64_tr_b16 v[200:201], v238 offset:57344
    ds_read_b64_tr_b16 v[202:203], v238 offset:57856
    s_waitcnt lgkmcnt(11)
    v_mfma_f32_32x32x16_bf16 v[164:179], v[180:183], v[124:127], v[164:179]
    v_rcp_f32 v205, v205
    v_rcp_f32 v206, v206
    v_rcp_f32 v207, v207
    s_waitcnt lgkmcnt(9)
    v_mfma_f32_32x32x16_bf16 v[164:179], v[184:187], v[128:131], v[164:179]
    v_rcp_f32 v208, v208
    v_rcp_f32 v209, v209
    v_rcp_f32 v210, v210
    v_rcp_f32 v211, v211
    s_waitcnt lgkmcnt(6)
    v_mfma_f32_16x16x32_bf16 v[220:223], v[224:227], v[188:191], v[220:223]
    v_mul_f32 v156, v156, v204
    v_mul_f32 v157, v157, v205
    v_mfma_f32_32x32x16_bf16 v[164:179], v[188:191], v[132:135], v[164:179]
    v_mul_f32 v158, v158, v206
    v_mul_f32 v159, v159, v207
    v_mul_f32 v160, v160, v208
    v_mul_f32 v161, v161, v209
    v_mul_f32 v162, v162, v210
    v_mul_f32 v163, v163, v211
    v_cvt_pk_bf16_f32 v156, v156, v157
    s_waitcnt lgkmcnt(4)
    v_mfma_f32_32x32x16_bf16 v[164:179], v[192:195], v[136:139], v[164:179]
    v_cvt_pk_bf16_f32 v157, v158, v159
    v_cvt_pk_bf16_f32 v158, v160, v161
    v_cvt_pk_bf16_f32 v159, v162, v163
    buffer_store_dwordx4 v[156:159], v242, s[28:31], s48 offen offset:1024 sc1
    s_add_u32 s48, s48, 4096
    buffer_load_dword v247, v251, s[20:23], s46 offen offset:384
    s_waitcnt lgkmcnt(2)
    v_mfma_f32_32x32x16_bf16 v[164:179], v[196:199], v[140:143], v[164:179]
    s_waitcnt lgkmcnt(0)
    v_mfma_f32_32x32x16_bf16 v[164:179], v[200:203], v[144:147], v[164:179]
    s_waitcnt vmcnt(6)
    s_waitcnt vmcnt(3)
    v_cvt_pk_bf16_f32 v228, v220, v220
    v_and_b32 v231, s53, v231
    v_and_b32 v229, 0xffff0000, v228
    v_sub_f32 v229, v220, v229
    v_cvt_pk_bf16_f32 v229, v229, v231
    ds_write_b64 v249, v[228:229] offset:2048
    s_waitcnt lgkmcnt(0)
    s_barrier
    s_sub_u32 s92, s92, 4096
    s_subb_u32 s93, s93, 0
    s_sub_u32 s96, s96, 4096
    s_subb_u32 s97, s97, 0
    s_mov_b32 s16, s92
    s_and_b32 s17, s93, 0xffff
    s_mov_b32 s18, 0x511000
    s_mov_b32 s19, 0x20000
    s_mov_b32 s24, s96
    s_and_b32 s25, s97, 0xffff
    s_mov_b32 s26, 0xa3000
    s_mov_b32 s27, 0x20000
    s_lshr_b32 s40, s43, 2
    s_mul_i32 s40, s40, 3
    s_add_u32 s40, s40, s37
    s_lshl_b32 s40, s40, 3
    s_add_u32 s40, s40, s32
    s_mul_i32 s55, s40, 3456
    s_mul_i32 s54, s40, 512
    s_add_u32 s55, s55, 4096
    s_add_u32 s54, s54, 4096
    v_min_u32 v248, 26, v246
    v_lshlrev_b32 v248, 7, v248
    s_cmp_ge_u32 s32, 4
    s_cbranch_scc1 p1_mlp_r1
    ds_read_b128 v[212:215], v241 offset:2048
    s_waitcnt lgkmcnt(0)
    v_mfma_f32_32x32x16_bf16 v[164:179], v[212:215], v[216:219], v[164:179]
    s_setprio 0
    s_add_u32 m0, s47, 0
    s_add_u32 s40, s46, 384
    buffer_load_dwordx4 v240, s[20:23], s40 offen lds
    s_add_u32 m0, s47, 4096
    s_add_u32 s40, s46, 295296
    buffer_load_dwordx4 v240, s[20:23], s40 offen lds
    s_add_u32 m0, s47, 8192
    s_add_u32 s40, s46, 590208
    buffer_load_dwordx4 v240, s[20:23], s40 offen lds
    s_nop 1
    v_mul_f32 v204, v164, v164
    v_mul_f32 v205, v165, v165
    v_mul_f32 v206, v166, v166
    v_mul_f32 v207, v167, v167
    v_mul_f32 v208, v168, v168
    v_mul_f32 v209, v169, v169
    s_add_u32 m0, s47, 12288
    s_add_u32 s40, s46, 885120
    buffer_load_dwordx4 v240, s[20:23], s40 offen lds
    v_mul_f32 v210, v170, v170
    v_mul_f32 v211, v171, v171
    v_fma_f32 v204, v204, v244, v243
    v_fma_f32 v205, v205, v244, v243
    v_fma_f32 v206, v206, v244, v243
    v_fma_f32 v207, v207, v244, v243
    s_add_u32 m0, s47, 16384
    s_add_u32 s40, s46, 1180032
    buffer_load_dwordx4 v240, s[20:23], s40 offen lds
    v_fma_f32 v208, v208, v244, v243
    v_fma_f32 v209, v209, v244, v243
    v_fma_f32 v210, v210, v244, v243
    v_fma_f32 v211, v211, v244, v243
    v_mul_f32 v204, v204, v164
    v_mul_f32 v205, v205, v165
    s_add_u32 m0, s47, 20480
    s_add_u32 s40, s46, 1474944
    buffer_load_dwordx4 v240, s[20:23], s40 offen lds
    v_mul_f32 v206, v206, v166
    v_mul_f32 v207, v207, v167
    v_mul_f32 v208, v208, v168
    v_mul_f32 v209, v209, v169
    v_mul_f32 v210, v210, v170
    v_mul_f32 v211, v211, v171
    s_add_u32 m0, s47, 24576
    s_add_u32 s40, s46, 1769856
    buffer_load_dwordx4 v240, s[20:23], s40 offen lds
    v_exp_f32 v204, v204
    v_exp_f32 v205, v205
    v_exp_f32 v206, v206
    v_exp_f32 v207, v207
    v_exp_f32 v208, v208
    v_exp_f32 v209, v209
    s_add_u32 m0, s47, 28672
    s_add_u32 s40, s46, 2064768
    buffer_load_dwordx4 v240, s[20:23], s40 offen lds
    v_exp_f32 v210, v210
    v_exp_f32 v211, v211
    v_fma_f32 v204, v204, v245, v245
    v_fma_f32 v205, v205, v245, v245
    v_fma_f32 v206, v206, v245, v245
    v_fma_f32 v207, v207, v245, v245
    s_add_u32 m0, s47, 32768
    s_add_u32 s40, s46, 2359680
    buffer_load_dwordx4 v240, s[20:23], s40 offen lds
    v_fma_f32 v208, v208, v245, v245
    v_fma_f32 v209, v209, v245, v245
    v_fma_f32 v210, v210, v245, v245
    v_fma_f32 v211, v211, v245, v245
    v_rcp_f32 v204, v204
    v_rcp_f32 v205, v205
    s_add_u32 m0, s47, 36864
    s_add_u32 s40, s46, 2654592
    buffer_load_dwordx4 v240, s[20:23], s40 offen lds
    v_rcp_f32 v206, v206
    v_rcp_f32 v207, v207
    v_rcp_f32 v208, v208
    v_rcp_f32 v209, v209
    v_rcp_f32 v210, v210
    v_rcp_f32 v211, v211
    s_add_u32 m0, s47, 40960
    s_add_u32 s40, s46, 2949504
    buffer_load_dwordx4 v240, s[20:23], s40 offen lds
    v_mul_f32 v164, v164, v204
    v_mul_f32 v165, v165, v205
    v_mul_f32 v166, v166, v206
    v_mul_f32 v167, v167, v207
    v_mul_f32 v168, v168, v208
    v_mul_f32 v169, v169, v209
    s_add_u32 m0, s47, 45056
    s_add_u32 s40, s46, 3244416
    buffer_load_dwordx4 v240, s[20:23], s40 offen lds
    v_mul_f32 v170, v170, v210
    v_mul_f32 v171, v171, v211
    v_cvt_pk_bf16_f32 v164, v164, v165
    v_cvt_pk_bf16_f32 v165, v166, v167
    v_cvt_pk_bf16_f32 v166, v168, v169
    v_cvt_pk_bf16_f32 v167, v170, v171
    s_add_u32 m0, s47, 49152
    s_add_u32 s40, s46, 3539328
    buffer_load_dwordx4 v240, s[20:23], s40 offen lds
    v_mul_f32 v204, v172, v172
    v_mul_f32 v205, v173, v173
    v_mul_f32 v206, v174, v174
    v_mul_f32 v207, v175, v175
    v_mul_f32 v208, v176, v176
    v_mul_f32 v209, v177, v177
    s_add_u32 m0, s47, 53248
    s_add_u32 s40, s46, 3834240
    buffer_load_dwordx4 v240, s[20:23], s40 offen lds
    v_mul_f32 v210, v178, v178
    v_mul_f32 v211, v179, v179
    v_fma_f32 v204, v204, v244, v243
    v_fma_f32 v205, v205, v244, v243
    v_fma_f32 v206, v206, v244, v243
    v_fma_f32 v207, v207, v244, v243
    s_add_u32 m0, s47, 57344
    s_add_u32 s40, s46, 4129152
    buffer_load_dwordx4 v240, s[20:23], s40 offen lds
    v_fma_f32 v208, v208, v244, v243
    v_fma_f32 v209, v209, v244, v243
    v_fma_f32 v210, v210, v244, v243
    v_fma_f32 v211, v211, v244, v243
    v_mul_f32 v204, v204, v172
    v_mul_f32 v205, v205, v173
    s_add_u32 m0, s47, 61440
    s_add_u32 s40, s46, 4424064
    buffer_load_dwordx4 v240, s[20:23], s40 offen lds
    v_mul_f32 v206, v206, v174
    v_mul_f32 v207, v207, v175
    v_mul_f32 v208, v208, v176
    v_mul_f32 v209, v209, v177
    v_mul_f32 v210, v210, v178
    v_mul_f32 v211, v211, v179
    s_add_u32 m0, s47, 147456
    s_add_u32 s40, s46, 4718976
    buffer_load_dwordx4 v240, s[20:23], s40 offen lds
    v_exp_f32 v204, v204
    v_exp_f32 v205, v205
    v_exp_f32 v206, v206
    v_exp_f32 v207, v207
    v_exp_f32 v208, v208
    v_exp_f32 v209, v209
    s_add_u32 m0, s47, 151552
    s_add_u32 s40, s46, 5013888
    buffer_load_dwordx4 v240, s[20:23], s40 offen lds
    v_exp_f32 v210, v210
    v_exp_f32 v211, v211
    v_fma_f32 v204, v204, v245, v245
    v_fma_f32 v205, v205, v245, v245
    v_fma_f32 v206, v206, v245, v245
    v_fma_f32 v207, v207, v245, v245
    v_fma_f32 v208, v208, v245, v245
    v_fma_f32 v209, v209, v245, v245
    v_fma_f32 v210, v210, v245, v245
    v_fma_f32 v211, v211, v245, v245
    v_rcp_f32 v204, v204
    v_rcp_f32 v205, v205
    v_rcp_f32 v206, v206
    v_rcp_f32 v207, v207
    v_rcp_f32 v208, v208
    v_rcp_f32 v209, v209
    v_rcp_f32 v210, v210
    v_rcp_f32 v211, v211
    ds_read_b64_tr_b16 v[180:181], v233 offset:0
    ds_read_b64_tr_b16 v[182:183], v233 offset:512
    ds_read_b64_tr_b16 v[184:185], v235 offset:0
    ds_read_b64_tr_b16 v[186:187], v235 offset:512
    ds_read_b64_tr_b16 v[188:189], v237 offset:0
    ds_read_b64_tr_b16 v[190:191], v237 offset:512
    ds_read_b64_tr_b16 v[192:193], v239 offset:0
    ds_read_b64_tr_b16 v[194:195], v239 offset:512
    ds_read_b64_tr_b16 v[196:197], v233 offset:8192
    ds_read_b64_tr_b16 v[198:199], v233 offset:8704
    v_mul_f32 v172, v172, v204
    v_mul_f32 v173, v173, v205
    v_mul_f32 v174, v174, v206
    v_mul_f32 v175, v175, v207
    v_mul_f32 v176, v176, v208
    v_mul_f32 v177, v177, v209
    v_mul_f32 v178, v178, v210
    v_mul_f32 v179, v179, v211
    v_cvt_pk_bf16_f32 v172, v172, v173
    v_cvt_pk_bf16_f32 v173, v174, v175
    v_cvt_pk_bf16_f32 v174, v176, v177
    v_cvt_pk_bf16_f32 v175, v178, v179
    buffer_store_dwordx4 v[164:167], v242, s[28:31], s48 offen offset:0 sc1
    buffer_store_dwordx4 v[172:175], v242, s[28:31], s48 offen offset:1024 sc1
    s_add_u32 s48, s48, 4096
    buffer_load_dword v247, v251, s[20:23], s46 offen offset:512
    s_setprio 1
    ds_read_b64_tr_b16 v[200:201], v235 offset:8192
    ds_read_b64_tr_b16 v[202:203], v235 offset:8704
    s_waitcnt lgkmcnt(10)
    v_mfma_f32_16x16x32_bf16 v[220:223], v[224:227], v[180:183], 0
    v_mfma_f32_32x32x16_bf16 v[148:163], v[180:183], v[4:7], 0
    ds_read_b64_tr_b16 v[180:181], v237 offset:8192
    ds_read_b64_tr_b16 v[182:183], v237 offset:8704
    s_waitcnt lgkmcnt(10)
    v_mfma_f32_32x32x16_bf16 v[148:163], v[184:187], v[8:11], v[148:163]
    ds_read_b64_tr_b16 v[184:185], v239 offset:8192
    ds_read_b64_tr_b16 v[186:187], v239 offset:8704
    s_waitcnt lgkmcnt(10)
    v_mfma_f32_32x32x16_bf16 v[148:163], v[188:191], v[12:15], v[148:163]
    ds_read_b64_tr_b16 v[188:189], v233 offset:24576
    ds_read_b64_tr_b16 v[190:191], v233 offset:25088
    s_waitcnt lgkmcnt(10)
    v_mfma_f32_32x32x16_bf16 v[148:163], v[192:195], v[16:19], v[148:163]
    ds_read_b64_tr_b16 v[192:193], v235 offset:24576
    ds_read_b64_tr_b16 v[194:195], v235 offset:25088
    s_waitcnt lgkmcnt(10)
    v_mfma_f32_16x16x32_bf16 v[220:223], v[224:227], v[196:199], v[220:223]
    v_mfma_f32_32x32x16_bf16 v[148:163], v[196:199], v[20:23], v[148:163]
    ds_read_b64_tr_b16 v[196:197], v237 offset:24576
    ds_read_b64_tr_b16 v[198:199], v237 offset:25088
    s_waitcnt lgkmcnt(10)
    v_mfma_f32_32x32x16_bf16 v[148:163], v[200:203], v[24:27], v[148:163]
    ds_read_b64_tr_b16 v[200:201], v239 offset:24576
    ds_read_b64_tr_b16 v[202:203], v239 offset:25088
    s_waitcnt lgkmcnt(10)
    v_mfma_f32_32x32x16_bf16 v[148:163], v[180:183], v[28:31], v[148:163]
    ds_read_b64_tr_b16 v[180:181], v233 offset:32768
    ds_read_b64_tr_b16 v[182:183], v233 offset:33280
    s_waitcnt lgkmcnt(10)
    v_mfma_f32_32x32x16_bf16 v[148:163], v[184:187], v[32:35], v[148:163]
    ds_read_b64_tr_b16 v[184:185], v235 offset:32768
    ds_read_b64_tr_b16 v[186:187], v235 offset:33280
    s_waitcnt lgkmcnt(10)
    v_mfma_f32_16x16x32_bf16 v[220:223], v[224:227], v[188:191], v[220:223]
    v_mfma_f32_32x32x16_bf16 v[148:163], v[188:191], v[36:39], v[148:163]
    ds_read_b64_tr_b16 v[188:189], v237 offset:32768
    ds_read_b64_tr_b16 v[190:191], v237 offset:33280
    s_waitcnt lgkmcnt(10)
    v_mfma_f32_32x32x16_bf16 v[148:163], v[192:195], v[40:43], v[148:163]
    ds_read_b64_tr_b16 v[192:193], v239 offset:32768
    ds_read_b64_tr_b16 v[194:195], v239 offset:33280
    s_waitcnt lgkmcnt(10)
    v_mfma_f32_32x32x16_bf16 v[148:163], v[196:199], v[44:47], v[148:163]
    ds_read_b64_tr_b16 v[196:197], v233 offset:40960
    ds_read_b64_tr_b16 v[198:199], v233 offset:41472
    s_waitcnt lgkmcnt(10)
    v_mfma_f32_32x32x16_bf16 v[148:163], v[200:203], v[48:51], v[148:163]
    ds_read_b64_tr_b16 v[200:201], v235 offset:40960
    ds_read_b64_tr_b16 v[202:203], v235 offset:41472
    s_waitcnt lgkmcnt(10)
    v_mfma_f32_16x16x32_bf16 v[220:223], v[224:227], v[180:183], v[220:223]
    v_mfma_f32_32x32x16_bf16 v[148:163], v[180:183], v[52:55], v[148:163]
    ds_read_b64_tr_b16 v[180:181], v237 offset:40960
    ds_read_b64_tr_b16 v[182:183], v237 offset:41472
    s_waitcnt lgkmcnt(10)
    v_mfma_f32_32x32x16_bf16 v[148:163], v[184:187], v[56:59], v[148:163]
    ds_read_b64_tr_b16 v[184:185], v239 offset:40960
    ds_read_b64_tr_b16 v[186:187], v239 offset:41472
    s_waitcnt lgkmcnt(10)
    v_mfma_f32_32x32x16_bf16 v[148:163], v[188:191], v[60:63], v[148:163]
    ds_read_b64_tr_b16 v[188:189], v233 offset:49152
    ds_read_b64_tr_b16 v[190:191], v233 offset:49664
    s_waitcnt lgkmcnt(10)
    v_mfma_f32_32x32x16_bf16 v[148:163], v[192:195], v[64:67], v[148:163]
    ds_read_b64_tr_b16 v[192:193], v235 offset:49152
    ds_read_b64_tr_b16 v[194:195], v235 offset:49664
    s_waitcnt lgkmcnt(10)
    v_mfma_f32_16x16x32_bf16 v[220:223], v[224:227], v[196:199], v[220:223]
    v_mfma_f32_32x32x16_bf16 v[148:163], v[196:199], v[68:71], v[148:163]
    ds_read_b64_tr_b16 v[196:197], v237 offset:49152
    ds_read_b64_tr_b16 v[198:199], v237 offset:49664
    s_waitcnt lgkmcnt(10)
    v_mfma_f32_32x32x16_bf16 v[148:163], v[200:203], v[72:75], v[148:163]
    ds_read_b64_tr_b16 v[200:201], v239 offset:49152
    ds_read_b64_tr_b16 v[202:203], v239 offset:49664
    s_waitcnt lgkmcnt(10)
    v_mfma_f32_32x32x16_bf16 v[148:163], v[180:183], v[76:79], v[148:163]
    ds_read_b64_tr_b16 v[180:181], v233 offset:57344
    ds_read_b64_tr_b16 v[182:183], v233 offset:57856
    s_waitcnt lgkmcnt(10)
    v_mfma_f32_32x32x16_bf16 v[148:163], v[184:187], v[80:83], v[148:163]
    ds_read_b64_tr_b16 v[184:185], v235 offset:57344
    ds_read_b64_tr_b16 v[186:187], v235 offset:57856
    s_waitcnt lgkmcnt(10)
    v_mfma_f32_16x16x32_bf16 v[220:223], v[224:227], v[188:191], v[220:223]
    v_mfma_f32_32x32x16_bf16 v[148:163], v[188:191], v[84:87], v[148:163]
    ds_read_b64_tr_b16 v[188:189], v237 offset:57344
    ds_read_b64_tr_b16 v[190:191], v237 offset:57856
    s_waitcnt lgkmcnt(10)
    v_mfma_f32_32x32x16_bf16 v[148:163], v[192:195], v[88:91], v[148:163]
    ds_read_b64_tr_b16 v[192:193], v239 offset:57344
    ds_read_b64_tr_b16 v[194:195], v239 offset:57856
    s_waitcnt lgkmcnt(10)
    v_mfma_f32_32x32x16_bf16 v[148:163], v[196:199], v[92:95], v[148:163]
    v_add_u32 v232, 0x20000, v232
    ds_read_b64_tr_b16 v[196:197], v232 offset:0
    ds_read_b64_tr_b16 v[198:199], v232 offset:512
    s_waitcnt lgkmcnt(10)
    v_mfma_f32_32x32x16_bf16 v[148:163], v[200:203], v[96:99], v[148:163]
    v_add_u32 v234, 0x20000, v234
    ds_read_b64_tr_b16 v[200:201], v234 offset:0
    ds_read_b64_tr_b16 v[202:203], v234 offset:512
    s_waitcnt lgkmcnt(10)
    v_mfma_f32_16x16x32_bf16 v[220:223], v[224:227], v[180:183], v[220:223]
    v_mfma_f32_32x32x16_bf16 v[148:163], v[180:183], v[100:103], v[148:163]
    v_add_u32 v236, 0x20000, v236
    ds_read_b64_tr_b16 v[180:181], v236 offset:0
    ds_read_b64_tr_b16 v[182:183], v236 offset:512
    s_waitcnt lgkmcnt(10)
    v_mfma_f32_32x32x16_bf16 v[148:163], v[184:187], v[104:107], v[148:163]
    v_add_u32 v238, 0x20000, v238
    ds_read_b64_tr_b16 v[184:185], v238 offset:0
    ds_read_b64_tr_b16 v[186:187], v238 offset:512
    ds_read_b32 v231, v250 offset:512
    s_waitcnt lgkmcnt(11)
    v_mfma_f32_32x32x16_bf16 v[148:163], v[188:191], v[108:111], v[148:163]
    ds_read_b64_tr_b16 v[188:189], v232 offset:8192
    ds_read_b64_tr_b16 v[190:191], v232 offset:8704
    s_waitcnt lgkmcnt(11)
    v_mfma_f32_32x32x16_bf16 v[148:163], v[192:195], v[112:115], v[148:163]
    ds_read_b64_tr_b16 v[192:193], v234 offset:8192
    ds_read_b64_tr_b16 v[194:195], v234 offset:8704
    s_waitcnt lgkmcnt(11)
    v_mfma_f32_16x16x32_bf16 v[220:223], v[224:227], v[196:199], v[220:223]
    v_mfma_f32_32x32x16_bf16 v[148:163], v[196:199], v[116:119], v[148:163]
    ds_read_b64_tr_b16 v[196:197], v236 offset:8192
    ds_read_b64_tr_b16 v[198:199], v236 offset:8704
    s_waitcnt lgkmcnt(11)
    v_mfma_f32_32x32x16_bf16 v[148:163], v[200:203], v[120:123], v[148:163]
    ds_read_b64_tr_b16 v[200:201], v238 offset:8192
    ds_read_b64_tr_b16 v[202:203], v238 offset:8704
    s_waitcnt lgkmcnt(11)
    v_mfma_f32_32x32x16_bf16 v[148:163], v[180:183], v[124:127], v[148:163]
    s_waitcnt lgkmcnt(9)
    v_mfma_f32_32x32x16_bf16 v[148:163], v[184:187], v[128:131], v[148:163]
    s_waitcnt lgkmcnt(6)
    v_mfma_f32_16x16x32_bf16 v[220:223], v[224:227], v[188:191], v[220:223]
    v_mfma_f32_32x32x16_bf16 v[148:163], v[188:191], v[132:135], v[148:163]
    s_nop 6
    v_cvt_pk_bf16_f32 v228, v220, v220
    v_and_b32 v231, s53, v231
    v_and_b32 v229, 0xffff0000, v228
    v_sub_f32 v229, v220, v229
    v_cvt_pk_bf16_f32 v229, v229, v231
    ds_write_b64 v249, v[228:229] offset:0
    s_waitcnt vmcnt(15)
    s_waitcnt vmcnt(9)
    s_waitcnt vmcnt(3)
    s_waitcnt lgkmcnt(0)
    s_barrier
    ds_read_b128 v[212:215], v241 offset:0
    v_mfma_f32_32x32x16_bf16 v[148:163], v[192:195], v[136:139], v[148:163]
    v_mfma_f32_32x32x16_bf16 v[148:163], v[196:199], v[140:143], v[148:163]
    v_mfma_f32_32x32x16_bf16 v[148:163], v[200:203], v[144:147], v[148:163]
    s_waitcnt lgkmcnt(0)
    v_mfma_f32_32x32x16_bf16 v[148:163], v[212:215], v[216:219], v[148:163]
    s_setprio 0
    s_cmp_lg_u32 s32, 0
    s_cbranch_scc1 ws_3
    s_mov_b64 exec, 1
    v_mov_b32 v228, 1
    buffer_store_dword v228, off, s[28:31], s14 sc1
    s_mov_b64 exec, -1
ws_3:
    s_add_u32 m0, s47, 73728
    s_add_u32 s40, s46, 512
    buffer_load_dwordx4 v240, s[20:23], s40 offen lds
    s_add_u32 m0, s47, 77824
    s_add_u32 s40, s46, 295424
    buffer_load_dwordx4 v240, s[20:23], s40 offen lds
    s_add_u32 m0, s47, 81920
    s_add_u32 s40, s46, 590336
    buffer_load_dwordx4 v240, s[20:23], s40 offen lds
    v_mul_f32 v204, v148, v148
    v_mul_f32 v205, v149, v149
    v_mul_f32 v206, v150, v150
    v_mul_f32 v207, v151, v151
    v_mul_f32 v208, v152, v152
    v_mul_f32 v209, v153, v153
    s_add_u32 m0, s47, 86016
    s_add_u32 s40, s46, 885248
    buffer_load_dwordx4 v240, s[20:23], s40 offen lds
    v_mul_f32 v210, v154, v154
    v_mul_f32 v211, v155, v155
    v_fma_f32 v204, v204, v244, v243
    v_fma_f32 v205, v205, v244, v243
    v_fma_f32 v206, v206, v244, v243
    v_fma_f32 v207, v207, v244, v243
    s_add_u32 m0, s47, 90112
    s_add_u32 s40, s46, 1180160
    buffer_load_dwordx4 v240, s[20:23], s40 offen lds
    v_fma_f32 v208, v208, v244, v243
    v_fma_f32 v209, v209, v244, v243
    v_fma_f32 v210, v210, v244, v243
    v_fma_f32 v211, v211, v244, v243
    v_mul_f32 v204, v204, v148
    v_mul_f32 v205, v205, v149
    s_add_u32 m0, s47, 94208
    s_add_u32 s40, s46, 1475072
    buffer_load_dwordx4 v240, s[20:23], s40 offen lds
    v_mul_f32 v206, v206, v150
    v_mul_f32 v207, v207, v151
    v_mul_f32 v208, v208, v152
    v_mul_f32 v209, v209, v153
    v_mul_f32 v210, v210, v154
    v_mul_f32 v211, v211, v155
    s_add_u32 m0, s47, 98304
    s_add_u32 s40, s46, 1769984
    buffer_load_dwordx4 v240, s[20:23], s40 offen lds
    v_exp_f32 v204, v204
    v_exp_f32 v205, v205
    v_exp_f32 v206, v206
    v_exp_f32 v207, v207
    v_exp_f32 v208, v208
    v_exp_f32 v209, v209
    s_add_u32 m0, s47, 102400
    s_add_u32 s40, s46, 2064896
    buffer_load_dwordx4 v240, s[20:23], s40 offen lds
    v_exp_f32 v210, v210
    v_exp_f32 v211, v211
    v_fma_f32 v204, v204, v245, v245
    v_fma_f32 v205, v205, v245, v245
    v_fma_f32 v206, v206, v245, v245
    v_fma_f32 v207, v207, v245, v245
    s_add_u32 m0, s47, 106496
    s_add_u32 s40, s46, 2359808
    buffer_load_dwordx4 v240, s[20:23], s40 offen lds
    v_fma_f32 v208, v208, v245, v245
    v_fma_f32 v209, v209, v245, v245
    v_fma_f32 v210, v210, v245, v245
    v_fma_f32 v211, v211, v245, v245
    v_rcp_f32 v204, v204
    v_rcp_f32 v205, v205
    s_add_u32 m0, s47, 110592
    s_add_u32 s40, s46, 2654720
    buffer_load_dwordx4 v240, s[20:23], s40 offen lds
    v_rcp_f32 v206, v206
    v_rcp_f32 v207, v207
    v_rcp_f32 v208, v208
    v_rcp_f32 v209, v209
    v_rcp_f32 v210, v210
    v_rcp_f32 v211, v211
    s_add_u32 m0, s47, 114688
    s_add_u32 s40, s46, 2949632
    buffer_load_dwordx4 v240, s[20:23], s40 offen lds
    v_mul_f32 v148, v148, v204
    v_mul_f32 v149, v149, v205
    v_mul_f32 v150, v150, v206
    v_mul_f32 v151, v151, v207
    v_mul_f32 v152, v152, v208
    v_mul_f32 v153, v153, v209
    s_add_u32 m0, s47, 118784
    s_add_u32 s40, s46, 3244544
    buffer_load_dwordx4 v240, s[20:23], s40 offen lds
    v_mul_f32 v154, v154, v210
    v_mul_f32 v155, v155, v211
    v_cvt_pk_bf16_f32 v148, v148, v149
    v_cvt_pk_bf16_f32 v149, v150, v151
    v_cvt_pk_bf16_f32 v150, v152, v153
    v_cvt_pk_bf16_f32 v151, v154, v155
    s_add_u32 m0, s47, 122880
    s_add_u32 s40, s46, 3539456
    buffer_load_dwordx4 v240, s[20:23], s40 offen lds
    v_mul_f32 v204, v156, v156
    v_mul_f32 v205, v157, v157
    v_mul_f32 v206, v158, v158
    v_mul_f32 v207, v159, v159
    v_mul_f32 v208, v160, v160
    v_mul_f32 v209, v161, v161
    s_add_u32 m0, s47, 126976
    s_add_u32 s40, s46, 3834368
    buffer_load_dwordx4 v240, s[20:23], s40 offen lds
    v_mul_f32 v210, v162, v162
    v_mul_f32 v211, v163, v163
    v_fma_f32 v204, v204, v244, v243
    v_fma_f32 v205, v205, v244, v243
    v_fma_f32 v206, v206, v244, v243
    v_fma_f32 v207, v207, v244, v243
    s_add_u32 m0, s47, 131072
    s_add_u32 s40, s46, 4129280
    buffer_load_dwordx4 v240, s[20:23], s40 offen lds
    v_fma_f32 v208, v208, v244, v243
    v_fma_f32 v209, v209, v244, v243
    v_fma_f32 v210, v210, v244, v243
    v_fma_f32 v211, v211, v244, v243
    v_mul_f32 v204, v204, v156
    v_mul_f32 v205, v205, v157
    s_add_u32 m0, s47, 135168
    s_add_u32 s40, s46, 4424192
    buffer_load_dwordx4 v240, s[20:23], s40 offen lds
    v_mul_f32 v206, v206, v158
    v_mul_f32 v207, v207, v159
    v_mul_f32 v208, v208, v160
    v_mul_f32 v209, v209, v161
    v_mul_f32 v210, v210, v162
    v_mul_f32 v211, v211, v163
    s_add_u32 m0, s47, 139264
    s_add_u32 s40, s46, 4719104
    buffer_load_dwordx4 v240, s[20:23], s40 offen lds
    v_exp_f32 v204, v204
    v_exp_f32 v205, v205
    v_exp_f32 v206, v206
    v_exp_f32 v207, v207
    v_exp_f32 v208, v208
    v_exp_f32 v209, v209
    s_add_u32 m0, s47, 143360
    s_add_u32 s40, s46, 5014016
    buffer_load_dwordx4 v240, s[20:23], s40 offen lds
    v_exp_f32 v210, v210
    v_exp_f32 v211, v211
    v_fma_f32 v204, v204, v245, v245
    v_fma_f32 v205, v205, v245, v245
    v_fma_f32 v206, v206, v245, v245
    v_fma_f32 v207, v207, v245, v245
    v_fma_f32 v208, v208, v245, v245
    v_fma_f32 v209, v209, v245, v245
    v_fma_f32 v210, v210, v245, v245
    v_fma_f32 v211, v211, v245, v245
    v_rcp_f32 v204, v204
    v_rcp_f32 v205, v205
    v_rcp_f32 v206, v206
    v_rcp_f32 v207, v207
    v_rcp_f32 v208, v208
    v_rcp_f32 v209, v209
    v_rcp_f32 v210, v210
    v_rcp_f32 v211, v211
    v_add_u32 v233, 0xffff0000, v233
    ds_read_b64_tr_b16 v[180:181], v233 offset:0
    ds_read_b64_tr_b16 v[182:183], v233 offset:512
    v_add_u32 v235, 0xffff0000, v235
    ds_read_b64_tr_b16 v[184:185], v235 offset:0
    ds_read_b64_tr_b16 v[186:187], v235 offset:512
    v_add_u32 v237, 0xffff0000, v237
    ds_read_b64_tr_b16 v[188:189], v237 offset:0
    ds_read_b64_tr_b16 v[190:191], v237 offset:512
    v_add_u32 v239, 0xffff0000, v239
    ds_read_b64_tr_b16 v[192:193], v239 offset:0
    ds_read_b64_tr_b16 v[194:195], v239 offset:512
    ds_read_b64_tr_b16 v[196:197], v233 offset:8192
    ds_read_b64_tr_b16 v[198:199], v233 offset:8704
    v_mul_f32 v156, v156, v204
    v_mul_f32 v157, v157, v205
    v_mul_f32 v158, v158, v206
    v_mul_f32 v159, v159, v207
    v_mul_f32 v160, v160, v208
    v_mul_f32 v161, v161, v209
    v_mul_f32 v162, v162, v210
    v_mul_f32 v163, v163, v211
    v_cvt_pk_bf16_f32 v156, v156, v157
    v_cvt_pk_bf16_f32 v157, v158, v159
    v_cvt_pk_bf16_f32 v158, v160, v161
    v_cvt_pk_bf16_f32 v159, v162, v163
    buffer_store_dwordx4 v[148:151], v242, s[28:31], s48 offen offset:0 sc1
    buffer_store_dwordx4 v[156:159], v242, s[28:31], s48 offen offset:1024 sc1
    s_add_u32 s48, s48, 4096
    buffer_load_dword v247, v251, s[20:23], s46 offen offset:640
    s_setprio 1
    ds_read_b64_tr_b16 v[200:201], v235 offset:8192
    ds_read_b64_tr_b16 v[202:203], v235 offset:8704
    s_waitcnt lgkmcnt(10)
    v_mfma_f32_16x16x32_bf16 v[220:223], v[224:227], v[180:183], 0
    v_mfma_f32_32x32x16_bf16 v[164:179], v[180:183], v[4:7], 0
    ds_read_b64_tr_b16 v[180:181], v237 offset:8192
    ds_read_b64_tr_b16 v[182:183], v237 offset:8704
    s_waitcnt lgkmcnt(10)
    v_mfma_f32_32x32x16_bf16 v[164:179], v[184:187], v[8:11], v[164:179]
    ds_read_b64_tr_b16 v[184:185], v239 offset:8192
    ds_read_b64_tr_b16 v[186:187], v239 offset:8704
    s_waitcnt lgkmcnt(10)
    v_mfma_f32_32x32x16_bf16 v[164:179], v[188:191], v[12:15], v[164:179]
    ds_read_b64_tr_b16 v[188:189], v233 offset:16384
    ds_read_b64_tr_b16 v[190:191], v233 offset:16896
    s_waitcnt lgkmcnt(10)
    v_mfma_f32_32x32x16_bf16 v[164:179], v[192:195], v[16:19], v[164:179]
    ds_read_b64_tr_b16 v[192:193], v235 offset:16384
    ds_read_b64_tr_b16 v[194:195], v235 offset:16896
    s_waitcnt lgkmcnt(10)
    v_mfma_f32_16x16x32_bf16 v[220:223], v[224:227], v[196:199], v[220:223]
    v_mfma_f32_32x32x16_bf16 v[164:179], v[196:199], v[20:23], v[164:179]
    ds_read_b64_tr_b16 v[196:197], v237 offset:16384
    ds_read_b64_tr_b16 v[198:199], v237 offset:16896
    s_waitcnt lgkmcnt(10)
    v_mfma_f32_32x32x16_bf16 v[164:179], v[200:203], v[24:27], v[164:179]
    ds_read_b64_tr_b16 v[200:201], v239 offset:16384
    ds_read_b64_tr_b16 v[202:203], v239 offset:16896
    s_waitcnt lgkmcnt(10)
    v_mfma_f32_32x32x16_bf16 v[164:179], v[180:183], v[28:31], v[164:179]
    ds_read_b64_tr_b16 v[180:181], v233 offset:24576
    ds_read_b64_tr_b16 v[182:183], v233 offset:25088
    s_waitcnt lgkmcnt(10)
    v_mfma_f32_32x32x16_bf16 v[164:179], v[184:187], v[32:35], v[164:179]
    ds_read_b64_tr_b16 v[184:185], v235 offset:24576
    ds_read_b64_tr_b16 v[186:187], v235 offset:25088
    s_waitcnt lgkmcnt(10)
    v_mfma_f32_16x16x32_bf16 v[220:223], v[224:227], v[188:191], v[220:223]
    v_mfma_f32_32x32x16_bf16 v[164:179], v[188:191], v[36:39], v[164:179]
    ds_read_b64_tr_b16 v[188:189], v237 offset:24576
    ds_read_b64_tr_b16 v[190:191], v237 offset:25088
    s_waitcnt lgkmcnt(10)
    v_mfma_f32_32x32x16_bf16 v[164:179], v[192:195], v[40:43], v[164:179]
    ds_read_b64_tr_b16 v[192:193], v239 offset:24576
    ds_read_b64_tr_b16 v[194:195], v239 offset:25088
    s_waitcnt lgkmcnt(10)
    v_mfma_f32_32x32x16_bf16 v[164:179], v[196:199], v[44:47], v[164:179]
    ds_read_b64_tr_b16 v[196:197], v233 offset:32768
    ds_read_b64_tr_b16 v[198:199], v233 offset:33280
    s_waitcnt lgkmcnt(10)
    v_mfma_f32_32x32x16_bf16 v[164:179], v[200:203], v[48:51], v[164:179]
    ds_read_b64_tr_b16 v[200:201], v235 offset:32768
    ds_read_b64_tr_b16 v[202:203], v235 offset:33280
    s_waitcnt lgkmcnt(10)
    v_mfma_f32_16x16x32_bf16 v[220:223], v[224:227], v[180:183], v[220:223]
    v_mfma_f32_32x32x16_bf16 v[164:179], v[180:183], v[52:55], v[164:179]
    ds_read_b64_tr_b16 v[180:181], v237 offset:32768
    ds_read_b64_tr_b16 v[182:183], v237 offset:33280
    s_waitcnt lgkmcnt(10)
    v_mfma_f32_32x32x16_bf16 v[164:179], v[184:187], v[56:59], v[164:179]
    ds_read_b64_tr_b16 v[184:185], v239 offset:32768
    ds_read_b64_tr_b16 v[186:187], v239 offset:33280
    s_waitcnt lgkmcnt(10)
    v_mfma_f32_32x32x16_bf16 v[164:179], v[188:191], v[60:63], v[164:179]
    ds_read_b64_tr_b16 v[188:189], v233 offset:40960
    ds_read_b64_tr_b16 v[190:191], v233 offset:41472
    s_waitcnt lgkmcnt(10)
    v_mfma_f32_32x32x16_bf16 v[164:179], v[192:195], v[64:67], v[164:179]
    ds_read_b64_tr_b16 v[192:193], v235 offset:40960
    ds_read_b64_tr_b16 v[194:195], v235 offset:41472
    s_waitcnt lgkmcnt(10)
    v_mfma_f32_16x16x32_bf16 v[220:223], v[224:227], v[196:199], v[220:223]
    v_mfma_f32_32x32x16_bf16 v[164:179], v[196:199], v[68:71], v[164:179]
    ds_read_b64_tr_b16 v[196:197], v237 offset:40960
    ds_read_b64_tr_b16 v[198:199], v237 offset:41472
    s_waitcnt lgkmcnt(10)
    v_mfma_f32_32x32x16_bf16 v[164:179], v[200:203], v[72:75], v[164:179]
    ds_read_b64_tr_b16 v[200:201], v239 offset:40960
    ds_read_b64_tr_b16 v[202:203], v239 offset:41472
    s_waitcnt lgkmcnt(10)
    v_mfma_f32_32x32x16_bf16 v[164:179], v[180:183], v[76:79], v[164:179]
    ds_read_b64_tr_b16 v[180:181], v233 offset:49152
    ds_read_b64_tr_b16 v[182:183], v233 offset:49664
    s_waitcnt lgkmcnt(10)
    v_mfma_f32_32x32x16_bf16 v[164:179], v[184:187], v[80:83], v[164:179]
    ds_read_b64_tr_b16 v[184:185], v235 offset:49152
    ds_read_b64_tr_b16 v[186:187], v235 offset:49664
    s_waitcnt lgkmcnt(10)
    v_mfma_f32_16x16x32_bf16 v[220:223], v[224:227], v[188:191], v[220:223]
    v_mfma_f32_32x32x16_bf16 v[164:179], v[188:191], v[84:87], v[164:179]
    ds_read_b64_tr_b16 v[188:189], v237 offset:49152
    ds_read_b64_tr_b16 v[190:191], v237 offset:49664
    s_waitcnt lgkmcnt(10)
    v_mfma_f32_32x32x16_bf16 v[164:179], v[192:195], v[88:91], v[164:179]
    ds_read_b64_tr_b16 v[192:193], v239 offset:49152
    ds_read_b64_tr_b16 v[194:195], v239 offset:49664
    s_waitcnt lgkmcnt(10)
    v_mfma_f32_32x32x16_bf16 v[164:179], v[196:199], v[92:95], v[164:179]
    ds_read_b64_tr_b16 v[196:197], v233 offset:57344
    ds_read_b64_tr_b16 v[198:199], v233 offset:57856
    s_waitcnt lgkmcnt(10)
    v_mfma_f32_32x32x16_bf16 v[164:179], v[200:203], v[96:99], v[164:179]
    ds_read_b64_tr_b16 v[200:201], v235 offset:57344
    ds_read_b64_tr_b16 v[202:203], v235 offset:57856
    s_waitcnt lgkmcnt(10)
    v_mfma_f32_16x16x32_bf16 v[220:223], v[224:227], v[180:183], v[220:223]
    v_mfma_f32_32x32x16_bf16 v[164:179], v[180:183], v[100:103], v[164:179]
    ds_read_b64_tr_b16 v[180:181], v237 offset:57344
    ds_read_b64_tr_b16 v[182:183], v237 offset:57856
    s_waitcnt lgkmcnt(10)
    v_mfma_f32_32x32x16_bf16 v[164:179], v[184:187], v[104:107], v[164:179]
    ds_read_b64_tr_b16 v[184:185], v239 offset:57344
    ds_read_b64_tr_b16 v[186:187], v239 offset:57856
    ds_read_b32 v231, v250 offset:768
    s_waitcnt lgkmcnt(11)
    v_mfma_f32_32x32x16_bf16 v[164:179], v[188:191], v[108:111], v[164:179]
    ds_read_b64_tr_b16 v[188:189], v232 offset:16384
    ds_read_b64_tr_b16 v[190:191], v232 offset:16896
    s_waitcnt lgkmcnt(11)
    v_mfma_f32_32x32x16_bf16 v[164:179], v[192:195], v[112:115], v[164:179]
    ds_read_b64_tr_b16 v[192:193], v234 offset:16384
    ds_read_b64_tr_b16 v[194:195], v234 offset:16896
    s_waitcnt lgkmcnt(11)
    v_mfma_f32_16x16x32_bf16 v[220:223], v[224:227], v[196:199], v[220:223]
    v_mfma_f32_32x32x16_bf16 v[164:179], v[196:199], v[116:119], v[164:179]
    ds_read_b64_tr_b16 v[196:197], v236 offset:16384
    ds_read_b64_tr_b16 v[198:199], v236 offset:16896
    s_waitcnt lgkmcnt(11)
    v_mfma_f32_32x32x16_bf16 v[164:179], v[200:203], v[120:123], v[164:179]
    ds_read_b64_tr_b16 v[200:201], v238 offset:16384
    ds_read_b64_tr_b16 v[202:203], v238 offset:16896
    s_waitcnt lgkmcnt(11)
    v_mfma_f32_32x32x16_bf16 v[164:179], v[180:183], v[124:127], v[164:179]
    s_waitcnt lgkmcnt(9)
    v_mfma_f32_32x32x16_bf16 v[164:179], v[184:187], v[128:131], v[164:179]
    s_waitcnt lgkmcnt(6)
    v_mfma_f32_16x16x32_bf16 v[220:223], v[224:227], v[188:191], v[220:223]
    v_mfma_f32_32x32x16_bf16 v[164:179], v[188:191], v[132:135], v[164:179]
    s_nop 6
    v_cvt_pk_bf16_f32 v228, v220, v220
    v_and_b32 v231, s53, v231
    v_and_b32 v229, 0xffff0000, v228
    v_sub_f32 v229, v220, v229
    v_cvt_pk_bf16_f32 v229, v229, v231
    ds_write_b64 v249, v[228:229] offset:2048
    s_waitcnt vmcnt(15)
    s_waitcnt vmcnt(9)
    s_waitcnt vmcnt(3)
    s_waitcnt lgkmcnt(0)
    s_barrier
    ds_read_b128 v[212:215], v241 offset:2048
    v_mfma_f32_32x32x16_bf16 v[164:179], v[192:195], v[136:139], v[164:179]
    v_mfma_f32_32x32x16_bf16 v[164:179], v[196:199], v[140:143], v[164:179]
    v_mfma_f32_32x32x16_bf16 v[164:179], v[200:203], v[144:147], v[164:179]
    s_waitcnt lgkmcnt(0)
    v_mfma_f32_32x32x16_bf16 v[164:179], v[212:215], v[216:219], v[164:179]
    s_setprio 0
    s_cmp_lg_u32 s32, 0
    s_cbranch_scc1 ws_4
    s_mov_b64 exec, 1
    v_mov_b32 v228, 2
    buffer_store_dword v228, off, s[28:31], s14 sc1
    s_mov_b64 exec, -1
ws_4:
    s_add_u32 m0, s47, 0
    s_add_u32 s40, s46, 640
    buffer_load_dwordx4 v240, s[20:23], s40 offen lds
    s_add_u32 m0, s47, 4096
    s_add_u32 s40, s46, 295552
    buffer_load_dwordx4 v240, s[20:23], s40 offen lds
    s_add_u32 m0, s47, 8192
    s_add_u32 s40, s46, 590464
    buffer_load_dwordx4 v240, s[20:23], s40 offen lds
    v_mul_f32 v204, v164, v164
    v_mul_f32 v205, v165, v165
    v_mul_f32 v206, v166, v166
    v_mul_f32 v207, v167, v167
    v_mul_f32 v208, v168, v168
    v_mul_f32 v209, v169, v169
    s_add_u32 m0, s47, 12288
    s_add_u32 s40, s46, 885376
    buffer_load_dwordx4 v240, s[20:23], s40 offen lds
    v_mul_f32 v210, v170, v170
    v_mul_f32 v211, v171, v171
    v_fma_f32 v204, v204, v244, v243
    v_fma_f32 v205, v205, v244, v243
    v_fma_f32 v206, v206, v244, v243
    v_fma_f32 v207, v207, v244, v243
    s_add_u32 m0, s47, 16384
    s_add_u32 s40, s46, 1180288
    buffer_load_dwordx4 v240, s[20:23], s40 offen lds
    v_fma_f32 v208, v208, v244, v243
    v_fma_f32 v209, v209, v244, v243
    v_fma_f32 v210, v210, v244, v243
    v_fma_f32 v211, v211, v244, v243
    v_mul_f32 v204, v204, v164
    v_mul_f32 v205, v205, v165
    s_add_u32 m0, s47, 20480
    s_add_u32 s40, s46, 1475200
    buffer_load_dwordx4 v240, s[20:23], s40 offen lds
    v_mul_f32 v206, v206, v166
    v_mul_f32 v207, v207, v167
    v_mul_f32 v208, v208, v168
    v_mul_f32 v209, v209, v169
    v_mul_f32 v210, v210, v170
    v_mul_f32 v211, v211, v171
    s_add_u32 m0, s47, 24576
    s_add_u32 s40, s46, 1770112
    buffer_load_dwordx4 v240, s[20:23], s40 offen lds
    v_exp_f32 v204, v204
    v_exp_f32 v205, v205
    v_exp_f32 v206, v206
    v_exp_f32 v207, v207
    v_exp_f32 v208, v208
    v_exp_f32 v209, v209
    s_add_u32 m0, s47, 28672
    s_add_u32 s40, s46, 2065024
    buffer_load_dwordx4 v240, s[20:23], s40 offen lds
    v_exp_f32 v210, v210
    v_exp_f32 v211, v211
    v_fma_f32 v204, v204, v245, v245
    v_fma_f32 v205, v205, v245, v245
    v_fma_f32 v206, v206, v245, v245
    v_fma_f32 v207, v207, v245, v245
    s_add_u32 m0, s47, 32768
    s_add_u32 s40, s46, 2359936
    buffer_load_dwordx4 v240, s[20:23], s40 offen lds
    v_fma_f32 v208, v208, v245, v245
    v_fma_f32 v209, v209, v245, v245
    v_fma_f32 v210, v210, v245, v245
    v_fma_f32 v211, v211, v245, v245
    v_rcp_f32 v204, v204
    v_rcp_f32 v205, v205
    s_add_u32 m0, s47, 36864
    s_add_u32 s40, s46, 2654848
    buffer_load_dwordx4 v240, s[20:23], s40 offen lds
    v_rcp_f32 v206, v206
    v_rcp_f32 v207, v207
    v_rcp_f32 v208, v208
    v_rcp_f32 v209, v209
    v_rcp_f32 v210, v210
    v_rcp_f32 v211, v211
    s_add_u32 m0, s47, 40960
    s_add_u32 s40, s46, 2949760
    buffer_load_dwordx4 v240, s[20:23], s40 offen lds
    v_mul_f32 v164, v164, v204
    v_mul_f32 v165, v165, v205
    v_mul_f32 v166, v166, v206
    v_mul_f32 v167, v167, v207
    v_mul_f32 v168, v168, v208
    v_mul_f32 v169, v169, v209
    s_add_u32 m0, s47, 45056
    s_add_u32 s40, s46, 3244672
    buffer_load_dwordx4 v240, s[20:23], s40 offen lds
    v_mul_f32 v170, v170, v210
    v_mul_f32 v171, v171, v211
    v_cvt_pk_bf16_f32 v164, v164, v165
    v_cvt_pk_bf16_f32 v165, v166, v167
    v_cvt_pk_bf16_f32 v166, v168, v169
    v_cvt_pk_bf16_f32 v167, v170, v171
    s_add_u32 m0, s47, 49152
    s_add_u32 s40, s46, 3539584
    buffer_load_dwordx4 v240, s[20:23], s40 offen lds
    v_mul_f32 v204, v172, v172
    v_mul_f32 v205, v173, v173
    v_mul_f32 v206, v174, v174
    v_mul_f32 v207, v175, v175
    v_mul_f32 v208, v176, v176
    v_mul_f32 v209, v177, v177
    s_add_u32 m0, s47, 53248
    s_add_u32 s40, s46, 3834496
    buffer_load_dwordx4 v240, s[20:23], s40 offen lds
    v_mul_f32 v210, v178, v178
    v_mul_f32 v211, v179, v179
    v_fma_f32 v204, v204, v244, v243
    v_fma_f32 v205, v205, v244, v243
    v_fma_f32 v206, v206, v244, v243
    v_fma_f32 v207, v207, v244, v243
    s_add_u32 m0, s47, 57344
    s_add_u32 s40, s46, 4129408
    buffer_load_dwordx4 v240, s[20:23], s40 offen lds
    v_fma_f32 v208, v208, v244, v243
    v_fma_f32 v209, v209, v244, v243
    v_fma_f32 v210, v210, v244, v243
    v_fma_f32 v211, v211, v244, v243
    v_mul_f32 v204, v204, v172
    v_mul_f32 v205, v205, v173
    s_add_u32 m0, s47, 61440
    s_add_u32 s40, s46, 4424320
    buffer_load_dwordx4 v240, s[20:23], s40 offen lds
    v_mul_f32 v206, v206, v174
    v_mul_f32 v207, v207, v175
    v_mul_f32 v208, v208, v176
    v_mul_f32 v209, v209, v177
    v_mul_f32 v210, v210, v178
    v_mul_f32 v211, v211, v179
    s_add_u32 m0, s47, 65536
    s_add_u32 s40, s46, 4719232
    buffer_load_dwordx4 v240, s[20:23], s40 offen lds
    v_exp_f32 v204, v204
    v_exp_f32 v205, v205
    v_exp_f32 v206, v206
    v_exp_f32 v207, v207
    v_exp_f32 v208, v208
    v_exp_f32 v209, v209
    s_add_u32 m0, s47, 69632
    s_add_u32 s40, s46, 5014144
    buffer_load_dwordx4 v240, s[20:23], s40 offen lds
    v_exp_f32 v210, v210
    v_exp_f32 v211, v211
    v_fma_f32 v204, v204, v245, v245
    v_fma_f32 v205, v205, v245, v245
    v_fma_f32 v206, v206, v245, v245
    v_fma_f32 v207, v207, v245, v245
    v_fma_f32 v208, v208, v245, v245
    v_fma_f32 v209, v209, v245, v245
    v_fma_f32 v210, v210, v245, v245
    v_fma_f32 v211, v211, v245, v245
    v_rcp_f32 v204, v204
    v_rcp_f32 v205, v205
    v_rcp_f32 v206, v206
    v_rcp_f32 v207, v207
    v_rcp_f32 v208, v208
    v_rcp_f32 v209, v209
    v_rcp_f32 v210, v210
    v_rcp_f32 v211, v211
    v_add_u32 v233, 0x10000, v233
    ds_read_b64_tr_b16 v[180:181], v233 offset:8192
    ds_read_b64_tr_b16 v[182:183], v233 offset:8704
    v_add_u32 v235, 0x10000, v235
    ds_read_b64_tr_b16 v[184:185], v235 offset:8192
    ds_read_b64_tr_b16 v[186:187], v235 offset:8704
    v_add_u32 v237, 0x10000, v237
    ds_read_b64_tr_b16 v[188:189], v237 offset:8192
    ds_read_b64_tr_b16 v[190:191], v237 offset:8704
    v_add_u32 v239, 0x10000, v239
    ds_read_b64_tr_b16 v[192:193], v239 offset:8192
    ds_read_b64_tr_b16 v[194:195], v239 offset:8704
    ds_read_b64_tr_b16 v[196:197], v233 offset:16384
    ds_read_b64_tr_b16 v[198:199], v233 offset:16896
    v_mul_f32 v172, v172, v204
    v_mul_f32 v173, v173, v205
    v_mul_f32 v174, v174, v206
    v_mul_f32 v175, v175, v207
    v_mul_f32 v176, v176, v208
    v_mul_f32 v177, v177, v209
    v_mul_f32 v178, v178, v210
    v_mul_f32 v179, v179, v211
    v_cvt_pk_bf16_f32 v172, v172, v173
    v_cvt_pk_bf16_f32 v173, v174, v175
    v_cvt_pk_bf16_f32 v174, v176, v177
    v_cvt_pk_bf16_f32 v175, v178, v179
    buffer_store_dwordx4 v[164:167], v242, s[28:31], s48 offen offset:0 sc1
    buffer_store_dwordx4 v[172:175], v242, s[28:31], s48 offen offset:1024 sc1
    s_add_u32 s48, s48, 4096
    buffer_load_dword v247, v248, s[16:19], s55 offen offset:0
    v_min_u32 v248, 384, v248
    buffer_load_dword v247, v248, s[24:27], s54 offen
    s_setprio 1
    ds_read_b64_tr_b16 v[200:201], v235 offset:16384
    ds_read_b64_tr_b16 v[202:203], v235 offset:16896
    s_waitcnt lgkmcnt(10)
    v_mfma_f32_16x16x32_bf16 v[220:223], v[224:227], v[180:183], 0
    v_mfma_f32_32x32x16_bf16 v[148:163], v[180:183], v[4:7], 0
    ds_read_b64_tr_b16 v[180:181], v237 offset:16384
    ds_read_b64_tr_b16 v[182:183], v237 offset:16896
    s_waitcnt lgkmcnt(10)
    v_mfma_f32_32x32x16_bf16 v[148:163], v[184:187], v[8:11], v[148:163]
    ds_read_b64_tr_b16 v[184:185], v239 offset:16384
    ds_read_b64_tr_b16 v[186:187], v239 offset:16896
    s_waitcnt lgkmcnt(10)
    v_mfma_f32_32x32x16_bf16 v[148:163], v[188:191], v[12:15], v[148:163]
    ds_read_b64_tr_b16 v[188:189], v233 offset:24576
    ds_read_b64_tr_b16 v[190:191], v233 offset:25088
    s_waitcnt lgkmcnt(10)
    v_mfma_f32_32x32x16_bf16 v[148:163], v[192:195], v[16:19], v[148:163]
    ds_read_b64_tr_b16 v[192:193], v235 offset:24576
    ds_read_b64_tr_b16 v[194:195], v235 offset:25088
    s_waitcnt lgkmcnt(10)
    v_mfma_f32_16x16x32_bf16 v[220:223], v[224:227], v[196:199], v[220:223]
    v_mfma_f32_32x32x16_bf16 v[148:163], v[196:199], v[20:23], v[148:163]
    ds_read_b64_tr_b16 v[196:197], v237 offset:24576
    ds_read_b64_tr_b16 v[198:199], v237 offset:25088
    s_waitcnt lgkmcnt(10)
    v_mfma_f32_32x32x16_bf16 v[148:163], v[200:203], v[24:27], v[148:163]
    ds_read_b64_tr_b16 v[200:201], v239 offset:24576
    ds_read_b64_tr_b16 v[202:203], v239 offset:25088
    s_waitcnt lgkmcnt(10)
    v_mfma_f32_32x32x16_bf16 v[148:163], v[180:183], v[28:31], v[148:163]
    ds_read_b64_tr_b16 v[180:181], v233 offset:32768
    ds_read_b64_tr_b16 v[182:183], v233 offset:33280
    s_waitcnt lgkmcnt(10)
    v_mfma_f32_32x32x16_bf16 v[148:163], v[184:187], v[32:35], v[148:163]
    ds_read_b64_tr_b16 v[184:185], v235 offset:32768
    ds_read_b64_tr_b16 v[186:187], v235 offset:33280
    s_waitcnt lgkmcnt(10)
    v_mfma_f32_16x16x32_bf16 v[220:223], v[224:227], v[188:191], v[220:223]
    v_mfma_f32_32x32x16_bf16 v[148:163], v[188:191], v[36:39], v[148:163]
    ds_read_b64_tr_b16 v[188:189], v237 offset:32768
    ds_read_b64_tr_b16 v[190:191], v237 offset:33280
    s_waitcnt lgkmcnt(10)
    v_mfma_f32_32x32x16_bf16 v[148:163], v[192:195], v[40:43], v[148:163]
    ds_read_b64_tr_b16 v[192:193], v239 offset:32768
    ds_read_b64_tr_b16 v[194:195], v239 offset:33280
    s_waitcnt lgkmcnt(10)
    v_mfma_f32_32x32x16_bf16 v[148:163], v[196:199], v[44:47], v[148:163]
    ds_read_b64_tr_b16 v[196:197], v233 offset:40960
    ds_read_b64_tr_b16 v[198:199], v233 offset:41472
    s_waitcnt lgkmcnt(10)
    v_mfma_f32_32x32x16_bf16 v[148:163], v[200:203], v[48:51], v[148:163]
    ds_read_b64_tr_b16 v[200:201], v235 offset:40960
    ds_read_b64_tr_b16 v[202:203], v235 offset:41472
    s_waitcnt lgkmcnt(10)
    v_mfma_f32_16x16x32_bf16 v[220:223], v[224:227], v[180:183], v[220:223]
    v_mfma_f32_32x32x16_bf16 v[148:163], v[180:183], v[52:55], v[148:163]
    ds_read_b64_tr_b16 v[180:181], v237 offset:40960
    ds_read_b64_tr_b16 v[182:183], v237 offset:41472
    s_waitcnt lgkmcnt(10)
    v_mfma_f32_32x32x16_bf16 v[148:163], v[184:187], v[56:59], v[148:163]
    ds_read_b64_tr_b16 v[184:185], v239 offset:40960
    ds_read_b64_tr_b16 v[186:187], v239 offset:41472
    s_waitcnt lgkmcnt(10)
    v_mfma_f32_32x32x16_bf16 v[148:163], v[188:191], v[60:63], v[148:163]
    ds_read_b64_tr_b16 v[188:189], v233 offset:49152
    ds_read_b64_tr_b16 v[190:191], v233 offset:49664
    s_waitcnt lgkmcnt(10)
    v_mfma_f32_32x32x16_bf16 v[148:163], v[192:195], v[64:67], v[148:163]
    ds_read_b64_tr_b16 v[192:193], v235 offset:49152
    ds_read_b64_tr_b16 v[194:195], v235 offset:49664
    s_waitcnt lgkmcnt(10)
    v_mfma_f32_16x16x32_bf16 v[220:223], v[224:227], v[196:199], v[220:223]
    v_mfma_f32_32x32x16_bf16 v[148:163], v[196:199], v[68:71], v[148:163]
    ds_read_b64_tr_b16 v[196:197], v237 offset:49152
    ds_read_b64_tr_b16 v[198:199], v237 offset:49664
    s_waitcnt lgkmcnt(10)
    v_mfma_f32_32x32x16_bf16 v[148:163], v[200:203], v[72:75], v[148:163]
    ds_read_b64_tr_b16 v[200:201], v239 offset:49152
    ds_read_b64_tr_b16 v[202:203], v239 offset:49664
    s_waitcnt lgkmcnt(10)
    v_mfma_f32_32x32x16_bf16 v[148:163], v[180:183], v[76:79], v[148:163]
    ds_read_b64_tr_b16 v[180:181], v233 offset:57344
    ds_read_b64_tr_b16 v[182:183], v233 offset:57856
    s_waitcnt lgkmcnt(10)
    v_mfma_f32_32x32x16_bf16 v[148:163], v[184:187], v[80:83], v[148:163]
    ds_read_b64_tr_b16 v[184:185], v235 offset:57344
    ds_read_b64_tr_b16 v[186:187], v235 offset:57856
    s_waitcnt lgkmcnt(10)
    v_mfma_f32_16x16x32_bf16 v[220:223], v[224:227], v[188:191], v[220:223]
    v_mfma_f32_32x32x16_bf16 v[148:163], v[188:191], v[84:87], v[148:163]
    ds_read_b64_tr_b16 v[188:189], v237 offset:57344
    ds_read_b64_tr_b16 v[190:191], v237 offset:57856
    s_waitcnt lgkmcnt(10)
    v_mfma_f32_32x32x16_bf16 v[148:163], v[192:195], v[88:91], v[148:163]
    ds_read_b64_tr_b16 v[192:193], v239 offset:57344
    ds_read_b64_tr_b16 v[194:195], v239 offset:57856
    s_waitcnt lgkmcnt(10)
    v_mfma_f32_32x32x16_bf16 v[148:163], v[196:199], v[92:95], v[148:163]
    ds_read_b64_tr_b16 v[196:197], v232 offset:0
    ds_read_b64_tr_b16 v[198:199], v232 offset:512
    s_waitcnt lgkmcnt(10)
    v_mfma_f32_32x32x16_bf16 v[148:163], v[200:203], v[96:99], v[148:163]
    ds_read_b64_tr_b16 v[200:201], v234 offset:0
    ds_read_b64_tr_b16 v[202:203], v234 offset:512
    s_waitcnt lgkmcnt(10)
    v_mfma_f32_16x16x32_bf16 v[220:223], v[224:227], v[180:183], v[220:223]
    v_mfma_f32_32x32x16_bf16 v[148:163], v[180:183], v[100:103], v[148:163]
    ds_read_b64_tr_b16 v[180:181], v236 offset:0
    ds_read_b64_tr_b16 v[182:183], v236 offset:512
    s_waitcnt lgkmcnt(10)
    v_mfma_f32_32x32x16_bf16 v[148:163], v[184:187], v[104:107], v[148:163]
    ds_read_b64_tr_b16 v[184:185], v238 offset:0
    ds_read_b64_tr_b16 v[186:187], v238 offset:512
    ds_read_b32 v231, v250 offset:1024
    s_waitcnt lgkmcnt(11)
    v_mfma_f32_32x32x16_bf16 v[148:163], v[188:191], v[108:111], v[148:163]
    ds_read_b64_tr_b16 v[188:189], v232 offset:8192
    ds_read_b64_tr_b16 v[190:191], v232 offset:8704
    s_waitcnt lgkmcnt(11)
    v_mfma_f32_32x32x16_bf16 v[148:163], v[192:195], v[112:115], v[148:163]
    ds_read_b64_tr_b16 v[192:193], v234 offset:8192
    ds_read_b64_tr_b16 v[194:195], v234 offset:8704
    s_waitcnt lgkmcnt(11)
    v_mfma_f32_16x16x32_bf16 v[220:223], v[224:227], v[196:199], v[220:223]
    v_mfma_f32_32x32x16_bf16 v[148:163], v[196:199], v[116:119], v[148:163]
    ds_read_b64_tr_b16 v[196:197], v236 offset:8192
    ds_read_b64_tr_b16 v[198:199], v236 offset:8704
    s_waitcnt lgkmcnt(11)
    v_mfma_f32_32x32x16_bf16 v[148:163], v[200:203], v[120:123], v[148:163]
    ds_read_b64_tr_b16 v[200:201], v238 offset:8192
    ds_read_b64_tr_b16 v[202:203], v238 offset:8704
    s_waitcnt lgkmcnt(11)
    v_mfma_f32_32x32x16_bf16 v[148:163], v[180:183], v[124:127], v[148:163]
    s_waitcnt lgkmcnt(9)
    v_mfma_f32_32x32x16_bf16 v[148:163], v[184:187], v[128:131], v[148:163]
    s_waitcnt lgkmcnt(6)
    v_mfma_f32_16x16x32_bf16 v[220:223], v[224:227], v[188:191], v[220:223]
    v_mfma_f32_32x32x16_bf16 v[148:163], v[188:191], v[132:135], v[148:163]
    s_nop 6
    v_cvt_pk_bf16_f32 v228, v220, v220
    v_and_b32 v231, s53, v231
    v_and_b32 v229, 0xffff0000, v228
    v_sub_f32 v229, v220, v229
    v_cvt_pk_bf16_f32 v229, v229, v231
    ds_write_b64 v249, v[228:229] offset:0
    s_waitcnt vmcnt(16)
    s_waitcnt vmcnt(10)
    s_waitcnt vmcnt(4)
    s_waitcnt lgkmcnt(0)
    s_barrier
    ds_read_b128 v[212:215], v241 offset:0
    v_mfma_f32_32x32x16_bf16 v[148:163], v[192:195], v[136:139], v[148:163]
    v_mfma_f32_32x32x16_bf16 v[148:163], v[196:199], v[140:143], v[148:163]
    v_mfma_f32_32x32x16_bf16 v[148:163], v[200:203], v[144:147], v[148:163]
    s_waitcnt lgkmcnt(0)
    v_mfma_f32_32x32x16_bf16 v[148:163], v[212:215], v[216:219], v[148:163]
    s_setprio 0
    s_cmp_lg_u32 s32, 0
    s_cbranch_scc1 ws_5
    s_mov_b64 exec, 1
    v_mov_b32 v228, 3
    buffer_store_dword v228, off, s[28:31], s14 sc1
    s_mov_b64 exec, -1
ws_5:
    s_nop 8
    v_mul_f32 v204, v148, v148
    v_mul_f32 v205, v149, v149
    v_mul_f32 v206, v150, v150
    v_mul_f32 v207, v151, v151
    v_mul_f32 v208, v152, v152
    v_mul_f32 v209, v153, v153
    v_mul_f32 v210, v154, v154
    v_mul_f32 v211, v155, v155
    v_fma_f32 v204, v204, v244, v243
    v_fma_f32 v205, v205, v244, v243
    v_fma_f32 v206, v206, v244, v243
    v_fma_f32 v207, v207, v244, v243
    v_fma_f32 v208, v208, v244, v243
    v_fma_f32 v209, v209, v244, v243
    v_fma_f32 v210, v210, v244, v243
    v_fma_f32 v211, v211, v244, v243
    v_mul_f32 v204, v204, v148
    v_mul_f32 v205, v205, v149
    v_mul_f32 v206, v206, v150
    v_mul_f32 v207, v207, v151
    v_mul_f32 v208, v208, v152
    v_mul_f32 v209, v209, v153
    v_mul_f32 v210, v210, v154
    v_mul_f32 v211, v211, v155
    v_exp_f32 v204, v204
    v_exp_f32 v205, v205
    v_exp_f32 v206, v206
    v_exp_f32 v207, v207
    v_exp_f32 v208, v208
    v_exp_f32 v209, v209
    v_exp_f32 v210, v210
    v_exp_f32 v211, v211
    v_fma_f32 v204, v204, v245, v245
    v_fma_f32 v205, v205, v245, v245
    v_fma_f32 v206, v206, v245, v245
    v_fma_f32 v207, v207, v245, v245
    v_fma_f32 v208, v208, v245, v245
    v_fma_f32 v209, v209, v245, v245
    v_fma_f32 v210, v210, v245, v245
    v_fma_f32 v211, v211, v245, v245
    v_rcp_f32 v204, v204
    v_rcp_f32 v205, v205
    v_rcp_f32 v206, v206
    v_rcp_f32 v207, v207
    v_rcp_f32 v208, v208
    v_rcp_f32 v209, v209
    v_rcp_f32 v210, v210
    v_rcp_f32 v211, v211
    v_mul_f32 v148, v148, v204
    v_mul_f32 v149, v149, v205
    v_mul_f32 v150, v150, v206
    v_mul_f32 v151, v151, v207
    v_mul_f32 v152, v152, v208
    v_mul_f32 v153, v153, v209
    v_mul_f32 v154, v154, v210
    v_mul_f32 v155, v155, v211
    v_cvt_pk_bf16_f32 v148, v148, v149
    v_cvt_pk_bf16_f32 v149, v150, v151
    v_cvt_pk_bf16_f32 v150, v152, v153
    v_cvt_pk_bf16_f32 v151, v154, v155
    buffer_store_dwordx4 v[148:151], v242, s[28:31], s48 offen offset:0 sc1
    v_mul_f32 v204, v156, v156
    v_mul_f32 v205, v157, v157
    v_mul_f32 v206, v158, v158
    v_mul_f32 v207, v159, v159
    v_mul_f32 v208, v160, v160
    v_mul_f32 v209, v161, v161
    v_mul_f32 v210, v162, v162
    v_mul_f32 v211, v163, v163
    v_fma_f32 v204, v204, v244, v243
    v_fma_f32 v205, v205, v244, v243
    v_fma_f32 v206, v206, v244, v243
    v_fma_f32 v207, v207, v244, v243
    v_fma_f32 v208, v208, v244, v243
    v_fma_f32 v209, v209, v244, v243
    v_fma_f32 v210, v210, v244, v243
    v_fma_f32 v211, v211, v244, v243
    v_mul_f32 v204, v204, v156
    v_mul_f32 v205, v205, v157
    v_mul_f32 v206, v206, v158
    v_mul_f32 v207, v207, v159
    v_mul_f32 v208, v208, v160
    v_mul_f32 v209, v209, v161
    v_mul_f32 v210, v210, v162
    v_mul_f32 v211, v211, v163
    v_exp_f32 v204, v204
    v_exp_f32 v205, v205
    v_exp_f32 v206, v206
    v_exp_f32 v207, v207
    v_exp_f32 v208, v208
    v_exp_f32 v209, v209
    v_exp_f32 v210, v210
    v_exp_f32 v211, v211
    v_fma_f32 v204, v204, v245, v245
    v_fma_f32 v205, v205, v245, v245
    v_fma_f32 v206, v206, v245, v245
    v_fma_f32 v207, v207, v245, v245
    v_fma_f32 v208, v208, v245, v245
    v_fma_f32 v209, v209, v245, v245
    v_fma_f32 v210, v210, v245, v245
    v_fma_f32 v211, v211, v245, v245
    v_rcp_f32 v204, v204
    v_rcp_f32 v205, v205
    v_rcp_f32 v206, v206
    v_rcp_f32 v207, v207
    v_rcp_f32 v208, v208
    v_rcp_f32 v209, v209
    v_rcp_f32 v210, v210
    v_rcp_f32 v211, v211
    v_mul_f32 v156, v156, v204
    v_mul_f32 v157, v157, v205
    v_add_u32 v233, 0xffff0000, v233
    ds_read_b64_tr_b16 v[180:181], v233 offset:0
    ds_read_b64_tr_b16 v[182:183], v233 offset:512
    v_add_u32 v235, 0xffff0000, v235
    ds_read_b64_tr_b16 v[184:185], v235 offset:0
    ds_read_b64_tr_b16 v[186:187], v235 offset:512
    v_add_u32 v237, 0xffff0000, v237
    ds_read_b64_tr_b16 v[188:189], v237 offset:0
    ds_read_b64_tr_b16 v[190:191], v237 offset:512
    v_add_u32 v239, 0xffff0000, v239
    ds_read_b64_tr_b16 v[192:193], v239 offset:0
    ds_read_b64_tr_b16 v[194:195], v239 offset:512
    ds_read_b64_tr_b16 v[196:197], v233 offset:8192
    ds_read_b64_tr_b16 v[198:199], v233 offset:8704
    v_mul_f32 v158, v158, v206
    v_mul_f32 v159, v159, v207
    v_mul_f32 v160, v160, v208
    v_mul_f32 v161, v161, v209
    v_mul_f32 v162, v162, v210
    v_mul_f32 v163, v163, v211
    v_cvt_pk_bf16_f32 v156, v156, v157
    v_cvt_pk_bf16_f32 v157, v158, v159
    v_cvt_pk_bf16_f32 v158, v160, v161
    v_cvt_pk_bf16_f32 v159, v162, v163
    buffer_store_dwordx4 v[156:159], v242, s[28:31], s48 offen offset:1024 sc1
    s_add_u32 s48, s48, 4096
    s_barrier
    s_setprio 1
    ds_read_b64_tr_b16 v[200:201], v235 offset:8192
    ds_read_b64_tr_b16 v[202:203], v235 offset:8704
    s_waitcnt lgkmcnt(10)
    v_mfma_f32_16x16x32_bf16 v[220:223], v[224:227], v[180:183], 0
    v_mfma_f32_32x32x16_bf16 v[164:179], v[180:183], v[4:7], 0
    ds_read_b64_tr_b16 v[180:181], v237 offset:8192
    ds_read_b64_tr_b16 v[182:183], v237 offset:8704
    s_waitcnt lgkmcnt(10)
    v_mfma_f32_32x32x16_bf16 v[164:179], v[184:187], v[8:11], v[164:179]
    ds_read_b64_tr_b16 v[184:185], v239 offset:8192
    ds_read_b64_tr_b16 v[186:187], v239 offset:8704
    s_waitcnt lgkmcnt(10)
    v_mfma_f32_32x32x16_bf16 v[164:179], v[188:191], v[12:15], v[164:179]
    ds_read_b64_tr_b16 v[188:189], v233 offset:16384
    ds_read_b64_tr_b16 v[190:191], v233 offset:16896
    s_waitcnt lgkmcnt(10)
    v_mfma_f32_32x32x16_bf16 v[164:179], v[192:195], v[16:19], v[164:179]
    ds_read_b64_tr_b16 v[192:193], v235 offset:16384
    ds_read_b64_tr_b16 v[194:195], v235 offset:16896
    s_waitcnt lgkmcnt(10)
    v_mfma_f32_16x16x32_bf16 v[220:223], v[224:227], v[196:199], v[220:223]
    v_mfma_f32_32x32x16_bf16 v[164:179], v[196:199], v[20:23], v[164:179]
    ds_read_b64_tr_b16 v[196:197], v237 offset:16384
    ds_read_b64_tr_b16 v[198:199], v237 offset:16896
    s_waitcnt lgkmcnt(10)
    v_mfma_f32_32x32x16_bf16 v[164:179], v[200:203], v[24:27], v[164:179]
    ds_read_b64_tr_b16 v[200:201], v239 offset:16384
    ds_read_b64_tr_b16 v[202:203], v239 offset:16896
    s_waitcnt lgkmcnt(10)
    v_mfma_f32_32x32x16_bf16 v[164:179], v[180:183], v[28:31], v[164:179]
    ds_read_b64_tr_b16 v[180:181], v233 offset:24576
    ds_read_b64_tr_b16 v[182:183], v233 offset:25088
    s_waitcnt lgkmcnt(10)
    v_mfma_f32_32x32x16_bf16 v[164:179], v[184:187], v[32:35], v[164:179]
    ds_read_b64_tr_b16 v[184:185], v235 offset:24576
    ds_read_b64_tr_b16 v[186:187], v235 offset:25088
    s_waitcnt lgkmcnt(10)
    v_mfma_f32_16x16x32_bf16 v[220:223], v[224:227], v[188:191], v[220:223]
    v_mfma_f32_32x32x16_bf16 v[164:179], v[188:191], v[36:39], v[164:179]
    ds_read_b64_tr_b16 v[188:189], v237 offset:24576
    ds_read_b64_tr_b16 v[190:191], v237 offset:25088
    s_waitcnt lgkmcnt(10)
    v_mfma_f32_32x32x16_bf16 v[164:179], v[192:195], v[40:43], v[164:179]
    ds_read_b64_tr_b16 v[192:193], v239 offset:24576
    ds_read_b64_tr_b16 v[194:195], v239 offset:25088
    s_waitcnt lgkmcnt(10)
    v_mfma_f32_32x32x16_bf16 v[164:179], v[196:199], v[44:47], v[164:179]
    ds_read_b64_tr_b16 v[196:197], v233 offset:32768
    ds_read_b64_tr_b16 v[198:199], v233 offset:33280
    s_waitcnt lgkmcnt(10)
    v_mfma_f32_32x32x16_bf16 v[164:179], v[200:203], v[48:51], v[164:179]
    ds_read_b64_tr_b16 v[200:201], v235 offset:32768
    ds_read_b64_tr_b16 v[202:203], v235 offset:33280
    s_waitcnt lgkmcnt(10)
    v_mfma_f32_16x16x32_bf16 v[220:223], v[224:227], v[180:183], v[220:223]
    v_mfma_f32_32x32x16_bf16 v[164:179], v[180:183], v[52:55], v[164:179]
    ds_read_b64_tr_b16 v[180:181], v237 offset:32768
    ds_read_b64_tr_b16 v[182:183], v237 offset:33280
    s_waitcnt lgkmcnt(10)
    v_mfma_f32_32x32x16_bf16 v[164:179], v[184:187], v[56:59], v[164:179]
    ds_read_b64_tr_b16 v[184:185], v239 offset:32768
    ds_read_b64_tr_b16 v[186:187], v239 offset:33280
    s_waitcnt lgkmcnt(10)
    v_mfma_f32_32x32x16_bf16 v[164:179], v[188:191], v[60:63], v[164:179]
    ds_read_b64_tr_b16 v[188:189], v233 offset:40960
    ds_read_b64_tr_b16 v[190:191], v233 offset:41472
    s_waitcnt lgkmcnt(10)
    v_mfma_f32_32x32x16_bf16 v[164:179], v[192:195], v[64:67], v[164:179]
    ds_read_b64_tr_b16 v[192:193], v235 offset:40960
    ds_read_b64_tr_b16 v[194:195], v235 offset:41472
    s_waitcnt lgkmcnt(10)
    v_mfma_f32_16x16x32_bf16 v[220:223], v[224:227], v[196:199], v[220:223]
    v_mfma_f32_32x32x16_bf16 v[164:179], v[196:199], v[68:71], v[164:179]
    ds_read_b64_tr_b16 v[196:197], v237 offset:40960
    ds_read_b64_tr_b16 v[198:199], v237 offset:41472
    s_waitcnt lgkmcnt(10)
    v_mfma_f32_32x32x16_bf16 v[164:179], v[200:203], v[72:75], v[164:179]
    ds_read_b64_tr_b16 v[200:201], v239 offset:40960
    ds_read_b64_tr_b16 v[202:203], v239 offset:41472
    s_waitcnt lgkmcnt(10)
    v_mfma_f32_32x32x16_bf16 v[164:179], v[180:183], v[76:79], v[164:179]
    ds_read_b64_tr_b16 v[180:181], v233 offset:49152
    ds_read_b64_tr_b16 v[182:183], v233 offset:49664
    s_waitcnt lgkmcnt(10)
    v_mfma_f32_32x32x16_bf16 v[164:179], v[184:187], v[80:83], v[164:179]
    ds_read_b64_tr_b16 v[184:185], v235 offset:49152
    ds_read_b64_tr_b16 v[186:187], v235 offset:49664
    s_waitcnt lgkmcnt(10)
    v_mfma_f32_16x16x32_bf16 v[220:223], v[224:227], v[188:191], v[220:223]
    v_mfma_f32_32x32x16_bf16 v[164:179], v[188:191], v[84:87], v[164:179]
    ds_read_b64_tr_b16 v[188:189], v237 offset:49152
    ds_read_b64_tr_b16 v[190:191], v237 offset:49664
    s_waitcnt lgkmcnt(10)
    v_mfma_f32_32x32x16_bf16 v[164:179], v[192:195], v[88:91], v[164:179]
    ds_read_b64_tr_b16 v[192:193], v239 offset:49152
    ds_read_b64_tr_b16 v[194:195], v239 offset:49664
    s_waitcnt lgkmcnt(10)
    v_mfma_f32_32x32x16_bf16 v[164:179], v[196:199], v[92:95], v[164:179]
    ds_read_b64_tr_b16 v[196:197], v233 offset:57344
    ds_read_b64_tr_b16 v[198:199], v233 offset:57856
    s_waitcnt lgkmcnt(10)
    v_mfma_f32_32x32x16_bf16 v[164:179], v[200:203], v[96:99], v[164:179]
    ds_read_b64_tr_b16 v[200:201], v235 offset:57344
    ds_read_b64_tr_b16 v[202:203], v235 offset:57856
    s_waitcnt lgkmcnt(10)
    v_mfma_f32_16x16x32_bf16 v[220:223], v[224:227], v[180:183], v[220:223]
    v_mfma_f32_32x32x16_bf16 v[164:179], v[180:183], v[100:103], v[164:179]
    ds_read_b64_tr_b16 v[180:181], v237 offset:57344
    ds_read_b64_tr_b16 v[182:183], v237 offset:57856
    s_waitcnt lgkmcnt(10)
    v_mfma_f32_32x32x16_bf16 v[164:179], v[184:187], v[104:107], v[164:179]
    ds_read_b64_tr_b16 v[184:185], v239 offset:57344
    ds_read_b64_tr_b16 v[186:187], v239 offset:57856
    ds_read_b32 v231, v250 offset:1280
    s_waitcnt lgkmcnt(11)
    v_mfma_f32_32x32x16_bf16 v[164:179], v[188:191], v[108:111], v[164:179]
    v_add_u32 v232, 0xffff0000, v232
    ds_read_b64_tr_b16 v[188:189], v232 offset:0
    ds_read_b64_tr_b16 v[190:191], v232 offset:512
    s_waitcnt lgkmcnt(11)
    v_mfma_f32_32x32x16_bf16 v[164:179], v[192:195], v[112:115], v[164:179]
    v_add_u32 v234, 0xffff0000, v234
    ds_read_b64_tr_b16 v[192:193], v234 offset:0
    ds_read_b64_tr_b16 v[194:195], v234 offset:512
    s_waitcnt lgkmcnt(11)
    v_mfma_f32_16x16x32_bf16 v[220:223], v[224:227], v[196:199], v[220:223]
    v_mfma_f32_32x32x16_bf16 v[164:179], v[196:199], v[116:119], v[164:179]
    v_add_u32 v236, 0xffff0000, v236
    ds_read_b64_tr_b16 v[196:197], v236 offset:0
    ds_read_b64_tr_b16 v[198:199], v236 offset:512
    s_waitcnt lgkmcnt(11)
    v_mfma_f32_32x32x16_bf16 v[164:179], v[200:203], v[120:123], v[164:179]
    v_add_u32 v238, 0xffff0000, v238
    ds_read_b64_tr_b16 v[200:201], v238 offset:0
    ds_read_b64_tr_b16 v[202:203], v238 offset:512
    s_waitcnt lgkmcnt(11)
    v_mfma_f32_32x32x16_bf16 v[164:179], v[180:183], v[124:127], v[164:179]
    s_waitcnt lgkmcnt(9)
    v_mfma_f32_32x32x16_bf16 v[164:179], v[184:187], v[128:131], v[164:179]
    s_waitcnt lgkmcnt(6)
    v_mfma_f32_16x16x32_bf16 v[220:223], v[224:227], v[188:191], v[220:223]
    v_mfma_f32_32x32x16_bf16 v[164:179], v[188:191], v[132:135], v[164:179]
    s_nop 6
    v_cvt_pk_bf16_f32 v228, v220, v220
    v_and_b32 v231, s53, v231
    v_and_b32 v229, 0xffff0000, v228
    v_sub_f32 v229, v220, v229
    v_cvt_pk_bf16_f32 v229, v229, v231
    ds_write_b64 v249, v[228:229] offset:2048
    v_mov_b32 v230, 163328
    v_mov_b32 v231, 1
    s_waitcnt lgkmcnt(0)
    s_mov_b64 exec, 1
    ds_add_u32 v230, v231 offset:4
    s_mov_b64 exec, -1
    ds_read_b32 v228, v230 offset:4
    v_mfma_f32_32x32x16_bf16 v[164:179], v[192:195], v[136:139], v[164:179]
    v_mfma_f32_32x32x16_bf16 v[164:179], v[196:199], v[140:143], v[164:179]
    v_mfma_f32_32x32x16_bf16 v[164:179], v[200:203], v[144:147], v[164:179]
    s_waitcnt lgkmcnt(0)
    v_readfirstlane_b32 s42, v228
    s_nop 3
    s_cmp_ge_u32 s42, 4
    s_cbranch_scc1 lr_7
    s_mov_b32 s15, 0x80000
lw_6:
    s_sub_u32 s15, s15, 1
    s_cbranch_scc1 lr_7
    ds_read_b32 v228, v230 offset:4
    s_waitcnt lgkmcnt(0)
    v_readfirstlane_b32 s42, v228
    s_nop 3
    s_cmp_ge_u32 s42, 4
    s_cbranch_scc0 lw_6
lr_7:
    ds_read_b128 v[212:215], v241 offset:2048
    s_waitcnt lgkmcnt(0)
    v_mfma_f32_32x32x16_bf16 v[164:179], v[212:215], v[216:219], v[164:179]
    s_setprio 0
    v_and_b32 v230, 63, v0
    v_min_u32 v229, 11, v230
    v_lshrrev_b32 v231, 2, v229
    s_sub_u32 s40, s36, 2
    v_add_u32 v231, s40, v231
    v_max_i32 v231, 0, v231
    v_and_b32 v229, 3, v229
    v_lshlrev_b32 v231, 9, v231
    v_lshl_add_u32 v231, v229, 7, v231
    v_add_u32 v231, 0x2d6000c, v231
    v_lshlrev_b32 v230, 2, v230
    buffer_load_dword v253, v230, s[4:7], 0 offen sc1
    buffer_load_dword v254, v231, s[28:31], 0 offen sc1
    v_mul_f32 v204, v164, v164
    v_mul_f32 v205, v165, v165
    v_mul_f32 v206, v166, v166
    v_mul_f32 v207, v167, v167
    v_mul_f32 v208, v168, v168
    v_mul_f32 v209, v169, v169
    v_mul_f32 v210, v170, v170
    v_mul_f32 v211, v171, v171
    v_fma_f32 v204, v204, v244, v243
    v_fma_f32 v205, v205, v244, v243
    v_fma_f32 v206, v206, v244, v243
    v_fma_f32 v207, v207, v244, v243
    v_fma_f32 v208, v208, v244, v243
    v_fma_f32 v209, v209, v244, v243
    v_fma_f32 v210, v210, v244, v243
    v_fma_f32 v211, v211, v244, v243
    v_mul_f32 v204, v204, v164
    v_mul_f32 v205, v205, v165
    v_mul_f32 v206, v206, v166
    v_mul_f32 v207, v207, v167
    v_mul_f32 v208, v208, v168
    v_mul_f32 v209, v209, v169
    v_mul_f32 v210, v210, v170
    v_mul_f32 v211, v211, v171
    v_exp_f32 v204, v204
    v_exp_f32 v205, v205
    v_exp_f32 v206, v206
    v_exp_f32 v207, v207
    v_exp_f32 v208, v208
    v_exp_f32 v209, v209
    v_exp_f32 v210, v210
    v_exp_f32 v211, v211
    v_fma_f32 v204, v204, v245, v245
    v_fma_f32 v205, v205, v245, v245
    v_fma_f32 v206, v206, v245, v245
    v_fma_f32 v207, v207, v245, v245
    v_fma_f32 v208, v208, v245, v245
    v_fma_f32 v209, v209, v245, v245
    v_fma_f32 v210, v210, v245, v245
    v_fma_f32 v211, v211, v245, v245
    v_rcp_f32 v204, v204
    v_rcp_f32 v205, v205
    v_rcp_f32 v206, v206
    v_rcp_f32 v207, v207
    v_rcp_f32 v208, v208
    v_rcp_f32 v209, v209
    v_rcp_f32 v210, v210
    v_rcp_f32 v211, v211
    v_mul_f32 v164, v164, v204
    v_mul_f32 v165, v165, v205
    v_mul_f32 v166, v166, v206
    v_mul_f32 v167, v167, v207
    v_mul_f32 v168, v168, v208
    v_mul_f32 v169, v169, v209
    v_mul_f32 v170, v170, v210
    v_mul_f32 v171, v171, v211
    v_cvt_pk_bf16_f32 v164, v164, v165
    v_cvt_pk_bf16_f32 v165, v166, v167
    v_cvt_pk_bf16_f32 v166, v168, v169
    v_cvt_pk_bf16_f32 v167, v170, v171
    buffer_store_dwordx4 v[164:167], v242, s[28:31], s48 offen offset:0 sc1
    v_mul_f32 v204, v172, v172
    v_mul_f32 v205, v173, v173
    v_mul_f32 v206, v174, v174
    v_mul_f32 v207, v175, v175
    v_mul_f32 v208, v176, v176
    v_mul_f32 v209, v177, v177
    v_mul_f32 v210, v178, v178
    v_mul_f32 v211, v179, v179
    v_fma_f32 v204, v204, v244, v243
    v_fma_f32 v205, v205, v244, v243
    v_fma_f32 v206, v206, v244, v243
    v_fma_f32 v207, v207, v244, v243
    v_fma_f32 v208, v208, v244, v243
    v_fma_f32 v209, v209, v244, v243
    v_fma_f32 v210, v210, v244, v243
    v_fma_f32 v211, v211, v244, v243
    v_mul_f32 v204, v204, v172
    v_mul_f32 v205, v205, v173
    v_mul_f32 v206, v206, v174
    v_mul_f32 v207, v207, v175
    v_mul_f32 v208, v208, v176
    v_mul_f32 v209, v209, v177
    v_mul_f32 v210, v210, v178
    v_mul_f32 v211, v211, v179
    v_exp_f32 v204, v204
    v_exp_f32 v205, v205
    v_exp_f32 v206, v206
    v_exp_f32 v207, v207
    v_exp_f32 v208, v208
    v_exp_f32 v209, v209
    v_exp_f32 v210, v210
    v_exp_f32 v211, v211
    v_fma_f32 v204, v204, v245, v245
    v_fma_f32 v205, v205, v245, v245
    v_fma_f32 v206, v206, v245, v245
    v_fma_f32 v207, v207, v245, v245
    v_fma_f32 v208, v208, v245, v245
    v_fma_f32 v209, v209, v245, v245
    v_fma_f32 v210, v210, v245, v245
    v_fma_f32 v211, v211, v245, v245
    v_rcp_f32 v204, v204
    v_rcp_f32 v205, v205
    v_rcp_f32 v206, v206
    v_rcp_f32 v207, v207
    v_rcp_f32 v208, v208
    v_rcp_f32 v209, v209
    v_rcp_f32 v210, v210
    v_rcp_f32 v211, v211
    v_mul_f32 v172, v172, v204
    v_mul_f32 v173, v173, v205
    v_mul_f32 v174, v174, v206
    v_mul_f32 v175, v175, v207
    v_mul_f32 v176, v176, v208
    v_mul_f32 v177, v177, v209
    v_mul_f32 v178, v178, v210
    v_mul_f32 v179, v179, v211
    v_cvt_pk_bf16_f32 v172, v172, v173
    v_cvt_pk_bf16_f32 v173, v174, v175
    v_cvt_pk_bf16_f32 v174, v176, v177
    v_cvt_pk_bf16_f32 v175, v178, v179
    buffer_store_dwordx4 v[172:175], v242, s[28:31], s48 offen offset:1024 sc1
    s_add_u32 s48, s48, 4096
    s_branch p2_attn
p1_mlp_r1:
    s_setprio 2
    ds_read_b64_tr_b16 v[180:181], v233 offset:0
    ds_read_b64_tr_b16 v[182:183], v233 offset:512
    ds_read_b64_tr_b16 v[184:185], v235 offset:0
    ds_read_b64_tr_b16 v[186:187], v235 offset:512
    ds_read_b64_tr_b16 v[188:189], v237 offset:0
    ds_read_b64_tr_b16 v[190:191], v237 offset:512
    ds_read_b64_tr_b16 v[192:193], v239 offset:0
    ds_read_b64_tr_b16 v[194:195], v239 offset:512
    ds_read_b64_tr_b16 v[196:197], v233 offset:8192
    ds_read_b64_tr_b16 v[198:199], v233 offset:8704
    ds_read_b128 v[212:215], v241 offset:2048
    ds_read_b64_tr_b16 v[200:201], v235 offset:8192
    ds_read_b64_tr_b16 v[202:203], v235 offset:8704
    s_waitcnt lgkmcnt(11)
    v_mfma_f32_16x16x32_bf16 v[220:223], v[224:227], v[180:183], 0
    v_mfma_f32_32x32x16_bf16 v[148:163], v[180:183], v[4:7], 0
    ds_read_b64_tr_b16 v[180:181], v237 offset:8192
    ds_read_b64_tr_b16 v[182:183], v237 offset:8704
    s_waitcnt lgkmcnt(11)
    v_mfma_f32_32x32x16_bf16 v[148:163], v[184:187], v[8:11], v[148:163]
    ds_read_b64_tr_b16 v[184:185], v239 offset:8192
    ds_read_b64_tr_b16 v[186:187], v239 offset:8704
    s_waitcnt lgkmcnt(11)
    v_mfma_f32_32x32x16_bf16 v[148:163], v[188:191], v[12:15], v[148:163]
    s_waitcnt lgkmcnt(6)
    v_mfma_f32_32x32x16_bf16 v[164:179], v[212:215], v[216:219], v[164:179]
    ds_read_b64_tr_b16 v[188:189], v233 offset:24576
    ds_read_b64_tr_b16 v[190:191], v233 offset:25088
    v_mfma_f32_32x32x16_bf16 v[148:163], v[192:195], v[16:19], v[148:163]
    ds_read_b64_tr_b16 v[192:193], v235 offset:24576
    ds_read_b64_tr_b16 v[194:195], v235 offset:25088
    v_mfma_f32_16x16x32_bf16 v[220:223], v[224:227], v[196:199], v[220:223]
    v_mfma_f32_32x32x16_bf16 v[148:163], v[196:199], v[20:23], v[148:163]
    ds_read_b64_tr_b16 v[196:197], v237 offset:24576
    ds_read_b64_tr_b16 v[198:199], v237 offset:25088
    s_waitcnt lgkmcnt(10)
    v_mfma_f32_32x32x16_bf16 v[148:163], v[200:203], v[24:27], v[148:163]
    ds_read_b64_tr_b16 v[200:201], v239 offset:24576
    ds_read_b64_tr_b16 v[202:203], v239 offset:25088
    s_waitcnt lgkmcnt(10)
    v_mfma_f32_32x32x16_bf16 v[148:163], v[180:183], v[28:31], v[148:163]
    ds_read_b64_tr_b16 v[180:181], v233 offset:32768
    ds_read_b64_tr_b16 v[182:183], v233 offset:33280
    s_waitcnt lgkmcnt(10)
    v_mfma_f32_32x32x16_bf16 v[148:163], v[184:187], v[32:35], v[148:163]
    ds_read_b64_tr_b16 v[184:185], v235 offset:32768
    ds_read_b64_tr_b16 v[186:187], v235 offset:33280
    s_waitcnt lgkmcnt(10)
    v_mfma_f32_16x16x32_bf16 v[220:223], v[224:227], v[188:191], v[220:223]
    v_mfma_f32_32x32x16_bf16 v[148:163], v[188:191], v[36:39], v[148:163]
    ds_read_b64_tr_b16 v[188:189], v237 offset:32768
    ds_read_b64_tr_b16 v[190:191], v237 offset:33280
    s_waitcnt lgkmcnt(10)
    v_mfma_f32_32x32x16_bf16 v[148:163], v[192:195], v[40:43], v[148:163]
    ds_read_b64_tr_b16 v[192:193], v239 offset:32768
    ds_read_b64_tr_b16 v[194:195], v239 offset:33280
    s_waitcnt lgkmcnt(10)
    v_mfma_f32_32x32x16_bf16 v[148:163], v[196:199], v[44:47], v[148:163]
    ds_read_b64_tr_b16 v[196:197], v233 offset:40960
    ds_read_b64_tr_b16 v[198:199], v233 offset:41472
    s_waitcnt lgkmcnt(10)
    v_mfma_f32_32x32x16_bf16 v[148:163], v[200:203], v[48:51], v[148:163]
    ds_read_b64_tr_b16 v[200:201], v235 offset:40960
    ds_read_b64_tr_b16 v[202:203], v235 offset:41472
    s_waitcnt lgkmcnt(10)
    v_mfma_f32_16x16x32_bf16 v[220:223], v[224:227], v[180:183], v[220:223]
    v_mfma_f32_32x32x16_bf16 v[148:163], v[180:183], v[52:55], v[148:163]
    ds_read_b64_tr_b16 v[180:181], v237 offset:40960
    ds_read_b64_tr_b16 v[182:183], v237 offset:41472
    s_waitcnt lgkmcnt(10)
    v_mfma_f32_32x32x16_bf16 v[148:163], v[184:187], v[56:59], v[148:163]
    ds_read_b64_tr_b16 v[184:185], v239 offset:40960
    ds_read_b64_tr_b16 v[186:187], v239 offset:41472
    s_waitcnt lgkmcnt(10)
    v_mfma_f32_32x32x16_bf16 v[148:163], v[188:191], v[60:63], v[148:163]
    ds_read_b64_tr_b16 v[188:189], v233 offset:49152
    ds_read_b64_tr_b16 v[190:191], v233 offset:49664
    s_waitcnt lgkmcnt(10)
    v_mfma_f32_32x32x16_bf16 v[148:163], v[192:195], v[64:67], v[148:163]
    ds_read_b64_tr_b16 v[192:193], v235 offset:49152
    ds_read_b64_tr_b16 v[194:195], v235 offset:49664
    s_waitcnt lgkmcnt(10)
    v_mfma_f32_16x16x32_bf16 v[220:223], v[224:227], v[196:199], v[220:223]
    v_mfma_f32_32x32x16_bf16 v[148:163], v[196:199], v[68:71], v[148:163]
    ds_read_b64_tr_b16 v[196:197], v237 offset:49152
    ds_read_b64_tr_b16 v[198:199], v237 offset:49664
    s_waitcnt lgkmcnt(10)
    v_mfma_f32_32x32x16_bf16 v[148:163], v[200:203], v[72:75], v[148:163]
    ds_read_b64_tr_b16 v[200:201], v239 offset:49152
    ds_read_b64_tr_b16 v[202:203], v239 offset:49664
    s_waitcnt lgkmcnt(10)
    v_mfma_f32_32x32x16_bf16 v[148:163], v[180:183], v[76:79], v[148:163]
    ds_read_b64_tr_b16 v[180:181], v233 offset:57344
    ds_read_b64_tr_b16 v[182:183], v233 offset:57856
    s_waitcnt lgkmcnt(10)
    v_mfma_f32_32x32x16_bf16 v[148:163], v[184:187], v[80:83], v[148:163]
    ds_read_b64_tr_b16 v[184:185], v235 offset:57344
    ds_read_b64_tr_b16 v[186:187], v235 offset:57856
    s_waitcnt lgkmcnt(10)
    v_mfma_f32_16x16x32_bf16 v[220:223], v[224:227], v[188:191], v[220:223]
    v_mfma_f32_32x32x16_bf16 v[148:163], v[188:191], v[84:87], v[148:163]
    ds_read_b64_tr_b16 v[188:189], v237 offset:57344
    ds_read_b64_tr_b16 v[190:191], v237 offset:57856
    s_waitcnt lgkmcnt(10)
    v_mfma_f32_32x32x16_bf16 v[148:163], v[192:195], v[88:91], v[148:163]
    ds_read_b64_tr_b16 v[192:193], v239 offset:57344
    ds_read_b64_tr_b16 v[194:195], v239 offset:57856
    s_waitcnt lgkmcnt(10)
    v_mfma_f32_32x32x16_bf16 v[148:163], v[196:199], v[92:95], v[148:163]
    v_add_u32 v232, 0x20000, v232
    ds_read_b64_tr_b16 v[196:197], v232 offset:0
    ds_read_b64_tr_b16 v[198:199], v232 offset:512
    s_waitcnt lgkmcnt(10)
    v_mfma_f32_32x32x16_bf16 v[148:163], v[200:203], v[96:99], v[148:163]
    v_add_u32 v234, 0x20000, v234
    ds_read_b64_tr_b16 v[200:201], v234 offset:0
    ds_read_b64_tr_b16 v[202:203], v234 offset:512
    s_waitcnt lgkmcnt(10)
    v_mfma_f32_16x16x32_bf16 v[220:223], v[224:227], v[180:183], v[220:223]
    v_mfma_f32_32x32x16_bf16 v[148:163], v[180:183], v[100:103], v[148:163]
    v_add_u32 v236, 0x20000, v236
    ds_read_b64_tr_b16 v[180:181], v236 offset:0
    ds_read_b64_tr_b16 v[182:183], v236 offset:512
    s_waitcnt lgkmcnt(10)
    v_mfma_f32_32x32x16_bf16 v[148:163], v[184:187], v[104:107], v[148:163]
    v_add_u32 v238, 0x20000, v238
    ds_read_b64_tr_b16 v[184:185], v238 offset:0
    ds_read_b64_tr_b16 v[186:187], v238 offset:512
    ds_read_b32 v231, v250 offset:512
    s_waitcnt lgkmcnt(11)
    v_mfma_f32_32x32x16_bf16 v[148:163], v[188:191], v[108:111], v[148:163]
    ds_read_b64_tr_b16 v[188:189], v232 offset:8192
    ds_read_b64_tr_b16 v[190:191], v232 offset:8704
    s_waitcnt lgkmcnt(11)
    v_mfma_f32_32x32x16_bf16 v[148:163], v[192:195], v[112:115], v[148:163]
    ds_read_b64_tr_b16 v[192:193], v234 offset:8192
    ds_read_b64_tr_b16 v[194:195], v234 offset:8704
    s_waitcnt lgkmcnt(11)
    v_mfma_f32_16x16x32_bf16 v[220:223], v[224:227], v[196:199], v[220:223]
    v_mfma_f32_32x32x16_bf16 v[148:163], v[196:199], v[116:119], v[148:163]
    ds_read_b64_tr_b16 v[196:197], v236 offset:8192
    ds_read_b64_tr_b16 v[198:199], v236 offset:8704
    s_waitcnt lgkmcnt(11)
    v_mfma_f32_32x32x16_bf16 v[148:163], v[200:203], v[120:123], v[148:163]
    ds_read_b64_tr_b16 v[200:201], v238 offset:8192
    ds_read_b64_tr_b16 v[202:203], v238 offset:8704
    s_waitcnt lgkmcnt(11)
    v_mfma_f32_32x32x16_bf16 v[148:163], v[180:183], v[124:127], v[148:163]
    s_waitcnt lgkmcnt(9)
    v_mfma_f32_32x32x16_bf16 v[148:163], v[184:187], v[128:131], v[148:163]
    s_waitcnt lgkmcnt(6)
    v_mfma_f32_16x16x32_bf16 v[220:223], v[224:227], v[188:191], v[220:223]
    v_mfma_f32_32x32x16_bf16 v[148:163], v[188:191], v[132:135], v[148:163]
    s_waitcnt lgkmcnt(4)
    v_mfma_f32_32x32x16_bf16 v[148:163], v[192:195], v[136:139], v[148:163]
    s_nop 4
    v_cvt_pk_bf16_f32 v228, v220, v220
    v_and_b32 v231, s53, v231
    v_and_b32 v229, 0xffff0000, v228
    v_sub_f32 v229, v220, v229
    v_cvt_pk_bf16_f32 v229, v229, v231
    ds_write_b64 v249, v[228:229] offset:0
    s_waitcnt lgkmcnt(3)
    v_mfma_f32_32x32x16_bf16 v[148:163], v[196:199], v[140:143], v[148:163]
    s_waitcnt lgkmcnt(1)
    v_mfma_f32_32x32x16_bf16 v[148:163], v[200:203], v[144:147], v[148:163]
    s_setprio 0
    v_mul_f32 v204, v164, v164
    v_mul_f32 v205, v165, v165
    v_mul_f32 v206, v166, v166
    v_mul_f32 v207, v167, v167
    v_mul_f32 v208, v168, v168
    v_mul_f32 v209, v169, v169
    v_mul_f32 v210, v170, v170
    v_mul_f32 v211, v171, v171
    v_fma_f32 v204, v204, v244, v243
    v_fma_f32 v205, v205, v244, v243
    v_fma_f32 v206, v206, v244, v243
    v_fma_f32 v207, v207, v244, v243
    v_fma_f32 v208, v208, v244, v243
    v_fma_f32 v209, v209, v244, v243
    v_fma_f32 v210, v210, v244, v243
    v_fma_f32 v211, v211, v244, v243
    v_mul_f32 v204, v204, v164
    v_mul_f32 v205, v205, v165
    v_mul_f32 v206, v206, v166
    v_mul_f32 v207, v207, v167
    v_mul_f32 v208, v208, v168
    v_mul_f32 v209, v209, v169
    v_mul_f32 v210, v210, v170
    v_mul_f32 v211, v211, v171
    v_exp_f32 v204, v204
    v_exp_f32 v205, v205
    v_exp_f32 v206, v206
    v_exp_f32 v207, v207
    v_exp_f32 v208, v208
    v_exp_f32 v209, v209
    v_exp_f32 v210, v210
    v_exp_f32 v211, v211
    v_fma_f32 v204, v204, v245, v245
    v_fma_f32 v205, v205, v245, v245
    v_fma_f32 v206, v206, v245, v245
    v_fma_f32 v207, v207, v245, v245
    v_fma_f32 v208, v208, v245, v245
    v_fma_f32 v209, v209, v245, v245
    v_fma_f32 v210, v210, v245, v245
    v_fma_f32 v211, v211, v245, v245
    v_rcp_f32 v204, v204
    v_rcp_f32 v205, v205
    v_rcp_f32 v206, v206
    v_rcp_f32 v207, v207
    v_rcp_f32 v208, v208
    v_rcp_f32 v209, v209
    v_rcp_f32 v210, v210
    v_rcp_f32 v211, v211
    v_mul_f32 v164, v164, v204
    v_mul_f32 v165, v165, v205
    v_mul_f32 v166, v166, v206
    v_mul_f32 v167, v167, v207
    v_mul_f32 v168, v168, v208
    v_mul_f32 v169, v169, v209
    v_mul_f32 v170, v170, v210
    v_mul_f32 v171, v171, v211
    v_cvt_pk_bf16_f32 v164, v164, v165
    v_cvt_pk_bf16_f32 v165, v166, v167
    v_cvt_pk_bf16_f32 v166, v168, v169
    v_cvt_pk_bf16_f32 v167, v170, v171
    buffer_store_dwordx4 v[164:167], v242, s[28:31], s48 offen offset:0 sc1
    v_mul_f32 v204, v172, v172
    v_mul_f32 v205, v173, v173
    v_mul_f32 v206, v174, v174
    v_mul_f32 v207, v175, v175
    v_mul_f32 v208, v176, v176
    v_mul_f32 v209, v177, v177
    v_mul_f32 v210, v178, v178
    v_mul_f32 v211, v179, v179
    v_fma_f32 v204, v204, v244, v243
    v_fma_f32 v205, v205, v244, v243
    v_fma_f32 v206, v206, v244, v243
    v_fma_f32 v207, v207, v244, v243
    v_fma_f32 v208, v208, v244, v243
    v_fma_f32 v209, v209, v244, v243
    v_fma_f32 v210, v210, v244, v243
    v_fma_f32 v211, v211, v244, v243
    v_mul_f32 v204, v204, v172
    v_mul_f32 v205, v205, v173
    v_mul_f32 v206, v206, v174
    v_mul_f32 v207, v207, v175
    v_mul_f32 v208, v208, v176
    v_mul_f32 v209, v209, v177
    v_mul_f32 v210, v210, v178
    v_mul_f32 v211, v211, v179
    v_exp_f32 v204, v204
    v_exp_f32 v205, v205
    v_exp_f32 v206, v206
    v_exp_f32 v207, v207
    v_exp_f32 v208, v208
    v_exp_f32 v209, v209
    v_exp_f32 v210, v210
    v_exp_f32 v211, v211
    v_fma_f32 v204, v204, v245, v245
    v_fma_f32 v205, v205, v245, v245
    v_fma_f32 v206, v206, v245, v245
    v_fma_f32 v207, v207, v245, v245
    v_fma_f32 v208, v208, v245, v245
    v_fma_f32 v209, v209, v245, v245
    v_fma_f32 v210, v210, v245, v245
    v_fma_f32 v211, v211, v245, v245
    v_rcp_f32 v204, v204
    v_rcp_f32 v205, v205
    v_rcp_f32 v206, v206
    v_rcp_f32 v207, v207
    v_rcp_f32 v208, v208
    v_rcp_f32 v209, v209
    v_rcp_f32 v210, v210
    v_rcp_f32 v211, v211
    v_mul_f32 v172, v172, v204
    v_mul_f32 v173, v173, v205
    v_mul_f32 v174, v174, v206
    v_mul_f32 v175, v175, v207
    v_mul_f32 v176, v176, v208
    v_mul_f32 v177, v177, v209
    v_mul_f32 v178, v178, v210
    v_mul_f32 v179, v179, v211
    v_cvt_pk_bf16_f32 v172, v172, v173
    v_cvt_pk_bf16_f32 v173, v174, v175
    v_cvt_pk_bf16_f32 v174, v176, v177
    v_cvt_pk_bf16_f32 v175, v178, v179
    buffer_store_dwordx4 v[172:175], v242, s[28:31], s48 offen offset:1024 sc1
    s_add_u32 s48, s48, 4096
    buffer_load_dword v247, v251, s[20:23], s46 offen offset:512
    s_waitcnt vmcnt(4)
    s_waitcnt lgkmcnt(0)
    s_barrier
    s_setprio 2
    v_add_u32 v233, 0xffff0000, v233
    ds_read_b64_tr_b16 v[180:181], v233 offset:0
    ds_read_b64_tr_b16 v[182:183], v233 offset:512
    v_add_u32 v235, 0xffff0000, v235
    ds_read_b64_tr_b16 v[184:185], v235 offset:0
    ds_read_b64_tr_b16 v[186:187], v235 offset:512
    v_add_u32 v237, 0xffff0000, v237
    ds_read_b64_tr_b16 v[188:189], v237 offset:0
    ds_read_b64_tr_b16 v[190:191], v237 offset:512
    v_add_u32 v239, 0xffff0000, v239
    ds_read_b64_tr_b16 v[192:193], v239 offset:0
    ds_read_b64_tr_b16 v[194:195], v239 offset:512
    ds_read_b64_tr_b16 v[196:197], v233 offset:8192
    ds_read_b64_tr_b16 v[198:199], v233 offset:8704
    ds_read_b128 v[212:215], v241 offset:0
    ds_read_b64_tr_b16 v[200:201], v235 offset:8192
    ds_read_b64_tr_b16 v[202:203], v235 offset:8704
    s_waitcnt lgkmcnt(11)
    v_mfma_f32_16x16x32_bf16 v[220:223], v[224:227], v[180:183], 0
    v_mfma_f32_32x32x16_bf16 v[164:179], v[180:183], v[4:7], 0
    ds_read_b64_tr_b16 v[180:181], v237 offset:8192
    ds_read_b64_tr_b16 v[182:183], v237 offset:8704
    s_waitcnt lgkmcnt(11)
    v_mfma_f32_32x32x16_bf16 v[164:179], v[184:187], v[8:11], v[164:179]
    ds_read_b64_tr_b16 v[184:185], v239 offset:8192
    ds_read_b64_tr_b16 v[186:187], v239 offset:8704
    s_waitcnt lgkmcnt(11)
    v_mfma_f32_32x32x16_bf16 v[164:179], v[188:191], v[12:15], v[164:179]
    s_waitcnt lgkmcnt(6)
    v_mfma_f32_32x32x16_bf16 v[148:163], v[212:215], v[216:219], v[148:163]
    ds_read_b64_tr_b16 v[188:189], v233 offset:16384
    ds_read_b64_tr_b16 v[190:191], v233 offset:16896
    v_mfma_f32_32x32x16_bf16 v[164:179], v[192:195], v[16:19], v[164:179]
    ds_read_b64_tr_b16 v[192:193], v235 offset:16384
    ds_read_b64_tr_b16 v[194:195], v235 offset:16896
    v_mfma_f32_16x16x32_bf16 v[220:223], v[224:227], v[196:199], v[220:223]
    v_mfma_f32_32x32x16_bf16 v[164:179], v[196:199], v[20:23], v[164:179]
    ds_read_b64_tr_b16 v[196:197], v237 offset:16384
    ds_read_b64_tr_b16 v[198:199], v237 offset:16896
    s_waitcnt lgkmcnt(10)
    v_mfma_f32_32x32x16_bf16 v[164:179], v[200:203], v[24:27], v[164:179]
    ds_read_b64_tr_b16 v[200:201], v239 offset:16384
    ds_read_b64_tr_b16 v[202:203], v239 offset:16896
    s_waitcnt lgkmcnt(10)
    v_mfma_f32_32x32x16_bf16 v[164:179], v[180:183], v[28:31], v[164:179]
    ds_read_b64_tr_b16 v[180:181], v233 offset:24576
    ds_read_b64_tr_b16 v[182:183], v233 offset:25088
    s_waitcnt lgkmcnt(10)
    v_mfma_f32_32x32x16_bf16 v[164:179], v[184:187], v[32:35], v[164:179]
    ds_read_b64_tr_b16 v[184:185], v235 offset:24576
    ds_read_b64_tr_b16 v[186:187], v235 offset:25088
    s_waitcnt lgkmcnt(10)
    v_mfma_f32_16x16x32_bf16 v[220:223], v[224:227], v[188:191], v[220:223]
    v_mfma_f32_32x32x16_bf16 v[164:179], v[188:191], v[36:39], v[164:179]
    ds_read_b64_tr_b16 v[188:189], v237 offset:24576
    ds_read_b64_tr_b16 v[190:191], v237 offset:25088
    s_waitcnt lgkmcnt(10)
    v_mfma_f32_32x32x16_bf16 v[164:179], v[192:195], v[40:43], v[164:179]
    ds_read_b64_tr_b16 v[192:193], v239 offset:24576
    ds_read_b64_tr_b16 v[194:195], v239 offset:25088
    s_waitcnt lgkmcnt(10)
    v_mfma_f32_32x32x16_bf16 v[164:179], v[196:199], v[44:47], v[164:179]
    ds_read_b64_tr_b16 v[196:197], v233 offset:32768
    ds_read_b64_tr_b16 v[198:199], v233 offset:33280
    s_waitcnt lgkmcnt(10)
    v_mfma_f32_32x32x16_bf16 v[164:179], v[200:203], v[48:51], v[164:179]
    ds_read_b64_tr_b16 v[200:201], v235 offset:32768
    ds_read_b64_tr_b16 v[202:203], v235 offset:33280
    s_waitcnt lgkmcnt(10)
    v_mfma_f32_16x16x32_bf16 v[220:223], v[224:227], v[180:183], v[220:223]
    v_mfma_f32_32x32x16_bf16 v[164:179], v[180:183], v[52:55], v[164:179]
    ds_read_b64_tr_b16 v[180:181], v237 offset:32768
    ds_read_b64_tr_b16 v[182:183], v237 offset:33280
    s_waitcnt lgkmcnt(10)
    v_mfma_f32_32x32x16_bf16 v[164:179], v[184:187], v[56:59], v[164:179]
    ds_read_b64_tr_b16 v[184:185], v239 offset:32768
    ds_read_b64_tr_b16 v[186:187], v239 offset:33280
    s_waitcnt lgkmcnt(10)
    v_mfma_f32_32x32x16_bf16 v[164:179], v[188:191], v[60:63], v[164:179]
    ds_read_b64_tr_b16 v[188:189], v233 offset:40960
    ds_read_b64_tr_b16 v[190:191], v233 offset:41472
    s_waitcnt lgkmcnt(10)
    v_mfma_f32_32x32x16_bf16 v[164:179], v[192:195], v[64:67], v[164:179]
    ds_read_b64_tr_b16 v[192:193], v235 offset:40960
    ds_read_b64_tr_b16 v[194:195], v235 offset:41472
    s_waitcnt lgkmcnt(10)
    v_mfma_f32_16x16x32_bf16 v[220:223], v[224:227], v[196:199], v[220:223]
    v_mfma_f32_32x32x16_bf16 v[164:179], v[196:199], v[68:71], v[164:179]
    ds_read_b64_tr_b16 v[196:197], v237 offset:40960
    ds_read_b64_tr_b16 v[198:199], v237 offset:41472
    s_waitcnt lgkmcnt(10)
    v_mfma_f32_32x32x16_bf16 v[164:179], v[200:203], v[72:75], v[164:179]
    ds_read_b64_tr_b16 v[200:201], v239 offset:40960
    ds_read_b64_tr_b16 v[202:203], v239 offset:41472
    s_waitcnt lgkmcnt(10)
    v_mfma_f32_32x32x16_bf16 v[164:179], v[180:183], v[76:79], v[164:179]
    ds_read_b64_tr_b16 v[180:181], v233 offset:49152
    ds_read_b64_tr_b16 v[182:183], v233 offset:49664
    s_waitcnt lgkmcnt(10)
    v_mfma_f32_32x32x16_bf16 v[164:179], v[184:187], v[80:83], v[164:179]
    ds_read_b64_tr_b16 v[184:185], v235 offset:49152
    ds_read_b64_tr_b16 v[186:187], v235 offset:49664
    s_waitcnt lgkmcnt(10)
    v_mfma_f32_16x16x32_bf16 v[220:223], v[224:227], v[188:191], v[220:223]
    v_mfma_f32_32x32x16_bf16 v[164:179], v[188:191], v[84:87], v[164:179]
    ds_read_b64_tr_b16 v[188:189], v237 offset:49152
    ds_read_b64_tr_b16 v[190:191], v237 offset:49664
    s_waitcnt lgkmcnt(10)
    v_mfma_f32_32x32x16_bf16 v[164:179], v[192:195], v[88:91], v[164:179]
    ds_read_b64_tr_b16 v[192:193], v239 offset:49152
    ds_read_b64_tr_b16 v[194:195], v239 offset:49664
    s_waitcnt lgkmcnt(10)
    v_mfma_f32_32x32x16_bf16 v[164:179], v[196:199], v[92:95], v[164:179]
    ds_read_b64_tr_b16 v[196:197], v233 offset:57344
    ds_read_b64_tr_b16 v[198:199], v233 offset:57856
    s_waitcnt lgkmcnt(10)
    v_mfma_f32_32x32x16_bf16 v[164:179], v[200:203], v[96:99], v[164:179]
    ds_read_b64_tr_b16 v[200:201], v235 offset:57344
    ds_read_b64_tr_b16 v[202:203], v235 offset:57856
    s_waitcnt lgkmcnt(10)
    v_mfma_f32_16x16x32_bf16 v[220:223], v[224:227], v[180:183], v[220:223]
    v_mfma_f32_32x32x16_bf16 v[164:179], v[180:183], v[100:103], v[164:179]
    ds_read_b64_tr_b16 v[180:181], v237 offset:57344
    ds_read_b64_tr_b16 v[182:183], v237 offset:57856
    s_waitcnt lgkmcnt(10)
    v_mfma_f32_32x32x16_bf16 v[164:179], v[184:187], v[104:107], v[164:179]
    ds_read_b64_tr_b16 v[184:185], v239 offset:57344
    ds_read_b64_tr_b16 v[186:187], v239 offset:57856
    ds_read_b32 v231, v250 offset:768
    s_waitcnt lgkmcnt(11)
    v_mfma_f32_32x32x16_bf16 v[164:179], v[188:191], v[108:111], v[164:179]
    ds_read_b64_tr_b16 v[188:189], v232 offset:16384
    ds_read_b64_tr_b16 v[190:191], v232 offset:16896
    s_waitcnt lgkmcnt(11)
    v_mfma_f32_32x32x16_bf16 v[164:179], v[192:195], v[112:115], v[164:179]
    ds_read_b64_tr_b16 v[192:193], v234 offset:16384
    ds_read_b64_tr_b16 v[194:195], v234 offset:16896
    s_waitcnt lgkmcnt(11)
    v_mfma_f32_16x16x32_bf16 v[220:223], v[224:227], v[196:199], v[220:223]
    v_mfma_f32_32x32x16_bf16 v[164:179], v[196:199], v[116:119], v[164:179]
    ds_read_b64_tr_b16 v[196:197], v236 offset:16384
    ds_read_b64_tr_b16 v[198:199], v236 offset:16896
    s_waitcnt lgkmcnt(11)
    v_mfma_f32_32x32x16_bf16 v[164:179], v[200:203], v[120:123], v[164:179]
    ds_read_b64_tr_b16 v[200:201], v238 offset:16384
    ds_read_b64_tr_b16 v[202:203], v238 offset:16896
    s_waitcnt lgkmcnt(11)
    v_mfma_f32_32x32x16_bf16 v[164:179], v[180:183], v[124:127], v[164:179]
    s_waitcnt lgkmcnt(9)
    v_mfma_f32_32x32x16_bf16 v[164:179], v[184:187], v[128:131], v[164:179]
    s_waitcnt lgkmcnt(6)
    v_mfma_f32_16x16x32_bf16 v[220:223], v[224:227], v[188:191], v[220:223]
    v_mfma_f32_32x32x16_bf16 v[164:179], v[188:191], v[132:135], v[164:179]
    s_waitcnt lgkmcnt(4)
    v_mfma_f32_32x32x16_bf16 v[164:179], v[192:195], v[136:139], v[164:179]
    s_nop 4
    v_cvt_pk_bf16_f32 v228, v220, v220
    v_and_b32 v231, s53, v231
    v_and_b32 v229, 0xffff0000, v228
    v_sub_f32 v229, v220, v229
    v_cvt_pk_bf16_f32 v229, v229, v231
    ds_write_b64 v249, v[228:229] offset:2048
    s_waitcnt lgkmcnt(3)
    v_mfma_f32_32x32x16_bf16 v[164:179], v[196:199], v[140:143], v[164:179]
    s_waitcnt lgkmcnt(1)
    v_mfma_f32_32x32x16_bf16 v[164:179], v[200:203], v[144:147], v[164:179]
    s_setprio 0
    v_mul_f32 v204, v148, v148
    v_mul_f32 v205, v149, v149
    v_mul_f32 v206, v150, v150
    v_mul_f32 v207, v151, v151
    v_mul_f32 v208, v152, v152
    v_mul_f32 v209, v153, v153
    v_mul_f32 v210, v154, v154
    v_mul_f32 v211, v155, v155
    v_fma_f32 v204, v204, v244, v243
    v_fma_f32 v205, v205, v244, v243
    v_fma_f32 v206, v206, v244, v243
    v_fma_f32 v207, v207, v244, v243
    v_fma_f32 v208, v208, v244, v243
    v_fma_f32 v209, v209, v244, v243
    v_fma_f32 v210, v210, v244, v243
    v_fma_f32 v211, v211, v244, v243
    v_mul_f32 v204, v204, v148
    v_mul_f32 v205, v205, v149
    v_mul_f32 v206, v206, v150
    v_mul_f32 v207, v207, v151
    v_mul_f32 v208, v208, v152
    v_mul_f32 v209, v209, v153
    v_mul_f32 v210, v210, v154
    v_mul_f32 v211, v211, v155
    v_exp_f32 v204, v204
    v_exp_f32 v205, v205
    v_exp_f32 v206, v206
    v_exp_f32 v207, v207
    v_exp_f32 v208, v208
    v_exp_f32 v209, v209
    v_exp_f32 v210, v210
    v_exp_f32 v211, v211
    v_fma_f32 v204, v204, v245, v245
    v_fma_f32 v205, v205, v245, v245
    v_fma_f32 v206, v206, v245, v245
    v_fma_f32 v207, v207, v245, v245
    v_fma_f32 v208, v208, v245, v245
    v_fma_f32 v209, v209, v245, v245
    v_fma_f32 v210, v210, v245, v245
    v_fma_f32 v211, v211, v245, v245
    v_rcp_f32 v204, v204
    v_rcp_f32 v205, v205
    v_rcp_f32 v206, v206
    v_rcp_f32 v207, v207
    v_rcp_f32 v208, v208
    v_rcp_f32 v209, v209
    v_rcp_f32 v210, v210
    v_rcp_f32 v211, v211
    v_mul_f32 v148, v148, v204
    v_mul_f32 v149, v149, v205
    v_mul_f32 v150, v150, v206
    v_mul_f32 v151, v151, v207
    v_mul_f32 v152, v152, v208
    v_mul_f32 v153, v153, v209
    v_mul_f32 v154, v154, v210
    v_mul_f32 v155, v155, v211
    v_cvt_pk_bf16_f32 v148, v148, v149
    v_cvt_pk_bf16_f32 v149, v150, v151
    v_cvt_pk_bf16_f32 v150, v152, v153
    v_cvt_pk_bf16_f32 v151, v154, v155
    buffer_store_dwordx4 v[148:151], v242, s[28:31], s48 offen offset:0 sc1
    v_mul_f32 v204, v156, v156
    v_mul_f32 v205, v157, v157
    v_mul_f32 v206, v158, v158
    v_mul_f32 v207, v159, v159
    v_mul_f32 v208, v160, v160
    v_mul_f32 v209, v161, v161
    v_mul_f32 v210, v162, v162
    v_mul_f32 v211, v163, v163
    v_fma_f32 v204, v204, v244, v243
    v_fma_f32 v205, v205, v244, v243
    v_fma_f32 v206, v206, v244, v243
    v_fma_f32 v207, v207, v244, v243
    v_fma_f32 v208, v208, v244, v243
    v_fma_f32 v209, v209, v244, v243
    v_fma_f32 v210, v210, v244, v243
    v_fma_f32 v211, v211, v244, v243
    v_mul_f32 v204, v204, v156
    v_mul_f32 v205, v205, v157
    v_mul_f32 v206, v206, v158
    v_mul_f32 v207, v207, v159
    v_mul_f32 v208, v208, v160
    v_mul_f32 v209, v209, v161
    v_mul_f32 v210, v210, v162
    v_mul_f32 v211, v211, v163
    v_exp_f32 v204, v204
    v_exp_f32 v205, v205
    v_exp_f32 v206, v206
    v_exp_f32 v207, v207
    v_exp_f32 v208, v208
    v_exp_f32 v209, v209
    v_exp_f32 v210, v210
    v_exp_f32 v211, v211
    v_fma_f32 v204, v204, v245, v245
    v_fma_f32 v205, v205, v245, v245
    v_fma_f32 v206, v206, v245, v245
    v_fma_f32 v207, v207, v245, v245
    v_fma_f32 v208, v208, v245, v245
    v_fma_f32 v209, v209, v245, v245
    v_fma_f32 v210, v210, v245, v245
    v_fma_f32 v211, v211, v245, v245
    v_rcp_f32 v204, v204
    v_rcp_f32 v205, v205
    v_rcp_f32 v206, v206
    v_rcp_f32 v207, v207
    v_rcp_f32 v208, v208
    v_rcp_f32 v209, v209
    v_rcp_f32 v210, v210
    v_rcp_f32 v211, v211
    v_mul_f32 v156, v156, v204
    v_mul_f32 v157, v157, v205
    v_mul_f32 v158, v158, v206
    v_mul_f32 v159, v159, v207
    v_mul_f32 v160, v160, v208
    v_mul_f32 v161, v161, v209
    v_mul_f32 v162, v162, v210
    v_mul_f32 v163, v163, v211
    v_cvt_pk_bf16_f32 v156, v156, v157
    v_cvt_pk_bf16_f32 v157, v158, v159
    v_cvt_pk_bf16_f32 v158, v160, v161
    v_cvt_pk_bf16_f32 v159, v162, v163
    buffer_store_dwordx4 v[156:159], v242, s[28:31], s48 offen offset:1024 sc1
    s_add_u32 s48, s48, 4096
    buffer_load_dword v247, v251, s[20:23], s46 offen offset:640
    s_waitcnt vmcnt(4)
    s_waitcnt lgkmcnt(0)
    s_barrier
    s_setprio 2
    v_add_u32 v233, 0x10000, v233
    ds_read_b64_tr_b16 v[180:181], v233 offset:8192
    ds_read_b64_tr_b16 v[182:183], v233 offset:8704
    v_add_u32 v235, 0x10000, v235
    ds_read_b64_tr_b16 v[184:185], v235 offset:8192
    ds_read_b64_tr_b16 v[186:187], v235 offset:8704
    v_add_u32 v237, 0x10000, v237
    ds_read_b64_tr_b16 v[188:189], v237 offset:8192
    ds_read_b64_tr_b16 v[190:191], v237 offset:8704
    v_add_u32 v239, 0x10000, v239
    ds_read_b64_tr_b16 v[192:193], v239 offset:8192
    ds_read_b64_tr_b16 v[194:195], v239 offset:8704
    ds_read_b64_tr_b16 v[196:197], v233 offset:16384
    ds_read_b64_tr_b16 v[198:199], v233 offset:16896
    ds_read_b128 v[212:215], v241 offset:2048
    ds_read_b64_tr_b16 v[200:201], v235 offset:16384
    ds_read_b64_tr_b16 v[202:203], v235 offset:16896
    s_waitcnt lgkmcnt(11)
    v_mfma_f32_16x16x32_bf16 v[220:223], v[224:227], v[180:183], 0
    v_mfma_f32_32x32x16_bf16 v[148:163], v[180:183], v[4:7], 0
    ds_read_b64_tr_b16 v[180:181], v237 offset:16384
    ds_read_b64_tr_b16 v[182:183], v237 offset:16896
    s_waitcnt lgkmcnt(11)
    v_mfma_f32_32x32x16_bf16 v[148:163], v[184:187], v[8:11], v[148:163]
    ds_read_b64_tr_b16 v[184:185], v239 offset:16384
    ds_read_b64_tr_b16 v[186:187], v239 offset:16896
    s_waitcnt lgkmcnt(11)
    v_mfma_f32_32x32x16_bf16 v[148:163], v[188:191], v[12:15], v[148:163]
    s_waitcnt lgkmcnt(6)
    v_mfma_f32_32x32x16_bf16 v[164:179], v[212:215], v[216:219], v[164:179]
    ds_read_b64_tr_b16 v[188:189], v233 offset:24576
    ds_read_b64_tr_b16 v[190:191], v233 offset:25088
    v_mfma_f32_32x32x16_bf16 v[148:163], v[192:195], v[16:19], v[148:163]
    ds_read_b64_tr_b16 v[192:193], v235 offset:24576
    ds_read_b64_tr_b16 v[194:195], v235 offset:25088
    v_mfma_f32_16x16x32_bf16 v[220:223], v[224:227], v[196:199], v[220:223]
    v_mfma_f32_32x32x16_bf16 v[148:163], v[196:199], v[20:23], v[148:163]
    ds_read_b64_tr_b16 v[196:197], v237 offset:24576
    ds_read_b64_tr_b16 v[198:199], v237 offset:25088
    s_waitcnt lgkmcnt(10)
    v_mfma_f32_32x32x16_bf16 v[148:163], v[200:203], v[24:27], v[148:163]
    ds_read_b64_tr_b16 v[200:201], v239 offset:24576
    ds_read_b64_tr_b16 v[202:203], v239 offset:25088
    s_waitcnt lgkmcnt(10)
    v_mfma_f32_32x32x16_bf16 v[148:163], v[180:183], v[28:31], v[148:163]
    ds_read_b64_tr_b16 v[180:181], v233 offset:32768
    ds_read_b64_tr_b16 v[182:183], v233 offset:33280
    s_waitcnt lgkmcnt(10)
    v_mfma_f32_32x32x16_bf16 v[148:163], v[184:187], v[32:35], v[148:163]
    ds_read_b64_tr_b16 v[184:185], v235 offset:32768
    ds_read_b64_tr_b16 v[186:187], v235 offset:33280
    s_waitcnt lgkmcnt(10)
    v_mfma_f32_16x16x32_bf16 v[220:223], v[224:227], v[188:191], v[220:223]
    v_mfma_f32_32x32x16_bf16 v[148:163], v[188:191], v[36:39], v[148:163]
    ds_read_b64_tr_b16 v[188:189], v237 offset:32768
    ds_read_b64_tr_b16 v[190:191], v237 offset:33280
    s_waitcnt lgkmcnt(10)
    v_mfma_f32_32x32x16_bf16 v[148:163], v[192:195], v[40:43], v[148:163]
    ds_read_b64_tr_b16 v[192:193], v239 offset:32768
    ds_read_b64_tr_b16 v[194:195], v239 offset:33280
    s_waitcnt lgkmcnt(10)
    v_mfma_f32_32x32x16_bf16 v[148:163], v[196:199], v[44:47], v[148:163]
    ds_read_b64_tr_b16 v[196:197], v233 offset:40960
    ds_read_b64_tr_b16 v[198:199], v233 offset:41472
    s_waitcnt lgkmcnt(10)
    v_mfma_f32_32x32x16_bf16 v[148:163], v[200:203], v[48:51], v[148:163]
    ds_read_b64_tr_b16 v[200:201], v235 offset:40960
    ds_read_b64_tr_b16 v[202:203], v235 offset:41472
    s_waitcnt lgkmcnt(10)
    v_mfma_f32_16x16x32_bf16 v[220:223], v[224:227], v[180:183], v[220:223]
    v_mfma_f32_32x32x16_bf16 v[148:163], v[180:183], v[52:55], v[148:163]
    ds_read_b64_tr_b16 v[180:181], v237 offset:40960
    ds_read_b64_tr_b16 v[182:183], v237 offset:41472
    s_waitcnt lgkmcnt(10)
    v_mfma_f32_32x32x16_bf16 v[148:163], v[184:187], v[56:59], v[148:163]
    ds_read_b64_tr_b16 v[184:185], v239 offset:40960
    ds_read_b64_tr_b16 v[186:187], v239 offset:41472
    s_waitcnt lgkmcnt(10)
    v_mfma_f32_32x32x16_bf16 v[148:163], v[188:191], v[60:63], v[148:163]
    ds_read_b64_tr_b16 v[188:189], v233 offset:49152
    ds_read_b64_tr_b16 v[190:191], v233 offset:49664
    s_waitcnt lgkmcnt(10)
    v_mfma_f32_32x32x16_bf16 v[148:163], v[192:195], v[64:67], v[148:163]
    ds_read_b64_tr_b16 v[192:193], v235 offset:49152
    ds_read_b64_tr_b16 v[194:195], v235 offset:49664
    s_waitcnt lgkmcnt(10)
    v_mfma_f32_16x16x32_bf16 v[220:223], v[224:227], v[196:199], v[220:223]
    v_mfma_f32_32x32x16_bf16 v[148:163], v[196:199], v[68:71], v[148:163]
    ds_read_b64_tr_b16 v[196:197], v237 offset:49152
    ds_read_b64_tr_b16 v[198:199], v237 offset:49664
    s_waitcnt lgkmcnt(10)
    v_mfma_f32_32x32x16_bf16 v[148:163], v[200:203], v[72:75], v[148:163]
    ds_read_b64_tr_b16 v[200:201], v239 offset:49152
    ds_read_b64_tr_b16 v[202:203], v239 offset:49664
    s_waitcnt lgkmcnt(10)
    v_mfma_f32_32x32x16_bf16 v[148:163], v[180:183], v[76:79], v[148:163]
    ds_read_b64_tr_b16 v[180:181], v233 offset:57344
    ds_read_b64_tr_b16 v[182:183], v233 offset:57856
    s_waitcnt lgkmcnt(10)
    v_mfma_f32_32x32x16_bf16 v[148:163], v[184:187], v[80:83], v[148:163]
    ds_read_b64_tr_b16 v[184:185], v235 offset:57344
    ds_read_b64_tr_b16 v[186:187], v235 offset:57856
    s_waitcnt lgkmcnt(10)
    v_mfma_f32_16x16x32_bf16 v[220:223], v[224:227], v[188:191], v[220:223]
    v_mfma_f32_32x32x16_bf16 v[148:163], v[188:191], v[84:87], v[148:163]
    ds_read_b64_tr_b16 v[188:189], v237 offset:57344
    ds_read_b64_tr_b16 v[190:191], v237 offset:57856
    s_waitcnt lgkmcnt(10)
    v_mfma_f32_32x32x16_bf16 v[148:163], v[192:195], v[88:91], v[148:163]
    ds_read_b64_tr_b16 v[192:193], v239 offset:57344
    ds_read_b64_tr_b16 v[194:195], v239 offset:57856
    s_waitcnt lgkmcnt(10)
    v_mfma_f32_32x32x16_bf16 v[148:163], v[196:199], v[92:95], v[148:163]
    ds_read_b64_tr_b16 v[196:197], v232 offset:0
    ds_read_b64_tr_b16 v[198:199], v232 offset:512
    s_waitcnt lgkmcnt(10)
    v_mfma_f32_32x32x16_bf16 v[148:163], v[200:203], v[96:99], v[148:163]
    ds_read_b64_tr_b16 v[200:201], v234 offset:0
    ds_read_b64_tr_b16 v[202:203], v234 offset:512
    s_waitcnt lgkmcnt(10)
    v_mfma_f32_16x16x32_bf16 v[220:223], v[224:227], v[180:183], v[220:223]
    v_mfma_f32_32x32x16_bf16 v[148:163], v[180:183], v[100:103], v[148:163]
    ds_read_b64_tr_b16 v[180:181], v236 offset:0
    ds_read_b64_tr_b16 v[182:183], v236 offset:512
    s_waitcnt lgkmcnt(10)
    v_mfma_f32_32x32x16_bf16 v[148:163], v[184:187], v[104:107], v[148:163]
    ds_read_b64_tr_b16 v[184:185], v238 offset:0
    ds_read_b64_tr_b16 v[186:187], v238 offset:512
    ds_read_b32 v231, v250 offset:1024
    s_waitcnt lgkmcnt(11)
    v_mfma_f32_32x32x16_bf16 v[148:163], v[188:191], v[108:111], v[148:163]
    ds_read_b64_tr_b16 v[188:189], v232 offset:8192
    ds_read_b64_tr_b16 v[190:191], v232 offset:8704
    s_waitcnt lgkmcnt(11)
    v_mfma_f32_32x32x16_bf16 v[148:163], v[192:195], v[112:115], v[148:163]
    ds_read_b64_tr_b16 v[192:193], v234 offset:8192
    ds_read_b64_tr_b16 v[194:195], v234 offset:8704
    s_waitcnt lgkmcnt(11)
    v_mfma_f32_16x16x32_bf16 v[220:223], v[224:227], v[196:199], v[220:223]
    v_mfma_f32_32x32x16_bf16 v[148:163], v[196:199], v[116:119], v[148:163]
    ds_read_b64_tr_b16 v[196:197], v236 offset:8192
    ds_read_b64_tr_b16 v[198:199], v236 offset:8704
    s_waitcnt lgkmcnt(11)
    v_mfma_f32_32x32x16_bf16 v[148:163], v[200:203], v[120:123], v[148:163]
    ds_read_b64_tr_b16 v[200:201], v238 offset:8192
    ds_read_b64_tr_b16 v[202:203], v238 offset:8704
    s_waitcnt lgkmcnt(11)
    v_mfma_f32_32x32x16_bf16 v[148:163], v[180:183], v[124:127], v[148:163]
    s_waitcnt lgkmcnt(9)
    v_mfma_f32_32x32x16_bf16 v[148:163], v[184:187], v[128:131], v[148:163]
    s_waitcnt lgkmcnt(6)
    v_mfma_f32_16x16x32_bf16 v[220:223], v[224:227], v[188:191], v[220:223]
    v_mfma_f32_32x32x16_bf16 v[148:163], v[188:191], v[132:135], v[148:163]
    s_waitcnt lgkmcnt(4)
    v_mfma_f32_32x32x16_bf16 v[148:163], v[192:195], v[136:139], v[148:163]
    s_nop 4
    v_cvt_pk_bf16_f32 v228, v220, v220
    v_and_b32 v231, s53, v231
    v_and_b32 v229, 0xffff0000, v228
    v_sub_f32 v229, v220, v229
    v_cvt_pk_bf16_f32 v229, v229, v231
    ds_write_b64 v249, v[228:229] offset:0
    s_waitcnt lgkmcnt(3)
    v_mfma_f32_32x32x16_bf16 v[148:163], v[196:199], v[140:143], v[148:163]
    s_waitcnt lgkmcnt(1)
    v_mfma_f32_32x32x16_bf16 v[148:163], v[200:203], v[144:147], v[148:163]
    s_setprio 0
    v_mul_f32 v204, v164, v164
    v_mul_f32 v205, v165, v165
    v_mul_f32 v206, v166, v166
    v_mul_f32 v207, v167, v167
    v_mul_f32 v208, v168, v168
    v_mul_f32 v209, v169, v169
    v_mul_f32 v210, v170, v170
    v_mul_f32 v211, v171, v171
    v_fma_f32 v204, v204, v244, v243
    v_fma_f32 v205, v205, v244, v243
    v_fma_f32 v206, v206, v244, v243
    v_fma_f32 v207, v207, v244, v243
    v_fma_f32 v208, v208, v244, v243
    v_fma_f32 v209, v209, v244, v243
    v_fma_f32 v210, v210, v244, v243
    v_fma_f32 v211, v211, v244, v243
    v_mul_f32 v204, v204, v164
    v_mul_f32 v205, v205, v165
    v_mul_f32 v206, v206, v166
    v_mul_f32 v207, v207, v167
    v_mul_f32 v208, v208, v168
    v_mul_f32 v209, v209, v169
    v_mul_f32 v210, v210, v170
    v_mul_f32 v211, v211, v171
    v_exp_f32 v204, v204
    v_exp_f32 v205, v205
    v_exp_f32 v206, v206
    v_exp_f32 v207, v207
    v_exp_f32 v208, v208
    v_exp_f32 v209, v209
    v_exp_f32 v210, v210
    v_exp_f32 v211, v211
    v_fma_f32 v204, v204, v245, v245
    v_fma_f32 v205, v205, v245, v245
    v_fma_f32 v206, v206, v245, v245
    v_fma_f32 v207, v207, v245, v245
    v_fma_f32 v208, v208, v245, v245
    v_fma_f32 v209, v209, v245, v245
    v_fma_f32 v210, v210, v245, v245
    v_fma_f32 v211, v211, v245, v245
    v_rcp_f32 v204, v204
    v_rcp_f32 v205, v205
    v_rcp_f32 v206, v206
    v_rcp_f32 v207, v207
    v_rcp_f32 v208, v208
    v_rcp_f32 v209, v209
    v_rcp_f32 v210, v210
    v_rcp_f32 v211, v211
    v_mul_f32 v164, v164, v204
    v_mul_f32 v165, v165, v205
    v_mul_f32 v166, v166, v206
    v_mul_f32 v167, v167, v207
    v_mul_f32 v168, v168, v208
    v_mul_f32 v169, v169, v209
    v_mul_f32 v170, v170, v210
    v_mul_f32 v171, v171, v211
    v_cvt_pk_bf16_f32 v164, v164, v165
    v_cvt_pk_bf16_f32 v165, v166, v167
    v_cvt_pk_bf16_f32 v166, v168, v169
    v_cvt_pk_bf16_f32 v167, v170, v171
    buffer_store_dwordx4 v[164:167], v242, s[28:31], s48 offen offset:0 sc1
    v_mul_f32 v204, v172, v172
    v_mul_f32 v205, v173, v173
    v_mul_f32 v206, v174, v174
    v_mul_f32 v207, v175, v175
    v_mul_f32 v208, v176, v176
    v_mul_f32 v209, v177, v177
    v_mul_f32 v210, v178, v178
    v_mul_f32 v211, v179, v179
    v_fma_f32 v204, v204, v244, v243
    v_fma_f32 v205, v205, v244, v243
    v_fma_f32 v206, v206, v244, v243
    v_fma_f32 v207, v207, v244, v243
    v_fma_f32 v208, v208, v244, v243
    v_fma_f32 v209, v209, v244, v243
    v_fma_f32 v210, v210, v244, v243
    v_fma_f32 v211, v211, v244, v243
    v_mul_f32 v204, v204, v172
    v_mul_f32 v205, v205, v173
    v_mul_f32 v206, v206, v174
    v_mul_f32 v207, v207, v175
    v_mul_f32 v208, v208, v176
    v_mul_f32 v209, v209, v177
    v_mul_f32 v210, v210, v178
    v_mul_f32 v211, v211, v179
    v_exp_f32 v204, v204
    v_exp_f32 v205, v205
    v_exp_f32 v206, v206
    v_exp_f32 v207, v207
    v_exp_f32 v208, v208
    v_exp_f32 v209, v209
    v_exp_f32 v210, v210
    v_exp_f32 v211, v211
    v_fma_f32 v204, v204, v245, v245
    v_fma_f32 v205, v205, v245, v245
    v_fma_f32 v206, v206, v245, v245
    v_fma_f32 v207, v207, v245, v245
    v_fma_f32 v208, v208, v245, v245
    v_fma_f32 v209, v209, v245, v245
    v_fma_f32 v210, v210, v245, v245
    v_fma_f32 v211, v211, v245, v245
    v_rcp_f32 v204, v204
    v_rcp_f32 v205, v205
    v_rcp_f32 v206, v206
    v_rcp_f32 v207, v207
    v_rcp_f32 v208, v208
    v_rcp_f32 v209, v209
    v_rcp_f32 v210, v210
    v_rcp_f32 v211, v211
    v_mul_f32 v172, v172, v204
    v_mul_f32 v173, v173, v205
    v_mul_f32 v174, v174, v206
    v_mul_f32 v175, v175, v207
    v_mul_f32 v176, v176, v208
    v_mul_f32 v177, v177, v209
    v_mul_f32 v178, v178, v210
    v_mul_f32 v179, v179, v211
    v_cvt_pk_bf16_f32 v172, v172, v173
    v_cvt_pk_bf16_f32 v173, v174, v175
    v_cvt_pk_bf16_f32 v174, v176, v177
    v_cvt_pk_bf16_f32 v175, v178, v179
    buffer_store_dwordx4 v[172:175], v242, s[28:31], s48 offen offset:1024 sc1
    s_add_u32 s48, s48, 4096
    buffer_load_dword v247, v248, s[16:19], s55 offen offset:0
    v_min_u32 v248, 384, v248
    buffer_load_dword v247, v248, s[24:27], s54 offen
    s_waitcnt vmcnt(5)
    s_waitcnt lgkmcnt(0)
    s_barrier
    s_setprio 2
    v_add_u32 v233, 0xffff0000, v233
    ds_read_b64_tr_b16 v[180:181], v233 offset:0
    ds_read_b64_tr_b16 v[182:183], v233 offset:512
    v_add_u32 v235, 0xffff0000, v235
    ds_read_b64_tr_b16 v[184:185], v235 offset:0
    ds_read_b64_tr_b16 v[186:187], v235 offset:512
    v_add_u32 v237, 0xffff0000, v237
    ds_read_b64_tr_b16 v[188:189], v237 offset:0
    ds_read_b64_tr_b16 v[190:191], v237 offset:512
    v_add_u32 v239, 0xffff0000, v239
    ds_read_b64_tr_b16 v[192:193], v239 offset:0
    ds_read_b64_tr_b16 v[194:195], v239 offset:512
    ds_read_b64_tr_b16 v[196:197], v233 offset:8192
    ds_read_b64_tr_b16 v[198:199], v233 offset:8704
    ds_read_b128 v[212:215], v241 offset:0
    ds_read_b64_tr_b16 v[200:201], v235 offset:8192
    ds_read_b64_tr_b16 v[202:203], v235 offset:8704
    s_waitcnt lgkmcnt(11)
    v_mfma_f32_16x16x32_bf16 v[220:223], v[224:227], v[180:183], 0
    v_mfma_f32_32x32x16_bf16 v[164:179], v[180:183], v[4:7], 0
    ds_read_b64_tr_b16 v[180:181], v237 offset:8192
    ds_read_b64_tr_b16 v[182:183], v237 offset:8704
    s_waitcnt lgkmcnt(11)
    v_mfma_f32_32x32x16_bf16 v[164:179], v[184:187], v[8:11], v[164:179]
    ds_read_b64_tr_b16 v[184:185], v239 offset:8192
    ds_read_b64_tr_b16 v[186:187], v239 offset:8704
    s_waitcnt lgkmcnt(11)
    v_mfma_f32_32x32x16_bf16 v[164:179], v[188:191], v[12:15], v[164:179]
    s_waitcnt lgkmcnt(6)
    v_mfma_f32_32x32x16_bf16 v[148:163], v[212:215], v[216:219], v[148:163]
    ds_read_b64_tr_b16 v[188:189], v233 offset:16384
    ds_read_b64_tr_b16 v[190:191], v233 offset:16896
    v_mfma_f32_32x32x16_bf16 v[164:179], v[192:195], v[16:19], v[164:179]
    ds_read_b64_tr_b16 v[192:193], v235 offset:16384
    ds_read_b64_tr_b16 v[194:195], v235 offset:16896
    v_mfma_f32_16x16x32_bf16 v[220:223], v[224:227], v[196:199], v[220:223]
    v_mfma_f32_32x32x16_bf16 v[164:179], v[196:199], v[20:23], v[164:179]
    ds_read_b64_tr_b16 v[196:197], v237 offset:16384
    ds_read_b64_tr_b16 v[198:199], v237 offset:16896
    s_waitcnt lgkmcnt(10)
    v_mfma_f32_32x32x16_bf16 v[164:179], v[200:203], v[24:27], v[164:179]
    ds_read_b64_tr_b16 v[200:201], v239 offset:16384
    ds_read_b64_tr_b16 v[202:203], v239 offset:16896
    s_waitcnt lgkmcnt(10)
    v_mfma_f32_32x32x16_bf16 v[164:179], v[180:183], v[28:31], v[164:179]
    ds_read_b64_tr_b16 v[180:181], v233 offset:24576
    ds_read_b64_tr_b16 v[182:183], v233 offset:25088
    s_waitcnt lgkmcnt(10)
    v_mfma_f32_32x32x16_bf16 v[164:179], v[184:187], v[32:35], v[164:179]
    ds_read_b64_tr_b16 v[184:185], v235 offset:24576
    ds_read_b64_tr_b16 v[186:187], v235 offset:25088
    s_waitcnt lgkmcnt(10)
    v_mfma_f32_16x16x32_bf16 v[220:223], v[224:227], v[188:191], v[220:223]
    v_mfma_f32_32x32x16_bf16 v[164:179], v[188:191], v[36:39], v[164:179]
    ds_read_b64_tr_b16 v[188:189], v237 offset:24576
    ds_read_b64_tr_b16 v[190:191], v237 offset:25088
    s_waitcnt lgkmcnt(10)
    v_mfma_f32_32x32x16_bf16 v[164:179], v[192:195], v[40:43], v[164:179]
    ds_read_b64_tr_b16 v[192:193], v239 offset:24576
    ds_read_b64_tr_b16 v[194:195], v239 offset:25088
    s_waitcnt lgkmcnt(10)
    v_mfma_f32_32x32x16_bf16 v[164:179], v[196:199], v[44:47], v[164:179]
    ds_read_b64_tr_b16 v[196:197], v233 offset:32768
    ds_read_b64_tr_b16 v[198:199], v233 offset:33280
    s_waitcnt lgkmcnt(10)
    v_mfma_f32_32x32x16_bf16 v[164:179], v[200:203], v[48:51], v[164:179]
    ds_read_b64_tr_b16 v[200:201], v235 offset:32768
    ds_read_b64_tr_b16 v[202:203], v235 offset:33280
    s_waitcnt lgkmcnt(10)
    v_mfma_f32_16x16x32_bf16 v[220:223], v[224:227], v[180:183], v[220:223]
    v_mfma_f32_32x32x16_bf16 v[164:179], v[180:183], v[52:55], v[164:179]
    ds_read_b64_tr_b16 v[180:181], v237 offset:32768
    ds_read_b64_tr_b16 v[182:183], v237 offset:33280
    s_waitcnt lgkmcnt(10)
    v_mfma_f32_32x32x16_bf16 v[164:179], v[184:187], v[56:59], v[164:179]
    ds_read_b64_tr_b16 v[184:185], v239 offset:32768
    ds_read_b64_tr_b16 v[186:187], v239 offset:33280
    s_waitcnt lgkmcnt(10)
    v_mfma_f32_32x32x16_bf16 v[164:179], v[188:191], v[60:63], v[164:179]
    ds_read_b64_tr_b16 v[188:189], v233 offset:40960
    ds_read_b64_tr_b16 v[190:191], v233 offset:41472
    s_waitcnt lgkmcnt(10)
    v_mfma_f32_32x32x16_bf16 v[164:179], v[192:195], v[64:67], v[164:179]
    ds_read_b64_tr_b16 v[192:193], v235 offset:40960
    ds_read_b64_tr_b16 v[194:195], v235 offset:41472
    s_waitcnt lgkmcnt(10)
    v_mfma_f32_16x16x32_bf16 v[220:223], v[224:227], v[196:199], v[220:223]
    v_mfma_f32_32x32x16_bf16 v[164:179], v[196:199], v[68:71], v[164:179]
    ds_read_b64_tr_b16 v[196:197], v237 offset:40960
    ds_read_b64_tr_b16 v[198:199], v237 offset:41472
    s_waitcnt lgkmcnt(10)
    v_mfma_f32_32x32x16_bf16 v[164:179], v[200:203], v[72:75], v[164:179]
    ds_read_b64_tr_b16 v[200:201], v239 offset:40960
    ds_read_b64_tr_b16 v[202:203], v239 offset:41472
    s_waitcnt lgkmcnt(10)
    v_mfma_f32_32x32x16_bf16 v[164:179], v[180:183], v[76:79], v[164:179]
    ds_read_b64_tr_b16 v[180:181], v233 offset:49152
    ds_read_b64_tr_b16 v[182:183], v233 offset:49664
    s_waitcnt lgkmcnt(10)
    v_mfma_f32_32x32x16_bf16 v[164:179], v[184:187], v[80:83], v[164:179]
    ds_read_b64_tr_b16 v[184:185], v235 offset:49152
    ds_read_b64_tr_b16 v[186:187], v235 offset:49664
    s_waitcnt lgkmcnt(10)
    v_mfma_f32_16x16x32_bf16 v[220:223], v[224:227], v[188:191], v[220:223]
    v_mfma_f32_32x32x16_bf16 v[164:179], v[188:191], v[84:87], v[164:179]
    ds_read_b64_tr_b16 v[188:189], v237 offset:49152
    ds_read_b64_tr_b16 v[190:191], v237 offset:49664
    s_waitcnt lgkmcnt(10)
    v_mfma_f32_32x32x16_bf16 v[164:179], v[192:195], v[88:91], v[164:179]
    ds_read_b64_tr_b16 v[192:193], v239 offset:49152
    ds_read_b64_tr_b16 v[194:195], v239 offset:49664
    s_waitcnt lgkmcnt(10)
    v_mfma_f32_32x32x16_bf16 v[164:179], v[196:199], v[92:95], v[164:179]
    ds_read_b64_tr_b16 v[196:197], v233 offset:57344
    ds_read_b64_tr_b16 v[198:199], v233 offset:57856
    s_waitcnt lgkmcnt(10)
    v_mfma_f32_32x32x16_bf16 v[164:179], v[200:203], v[96:99], v[164:179]
    ds_read_b64_tr_b16 v[200:201], v235 offset:57344
    ds_read_b64_tr_b16 v[202:203], v235 offset:57856
    s_waitcnt lgkmcnt(10)
    v_mfma_f32_16x16x32_bf16 v[220:223], v[224:227], v[180:183], v[220:223]
    v_mfma_f32_32x32x16_bf16 v[164:179], v[180:183], v[100:103], v[164:179]
    ds_read_b64_tr_b16 v[180:181], v237 offset:57344
    ds_read_b64_tr_b16 v[182:183], v237 offset:57856
    s_waitcnt lgkmcnt(10)
    v_mfma_f32_32x32x16_bf16 v[164:179], v[184:187], v[104:107], v[164:179]
    ds_read_b64_tr_b16 v[184:185], v239 offset:57344
    ds_read_b64_tr_b16 v[186:187], v239 offset:57856
    ds_read_b32 v231, v250 offset:1280
    s_waitcnt lgkmcnt(11)
    v_mfma_f32_32x32x16_bf16 v[164:179], v[188:191], v[108:111], v[164:179]
    v_add_u32 v232, 0xffff0000, v232
    ds_read_b64_tr_b16 v[188:189], v232 offset:0
    ds_read_b64_tr_b16 v[190:191], v232 offset:512
    s_waitcnt lgkmcnt(11)
    v_mfma_f32_32x32x16_bf16 v[164:179], v[192:195], v[112:115], v[164:179]
    v_add_u32 v234, 0xffff0000, v234
    ds_read_b64_tr_b16 v[192:193], v234 offset:0
    ds_read_b64_tr_b16 v[194:195], v234 offset:512
    s_waitcnt lgkmcnt(11)
    v_mfma_f32_16x16x32_bf16 v[220:223], v[224:227], v[196:199], v[220:223]
    v_mfma_f32_32x32x16_bf16 v[164:179], v[196:199], v[116:119], v[164:179]
    v_add_u32 v236, 0xffff0000, v236
    ds_read_b64_tr_b16 v[196:197], v236 offset:0
    ds_read_b64_tr_b16 v[198:199], v236 offset:512
    s_waitcnt lgkmcnt(11)
    v_mfma_f32_32x32x16_bf16 v[164:179], v[200:203], v[120:123], v[164:179]
    v_add_u32 v238, 0xffff0000, v238
    ds_read_b64_tr_b16 v[200:201], v238 offset:0
    ds_read_b64_tr_b16 v[202:203], v238 offset:512
    s_waitcnt lgkmcnt(11)
    v_mfma_f32_32x32x16_bf16 v[164:179], v[180:183], v[124:127], v[164:179]
    s_waitcnt lgkmcnt(9)
    v_mfma_f32_32x32x16_bf16 v[164:179], v[184:187], v[128:131], v[164:179]
    s_waitcnt lgkmcnt(6)
    v_mfma_f32_16x16x32_bf16 v[220:223], v[224:227], v[188:191], v[220:223]
    v_mfma_f32_32x32x16_bf16 v[164:179], v[188:191], v[132:135], v[164:179]
    s_waitcnt lgkmcnt(4)
    v_mfma_f32_32x32x16_bf16 v[164:179], v[192:195], v[136:139], v[164:179]
    s_nop 4
    v_cvt_pk_bf16_f32 v228, v220, v220
    v_and_b32 v231, s53, v231
    v_and_b32 v229, 0xffff0000, v228
    v_sub_f32 v229, v220, v229
    v_cvt_pk_bf16_f32 v229, v229, v231
    ds_write_b64 v249, v[228:229] offset:2048
    s_waitcnt lgkmcnt(3)
    v_mfma_f32_32x32x16_bf16 v[164:179], v[196:199], v[140:143], v[164:179]
    s_waitcnt lgkmcnt(1)
    v_mfma_f32_32x32x16_bf16 v[164:179], v[200:203], v[144:147], v[164:179]
    s_setprio 0
    s_waitcnt lgkmcnt(0)
    s_barrier
    ds_read_b128 v[212:215], v241 offset:2048
    v_bfe_u32 v254, v0, 2, 2
    v_mul_u32_u24 v254, 1152, v254
    v_and_b32 v253, 3, v0
    v_lshl_add_u32 v254, v253, 4, v254
    v_bfe_u32 v253, v0, 4, 2
    v_lshl_add_u32 v254, v253, 6, v254
    v_bfe_u32 v253, v0, 1, 5
    v_mul_u32_u24 v253, 72, v253
    v_bfi_b32 v253, 1, v0, v253
    v_lshlrev_b32 v253, 4, v253
    s_mul_i32 s40, s37, -224
    s_add_u32 s40, s40, 1024
    v_add_u32 v253, s40, v253
    s_mul_i32 s8, s35, 1152
    s_mul_i32 s11, s35, 144
    s_lshl_b32 s40, s33, 4
    s_lshl_b32 s41, s37, 8
    s_add_u32 s8, s8, s40
    s_mul_i32 s8, s8, 1152
    s_add_u32 s8, s8, s41
    s_add_u32 s11, s11, s40
    s_mul_i32 s11, s11, 1152
    s_add_u32 s11, s11, s41
    s_mul_i32 s9, s33, 4608
    v_add_u32 v14, 14336, v254
    v_add_u32 v13, 10752, v254
    v_add_u32 v12, 7168, v254
    v_add_u32 v254, 3584, v254
    v_add_u32 v253, 4096, v253
    s_andn2_b32 s40, s14, 15
    v_and_b32 v8, 63, v0
    v_lshlrev_b32 v8, 2, v8
    buffer_load_dword v8, v8, s[4:7], 0 offen sc1
    buffer_load_dwordx4 v[4:7], off, s[28:31], s40 sc1
    v_mul_f32 v204, v148, v148
    v_mul_f32 v205, v149, v149
    v_mul_f32 v206, v150, v150
    v_mul_f32 v207, v151, v151
    v_mul_f32 v208, v152, v152
    v_mul_f32 v209, v153, v153
    v_mul_f32 v210, v154, v154
    v_mul_f32 v211, v155, v155
    s_add_u32 m0, s9, 81920
    v_fma_f32 v204, v204, v244, v243
    v_fma_f32 v205, v205, v244, v243
    v_fma_f32 v206, v206, v244, v243
    v_fma_f32 v207, v207, v244, v243
    v_fma_f32 v208, v208, v244, v243
    v_fma_f32 v209, v209, v244, v243
    v_fma_f32 v210, v210, v244, v243
    v_fma_f32 v211, v211, v244, v243
    s_add_u32 s10, s8, 0
    v_mul_f32 v204, v204, v148
    v_mul_f32 v205, v205, v149
    v_mul_f32 v206, v206, v150
    v_mul_f32 v207, v207, v151
    v_mul_f32 v208, v208, v152
    v_mul_f32 v209, v209, v153
    v_mul_f32 v210, v210, v154
    v_mul_f32 v211, v211, v155
    buffer_load_dwordx4 v254, s[16:19], s10 offen offset:512 lds
    v_exp_f32 v204, v204
    v_exp_f32 v205, v205
    v_exp_f32 v206, v206
    v_exp_f32 v207, v207
    v_exp_f32 v208, v208
    v_exp_f32 v209, v209
    v_exp_f32 v210, v210
    v_exp_f32 v211, v211
    buffer_load_dwordx4 v12, s[16:19], s10 offen offset:1536 lds
    v_fma_f32 v204, v204, v245, v245
    v_fma_f32 v205, v205, v245, v245
    v_fma_f32 v206, v206, v245, v245
    v_fma_f32 v207, v207, v245, v245
    v_fma_f32 v208, v208, v245, v245
    v_fma_f32 v209, v209, v245, v245
    v_fma_f32 v210, v210, v245, v245
    v_fma_f32 v211, v211, v245, v245
    buffer_load_dwordx4 v13, s[16:19], s10 offen offset:2560 lds
    v_rcp_f32 v204, v204
    v_rcp_f32 v205, v205
    v_rcp_f32 v206, v206
    v_rcp_f32 v207, v207
    v_rcp_f32 v208, v208
    v_rcp_f32 v209, v209
    v_rcp_f32 v210, v210
    v_rcp_f32 v211, v211
    buffer_load_dwordx4 v14, s[16:19], s10 offen offset:3584 lds
    v_mul_f32 v148, v148, v204
    v_mul_f32 v149, v149, v205
    v_mul_f32 v150, v150, v206
    v_mul_f32 v151, v151, v207
    v_mul_f32 v152, v152, v208
    v_mul_f32 v153, v153, v209
    v_mul_f32 v154, v154, v210
    v_mul_f32 v155, v155, v211
    s_mov_b32 exec_hi, 0
    buffer_load_dwordx4 v253, s[16:19], s10 offen lds
    s_mov_b32 exec_hi, -1
    v_cvt_pk_bf16_f32 v148, v148, v149
    v_cvt_pk_bf16_f32 v149, v150, v151
    v_cvt_pk_bf16_f32 v150, v152, v153
    v_cvt_pk_bf16_f32 v151, v154, v155
    buffer_store_dwordx4 v[148:151], v242, s[28:31], s48 offen offset:0 sc1
    v_mul_f32 v204, v156, v156
    v_mul_f32 v205, v157, v157
    v_mul_f32 v206, v158, v158
    s_add_u32 m0, s9, 100352
    v_mul_f32 v207, v159, v159
    v_mul_f32 v208, v160, v160
    v_mul_f32 v209, v161, v161
    v_mul_f32 v210, v162, v162
    v_mul_f32 v211, v163, v163
    v_fma_f32 v204, v204, v244, v243
    v_fma_f32 v205, v205, v244, v243
    v_fma_f32 v206, v206, v244, v243
    s_add_u32 s10, s8, 442368
    v_fma_f32 v207, v207, v244, v243
    v_fma_f32 v208, v208, v244, v243
    v_fma_f32 v209, v209, v244, v243
    v_fma_f32 v210, v210, v244, v243
    v_fma_f32 v211, v211, v244, v243
    v_mul_f32 v204, v204, v156
    v_mul_f32 v205, v205, v157
    v_mul_f32 v206, v206, v158
    buffer_load_dwordx4 v254, s[16:19], s10 offen offset:512 lds
    v_mul_f32 v207, v207, v159
    v_mul_f32 v208, v208, v160
    v_mul_f32 v209, v209, v161
    v_mul_f32 v210, v210, v162
    v_mul_f32 v211, v211, v163
    v_exp_f32 v204, v204
    v_exp_f32 v205, v205
    v_exp_f32 v206, v206
    buffer_load_dwordx4 v12, s[16:19], s10 offen offset:1536 lds
    v_exp_f32 v207, v207
    v_exp_f32 v208, v208
    v_exp_f32 v209, v209
    v_exp_f32 v210, v210
    v_exp_f32 v211, v211
    v_fma_f32 v204, v204, v245, v245
    v_fma_f32 v205, v205, v245, v245
    v_fma_f32 v206, v206, v245, v245
    buffer_load_dwordx4 v13, s[16:19], s10 offen offset:2560 lds
    v_fma_f32 v207, v207, v245, v245
    v_fma_f32 v208, v208, v245, v245
    v_fma_f32 v209, v209, v245, v245
    v_fma_f32 v210, v210, v245, v245
    v_fma_f32 v211, v211, v245, v245
    v_rcp_f32 v204, v204
    v_rcp_f32 v205, v205
    v_rcp_f32 v206, v206
    buffer_load_dwordx4 v14, s[16:19], s10 offen offset:3584 lds
    v_rcp_f32 v207, v207
    v_rcp_f32 v208, v208
    v_rcp_f32 v209, v209
    v_rcp_f32 v210, v210
    v_rcp_f32 v211, v211
    v_mul_f32 v156, v156, v204
    v_mul_f32 v157, v157, v205
    v_mul_f32 v158, v158, v206
    s_mov_b32 exec_hi, 0
    buffer_load_dwordx4 v253, s[16:19], s10 offen lds
    s_mov_b32 exec_hi, -1
    v_mul_f32 v159, v159, v207
    v_mul_f32 v160, v160, v208
    v_mul_f32 v161, v161, v209
    v_mul_f32 v162, v162, v210
    v_mul_f32 v163, v163, v211
    v_cvt_pk_bf16_f32 v156, v156, v157
    v_cvt_pk_bf16_f32 v157, v158, v159
    v_cvt_pk_bf16_f32 v158, v160, v161
    v_cvt_pk_bf16_f32 v159, v162, v163
    buffer_store_dwordx4 v[156:159], v242, s[28:31], s48 offen offset:1024 sc1
    s_add_u32 s48, s48, 4096
    s_setprio 3
    s_waitcnt lgkmcnt(0)
    v_mfma_f32_32x32x16_bf16 v[164:179], v[212:215], v[216:219], v[164:179]
    s_setprio 0
    s_nop 10
    v_mul_f32 v204, v164, v164
    v_mul_f32 v205, v165, v165
    v_mul_f32 v206, v166, v166
    v_mul_f32 v207, v167, v167
    v_mul_f32 v208, v168, v168
    v_mul_f32 v209, v169, v169
    v_mul_f32 v210, v170, v170
    v_mul_f32 v211, v171, v171
    v_fma_f32 v204, v204, v244, v243
    v_fma_f32 v205, v205, v244, v243
    v_fma_f32 v206, v206, v244, v243
    v_fma_f32 v207, v207, v244, v243
    v_fma_f32 v208, v208, v244, v243
    v_fma_f32 v209, v209, v244, v243
    v_fma_f32 v210, v210, v244, v243
    s_add_u32 m0, s9, 118784
    v_fma_f32 v211, v211, v244, v243
    v_mul_f32 v204, v204, v164
    v_mul_f32 v205, v205, v165
    v_mul_f32 v206, v206, v166
    v_mul_f32 v207, v207, v167
    v_mul_f32 v208, v208, v168
    v_mul_f32 v209, v209, v169
    v_mul_f32 v210, v210, v170
    v_mul_f32 v211, v211, v171
    v_exp_f32 v204, v204
    v_exp_f32 v205, v205
    v_exp_f32 v206, v206
    v_exp_f32 v207, v207
    v_exp_f32 v208, v208
    v_exp_f32 v209, v209
    s_add_u32 s10, s8, 884736
    v_exp_f32 v210, v210
    v_exp_f32 v211, v211
    v_fma_f32 v204, v204, v245, v245
    v_fma_f32 v205, v205, v245, v245
    v_fma_f32 v206, v206, v245, v245
    v_fma_f32 v207, v207, v245, v245
    v_fma_f32 v208, v208, v245, v245
    v_fma_f32 v209, v209, v245, v245
    v_fma_f32 v210, v210, v245, v245
    v_fma_f32 v211, v211, v245, v245
    v_rcp_f32 v204, v204
    v_rcp_f32 v205, v205
    v_rcp_f32 v206, v206
    v_rcp_f32 v207, v207
    v_rcp_f32 v208, v208
    buffer_load_dwordx4 v254, s[16:19], s10 offen offset:512 lds
    v_rcp_f32 v209, v209
    v_rcp_f32 v210, v210
    v_rcp_f32 v211, v211
    v_mul_f32 v164, v164, v204
    v_mul_f32 v165, v165, v205
    v_mul_f32 v166, v166, v206
    v_mul_f32 v167, v167, v207
    v_mul_f32 v168, v168, v208
    v_mul_f32 v169, v169, v209
    v_mul_f32 v170, v170, v210
    v_mul_f32 v171, v171, v211
    v_cvt_pk_bf16_f32 v164, v164, v165
    v_cvt_pk_bf16_f32 v165, v166, v167
    v_cvt_pk_bf16_f32 v166, v168, v169
    v_cvt_pk_bf16_f32 v167, v170, v171
    buffer_load_dwordx4 v12, s[16:19], s10 offen offset:1536 lds
    buffer_store_dwordx4 v[164:167], v242, s[28:31], s48 offen offset:0 sc1
    v_mul_f32 v204, v172, v172
    v_mul_f32 v205, v173, v173
    v_mul_f32 v206, v174, v174
    v_mul_f32 v207, v175, v175
    v_mul_f32 v208, v176, v176
    v_mul_f32 v209, v177, v177
    v_mul_f32 v210, v178, v178
    v_mul_f32 v211, v179, v179
    v_fma_f32 v204, v204, v244, v243
    v_fma_f32 v205, v205, v244, v243
    v_fma_f32 v206, v206, v244, v243
    v_fma_f32 v207, v207, v244, v243
    v_fma_f32 v208, v208, v244, v243
    v_fma_f32 v209, v209, v244, v243
    buffer_load_dwordx4 v13, s[16:19], s10 offen offset:2560 lds
    v_fma_f32 v210, v210, v244, v243
    v_fma_f32 v211, v211, v244, v243
    v_mul_f32 v204, v204, v172
    v_mul_f32 v205, v205, v173
    v_mul_f32 v206, v206, v174
    v_mul_f32 v207, v207, v175
    v_mul_f32 v208, v208, v176
    v_mul_f32 v209, v209, v177
    v_mul_f32 v210, v210, v178
    v_mul_f32 v211, v211, v179
    v_exp_f32 v204, v204
    v_exp_f32 v205, v205
    v_exp_f32 v206, v206
    v_exp_f32 v207, v207
    v_exp_f32 v208, v208
    buffer_load_dwordx4 v14, s[16:19], s10 offen offset:3584 lds
    v_exp_f32 v209, v209
    v_exp_f32 v210, v210
    v_exp_f32 v211, v211
    v_fma_f32 v204, v204, v245, v245
    v_fma_f32 v205, v205, v245, v245
    v_fma_f32 v206, v206, v245, v245
    v_fma_f32 v207, v207, v245, v245
    v_fma_f32 v208, v208, v245, v245
    v_fma_f32 v209, v209, v245, v245
    v_fma_f32 v210, v210, v245, v245
    v_fma_f32 v211, v211, v245, v245
    v_rcp_f32 v204, v204
    v_rcp_f32 v205, v205
    v_rcp_f32 v206, v206
    v_rcp_f32 v207, v207
    s_mov_b32 exec_hi, 0
    buffer_load_dwordx4 v253, s[16:19], s10 offen lds
    s_mov_b32 exec_hi, -1
    v_rcp_f32 v208, v208
    v_rcp_f32 v209, v209
    v_rcp_f32 v210, v210
    v_rcp_f32 v211, v211
    v_mul_f32 v172, v172, v204
    v_mul_f32 v173, v173, v205
    v_mul_f32 v174, v174, v206
    v_mul_f32 v175, v175, v207
    v_mul_f32 v176, v176, v208
    v_mul_f32 v177, v177, v209
    v_mul_f32 v178, v178, v210
    v_mul_f32 v179, v179, v211
    v_cvt_pk_bf16_f32 v172, v172, v173
    v_cvt_pk_bf16_f32 v173, v174, v175
    v_cvt_pk_bf16_f32 v174, v176, v177
    v_cvt_pk_bf16_f32 v175, v178, v179
    buffer_store_dwordx4 v[172:175], v242, s[28:31], s48 offen offset:1024 sc1
    s_add_u32 s48, s48, 4096
    s_branch p2_gemm
p1_qkv:
    s_mov_b32 s20, s6
    s_and_b32 s21, s7, 0xffff
    s_mov_b32 s22, 0x1e6000
    s_mov_b32 s23, 0x20000
    s_mul_i32 s50, s35, 14
    s_lshl_b32 s51, s50, 6
    s_add_u32 s46, s46, s51
    s_add_u32 m0, s47, 8192
    s_add_u32 s40, s46, 0
    buffer_load_dwordx4 v240, s[20:23], s40 offen lds
    s_mov_b32 s24, s12
    s_and_b32 s25, s13, 0xffff
    s_mov_b32 s26, 0x480
    s_mov_b32 s27, 0x20000
    s_mov_b32 s4, s8
    s_and_b32 s5, s9, 0xffff
    s_mov_b32 s6, 0x100
    s_mov_b32 s7, 0x20000
    s_lshl_b32 s40, s32, 8
    s_add_u32 s40, s40, 161792
    s_cmp_lt_u32 s32, 5
    s_cselect_b32 m0, s40, 163840
    v_lshlrev_b32 v242, 2, v0
    buffer_load_dword v242, s[24:27], 0 offen lds
    s_mul_i32 s54, s36, 124416
    s_add_u32 s54, s54, s51
    v_min_u32 v248, 35, v246
    v_mul_u32_u24 v248, 3456, v248
    s_lshl_b32 s40, s43, 3
    s_add_u32 s40, s40, s32
    s_mul_i32 s40, s40, 1152
    v_min_u32 v251, 8, v246
    v_lshlrev_b32 v251, 7, v251
    buffer_load_dword v247, v251, s[16:19], s40 offen
    s_lshl_b32 s40, s32, 7
    s_add_u32 s40, s40, s54
    s_cmp_lt_u32 s32, 7
    s_cselect_b32 s40, s40, 0x40000000
    buffer_load_dword v247, v248, s[20:23], s40 offen offset:0
    s_add_u32 m0, s45, 106496
    s_add_u32 s41, s44, 128
    buffer_load_dwordx4 v208, s[16:19], s41 offen lds
    s_add_u32 m0, s45, 107520
    s_add_u32 s41, s44, 9344
    buffer_load_dwordx4 v209, s[16:19], s41 offen lds
    s_add_u32 m0, s47, 16384
    s_add_u32 s40, s46, 221184
    buffer_load_dwordx4 v240, s[20:23], s40 offen lds
    s_add_u32 m0, s45, 122880
    s_add_u32 s41, s44, 256
    buffer_load_dwordx4 v208, s[16:19], s41 offen lds
    s_add_u32 m0, s45, 123904
    s_add_u32 s41, s44, 9472
    buffer_load_dwordx4 v209, s[16:19], s41 offen lds
    s_add_u32 m0, s47, 24576
    s_add_u32 s40, s46, 442368
    buffer_load_dwordx4 v240, s[20:23], s40 offen lds
    s_lshl_b32 s40, s34, 1
    s_xor_b32 s40, s40, s33
    s_lshr_b32 s41, s40, 1
    s_and_b32 s40, s40, 1
    v_lshlrev_b32 v229, 6, v228
    v_lshl_add_u32 v229, v231, 3, v229
    v_lshl_add_u32 v229, v230, 5, v229
    v_lshl_add_u32 v229, v241, 11, v229
    s_lshl_b32 s42, s34, 8
    s_lshl_b32 s12, s41, 12
    s_add_u32 s42, s42, s12
    s_lshl_b32 s12, s40, 10
    s_add_u32 s42, s42, s12
    v_add_u32 v232, s42, v229
    v_xor_b32 v234, 1024, v232
    v_xor_b32 v236, 4096, v232
    v_xor_b32 v238, 5120, v232
    v_add_u32 v233, 0x10000, v232
    v_add_u32 v235, 0x10000, v234
    v_add_u32 v237, 0x10000, v236
    v_add_u32 v239, 0x10000, v238
    s_lshl_b32 s41, s41, 6
    s_lshl_b32 s40, s40, 4
    s_add_u32 s40, s40, s41
    v_and_b32 v228, 31, v246
    v_bfe_u32 v229, v228, 1, 3
    v_lshlrev_b32 v230, 1, v241
    v_xor_b32 v229, v229, v230
    v_lshlrev_b32 v229, 4, v229
    v_lshl_add_u32 v229, v228, 7, v229
    v_xor_b32 v229, s40, v229
    s_lshl_b32 s41, s33, 12
    s_add_u32 s41, s41, 90112
    v_add_u32 v204, s41, v229
    v_xor_b32 v205, 16, v204
    v_xor_b32 v206, 64, v204
    v_xor_b32 v207, 80, v204
    s_add_u32 s40, s40, 161792
    v_lshl_add_u32 v210, v241, 5, s40
    v_xor_b32 v211, 16, v210
    v_lshlrev_b32 v242, 4, v246
    s_mov_b32 s52, 0x3f803f80
    v_mov_b32 v216, 0
    v_mov_b32 v217, 0
    v_mov_b32 v218, 0
    v_mov_b32 v230, 0
    v_mov_b32 v231, 0
    v_mov_b32 v229, 163328
    ds_write_b64 v229, v[230:231]
    ds_write_b64 v229, v[230:231] offset:8
    ds_write_b64 v229, v[230:231] offset:16
    s_and_b32 s40, s36, 7
    s_mul_i32 s40, s40, 72
    s_add_u32 s40, s40, s32
    v_min_u32 v251, 8, v246
    v_add_u32 v251, s40, v251
    v_mul_u32_u24 v251, 3456, v251
    s_getpc_b64 s[100:101]
here_8:
    s_sub_u32 s100, s100, here_8-mk_kernel
    s_subb_u32 s101, s101, 0
    s_mul_i32 s40, s39, 3072
    s_mul_i32 s41, s32, 384
    s_add_u32 s40, s40, s41
    v_min_u32 v252, 2, v246
    v_lshl_add_u32 v252, v252, 7, s40
    s_mov_b32 s40, all_code_end-mk_kernel-4
    v_min_u32 v252, s40, v252
    global_load_dword v247, v252, s[100:101]
    s_add_u32 s50, s50, s34
    s_mul_i32 s48, s38, 108
    s_lshl_b32 s40, s50, 1
    s_add_u32 s48, s48, s40
    s_lshl_b32 s48, s48, 10
    s_add_u32 s48, s48, 0x1200000
    s_waitcnt vmcnt(9) lgkmcnt(0)
    s_barrier
    ds_read_b128 v[4:7], v204 offset:0
    ds_read_b128 v[8:11], v205 offset:0
    ds_read_b128 v[12:15], v206 offset:0
    ds_read_b128 v[16:19], v207 offset:0
    ds_read_b64_tr_b16 v[180:181], v232 offset:8192
    ds_read_b64_tr_b16 v[182:183], v232 offset:8704
    ds_read_b64_tr_b16 v[184:185], v234 offset:8192
    ds_read_b64_tr_b16 v[186:187], v234 offset:8704
    ds_read_b64_tr_b16 v[188:189], v236 offset:8192
    ds_read_b64_tr_b16 v[190:191], v236 offset:8704
    ds_read_b64_tr_b16 v[192:193], v238 offset:8192
    ds_read_b64_tr_b16 v[194:195], v238 offset:8704
    ds_read_b128 v[164:167], v210 offset:0
    ds_read_b128 v[168:171], v211 offset:0
    s_add_u32 m0, s45, 139264
    s_add_u32 s41, s44, 384
    buffer_load_dwordx4 v208, s[16:19], s41 offen lds
    s_add_u32 m0, s45, 140288
    s_add_u32 s41, s44, 9600
    buffer_load_dwordx4 v209, s[16:19], s41 offen lds
    s_add_u32 m0, s47, 32768
    s_add_u32 s40, s46, 663552
    buffer_load_dwordx4 v240, s[20:23], s40 offen lds
    s_waitcnt vmcnt(7) lgkmcnt(0)
    s_barrier
    ds_read_b128 v[20:23], v204 offset:16384
    ds_read_b128 v[24:27], v205 offset:16384
    ds_read_b128 v[28:31], v206 offset:16384
    ds_read_b128 v[32:35], v207 offset:16384
    ds_read_b64_tr_b16 v[196:197], v232 offset:16384
    ds_read_b64_tr_b16 v[198:199], v232 offset:16896
    ds_read_b64_tr_b16 v[200:201], v234 offset:16384
    ds_read_b64_tr_b16 v[202:203], v234 offset:16896
    ds_read_b64_tr_b16 v[212:213], v236 offset:16384
    ds_read_b64_tr_b16 v[214:215], v236 offset:16896
    ds_read_b64_tr_b16 v[228:229], v238 offset:16384
    ds_read_b64_tr_b16 v[230:231], v238 offset:16896
    ds_read_b128 v[172:175], v210 offset:128
    ds_read_b128 v[176:179], v211 offset:128
    v_mfma_f32_32x32x16_bf16 v[148:163], v[180:183], v[4:7], 0
    s_add_u32 m0, s45, 90112
    s_add_u32 s41, s44, 512
    buffer_load_dwordx4 v208, s[16:19], s41 offen lds
    v_mfma_f32_32x32x16_bf16 v[148:163], v[184:187], v[8:11], v[148:163]
    s_add_u32 m0, s45, 91136
    s_add_u32 s41, s44, 9728
    buffer_load_dwordx4 v209, s[16:19], s41 offen lds
    v_mfma_f32_32x32x16_bf16 v[148:163], v[188:191], v[12:15], v[148:163]
    s_add_u32 m0, s47, 40960
    s_add_u32 s40, s46, 884736
    buffer_load_dwordx4 v240, s[20:23], s40 offen lds
    v_mfma_f32_32x32x16_bf16 v[148:163], v[192:195], v[16:19], v[148:163]
    v_dot2_f32_bf16 v218, v4, v164, v218
    v_dot2_f32_bf16 v218, v5, v165, v218
    v_dot2_f32_bf16 v218, v6, v166, v218
    v_dot2_f32_bf16 v218, v7, v167, v218
    v_dot2_f32_bf16 v218, v8, v168, v218
    v_dot2_f32_bf16 v218, v9, v169, v218
    v_dot2_f32_bf16 v218, v10, v170, v218
    v_dot2_f32_bf16 v218, v11, v171, v218
    s_waitcnt vmcnt(7) lgkmcnt(0)
    s_barrier
    ds_read_b128 v[36:39], v204 offset:32768
    ds_read_b128 v[40:43], v205 offset:32768
    ds_read_b128 v[44:47], v206 offset:32768
    ds_read_b128 v[48:51], v207 offset:32768
    ds_read_b64_tr_b16 v[180:181], v232 offset:24576
    ds_read_b64_tr_b16 v[182:183], v232 offset:25088
    ds_read_b64_tr_b16 v[184:185], v234 offset:24576
    ds_read_b64_tr_b16 v[186:187], v234 offset:25088
    ds_read_b64_tr_b16 v[188:189], v236 offset:24576
    ds_read_b64_tr_b16 v[190:191], v236 offset:25088
    ds_read_b64_tr_b16 v[192:193], v238 offset:24576
    ds_read_b64_tr_b16 v[194:195], v238 offset:25088
    ds_read_b128 v[164:167], v210 offset:256
    ds_read_b128 v[168:171], v211 offset:256
    v_mfma_f32_32x32x16_bf16 v[148:163], v[196:199], v[20:23], v[148:163]
    s_add_u32 m0, s45, 106496
    s_add_u32 s41, s44, 640
    buffer_load_dwordx4 v208, s[16:19], s41 offen lds
    v_mfma_f32_32x32x16_bf16 v[148:163], v[200:203], v[24:27], v[148:163]
    s_add_u32 m0, s45, 107520
    s_add_u32 s41, s44, 9856
    buffer_load_dwordx4 v209, s[16:19], s41 offen lds
    v_mfma_f32_32x32x16_bf16 v[148:163], v[212:215], v[28:31], v[148:163]
    s_add_u32 m0, s47, 49152
    s_add_u32 s40, s46, 1105920
    buffer_load_dwordx4 v240, s[20:23], s40 offen lds
    v_mfma_f32_32x32x16_bf16 v[148:163], v[228:231], v[32:35], v[148:163]
    v_dot2_f32_bf16 v218, v20, v172, v218
    v_dot2_f32_bf16 v218, v21, v173, v218
    v_dot2_f32_bf16 v218, v22, v174, v218
    v_dot2_f32_bf16 v218, v23, v175, v218
    v_dot2_f32_bf16 v218, v24, v176, v218
    v_dot2_f32_bf16 v218, v25, v177, v218
    v_dot2_f32_bf16 v218, v26, v178, v218
    v_dot2_f32_bf16 v218, v27, v179, v218
    s_waitcnt vmcnt(6) lgkmcnt(0)
    s_barrier
    ds_read_b128 v[52:55], v204 offset:49152
    ds_read_b128 v[56:59], v205 offset:49152
    ds_read_b128 v[60:63], v206 offset:49152
    ds_read_b128 v[64:67], v207 offset:49152
    ds_read_b64_tr_b16 v[196:197], v232 offset:32768
    ds_read_b64_tr_b16 v[198:199], v232 offset:33280
    ds_read_b64_tr_b16 v[200:201], v234 offset:32768
    ds_read_b64_tr_b16 v[202:203], v234 offset:33280
    ds_read_b64_tr_b16 v[212:213], v236 offset:32768
    ds_read_b64_tr_b16 v[214:215], v236 offset:33280
    ds_read_b64_tr_b16 v[228:229], v238 offset:32768
    ds_read_b64_tr_b16 v[230:231], v238 offset:33280
    ds_read_b128 v[172:175], v210 offset:384
    ds_read_b128 v[176:179], v211 offset:384
    v_mfma_f32_32x32x16_bf16 v[148:163], v[180:183], v[36:39], v[148:163]
    s_add_u32 m0, s45, 122880
    s_add_u32 s41, s44, 768
    buffer_load_dwordx4 v208, s[16:19], s41 offen lds
    v_mfma_f32_32x32x16_bf16 v[148:163], v[184:187], v[40:43], v[148:163]
    s_add_u32 m0, s45, 123904
    s_add_u32 s41, s44, 9984
    buffer_load_dwordx4 v209, s[16:19], s41 offen lds
    v_mfma_f32_32x32x16_bf16 v[148:163], v[188:191], v[44:47], v[148:163]
    s_add_u32 m0, s47, 57344
    s_add_u32 s40, s46, 1327104
    buffer_load_dwordx4 v240, s[20:23], s40 offen lds
    v_mfma_f32_32x32x16_bf16 v[148:163], v[192:195], v[48:51], v[148:163]
    v_dot2_f32_bf16 v218, v36, v164, v218
    v_dot2_f32_bf16 v218, v37, v165, v218
    v_dot2_f32_bf16 v218, v38, v166, v218
    v_dot2_f32_bf16 v218, v39, v167, v218
    v_dot2_f32_bf16 v218, v40, v168, v218
    v_dot2_f32_bf16 v218, v41, v169, v218
    v_dot2_f32_bf16 v218, v42, v170, v218
    v_dot2_f32_bf16 v218, v43, v171, v218
    s_waitcnt vmcnt(6) lgkmcnt(0)
    s_barrier
    ds_read_b128 v[68:71], v204 offset:0
    ds_read_b128 v[72:75], v205 offset:0
    ds_read_b128 v[76:79], v206 offset:0
    ds_read_b128 v[80:83], v207 offset:0
    ds_read_b64_tr_b16 v[180:181], v232 offset:40960
    ds_read_b64_tr_b16 v[182:183], v232 offset:41472
    ds_read_b64_tr_b16 v[184:185], v234 offset:40960
    ds_read_b64_tr_b16 v[186:187], v234 offset:41472
    ds_read_b64_tr_b16 v[188:189], v236 offset:40960
    ds_read_b64_tr_b16 v[190:191], v236 offset:41472
    ds_read_b64_tr_b16 v[192:193], v238 offset:40960
    ds_read_b64_tr_b16 v[194:195], v238 offset:41472
    ds_read_b128 v[164:167], v210 offset:512
    ds_read_b128 v[168:171], v211 offset:512
    v_mfma_f32_32x32x16_bf16 v[148:163], v[196:199], v[52:55], v[148:163]
    s_add_u32 m0, s45, 139264
    s_add_u32 s41, s44, 896
    buffer_load_dwordx4 v208, s[16:19], s41 offen lds
    v_mfma_f32_32x32x16_bf16 v[148:163], v[200:203], v[56:59], v[148:163]
    s_add_u32 m0, s45, 140288
    s_add_u32 s41, s44, 10112
    buffer_load_dwordx4 v209, s[16:19], s41 offen lds
    v_mfma_f32_32x32x16_bf16 v[148:163], v[212:215], v[60:63], v[148:163]
    s_add_u32 m0, s47, 65536
    s_add_u32 s40, s46, 1548288
    buffer_load_dwordx4 v240, s[20:23], s40 offen lds
    v_mfma_f32_32x32x16_bf16 v[148:163], v[228:231], v[64:67], v[148:163]
    v_dot2_f32_bf16 v218, v52, v172, v218
    v_dot2_f32_bf16 v218, v53, v173, v218
    v_dot2_f32_bf16 v218, v54, v174, v218
    v_dot2_f32_bf16 v218, v55, v175, v218
    v_dot2_f32_bf16 v218, v56, v176, v218
    v_dot2_f32_bf16 v218, v57, v177, v218
    v_dot2_f32_bf16 v218, v58, v178, v218
    v_dot2_f32_bf16 v218, v59, v179, v218
    s_waitcnt vmcnt(6) lgkmcnt(0)
    s_barrier
    ds_read_b128 v[84:87], v204 offset:16384
    ds_read_b128 v[88:91], v205 offset:16384
    ds_read_b128 v[92:95], v206 offset:16384
    ds_read_b128 v[96:99], v207 offset:16384
    ds_read_b64_tr_b16 v[196:197], v232 offset:49152
    ds_read_b64_tr_b16 v[198:199], v232 offset:49664
    ds_read_b64_tr_b16 v[200:201], v234 offset:49152
    ds_read_b64_tr_b16 v[202:203], v234 offset:49664
    ds_read_b64_tr_b16 v[212:213], v236 offset:49152
    ds_read_b64_tr_b16 v[214:215], v236 offset:49664
    ds_read_b64_tr_b16 v[228:229], v238 offset:49152
    ds_read_b64_tr_b16 v[230:231], v238 offset:49664
    ds_read_b128 v[172:175], v210 offset:640
    ds_read_b128 v[176:179], v211 offset:640
    v_mfma_f32_32x32x16_bf16 v[148:163], v[180:183], v[68:71], v[148:163]
    s_add_u32 m0, s45, 90112
    s_add_u32 s41, s44, 1024
    buffer_load_dwordx4 v208, s[16:19], s41 offen lds
    v_mfma_f32_32x32x16_bf16 v[148:163], v[184:187], v[72:75], v[148:163]
    s_add_u32 m0, s45, 91136
    s_add_u32 s41, s44, 10240
    buffer_load_dwordx4 v209, s[16:19], s41 offen lds
    v_mfma_f32_32x32x16_bf16 v[148:163], v[188:191], v[76:79], v[148:163]
    s_add_u32 m0, s47, 73728
    s_add_u32 s40, s46, 1769472
    buffer_load_dwordx4 v240, s[20:23], s40 offen lds
    v_mfma_f32_32x32x16_bf16 v[148:163], v[192:195], v[80:83], v[148:163]
    v_dot2_f32_bf16 v218, v68, v164, v218
    v_dot2_f32_bf16 v218, v69, v165, v218
    v_dot2_f32_bf16 v218, v70, v166, v218
    v_dot2_f32_bf16 v218, v71, v167, v218
    v_dot2_f32_bf16 v218, v72, v168, v218
    v_dot2_f32_bf16 v218, v73, v169, v218
    v_dot2_f32_bf16 v218, v74, v170, v218
    v_dot2_f32_bf16 v218, v75, v171, v218
    s_waitcnt vmcnt(6) lgkmcnt(0)
    s_barrier
    ds_read_b128 v[100:103], v204 offset:32768
    ds_read_b128 v[104:107], v205 offset:32768
    ds_read_b128 v[108:111], v206 offset:32768
    ds_read_b128 v[112:115], v207 offset:32768
    ds_read_b64_tr_b16 v[180:181], v232 offset:57344
    ds_read_b64_tr_b16 v[182:183], v232 offset:57856
    ds_read_b64_tr_b16 v[184:185], v234 offset:57344
    ds_read_b64_tr_b16 v[186:187], v234 offset:57856
    ds_read_b64_tr_b16 v[188:189], v236 offset:57344
    ds_read_b64_tr_b16 v[190:191], v236 offset:57856
    ds_read_b64_tr_b16 v[192:193], v238 offset:57344
    ds_read_b64_tr_b16 v[194:195], v238 offset:57856
    ds_read_b128 v[164:167], v210 offset:768
    ds_read_b128 v[168:171], v211 offset:768
    v_mfma_f32_32x32x16_bf16 v[148:163], v[196:199], v[84:87], v[148:163]
    s_add_u32 m0, s47, 0
    s_add_u32 s40, s46, 128
    buffer_load_dwordx4 v240, s[20:23], s40 offen lds
    v_mfma_f32_32x32x16_bf16 v[148:163], v[200:203], v[88:91], v[148:163]
    s_add_u32 m0, s47, 81920
    s_add_u32 s40, s46, 221312
    buffer_load_dwordx4 v240, s[20:23], s40 offen lds
    v_mfma_f32_32x32x16_bf16 v[148:163], v[212:215], v[92:95], v[148:163]
    s_add_u32 m0, s47, 8192
    s_add_u32 s40, s46, 442496
    buffer_load_dwordx4 v240, s[20:23], s40 offen lds
    v_mfma_f32_32x32x16_bf16 v[148:163], v[228:231], v[96:99], v[148:163]
    v_dot2_f32_bf16 v218, v84, v172, v218
    v_dot2_f32_bf16 v218, v85, v173, v218
    v_dot2_f32_bf16 v218, v86, v174, v218
    v_dot2_f32_bf16 v218, v87, v175, v218
    v_dot2_f32_bf16 v218, v88, v176, v218
    v_dot2_f32_bf16 v218, v89, v177, v218
    v_dot2_f32_bf16 v218, v90, v178, v218
    v_dot2_f32_bf16 v218, v91, v179, v218
    s_waitcnt vmcnt(6) lgkmcnt(0)
    s_barrier
    ds_read_b128 v[116:119], v204 offset:49152
    ds_read_b128 v[120:123], v205 offset:49152
    ds_read_b128 v[124:127], v206 offset:49152
    ds_read_b128 v[128:131], v207 offset:49152
    ds_read_b64_tr_b16 v[196:197], v233 offset:0
    ds_read_b64_tr_b16 v[198:199], v233 offset:512
    ds_read_b64_tr_b16 v[200:201], v235 offset:0
    ds_read_b64_tr_b16 v[202:203], v235 offset:512
    ds_read_b64_tr_b16 v[212:213], v237 offset:0
    ds_read_b64_tr_b16 v[214:215], v237 offset:512
    ds_read_b64_tr_b16 v[228:229], v239 offset:0
    ds_read_b64_tr_b16 v[230:231], v239 offset:512
    ds_read_b128 v[172:175], v210 offset:896
    ds_read_b128 v[176:179], v211 offset:896
    v_mfma_f32_32x32x16_bf16 v[148:163], v[180:183], v[100:103], v[148:163]
    s_add_u32 m0, s47, 16384
    s_add_u32 s40, s46, 663680
    buffer_load_dwordx4 v240, s[20:23], s40 offen lds
    v_mfma_f32_32x32x16_bf16 v[148:163], v[184:187], v[104:107], v[148:163]
    s_add_u32 m0, s47, 24576
    s_add_u32 s40, s46, 884864
    buffer_load_dwordx4 v240, s[20:23], s40 offen lds
    v_mfma_f32_32x32x16_bf16 v[148:163], v[188:191], v[108:111], v[148:163]
    s_add_u32 m0, s47, 32768
    s_add_u32 s40, s46, 1106048
    buffer_load_dwordx4 v240, s[20:23], s40 offen lds
    v_mfma_f32_32x32x16_bf16 v[148:163], v[192:195], v[112:115], v[148:163]
    v_dot2_f32_bf16 v218, v100, v164, v218
    v_dot2_f32_bf16 v218, v101, v165, v218
    v_dot2_f32_bf16 v218, v102, v166, v218
    v_dot2_f32_bf16 v218, v103, v167, v218
    v_dot2_f32_bf16 v218, v104, v168, v218
    v_dot2_f32_bf16 v218, v105, v169, v218
    v_dot2_f32_bf16 v218, v106, v170, v218
    v_dot2_f32_bf16 v218, v107, v171, v218
    s_waitcnt vmcnt(6) lgkmcnt(0)
    s_barrier
    ds_read_b128 v[132:135], v204 offset:0
    ds_read_b128 v[136:139], v205 offset:0
    ds_read_b128 v[140:143], v206 offset:0
    ds_read_b128 v[144:147], v207 offset:0
    ds_read_b64_tr_b16 v[180:181], v233 offset:8192
    ds_read_b64_tr_b16 v[182:183], v233 offset:8704
    ds_read_b64_tr_b16 v[184:185], v235 offset:8192
    ds_read_b64_tr_b16 v[186:187], v235 offset:8704
    ds_read_b64_tr_b16 v[188:189], v237 offset:8192
    ds_read_b64_tr_b16 v[190:191], v237 offset:8704
    ds_read_b64_tr_b16 v[192:193], v239 offset:8192
    ds_read_b64_tr_b16 v[194:195], v239 offset:8704
    ds_read_b128 v[164:167], v210 offset:1024
    ds_read_b128 v[168:171], v211 offset:1024
    v_mfma_f32_32x32x16_bf16 v[148:163], v[196:199], v[116:119], v[148:163]
    s_add_u32 m0, s47, 40960
    s_add_u32 s40, s46, 1327232
    buffer_load_dwordx4 v240, s[20:23], s40 offen lds
    v_mfma_f32_32x32x16_bf16 v[148:163], v[200:203], v[120:123], v[148:163]
    s_add_u32 m0, s47, 49152
    s_add_u32 s40, s46, 1548416
    buffer_load_dwordx4 v240, s[20:23], s40 offen lds
    v_mfma_f32_32x32x16_bf16 v[148:163], v[212:215], v[124:127], v[148:163]
    s_add_u32 m0, s47, 57344
    s_add_u32 s40, s46, 1769600
    buffer_load_dwordx4 v240, s[20:23], s40 offen lds
    v_mfma_f32_32x32x16_bf16 v[148:163], v[228:231], v[128:131], v[148:163]
    buffer_load_dword v247, v251, s[20:23], s46 offen offset:256
    v_dot2_f32_bf16 v218, v116, v172, v218
    v_dot2_f32_bf16 v218, v117, v173, v218
    v_dot2_f32_bf16 v218, v118, v174, v218
    v_dot2_f32_bf16 v218, v119, v175, v218
    v_dot2_f32_bf16 v218, v120, v176, v218
    v_dot2_f32_bf16 v218, v121, v177, v218
    v_dot2_f32_bf16 v218, v122, v178, v218
    v_dot2_f32_bf16 v218, v123, v179, v218
    s_waitcnt lgkmcnt(8)
    v_mfma_f32_32x32x16_bf16 v[148:163], v[180:183], v[132:135], v[148:163]
    s_waitcnt lgkmcnt(6)
    v_mfma_f32_32x32x16_bf16 v[148:163], v[184:187], v[136:139], v[148:163]
    s_waitcnt lgkmcnt(4)
    v_mfma_f32_32x32x16_bf16 v[148:163], v[188:191], v[140:143], v[148:163]
    s_waitcnt lgkmcnt(2)
    v_mfma_f32_32x32x16_bf16 v[148:163], v[192:195], v[144:147], v[148:163]
    s_waitcnt lgkmcnt(1)
    v_dot2_f32_bf16 v218, v132, v164, v218
    v_dot2_f32_bf16 v218, v133, v165, v218
    v_dot2_f32_bf16 v218, v134, v166, v218
    v_dot2_f32_bf16 v218, v135, v167, v218
    s_waitcnt lgkmcnt(0)
    v_dot2_f32_bf16 v218, v136, v168, v218
    v_dot2_f32_bf16 v218, v137, v169, v218
    v_dot2_f32_bf16 v218, v138, v170, v218
    v_dot2_f32_bf16 v218, v139, v171, v218
    s_lshl_b32 s40, s32, 10
    s_add_u32 s40, s40, 147456
    v_add_u32 v243, s40, v242
    ds_write_b96 v243, v[216:218]
    v_xor_b32 v243, 4096, v243
    s_waitcnt vmcnt(4) lgkmcnt(0)
    s_barrier
    s_cmp_lg_u32 s32, 0
    s_cbranch_scc1 ws_9
    s_mov_b64 exec, 1
    v_mov_b32 v228, 1
    buffer_store_byte v228, off, s[4:7], s43 sc1
    s_mov_b64 exec, -1
ws_9:
    s_sub_u32 s92, s92, 4096
    s_subb_u32 s93, s93, 0
    s_sub_u32 s96, s96, 4096
    s_subb_u32 s97, s97, 0
    s_mov_b32 s16, s92
    s_and_b32 s17, s93, 0xffff
    s_mov_b32 s18, 0x511000
    s_mov_b32 s19, 0x20000
    s_mov_b32 s24, s96
    s_and_b32 s25, s97, 0xffff
    s_mov_b32 s26, 0xa3000
    s_mov_b32 s27, 0x20000
    s_lshr_b32 s40, s43, 2
    s_mul_i32 s40, s40, 3
    s_add_u32 s40, s40, s37
    s_lshl_b32 s40, s40, 3
    s_add_u32 s40, s40, s32
    s_mul_i32 s55, s40, 3456
    s_mul_i32 s54, s40, 512
    s_add_u32 s55, s55, 4096
    s_add_u32 s54, s54, 4096
    v_min_u32 v248, 26, v246
    v_lshlrev_b32 v248, 7, v248
    ds_read_b64_tr_b16 v[180:181], v232 offset:0
    ds_read_b64_tr_b16 v[182:183], v232 offset:512
    ds_read_b64_tr_b16 v[184:185], v234 offset:0
    ds_read_b64_tr_b16 v[186:187], v234 offset:512
    ds_read_b64_tr_b16 v[188:189], v236 offset:0
    ds_read_b64_tr_b16 v[190:191], v236 offset:512
    ds_read_b64_tr_b16 v[192:193], v238 offset:0
    ds_read_b64_tr_b16 v[194:195], v238 offset:512
    ds_read_b64_tr_b16 v[196:197], v233 offset:16384
    ds_read_b64_tr_b16 v[198:199], v233 offset:16896
    ds_read_b64_tr_b16 v[200:201], v235 offset:16384
    ds_read_b64_tr_b16 v[202:203], v235 offset:16896
    s_waitcnt lgkmcnt(10)
    v_mfma_f32_32x32x16_bf16 v[164:179], v[180:183], v[4:7], 0
    ds_read_b96 v[228:230], v243
    s_waitcnt lgkmcnt(0)
    v_add_f32 v216, v216, v228
    v_add_f32 v217, v217, v229
    v_add_f32 v218, v218, v230
    v_mov_b32 v228, v216
    s_add_u32 m0, s47, 65536
    s_add_u32 s40, s46, 256
    ds_read_b64_tr_b16 v[180:181], v237 offset:16384
    ds_read_b64_tr_b16 v[182:183], v237 offset:16896
    v_mfma_f32_32x32x16_bf16 v[164:179], v[184:187], v[8:11], v[164:179]
    buffer_load_dwordx4 v240, s[20:23], s40 offen lds
    v_mov_b32 v229, v217
    v_mov_b32 v230, v218
    v_permlane32_swap_b32 v216, v228
    v_permlane32_swap_b32 v217, v229
    ds_read_b64_tr_b16 v[184:185], v239 offset:16384
    ds_read_b64_tr_b16 v[186:187], v239 offset:16896
    v_mfma_f32_32x32x16_bf16 v[164:179], v[188:191], v[12:15], v[164:179]
    v_permlane32_swap_b32 v218, v230
    s_add_u32 m0, s47, 73728
    s_add_u32 s40, s46, 221440
    buffer_load_dwordx4 v240, s[20:23], s40 offen lds
    v_add_f32 v228, v216, v228
    v_add_f32 v229, v217, v229
    v_add_f32 v230, v218, v230
    ds_read_b64_tr_b16 v[188:189], v232 offset:8192
    ds_read_b64_tr_b16 v[190:191], v232 offset:8704
    v_mfma_f32_32x32x16_bf16 v[164:179], v[192:195], v[16:19], v[164:179]
    v_mul_f32 v230, 0xbfb8aa3b, v230
    v_mul_f32 v228, 0xbae38e39, v228
    s_add_u32 m0, s47, 90112
    s_add_u32 s40, s46, 442624
    buffer_load_dwordx4 v240, s[20:23], s40 offen lds
    v_exp_f32 v230, v230
    ds_read_b64_tr_b16 v[192:193], v234 offset:8192
    ds_read_b64_tr_b16 v[194:195], v234 offset:8704
    v_mfma_f32_32x32x16_bf16 v[164:179], v[196:199], v[20:23], v[164:179]
    v_mul_f32 v229, 0x3ae38e39, v229
    v_add_f32 v230, 1.0, v230
    v_fma_f32 v229, -v228, v228, v229
    v_rcp_f32 v255, v230
    s_add_u32 m0, s47, 98304
    s_add_u32 s40, s46, 663808
    buffer_load_dwordx4 v240, s[20:23], s40 offen lds
    ds_read_b64_tr_b16 v[196:197], v236 offset:8192
    ds_read_b64_tr_b16 v[198:199], v236 offset:8704
    v_mfma_f32_32x32x16_bf16 v[164:179], v[200:203], v[24:27], v[164:179]
    s_cmp_lt_i32 s50, 18
    s_cselect_b32 s49, 0x3eae1a93, 1.0
    v_mul_f32 v148, s49, v148
    v_mul_f32 v149, s49, v149
    v_mul_f32 v150, s49, v150
    v_mul_f32 v151, s49, v151
    s_add_u32 m0, s47, 106496
    s_add_u32 s40, s46, 884992
    ds_read_b64_tr_b16 v[200:201], v238 offset:8192
    ds_read_b64_tr_b16 v[202:203], v238 offset:8704
    s_waitcnt lgkmcnt(10)
    v_mfma_f32_32x32x16_bf16 v[164:179], v[180:183], v[28:31], v[164:179]
    buffer_load_dwordx4 v240, s[20:23], s40 offen lds
    v_mul_f32 v152, s49, v152
    v_mul_f32 v153, s49, v153
    v_mul_f32 v154, s49, v154
    v_mul_f32 v155, s49, v155
    ds_read_b64_tr_b16 v[180:181], v232 offset:16384
    ds_read_b64_tr_b16 v[182:183], v232 offset:16896
    s_waitcnt lgkmcnt(10)
    v_mfma_f32_32x32x16_bf16 v[164:179], v[184:187], v[32:35], v[164:179]
    v_mul_f32 v156, s49, v156
    s_add_u32 m0, s47, 114688
    s_add_u32 s40, s46, 1106176
    buffer_load_dwordx4 v240, s[20:23], s40 offen lds
    v_mul_f32 v157, s49, v157
    v_mul_f32 v158, s49, v158
    v_mul_f32 v159, s49, v159
    ds_read_b64_tr_b16 v[184:185], v234 offset:16384
    ds_read_b64_tr_b16 v[186:187], v234 offset:16896
    s_waitcnt lgkmcnt(10)
    v_mfma_f32_32x32x16_bf16 v[164:179], v[188:191], v[36:39], v[164:179]
    v_mul_f32 v160, s49, v160
    v_mul_f32 v161, s49, v161
    v_mul_f32 v162, s49, v162
    v_mul_f32 v163, s49, v163
    v_cvt_pk_bf16_f32 v148, v148, v149
    ds_read_b64_tr_b16 v[188:189], v236 offset:16384
    ds_read_b64_tr_b16 v[190:191], v236 offset:16896
    s_waitcnt lgkmcnt(10)
    v_mfma_f32_32x32x16_bf16 v[164:179], v[192:195], v[40:43], v[164:179]
    v_cvt_pk_bf16_f32 v149, v150, v151
    v_cvt_pk_bf16_f32 v150, v152, v153
    v_cvt_pk_bf16_f32 v151, v154, v155
    buffer_store_dwordx4 v[148:151], v242, s[28:31], s48 offen offset:0 sc1
    v_cvt_pk_bf16_f32 v156, v156, v157
    v_cvt_pk_bf16_f32 v157, v158, v159
    ds_read_b64_tr_b16 v[192:193], v238 offset:16384
    ds_read_b64_tr_b16 v[194:195], v238 offset:16896
    s_waitcnt lgkmcnt(10)
    v_mfma_f32_32x32x16_bf16 v[164:179], v[196:199], v[44:47], v[164:179]
    v_cvt_pk_bf16_f32 v158, v160, v161
    v_cvt_pk_bf16_f32 v159, v162, v163
    buffer_store_dwordx4 v[156:159], v242, s[28:31], s48 offen offset:1024 sc1
    s_add_u32 s48, s48, 4096
    ds_read_b64_tr_b16 v[196:197], v232 offset:24576
    ds_read_b64_tr_b16 v[198:199], v232 offset:25088
    s_waitcnt lgkmcnt(10)
    v_mfma_f32_32x32x16_bf16 v[164:179], v[200:203], v[48:51], v[164:179]
    s_waitcnt vmcnt(9)
    s_barrier
    ds_read_b64_tr_b16 v[200:201], v234 offset:24576
    ds_read_b64_tr_b16 v[202:203], v234 offset:25088
    s_waitcnt lgkmcnt(10)
    v_mfma_f32_32x32x16_bf16 v[164:179], v[180:183], v[52:55], v[164:179]
    s_nop 0
    s_add_u32 m0, s47, 122880
    s_add_u32 s40, s46, 1327360
    ds_read_b64_tr_b16 v[180:181], v236 offset:24576
    ds_read_b64_tr_b16 v[182:183], v236 offset:25088
    s_waitcnt lgkmcnt(10)
    v_mfma_f32_32x32x16_bf16 v[164:179], v[184:187], v[56:59], v[164:179]
    buffer_load_dwordx4 v240, s[20:23], s40 offen lds
    s_nop 0
    s_add_u32 m0, s47, 131072
    s_add_u32 s40, s46, 1548544
    ds_read_b64_tr_b16 v[184:185], v238 offset:24576
    ds_read_b64_tr_b16 v[186:187], v238 offset:25088
    s_waitcnt lgkmcnt(10)
    v_mfma_f32_32x32x16_bf16 v[164:179], v[188:191], v[60:63], v[164:179]
    buffer_load_dwordx4 v240, s[20:23], s40 offen lds
    s_nop 0
    s_add_u32 m0, s47, 139264
    s_add_u32 s40, s46, 1769728
    ds_read_b64_tr_b16 v[188:189], v232 offset:32768
    ds_read_b64_tr_b16 v[190:191], v232 offset:33280
    s_waitcnt lgkmcnt(10)
    v_mfma_f32_32x32x16_bf16 v[164:179], v[192:195], v[64:67], v[164:179]
    buffer_load_dwordx4 v240, s[20:23], s40 offen lds
    s_nop 0
    s_add_u32 m0, s47, 0
    s_add_u32 s40, s46, 384
    ds_read_b64_tr_b16 v[192:193], v234 offset:32768
    ds_read_b64_tr_b16 v[194:195], v234 offset:33280
    s_waitcnt lgkmcnt(10)
    v_mfma_f32_32x32x16_bf16 v[164:179], v[196:199], v[68:71], v[164:179]
    buffer_load_dwordx4 v240, s[20:23], s40 offen lds
    s_nop 0
    s_add_u32 m0, s47, 81920
    s_add_u32 s40, s46, 221568
    ds_read_b64_tr_b16 v[196:197], v236 offset:32768
    ds_read_b64_tr_b16 v[198:199], v236 offset:33280
    s_waitcnt lgkmcnt(10)
    v_mfma_f32_32x32x16_bf16 v[164:179], v[200:203], v[72:75], v[164:179]
    buffer_load_dwordx4 v240, s[20:23], s40 offen lds
    s_nop 0
    s_add_u32 m0, s47, 8192
    ds_read_b64_tr_b16 v[200:201], v238 offset:32768
    ds_read_b64_tr_b16 v[202:203], v238 offset:33280
    s_waitcnt lgkmcnt(10)
    v_mfma_f32_32x32x16_bf16 v[164:179], v[180:183], v[76:79], v[164:179]
    s_add_u32 s40, s46, 442752
    buffer_load_dwordx4 v240, s[20:23], s40 offen lds
    s_nop 0
    s_nop 0
    ds_read_b64_tr_b16 v[180:181], v232 offset:40960
    ds_read_b64_tr_b16 v[182:183], v232 offset:41472
    s_waitcnt lgkmcnt(10)
    v_mfma_f32_32x32x16_bf16 v[164:179], v[184:187], v[80:83], v[164:179]
    s_nop 0
    s_nop 0
    s_nop 0
    s_nop 0
    ds_read_b64_tr_b16 v[184:185], v234 offset:40960
    ds_read_b64_tr_b16 v[186:187], v234 offset:41472
    s_waitcnt lgkmcnt(10)
    v_mfma_f32_32x32x16_bf16 v[164:179], v[188:191], v[84:87], v[164:179]
    buffer_load_dword v247, v251, s[20:23], s46 offen offset:384
    ds_read_b64_tr_b16 v[188:189], v236 offset:40960
    ds_read_b64_tr_b16 v[190:191], v236 offset:41472
    s_waitcnt lgkmcnt(10)
    v_mfma_f32_32x32x16_bf16 v[164:179], v[192:195], v[88:91], v[164:179]
    ds_read_b64_tr_b16 v[192:193], v238 offset:40960
    ds_read_b64_tr_b16 v[194:195], v238 offset:41472
    s_waitcnt lgkmcnt(10)
    v_mfma_f32_32x32x16_bf16 v[164:179], v[196:199], v[92:95], v[164:179]
    ds_read_b64_tr_b16 v[196:197], v232 offset:49152
    ds_read_b64_tr_b16 v[198:199], v232 offset:49664
    s_waitcnt lgkmcnt(10)
    v_mfma_f32_32x32x16_bf16 v[164:179], v[200:203], v[96:99], v[164:179]
    s_waitcnt vmcnt(12)
    s_barrier
    ds_read_b64_tr_b16 v[200:201], v234 offset:49152
    ds_read_b64_tr_b16 v[202:203], v234 offset:49664
    s_waitcnt lgkmcnt(10)
    v_mfma_f32_32x32x16_bf16 v[164:179], v[180:183], v[100:103], v[164:179]
    s_add_u32 m0, s47, 16384
    s_add_u32 s40, s46, 663936
    buffer_load_dwordx4 v240, s[20:23], s40 offen lds
    ds_read_b64_tr_b16 v[180:181], v236 offset:49152
    ds_read_b64_tr_b16 v[182:183], v236 offset:49664
    s_waitcnt lgkmcnt(10)
    v_mfma_f32_32x32x16_bf16 v[164:179], v[184:187], v[104:107], v[164:179]
    s_add_u32 m0, s47, 24576
    s_add_u32 s40, s46, 885120
    buffer_load_dwordx4 v240, s[20:23], s40 offen lds
    ds_read_b64_tr_b16 v[184:185], v238 offset:49152
    ds_read_b64_tr_b16 v[186:187], v238 offset:49664
    s_waitcnt lgkmcnt(10)
    v_mfma_f32_32x32x16_bf16 v[164:179], v[188:191], v[108:111], v[164:179]
    s_add_u32 m0, s47, 32768
    s_add_u32 s40, s46, 1106304
    buffer_load_dwordx4 v240, s[20:23], s40 offen lds
    ds_read_b64_tr_b16 v[188:189], v232 offset:57344
    ds_read_b64_tr_b16 v[190:191], v232 offset:57856
    s_waitcnt lgkmcnt(10)
    v_mfma_f32_32x32x16_bf16 v[164:179], v[192:195], v[112:115], v[164:179]
    ds_read_b64_tr_b16 v[192:193], v234 offset:57344
    ds_read_b64_tr_b16 v[194:195], v234 offset:57856
    s_waitcnt lgkmcnt(10)
    v_mfma_f32_32x32x16_bf16 v[164:179], v[196:199], v[116:119], v[164:179]
    ds_read_b64_tr_b16 v[196:197], v236 offset:57344
    ds_read_b64_tr_b16 v[198:199], v236 offset:57856
    s_waitcnt lgkmcnt(10)
    v_mfma_f32_32x32x16_bf16 v[164:179], v[200:203], v[120:123], v[164:179]
    ds_read_b64_tr_b16 v[200:201], v238 offset:57344
    ds_read_b64_tr_b16 v[202:203], v238 offset:57856
    s_waitcnt lgkmcnt(10)
    v_mfma_f32_32x32x16_bf16 v[164:179], v[180:183], v[124:127], v[164:179]
    ds_read_b64_tr_b16 v[180:181], v233 offset:0
    ds_read_b64_tr_b16 v[182:183], v233 offset:512
    s_waitcnt lgkmcnt(10)
    v_mfma_f32_32x32x16_bf16 v[164:179], v[184:187], v[128:131], v[164:179]
    ds_read_b64_tr_b16 v[184:185], v235 offset:0
    ds_read_b64_tr_b16 v[186:187], v235 offset:512
    s_waitcnt lgkmcnt(10)
    v_mfma_f32_32x32x16_bf16 v[164:179], v[188:191], v[132:135], v[164:179]
    ds_read_b64_tr_b16 v[188:189], v237 offset:0
    ds_read_b64_tr_b16 v[190:191], v237 offset:512
    s_waitcnt lgkmcnt(10)
    v_mfma_f32_32x32x16_bf16 v[164:179], v[192:195], v[136:139], v[164:179]
    ds_read_b64_tr_b16 v[192:193], v239 offset:0
    ds_read_b64_tr_b16 v[194:195], v239 offset:512
    s_waitcnt lgkmcnt(10)
    v_mfma_f32_32x32x16_bf16 v[164:179], v[196:199], v[140:143], v[164:179]
    ds_read_b64_tr_b16 v[196:197], v233 offset:8192
    ds_read_b64_tr_b16 v[198:199], v233 offset:8704
    s_waitcnt lgkmcnt(10)
    v_mfma_f32_32x32x16_bf16 v[164:179], v[200:203], v[144:147], v[164:179]
    s_waitcnt vmcnt(12)
    s_barrier
    ds_read_b64_tr_b16 v[200:201], v235 offset:8192
    ds_read_b64_tr_b16 v[202:203], v235 offset:8704
    s_waitcnt lgkmcnt(10)
    v_mfma_f32_32x32x16_bf16 v[148:163], v[180:183], v[4:7], 0
    s_cmp_lt_i32 s50, 16
    s_cselect_b32 s49, 0x3eae1a93, 1.0
    s_nop 4
    v_mul_f32 v164, s49, v164
    v_mul_f32 v165, s49, v165
    ds_read_b64_tr_b16 v[180:181], v237 offset:8192
    ds_read_b64_tr_b16 v[182:183], v237 offset:8704
    s_waitcnt lgkmcnt(10)
    v_mfma_f32_32x32x16_bf16 v[148:163], v[184:187], v[8:11], v[148:163]
    v_mul_f32 v166, s49, v166
    v_mul_f32 v167, s49, v167
    s_add_u32 m0, s47, 40960
    s_add_u32 s40, s46, 1327488
    buffer_load_dwordx4 v240, s[20:23], s40 offen lds
    ds_read_b64_tr_b16 v[184:185], v239 offset:8192
    ds_read_b64_tr_b16 v[186:187], v239 offset:8704
    s_waitcnt lgkmcnt(10)
    v_mfma_f32_32x32x16_bf16 v[148:163], v[188:191], v[12:15], v[148:163]
    v_mul_f32 v168, s49, v168
    v_mul_f32 v169, s49, v169
    v_mul_f32 v170, s49, v170
    ds_read_b64_tr_b16 v[188:189], v233 offset:24576
    ds_read_b64_tr_b16 v[190:191], v233 offset:25088
    s_waitcnt lgkmcnt(10)
    v_mfma_f32_32x32x16_bf16 v[148:163], v[192:195], v[16:19], v[148:163]
    v_mul_f32 v171, s49, v171
    v_mul_f32 v172, s49, v172
    s_add_u32 m0, s47, 49152
    s_add_u32 s40, s46, 1548672
    buffer_load_dwordx4 v240, s[20:23], s40 offen lds
    ds_read_b64_tr_b16 v[192:193], v235 offset:24576
    ds_read_b64_tr_b16 v[194:195], v235 offset:25088
    s_waitcnt lgkmcnt(10)
    v_mfma_f32_32x32x16_bf16 v[148:163], v[196:199], v[20:23], v[148:163]
    v_mul_f32 v173, s49, v173
    v_mul_f32 v174, s49, v174
    ds_read_b64_tr_b16 v[196:197], v237 offset:24576
    ds_read_b64_tr_b16 v[198:199], v237 offset:25088
    s_waitcnt lgkmcnt(10)
    v_mfma_f32_32x32x16_bf16 v[148:163], v[200:203], v[24:27], v[148:163]
    v_mul_f32 v175, s49, v175
    v_mul_f32 v176, s49, v176
    v_mul_f32 v177, s49, v177
    s_add_u32 m0, s47, 57344
    s_add_u32 s40, s46, 1769856
    ds_read_b64_tr_b16 v[200:201], v239 offset:24576
    ds_read_b64_tr_b16 v[202:203], v239 offset:25088
    s_waitcnt lgkmcnt(10)
    v_mfma_f32_32x32x16_bf16 v[148:163], v[180:183], v[28:31], v[148:163]
    buffer_load_dwordx4 v240, s[20:23], s40 offen lds
    v_mul_f32 v178, s49, v178
    v_mul_f32 v179, s49, v179
    ds_read_b64_tr_b16 v[180:181], v233 offset:32768
    ds_read_b64_tr_b16 v[182:183], v233 offset:33280
    s_waitcnt lgkmcnt(10)
    v_mfma_f32_32x32x16_bf16 v[148:163], v[184:187], v[32:35], v[148:163]
    v_cvt_pk_bf16_f32 v164, v164, v165
    v_cvt_pk_bf16_f32 v165, v166, v167
    v_cvt_pk_bf16_f32 v166, v168, v169
    ds_read_b64_tr_b16 v[184:185], v235 offset:32768
    ds_read_b64_tr_b16 v[186:187], v235 offset:33280
    s_waitcnt lgkmcnt(10)
    v_mfma_f32_32x32x16_bf16 v[148:163], v[188:191], v[36:39], v[148:163]
    v_cvt_pk_bf16_f32 v167, v170, v171
    buffer_store_dwordx4 v[164:167], v242, s[28:31], s48 offen offset:0 sc1
    v_cvt_pk_bf16_f32 v172, v172, v173
    ds_read_b64_tr_b16 v[188:189], v237 offset:32768
    ds_read_b64_tr_b16 v[190:191], v237 offset:33280
    s_waitcnt lgkmcnt(10)
    v_mfma_f32_32x32x16_bf16 v[148:163], v[192:195], v[40:43], v[148:163]
    v_cvt_pk_bf16_f32 v173, v174, v175
    v_cvt_pk_bf16_f32 v174, v176, v177
    v_cvt_pk_bf16_f32 v175, v178, v179
    buffer_store_dwordx4 v[172:175], v242, s[28:31], s48 offen offset:1024 sc1
    s_add_u32 s48, s48, 4096
    ds_read_b64_tr_b16 v[192:193], v239 offset:32768
    ds_read_b64_tr_b16 v[194:195], v239 offset:33280
    s_waitcnt lgkmcnt(10)
    v_mfma_f32_32x32x16_bf16 v[148:163], v[196:199], v[44:47], v[148:163]
    ds_read_b64_tr_b16 v[196:197], v233 offset:40960
    ds_read_b64_tr_b16 v[198:199], v233 offset:41472
    s_waitcnt lgkmcnt(10)
    v_mfma_f32_32x32x16_bf16 v[148:163], v[200:203], v[48:51], v[148:163]
    s_waitcnt vmcnt(12)
    s_barrier
    ds_read_b64_tr_b16 v[200:201], v235 offset:40960
    ds_read_b64_tr_b16 v[202:203], v235 offset:41472
    s_waitcnt lgkmcnt(10)
    v_mfma_f32_32x32x16_bf16 v[148:163], v[180:183], v[52:55], v[148:163]
    s_nop 0
    s_nop 0
    s_add_u32 m0, s47, 65536
    ds_read_b64_tr_b16 v[180:181], v237 offset:40960
    ds_read_b64_tr_b16 v[182:183], v237 offset:41472
    s_waitcnt lgkmcnt(10)
    v_mfma_f32_32x32x16_bf16 v[148:163], v[184:187], v[56:59], v[148:163]
    s_add_u32 s40, s46, 512
    buffer_load_dwordx4 v240, s[20:23], s40 offen lds
    s_nop 0
    ds_read_b64_tr_b16 v[184:185], v239 offset:40960
    ds_read_b64_tr_b16 v[186:187], v239 offset:41472
    s_waitcnt lgkmcnt(10)
    v_mfma_f32_32x32x16_bf16 v[148:163], v[188:191], v[60:63], v[148:163]
    s_nop 0
    s_add_u32 m0, s47, 73728
    s_add_u32 s40, s46, 221696
    ds_read_b64_tr_b16 v[188:189], v233 offset:49152
    ds_read_b64_tr_b16 v[190:191], v233 offset:49664
    s_waitcnt lgkmcnt(10)
    v_mfma_f32_32x32x16_bf16 v[148:163], v[192:195], v[64:67], v[148:163]
    buffer_load_dwordx4 v240, s[20:23], s40 offen lds
    s_nop 0
    s_nop 0
    ds_read_b64_tr_b16 v[192:193], v235 offset:49152
    ds_read_b64_tr_b16 v[194:195], v235 offset:49664
    s_waitcnt lgkmcnt(10)
    v_mfma_f32_32x32x16_bf16 v[148:163], v[196:199], v[68:71], v[148:163]
    s_add_u32 m0, s47, 90112
    s_add_u32 s40, s46, 442880
    buffer_load_dwordx4 v240, s[20:23], s40 offen lds
    ds_read_b64_tr_b16 v[196:197], v237 offset:49152
    ds_read_b64_tr_b16 v[198:199], v237 offset:49664
    s_waitcnt lgkmcnt(10)
    v_mfma_f32_32x32x16_bf16 v[148:163], v[200:203], v[72:75], v[148:163]
    s_nop 0
    s_nop 0
    s_nop 0
    ds_read_b64_tr_b16 v[200:201], v239 offset:49152
    ds_read_b64_tr_b16 v[202:203], v239 offset:49664
    s_waitcnt lgkmcnt(10)
    v_mfma_f32_32x32x16_bf16 v[148:163], v[180:183], v[76:79], v[148:163]
    s_nop 0
    s_nop 0
    s_nop 0
    ds_read_b64_tr_b16 v[180:181], v233 offset:57344
    ds_read_b64_tr_b16 v[182:183], v233 offset:57856
    s_waitcnt lgkmcnt(10)
    v_mfma_f32_32x32x16_bf16 v[148:163], v[184:187], v[80:83], v[148:163]
    buffer_load_dword v247, v251, s[20:23], s46 offen offset:512
    ds_read_b64_tr_b16 v[184:185], v235 offset:57344
    ds_read_b64_tr_b16 v[186:187], v235 offset:57856
    s_waitcnt lgkmcnt(10)
    v_mfma_f32_32x32x16_bf16 v[148:163], v[188:191], v[84:87], v[148:163]
    ds_read_b64_tr_b16 v[188:189], v237 offset:57344
    ds_read_b64_tr_b16 v[190:191], v237 offset:57856
    s_waitcnt lgkmcnt(10)
    v_mfma_f32_32x32x16_bf16 v[148:163], v[192:195], v[88:91], v[148:163]
    ds_read_b64_tr_b16 v[192:193], v239 offset:57344
    ds_read_b64_tr_b16 v[194:195], v239 offset:57856
    s_waitcnt lgkmcnt(10)
    v_mfma_f32_32x32x16_bf16 v[148:163], v[196:199], v[92:95], v[148:163]
    v_add_u32 v232, 0x20000, v232
    ds_read_b64_tr_b16 v[196:197], v232 offset:0
    ds_read_b64_tr_b16 v[198:199], v232 offset:512
    s_waitcnt lgkmcnt(10)
    v_mfma_f32_32x32x16_bf16 v[148:163], v[200:203], v[96:99], v[148:163]
    s_waitcnt vmcnt(13)
    s_barrier
    v_add_u32 v234, 0x20000, v234
    ds_read_b64_tr_b16 v[200:201], v234 offset:0
    ds_read_b64_tr_b16 v[202:203], v234 offset:512
    s_waitcnt lgkmcnt(10)
    v_mfma_f32_32x32x16_bf16 v[148:163], v[180:183], v[100:103], v[148:163]
    s_add_u32 m0, s47, 98304
    s_add_u32 s40, s46, 664064
    buffer_load_dwordx4 v240, s[20:23], s40 offen lds
    v_add_u32 v236, 0x20000, v236
    ds_read_b64_tr_b16 v[180:181], v236 offset:0
    ds_read_b64_tr_b16 v[182:183], v236 offset:512
    s_waitcnt lgkmcnt(10)
    v_mfma_f32_32x32x16_bf16 v[148:163], v[184:187], v[104:107], v[148:163]
    s_add_u32 m0, s47, 106496
    s_add_u32 s40, s46, 885248
    buffer_load_dwordx4 v240, s[20:23], s40 offen lds
    v_add_u32 v238, 0x20000, v238
    ds_read_b64_tr_b16 v[184:185], v238 offset:0
    ds_read_b64_tr_b16 v[186:187], v238 offset:512
    s_waitcnt lgkmcnt(10)
    v_mfma_f32_32x32x16_bf16 v[148:163], v[188:191], v[108:111], v[148:163]
    s_add_u32 m0, s47, 114688
    s_add_u32 s40, s46, 1106432
    buffer_load_dwordx4 v240, s[20:23], s40 offen lds
    ds_read_b64_tr_b16 v[188:189], v232 offset:8192
    ds_read_b64_tr_b16 v[190:191], v232 offset:8704
    s_waitcnt lgkmcnt(10)
    v_mfma_f32_32x32x16_bf16 v[148:163], v[192:195], v[112:115], v[148:163]
    ds_read_b64_tr_b16 v[192:193], v234 offset:8192
    ds_read_b64_tr_b16 v[194:195], v234 offset:8704
    s_waitcnt lgkmcnt(10)
    v_mfma_f32_32x32x16_bf16 v[148:163], v[196:199], v[116:119], v[148:163]
    ds_read_b64_tr_b16 v[196:197], v236 offset:8192
    ds_read_b64_tr_b16 v[198:199], v236 offset:8704
    s_waitcnt lgkmcnt(10)
    v_mfma_f32_32x32x16_bf16 v[148:163], v[200:203], v[120:123], v[148:163]
    ds_read_b64_tr_b16 v[200:201], v238 offset:8192
    ds_read_b64_tr_b16 v[202:203], v238 offset:8704
    s_waitcnt lgkmcnt(10)
    v_mfma_f32_32x32x16_bf16 v[148:163], v[180:183], v[124:127], v[148:163]
    v_add_u32 v233, 0xffff0000, v233
    ds_read_b64_tr_b16 v[180:181], v233 offset:0
    ds_read_b64_tr_b16 v[182:183], v233 offset:512
    s_waitcnt lgkmcnt(10)
    v_mfma_f32_32x32x16_bf16 v[148:163], v[184:187], v[128:131], v[148:163]
    v_add_u32 v235, 0xffff0000, v235
    ds_read_b64_tr_b16 v[184:185], v235 offset:0
    ds_read_b64_tr_b16 v[186:187], v235 offset:512
    s_waitcnt lgkmcnt(10)
    v_mfma_f32_32x32x16_bf16 v[148:163], v[188:191], v[132:135], v[148:163]
    v_add_u32 v237, 0xffff0000, v237
    ds_read_b64_tr_b16 v[188:189], v237 offset:0
    ds_read_b64_tr_b16 v[190:191], v237 offset:512
    s_waitcnt lgkmcnt(10)
    v_mfma_f32_32x32x16_bf16 v[148:163], v[192:195], v[136:139], v[148:163]
    v_add_u32 v239, 0xffff0000, v239
    ds_read_b64_tr_b16 v[192:193], v239 offset:0
    ds_read_b64_tr_b16 v[194:195], v239 offset:512
    s_waitcnt lgkmcnt(10)
    v_mfma_f32_32x32x16_bf16 v[148:163], v[196:199], v[140:143], v[148:163]
    v_add_u32 v232, 0xffff0000, v232
    ds_read_b64_tr_b16 v[196:197], v232 offset:16384
    ds_read_b64_tr_b16 v[198:199], v232 offset:16896
    s_waitcnt lgkmcnt(10)
    v_mfma_f32_32x32x16_bf16 v[148:163], v[200:203], v[144:147], v[148:163]
    s_waitcnt vmcnt(12)
    s_barrier
    v_add_u32 v234, 0xffff0000, v234
    ds_read_b64_tr_b16 v[200:201], v234 offset:16384
    ds_read_b64_tr_b16 v[202:203], v234 offset:16896
    s_waitcnt lgkmcnt(10)
    v_mfma_f32_32x32x16_bf16 v[164:179], v[180:183], v[4:7], 0
    s_cmp_lt_i32 s50, 14
    s_cselect_b32 s49, 0x3eae1a93, 1.0
    s_nop 3
    v_mul_f32 v148, s49, v148
    v_mul_f32 v149, s49, v149
    v_add_u32 v236, 0xffff0000, v236
    ds_read_b64_tr_b16 v[180:181], v236 offset:16384
    ds_read_b64_tr_b16 v[182:183], v236 offset:16896
    s_waitcnt lgkmcnt(10)
    v_mfma_f32_32x32x16_bf16 v[164:179], v[184:187], v[8:11], v[164:179]
    v_mul_f32 v150, s49, v150
    v_mul_f32 v151, s49, v151
    s_add_u32 m0, s47, 122880
    s_add_u32 s40, s46, 1327616
    buffer_load_dwordx4 v240, s[20:23], s40 offen lds
    v_add_u32 v238, 0xffff0000, v238
    ds_read_b64_tr_b16 v[184:185], v238 offset:16384
    ds_read_b64_tr_b16 v[186:187], v238 offset:16896
    s_waitcnt lgkmcnt(10)
    v_mfma_f32_32x32x16_bf16 v[164:179], v[188:191], v[12:15], v[164:179]
    v_mul_f32 v152, s49, v152
    v_mul_f32 v153, s49, v153
    v_mul_f32 v154, s49, v154
    ds_read_b64_tr_b16 v[188:189], v233 offset:8192
    ds_read_b64_tr_b16 v[190:191], v233 offset:8704
    s_waitcnt lgkmcnt(10)
    v_mfma_f32_32x32x16_bf16 v[164:179], v[192:195], v[16:19], v[164:179]
    v_mul_f32 v155, s49, v155
    v_mul_f32 v156, s49, v156
    s_add_u32 m0, s47, 131072
    s_add_u32 s40, s46, 1548800
    buffer_load_dwordx4 v240, s[20:23], s40 offen lds
    ds_read_b64_tr_b16 v[192:193], v235 offset:8192
    ds_read_b64_tr_b16 v[194:195], v235 offset:8704
    s_waitcnt lgkmcnt(10)
    v_mfma_f32_32x32x16_bf16 v[164:179], v[196:199], v[20:23], v[164:179]
    v_mul_f32 v157, s49, v157
    v_mul_f32 v158, s49, v158
    ds_read_b64_tr_b16 v[196:197], v237 offset:8192
    ds_read_b64_tr_b16 v[198:199], v237 offset:8704
    s_waitcnt lgkmcnt(10)
    v_mfma_f32_32x32x16_bf16 v[164:179], v[200:203], v[24:27], v[164:179]
    v_mul_f32 v159, s49, v159
    v_mul_f32 v160, s49, v160
    v_mul_f32 v161, s49, v161
    s_add_u32 m0, s47, 139264
    s_add_u32 s40, s46, 1769984
    ds_read_b64_tr_b16 v[200:201], v239 offset:8192
    ds_read_b64_tr_b16 v[202:203], v239 offset:8704
    s_waitcnt lgkmcnt(10)
    v_mfma_f32_32x32x16_bf16 v[164:179], v[180:183], v[28:31], v[164:179]
    buffer_load_dwordx4 v240, s[20:23], s40 offen lds
    v_mul_f32 v162, s49, v162
    v_mul_f32 v163, s49, v163
    ds_read_b64_tr_b16 v[180:181], v233 offset:16384
    ds_read_b64_tr_b16 v[182:183], v233 offset:16896
    s_waitcnt lgkmcnt(10)
    v_mfma_f32_32x32x16_bf16 v[164:179], v[184:187], v[32:35], v[164:179]
    v_cvt_pk_bf16_f32 v148, v148, v149
    v_cvt_pk_bf16_f32 v149, v150, v151
    v_cvt_pk_bf16_f32 v150, v152, v153
    ds_read_b64_tr_b16 v[184:185], v235 offset:16384
    ds_read_b64_tr_b16 v[186:187], v235 offset:16896
    s_waitcnt lgkmcnt(10)
    v_mfma_f32_32x32x16_bf16 v[164:179], v[188:191], v[36:39], v[164:179]
    v_cvt_pk_bf16_f32 v151, v154, v155
    buffer_store_dwordx4 v[148:151], v242, s[28:31], s48 offen offset:0 sc1
    v_cvt_pk_bf16_f32 v156, v156, v157
    ds_read_b64_tr_b16 v[188:189], v237 offset:16384
    ds_read_b64_tr_b16 v[190:191], v237 offset:16896
    s_waitcnt lgkmcnt(10)
    v_mfma_f32_32x32x16_bf16 v[164:179], v[192:195], v[40:43], v[164:179]
    v_cvt_pk_bf16_f32 v157, v158, v159
    v_cvt_pk_bf16_f32 v158, v160, v161
    v_cvt_pk_bf16_f32 v159, v162, v163
    buffer_store_dwordx4 v[156:159], v242, s[28:31], s48 offen offset:1024 sc1
    s_add_u32 s48, s48, 4096
    ds_read_b64_tr_b16 v[192:193], v239 offset:16384
    ds_read_b64_tr_b16 v[194:195], v239 offset:16896
    s_waitcnt lgkmcnt(10)
    v_mfma_f32_32x32x16_bf16 v[164:179], v[196:199], v[44:47], v[164:179]
    ds_read_b64_tr_b16 v[196:197], v233 offset:24576
    ds_read_b64_tr_b16 v[198:199], v233 offset:25088
    s_waitcnt lgkmcnt(10)
    v_mfma_f32_32x32x16_bf16 v[164:179], v[200:203], v[48:51], v[164:179]
    s_waitcnt vmcnt(14)
    s_barrier
    ds_read_b64_tr_b16 v[200:201], v235 offset:24576
    ds_read_b64_tr_b16 v[202:203], v235 offset:25088
    s_waitcnt lgkmcnt(10)
    v_mfma_f32_32x32x16_bf16 v[164:179], v[180:183], v[52:55], v[164:179]
    s_nop 0
    s_nop 0
    s_add_u32 m0, s47, 0
    ds_read_b64_tr_b16 v[180:181], v237 offset:24576
    ds_read_b64_tr_b16 v[182:183], v237 offset:25088
    s_waitcnt lgkmcnt(10)
    v_mfma_f32_32x32x16_bf16 v[164:179], v[184:187], v[56:59], v[164:179]
    s_add_u32 s40, s46, 640
    buffer_load_dwordx4 v240, s[20:23], s40 offen lds
    s_nop 0
    ds_read_b64_tr_b16 v[184:185], v239 offset:24576
    ds_read_b64_tr_b16 v[186:187], v239 offset:25088
    s_waitcnt lgkmcnt(10)
    v_mfma_f32_32x32x16_bf16 v[164:179], v[188:191], v[60:63], v[164:179]
    s_nop 0
    s_add_u32 m0, s47, 81920
    s_add_u32 s40, s46, 221824
    ds_read_b64_tr_b16 v[188:189], v233 offset:32768
    ds_read_b64_tr_b16 v[190:191], v233 offset:33280
    s_waitcnt lgkmcnt(10)
    v_mfma_f32_32x32x16_bf16 v[164:179], v[192:195], v[64:67], v[164:179]
    buffer_load_dwordx4 v240, s[20:23], s40 offen lds
    s_nop 0
    s_nop 0
    ds_read_b64_tr_b16 v[192:193], v235 offset:32768
    ds_read_b64_tr_b16 v[194:195], v235 offset:33280
    s_waitcnt lgkmcnt(10)
    v_mfma_f32_32x32x16_bf16 v[164:179], v[196:199], v[68:71], v[164:179]
    s_add_u32 m0, s47, 8192
    s_add_u32 s40, s46, 443008
    buffer_load_dwordx4 v240, s[20:23], s40 offen lds
    ds_read_b64_tr_b16 v[196:197], v237 offset:32768
    ds_read_b64_tr_b16 v[198:199], v237 offset:33280
    s_waitcnt lgkmcnt(10)
    v_mfma_f32_32x32x16_bf16 v[164:179], v[200:203], v[72:75], v[164:179]
    s_nop 0
    s_nop 0
    s_nop 0
    ds_read_b64_tr_b16 v[200:201], v239 offset:32768
    ds_read_b64_tr_b16 v[202:203], v239 offset:33280
    s_waitcnt lgkmcnt(10)
    v_mfma_f32_32x32x16_bf16 v[164:179], v[180:183], v[76:79], v[164:179]
    s_nop 0
    s_nop 0
    s_nop 0
    ds_read_b64_tr_b16 v[180:181], v233 offset:40960
    ds_read_b64_tr_b16 v[182:183], v233 offset:41472
    s_waitcnt lgkmcnt(10)
    v_mfma_f32_32x32x16_bf16 v[164:179], v[184:187], v[80:83], v[164:179]
    buffer_load_dword v247, v251, s[20:23], s46 offen offset:640
    ds_read_b64_tr_b16 v[184:185], v235 offset:40960
    ds_read_b64_tr_b16 v[186:187], v235 offset:41472
    s_waitcnt lgkmcnt(10)
    v_mfma_f32_32x32x16_bf16 v[164:179], v[188:191], v[84:87], v[164:179]
    ds_read_b64_tr_b16 v[188:189], v237 offset:40960
    ds_read_b64_tr_b16 v[190:191], v237 offset:41472
    s_waitcnt lgkmcnt(10)
    v_mfma_f32_32x32x16_bf16 v[164:179], v[192:195], v[88:91], v[164:179]
    ds_read_b64_tr_b16 v[192:193], v239 offset:40960
    ds_read_b64_tr_b16 v[194:195], v239 offset:41472
    s_waitcnt lgkmcnt(10)
    v_mfma_f32_32x32x16_bf16 v[164:179], v[196:199], v[92:95], v[164:179]
    ds_read_b64_tr_b16 v[196:197], v233 offset:49152
    ds_read_b64_tr_b16 v[198:199], v233 offset:49664
    s_waitcnt lgkmcnt(10)
    v_mfma_f32_32x32x16_bf16 v[164:179], v[200:203], v[96:99], v[164:179]
    s_waitcnt vmcnt(13)
    s_barrier
    ds_read_b64_tr_b16 v[200:201], v235 offset:49152
    ds_read_b64_tr_b16 v[202:203], v235 offset:49664
    s_waitcnt lgkmcnt(10)
    v_mfma_f32_32x32x16_bf16 v[164:179], v[180:183], v[100:103], v[164:179]
    s_add_u32 m0, s47, 16384
    s_add_u32 s40, s46, 664192
    buffer_load_dwordx4 v240, s[20:23], s40 offen lds
    ds_read_b64_tr_b16 v[180:181], v237 offset:49152
    ds_read_b64_tr_b16 v[182:183], v237 offset:49664
    s_waitcnt lgkmcnt(10)
    v_mfma_f32_32x32x16_bf16 v[164:179], v[184:187], v[104:107], v[164:179]
    s_add_u32 m0, s47, 24576
    s_add_u32 s40, s46, 885376
    buffer_load_dwordx4 v240, s[20:23], s40 offen lds
    ds_read_b64_tr_b16 v[184:185], v239 offset:49152
    ds_read_b64_tr_b16 v[186:187], v239 offset:49664
    s_waitcnt lgkmcnt(10)
    v_mfma_f32_32x32x16_bf16 v[164:179], v[188:191], v[108:111], v[164:179]
    s_add_u32 m0, s47, 32768
    s_add_u32 s40, s46, 1106560
    buffer_load_dwordx4 v240, s[20:23], s40 offen lds
    ds_read_b64_tr_b16 v[188:189], v233 offset:57344
    ds_read_b64_tr_b16 v[190:191], v233 offset:57856
    s_waitcnt lgkmcnt(10)
    v_mfma_f32_32x32x16_bf16 v[164:179], v[192:195], v[112:115], v[164:179]
    ds_read_b64_tr_b16 v[192:193], v235 offset:57344
    ds_read_b64_tr_b16 v[194:195], v235 offset:57856
    s_waitcnt lgkmcnt(10)
    v_mfma_f32_32x32x16_bf16 v[164:179], v[196:199], v[116:119], v[164:179]
    ds_read_b64_tr_b16 v[196:197], v237 offset:57344
    ds_read_b64_tr_b16 v[198:199], v237 offset:57856
    s_waitcnt lgkmcnt(10)
    v_mfma_f32_32x32x16_bf16 v[164:179], v[200:203], v[120:123], v[164:179]
    ds_read_b64_tr_b16 v[200:201], v239 offset:57344
    ds_read_b64_tr_b16 v[202:203], v239 offset:57856
    s_waitcnt lgkmcnt(10)
    v_mfma_f32_32x32x16_bf16 v[164:179], v[180:183], v[124:127], v[164:179]
    ds_read_b64_tr_b16 v[180:181], v232 offset:0
    ds_read_b64_tr_b16 v[182:183], v232 offset:512
    s_waitcnt lgkmcnt(10)
    v_mfma_f32_32x32x16_bf16 v[164:179], v[184:187], v[128:131], v[164:179]
    ds_read_b64_tr_b16 v[184:185], v234 offset:0
    ds_read_b64_tr_b16 v[186:187], v234 offset:512
    s_waitcnt lgkmcnt(10)
    v_mfma_f32_32x32x16_bf16 v[164:179], v[188:191], v[132:135], v[164:179]
    ds_read_b64_tr_b16 v[188:189], v236 offset:0
    ds_read_b64_tr_b16 v[190:191], v236 offset:512
    s_waitcnt lgkmcnt(10)
    v_mfma_f32_32x32x16_bf16 v[164:179], v[192:195], v[136:139], v[164:179]
    ds_read_b64_tr_b16 v[192:193], v238 offset:0
    ds_read_b64_tr_b16 v[194:195], v238 offset:512
    s_waitcnt lgkmcnt(10)
    v_mfma_f32_32x32x16_bf16 v[164:179], v[196:199], v[140:143], v[164:179]
    ds_read_b64_tr_b16 v[196:197], v232 offset:8192
    ds_read_b64_tr_b16 v[198:199], v232 offset:8704
    s_waitcnt lgkmcnt(10)
    v_mfma_f32_32x32x16_bf16 v[164:179], v[200:203], v[144:147], v[164:179]
    s_waitcnt vmcnt(12)
    s_barrier
    ds_read_b64_tr_b16 v[200:201], v234 offset:8192
    ds_read_b64_tr_b16 v[202:203], v234 offset:8704
    s_waitcnt lgkmcnt(10)
    v_mfma_f32_32x32x16_bf16 v[148:163], v[180:183], v[4:7], 0
    s_cmp_lt_i32 s50, 12
    s_cselect_b32 s49, 0x3eae1a93, 1.0
    s_nop 4
    v_mul_f32 v164, s49, v164
    v_mul_f32 v165, s49, v165
    ds_read_b64_tr_b16 v[180:181], v236 offset:8192
    ds_read_b64_tr_b16 v[182:183], v236 offset:8704
    s_waitcnt lgkmcnt(10)
    v_mfma_f32_32x32x16_bf16 v[148:163], v[184:187], v[8:11], v[148:163]
    v_mul_f32 v166, s49, v166
    v_mul_f32 v167, s49, v167
    s_add_u32 m0, s47, 40960
    s_add_u32 s40, s46, 1327744
    buffer_load_dwordx4 v240, s[20:23], s40 offen lds
    ds_read_b64_tr_b16 v[184:185], v238 offset:8192
    ds_read_b64_tr_b16 v[186:187], v238 offset:8704
    s_waitcnt lgkmcnt(10)
    v_mfma_f32_32x32x16_bf16 v[148:163], v[188:191], v[12:15], v[148:163]
    v_mul_f32 v168, s49, v168
    v_mul_f32 v169, s49, v169
    v_mul_f32 v170, s49, v170
    ds_read_b64_tr_b16 v[188:189], v232 offset:24576
    ds_read_b64_tr_b16 v[190:191], v232 offset:25088
    s_waitcnt lgkmcnt(10)
    v_mfma_f32_32x32x16_bf16 v[148:163], v[192:195], v[16:19], v[148:163]
    v_mul_f32 v171, s49, v171
    v_mul_f32 v172, s49, v172
    s_add_u32 m0, s47, 49152
    s_add_u32 s40, s46, 1548928
    buffer_load_dwordx4 v240, s[20:23], s40 offen lds
    ds_read_b64_tr_b16 v[192:193], v234 offset:24576
    ds_read_b64_tr_b16 v[194:195], v234 offset:25088
    s_waitcnt lgkmcnt(10)
    v_mfma_f32_32x32x16_bf16 v[148:163], v[196:199], v[20:23], v[148:163]
    v_mul_f32 v173, s49, v173
    v_mul_f32 v174, s49, v174
    ds_read_b64_tr_b16 v[196:197], v236 offset:24576
    ds_read_b64_tr_b16 v[198:199], v236 offset:25088
    s_waitcnt lgkmcnt(10)
    v_mfma_f32_32x32x16_bf16 v[148:163], v[200:203], v[24:27], v[148:163]
    v_mul_f32 v175, s49, v175
    v_mul_f32 v176, s49, v176
    v_mul_f32 v177, s49, v177
    s_add_u32 m0, s47, 57344
    s_add_u32 s40, s46, 1770112
    ds_read_b64_tr_b16 v[200:201], v238 offset:24576
    ds_read_b64_tr_b16 v[202:203], v238 offset:25088
    s_waitcnt lgkmcnt(10)
    v_mfma_f32_32x32x16_bf16 v[148:163], v[180:183], v[28:31], v[148:163]
    buffer_load_dwordx4 v240, s[20:23], s40 offen lds
    v_mul_f32 v178, s49, v178
    v_mul_f32 v179, s49, v179
    ds_read_b64_tr_b16 v[180:181], v232 offset:32768
    ds_read_b64_tr_b16 v[182:183], v232 offset:33280
    s_waitcnt lgkmcnt(10)
    v_mfma_f32_32x32x16_bf16 v[148:163], v[184:187], v[32:35], v[148:163]
    v_cvt_pk_bf16_f32 v164, v164, v165
    v_cvt_pk_bf16_f32 v165, v166, v167
    v_cvt_pk_bf16_f32 v166, v168, v169
    ds_read_b64_tr_b16 v[184:185], v234 offset:32768
    ds_read_b64_tr_b16 v[186:187], v234 offset:33280
    s_waitcnt lgkmcnt(10)
    v_mfma_f32_32x32x16_bf16 v[148:163], v[188:191], v[36:39], v[148:163]
    v_cvt_pk_bf16_f32 v167, v170, v171
    buffer_store_dwordx4 v[164:167], v242, s[28:31], s48 offen offset:0 sc1
    v_cvt_pk_bf16_f32 v172, v172, v173
    ds_read_b64_tr_b16 v[188:189], v236 offset:32768
    ds_read_b64_tr_b16 v[190:191], v236 offset:33280
    s_waitcnt lgkmcnt(10)
    v_mfma_f32_32x32x16_bf16 v[148:163], v[192:195], v[40:43], v[148:163]
    v_cvt_pk_bf16_f32 v173, v174, v175
    v_cvt_pk_bf16_f32 v174, v176, v177
    v_cvt_pk_bf16_f32 v175, v178, v179
    buffer_store_dwordx4 v[172:175], v242, s[28:31], s48 offen offset:1024 sc1
    s_add_u32 s48, s48, 4096
    ds_read_b64_tr_b16 v[192:193], v238 offset:32768
    ds_read_b64_tr_b16 v[194:195], v238 offset:33280
    s_waitcnt lgkmcnt(10)
    v_mfma_f32_32x32x16_bf16 v[148:163], v[196:199], v[44:47], v[148:163]
    ds_read_b64_tr_b16 v[196:197], v232 offset:40960
    ds_read_b64_tr_b16 v[198:199], v232 offset:41472
    s_waitcnt lgkmcnt(10)
    v_mfma_f32_32x32x16_bf16 v[148:163], v[200:203], v[48:51], v[148:163]
    s_waitcnt vmcnt(14)
    s_barrier
    ds_read_b64_tr_b16 v[200:201], v234 offset:40960
    ds_read_b64_tr_b16 v[202:203], v234 offset:41472
    s_waitcnt lgkmcnt(10)
    v_mfma_f32_32x32x16_bf16 v[148:163], v[180:183], v[52:55], v[148:163]
    s_nop 0
    s_nop 0
    s_add_u32 m0, s47, 65536
    ds_read_b64_tr_b16 v[180:181], v236 offset:40960
    ds_read_b64_tr_b16 v[182:183], v236 offset:41472
    s_waitcnt lgkmcnt(10)
    v_mfma_f32_32x32x16_bf16 v[148:163], v[184:187], v[56:59], v[148:163]
    s_add_u32 s40, s46, 768
    buffer_load_dwordx4 v240, s[20:23], s40 offen lds
    s_nop 0
    ds_read_b64_tr_b16 v[184:185], v238 offset:40960
    ds_read_b64_tr_b16 v[186:187], v238 offset:41472
    s_waitcnt lgkmcnt(10)
    v_mfma_f32_32x32x16_bf16 v[148:163], v[188:191], v[60:63], v[148:163]
    s_nop 0
    s_add_u32 m0, s47, 73728
    s_add_u32 s40, s46, 221952
    ds_read_b64_tr_b16 v[188:189], v232 offset:49152
    ds_read_b64_tr_b16 v[190:191], v232 offset:49664
    s_waitcnt lgkmcnt(10)
    v_mfma_f32_32x32x16_bf16 v[148:163], v[192:195], v[64:67], v[148:163]
    buffer_load_dwordx4 v240, s[20:23], s40 offen lds
    s_nop 0
    s_nop 0
    ds_read_b64_tr_b16 v[192:193], v234 offset:49152
    ds_read_b64_tr_b16 v[194:195], v234 offset:49664
    s_waitcnt lgkmcnt(10)
    v_mfma_f32_32x32x16_bf16 v[148:163], v[196:199], v[68:71], v[148:163]
    s_add_u32 m0, s47, 90112
    s_add_u32 s40, s46, 443136
    buffer_load_dwordx4 v240, s[20:23], s40 offen lds
    ds_read_b64_tr_b16 v[196:197], v236 offset:49152
    ds_read_b64_tr_b16 v[198:199], v236 offset:49664
    s_waitcnt lgkmcnt(10)
    v_mfma_f32_32x32x16_bf16 v[148:163], v[200:203], v[72:75], v[148:163]
    s_nop 0
    s_nop 0
    s_nop 0
    ds_read_b64_tr_b16 v[200:201], v238 offset:49152
    ds_read_b64_tr_b16 v[202:203], v238 offset:49664
    s_waitcnt lgkmcnt(10)
    v_mfma_f32_32x32x16_bf16 v[148:163], v[180:183], v[76:79], v[148:163]
    s_nop 0
    s_nop 0
    s_nop 0
    ds_read_b64_tr_b16 v[180:181], v232 offset:57344
    ds_read_b64_tr_b16 v[182:183], v232 offset:57856
    s_waitcnt lgkmcnt(10)
    v_mfma_f32_32x32x16_bf16 v[148:163], v[184:187], v[80:83], v[148:163]
    buffer_load_dword v247, v251, s[20:23], s46 offen offset:768
    ds_read_b64_tr_b16 v[184:185], v234 offset:57344
    ds_read_b64_tr_b16 v[186:187], v234 offset:57856
    s_waitcnt lgkmcnt(10)
    v_mfma_f32_32x32x16_bf16 v[148:163], v[188:191], v[84:87], v[148:163]
    ds_read_b64_tr_b16 v[188:189], v236 offset:57344
    ds_read_b64_tr_b16 v[190:191], v236 offset:57856
    s_waitcnt lgkmcnt(10)
    v_mfma_f32_32x32x16_bf16 v[148:163], v[192:195], v[88:91], v[148:163]
    ds_read_b64_tr_b16 v[192:193], v238 offset:57344
    ds_read_b64_tr_b16 v[194:195], v238 offset:57856
    s_waitcnt lgkmcnt(10)
    v_mfma_f32_32x32x16_bf16 v[148:163], v[196:199], v[92:95], v[148:163]
    v_add_u32 v233, 0x20000, v233
    ds_read_b64_tr_b16 v[196:197], v233 offset:0
    ds_read_b64_tr_b16 v[198:199], v233 offset:512
    s_waitcnt lgkmcnt(10)
    v_mfma_f32_32x32x16_bf16 v[148:163], v[200:203], v[96:99], v[148:163]
    s_waitcnt vmcnt(13)
    s_barrier
    v_add_u32 v235, 0x20000, v235
    ds_read_b64_tr_b16 v[200:201], v235 offset:0
    ds_read_b64_tr_b16 v[202:203], v235 offset:512
    s_waitcnt lgkmcnt(10)
    v_mfma_f32_32x32x16_bf16 v[148:163], v[180:183], v[100:103], v[148:163]
    s_add_u32 m0, s47, 98304
    s_add_u32 s40, s46, 664320
    buffer_load_dwordx4 v240, s[20:23], s40 offen lds
    v_add_u32 v237, 0x20000, v237
    ds_read_b64_tr_b16 v[180:181], v237 offset:0
    ds_read_b64_tr_b16 v[182:183], v237 offset:512
    s_waitcnt lgkmcnt(10)
    v_mfma_f32_32x32x16_bf16 v[148:163], v[184:187], v[104:107], v[148:163]
    s_add_u32 m0, s47, 106496
    s_add_u32 s40, s46, 885504
    buffer_load_dwordx4 v240, s[20:23], s40 offen lds
    v_add_u32 v239, 0x20000, v239
    ds_read_b64_tr_b16 v[184:185], v239 offset:0
    ds_read_b64_tr_b16 v[186:187], v239 offset:512
    s_waitcnt lgkmcnt(10)
    v_mfma_f32_32x32x16_bf16 v[148:163], v[188:191], v[108:111], v[148:163]
    s_add_u32 m0, s47, 114688
    s_add_u32 s40, s46, 1106688
    buffer_load_dwordx4 v240, s[20:23], s40 offen lds
    ds_read_b64_tr_b16 v[188:189], v233 offset:8192
    ds_read_b64_tr_b16 v[190:191], v233 offset:8704
    s_waitcnt lgkmcnt(10)
    v_mfma_f32_32x32x16_bf16 v[148:163], v[192:195], v[112:115], v[148:163]
    ds_read_b64_tr_b16 v[192:193], v235 offset:8192
    ds_read_b64_tr_b16 v[194:195], v235 offset:8704
    s_waitcnt lgkmcnt(10)
    v_mfma_f32_32x32x16_bf16 v[148:163], v[196:199], v[116:119], v[148:163]
    ds_read_b64_tr_b16 v[196:197], v237 offset:8192
    ds_read_b64_tr_b16 v[198:199], v237 offset:8704
    s_waitcnt lgkmcnt(10)
    v_mfma_f32_32x32x16_bf16 v[148:163], v[200:203], v[120:123], v[148:163]
    ds_read_b64_tr_b16 v[200:201], v239 offset:8192
    ds_read_b64_tr_b16 v[202:203], v239 offset:8704
    s_waitcnt lgkmcnt(10)
    v_mfma_f32_32x32x16_bf16 v[148:163], v[180:183], v[124:127], v[148:163]
    v_add_u32 v232, 0xffff0000, v232
    ds_read_b64_tr_b16 v[180:181], v232 offset:0
    ds_read_b64_tr_b16 v[182:183], v232 offset:512
    s_waitcnt lgkmcnt(10)
    v_mfma_f32_32x32x16_bf16 v[148:163], v[184:187], v[128:131], v[148:163]
    v_add_u32 v234, 0xffff0000, v234
    ds_read_b64_tr_b16 v[184:185], v234 offset:0
    ds_read_b64_tr_b16 v[186:187], v234 offset:512
    s_waitcnt lgkmcnt(10)
    v_mfma_f32_32x32x16_bf16 v[148:163], v[188:191], v[132:135], v[148:163]
    v_add_u32 v236, 0xffff0000, v236
    ds_read_b64_tr_b16 v[188:189], v236 offset:0
    ds_read_b64_tr_b16 v[190:191], v236 offset:512
    s_waitcnt lgkmcnt(10)
    v_mfma_f32_32x32x16_bf16 v[148:163], v[192:195], v[136:139], v[148:163]
    v_add_u32 v238, 0xffff0000, v238
    ds_read_b64_tr_b16 v[192:193], v238 offset:0
    ds_read_b64_tr_b16 v[194:195], v238 offset:512
    s_waitcnt lgkmcnt(10)
    v_mfma_f32_32x32x16_bf16 v[148:163], v[196:199], v[140:143], v[148:163]
    v_add_u32 v233, 0xffff0000, v233
    ds_read_b64_tr_b16 v[196:197], v233 offset:16384
    ds_read_b64_tr_b16 v[198:199], v233 offset:16896
    s_waitcnt lgkmcnt(10)
    v_mfma_f32_32x32x16_bf16 v[148:163], v[200:203], v[144:147], v[148:163]
    s_waitcnt vmcnt(12)
    s_barrier
    v_add_u32 v235, 0xffff0000, v235
    ds_read_b64_tr_b16 v[200:201], v235 offset:16384
    ds_read_b64_tr_b16 v[202:203], v235 offset:16896
    s_waitcnt lgkmcnt(10)
    v_mfma_f32_32x32x16_bf16 v[164:179], v[180:183], v[4:7], 0
    s_cmp_lt_i32 s50, 10
    s_cselect_b32 s49, 0x3eae1a93, 1.0
    s_nop 3
    v_mul_f32 v148, s49, v148
    v_mul_f32 v149, s49, v149
    v_add_u32 v237, 0xffff0000, v237
    ds_read_b64_tr_b16 v[180:181], v237 offset:16384
    ds_read_b64_tr_b16 v[182:183], v237 offset:16896
    s_waitcnt lgkmcnt(10)
    v_mfma_f32_32x32x16_bf16 v[164:179], v[184:187], v[8:11], v[164:179]
    v_mul_f32 v150, s49, v150
    v_mul_f32 v151, s49, v151
    s_add_u32 m0, s47, 122880
    s_add_u32 s40, s46, 1327872
    buffer_load_dwordx4 v240, s[20:23], s40 offen lds
    v_add_u32 v239, 0xffff0000, v239
    ds_read_b64_tr_b16 v[184:185], v239 offset:16384
    ds_read_b64_tr_b16 v[186:187], v239 offset:16896
    s_waitcnt lgkmcnt(10)
    v_mfma_f32_32x32x16_bf16 v[164:179], v[188:191], v[12:15], v[164:179]
    v_mul_f32 v152, s49, v152
    v_mul_f32 v153, s49, v153
    v_mul_f32 v154, s49, v154
    ds_read_b64_tr_b16 v[188:189], v232 offset:8192
    ds_read_b64_tr_b16 v[190:191], v232 offset:8704
    s_waitcnt lgkmcnt(10)
    v_mfma_f32_32x32x16_bf16 v[164:179], v[192:195], v[16:19], v[164:179]
    v_mul_f32 v155, s49, v155
    v_mul_f32 v156, s49, v156
    s_add_u32 m0, s47, 131072
    s_add_u32 s40, s46, 1549056
    buffer_load_dwordx4 v240, s[20:23], s40 offen lds
    ds_read_b64_tr_b16 v[192:193], v234 offset:8192
    ds_read_b64_tr_b16 v[194:195], v234 offset:8704
    s_waitcnt lgkmcnt(10)
    v_mfma_f32_32x32x16_bf16 v[164:179], v[196:199], v[20:23], v[164:179]
    v_mul_f32 v157, s49, v157
    v_mul_f32 v158, s49, v158
    ds_read_b64_tr_b16 v[196:197], v236 offset:8192
    ds_read_b64_tr_b16 v[198:199], v236 offset:8704
    s_waitcnt lgkmcnt(10)
    v_mfma_f32_32x32x16_bf16 v[164:179], v[200:203], v[24:27], v[164:179]
    v_mul_f32 v159, s49, v159
    v_mul_f32 v160, s49, v160
    v_mul_f32 v161, s49, v161
    s_add_u32 m0, s47, 139264
    s_add_u32 s40, s46, 1770240
    ds_read_b64_tr_b16 v[200:201], v238 offset:8192
    ds_read_b64_tr_b16 v[202:203], v238 offset:8704
    s_waitcnt lgkmcnt(10)
    v_mfma_f32_32x32x16_bf16 v[164:179], v[180:183], v[28:31], v[164:179]
    buffer_load_dwordx4 v240, s[20:23], s40 offen lds
    v_mul_f32 v162, s49, v162
    v_mul_f32 v163, s49, v163
    ds_read_b64_tr_b16 v[180:181], v232 offset:16384
    ds_read_b64_tr_b16 v[182:183], v232 offset:16896
    s_waitcnt lgkmcnt(10)
    v_mfma_f32_32x32x16_bf16 v[164:179], v[184:187], v[32:35], v[164:179]
    v_cvt_pk_bf16_f32 v148, v148, v149
    v_cvt_pk_bf16_f32 v149, v150, v151
    v_cvt_pk_bf16_f32 v150, v152, v153
    ds_read_b64_tr_b16 v[184:185], v234 offset:16384
    ds_read_b64_tr_b16 v[186:187], v234 offset:16896
    s_waitcnt lgkmcnt(10)
    v_mfma_f32_32x32x16_bf16 v[164:179], v[188:191], v[36:39], v[164:179]
    v_cvt_pk_bf16_f32 v151, v154, v155
    buffer_store_dwordx4 v[148:151], v242, s[28:31], s48 offen offset:0 sc1
    v_cvt_pk_bf16_f32 v156, v156, v157
    ds_read_b64_tr_b16 v[188:189], v236 offset:16384
    ds_read_b64_tr_b16 v[190:191], v236 offset:16896
    s_waitcnt lgkmcnt(10)
    v_mfma_f32_32x32x16_bf16 v[164:179], v[192:195], v[40:43], v[164:179]
    v_cvt_pk_bf16_f32 v157, v158, v159
    v_cvt_pk_bf16_f32 v158, v160, v161
    v_cvt_pk_bf16_f32 v159, v162, v163
    buffer_store_dwordx4 v[156:159], v242, s[28:31], s48 offen offset:1024 sc1
    s_add_u32 s48, s48, 4096
    ds_read_b64_tr_b16 v[192:193], v238 offset:16384
    ds_read_b64_tr_b16 v[194:195], v238 offset:16896
    s_waitcnt lgkmcnt(10)
    v_mfma_f32_32x32x16_bf16 v[164:179], v[196:199], v[44:47], v[164:179]
    ds_read_b64_tr_b16 v[196:197], v232 offset:24576
    ds_read_b64_tr_b16 v[198:199], v232 offset:25088
    s_waitcnt lgkmcnt(10)
    v_mfma_f32_32x32x16_bf16 v[164:179], v[200:203], v[48:51], v[164:179]
    s_waitcnt vmcnt(14)
    s_barrier
    ds_read_b64_tr_b16 v[200:201], v234 offset:24576
    ds_read_b64_tr_b16 v[202:203], v234 offset:25088
    s_waitcnt lgkmcnt(10)
    v_mfma_f32_32x32x16_bf16 v[164:179], v[180:183], v[52:55], v[164:179]
    s_nop 0
    s_nop 0
    s_nop 0
    ds_read_b64_tr_b16 v[180:181], v236 offset:24576
    ds_read_b64_tr_b16 v[182:183], v236 offset:25088
    s_waitcnt lgkmcnt(10)
    v_mfma_f32_32x32x16_bf16 v[164:179], v[184:187], v[56:59], v[164:179]
    s_nop 0
    s_nop 0
    s_nop 0
    ds_read_b64_tr_b16 v[184:185], v238 offset:24576
    ds_read_b64_tr_b16 v[186:187], v238 offset:25088
    s_waitcnt lgkmcnt(10)
    v_mfma_f32_32x32x16_bf16 v[164:179], v[188:191], v[60:63], v[164:179]
    s_nop 0
    s_nop 0
    s_nop 0
    ds_read_b64_tr_b16 v[188:189], v232 offset:32768
    ds_read_b64_tr_b16 v[190:191], v232 offset:33280
    s_waitcnt lgkmcnt(10)
    v_mfma_f32_32x32x16_bf16 v[164:179], v[192:195], v[64:67], v[164:179]
    s_nop 0
    s_nop 0
    s_nop 0
    ds_read_b64_tr_b16 v[192:193], v234 offset:32768
    ds_read_b64_tr_b16 v[194:195], v234 offset:33280
    s_waitcnt lgkmcnt(10)
    v_mfma_f32_32x32x16_bf16 v[164:179], v[196:199], v[68:71], v[164:179]
    ds_read_b64_tr_b16 v[196:197], v236 offset:32768
    ds_read_b64_tr_b16 v[198:199], v236 offset:33280
    s_waitcnt lgkmcnt(10)
    v_mfma_f32_32x32x16_bf16 v[164:179], v[200:203], v[72:75], v[164:179]
    ds_read_b64_tr_b16 v[200:201], v238 offset:32768
    ds_read_b64_tr_b16 v[202:203], v238 offset:33280
    s_waitcnt lgkmcnt(10)
    v_mfma_f32_32x32x16_bf16 v[164:179], v[180:183], v[76:79], v[164:179]
    ds_read_b64_tr_b16 v[180:181], v232 offset:40960
    ds_read_b64_tr_b16 v[182:183], v232 offset:41472
    s_waitcnt lgkmcnt(10)
    v_mfma_f32_32x32x16_bf16 v[164:179], v[184:187], v[80:83], v[164:179]
    ds_read_b64_tr_b16 v[184:185], v234 offset:40960
    ds_read_b64_tr_b16 v[186:187], v234 offset:41472
    s_waitcnt lgkmcnt(10)
    v_mfma_f32_32x32x16_bf16 v[164:179], v[188:191], v[84:87], v[164:179]
    ds_read_b64_tr_b16 v[188:189], v236 offset:40960
    ds_read_b64_tr_b16 v[190:191], v236 offset:41472
    s_waitcnt lgkmcnt(10)
    v_mfma_f32_32x32x16_bf16 v[164:179], v[192:195], v[88:91], v[164:179]
    ds_read_b64_tr_b16 v[192:193], v238 offset:40960
    ds_read_b64_tr_b16 v[194:195], v238 offset:41472
    s_waitcnt lgkmcnt(10)
    v_mfma_f32_32x32x16_bf16 v[164:179], v[196:199], v[92:95], v[164:179]
    ds_read_b64_tr_b16 v[196:197], v232 offset:49152
    ds_read_b64_tr_b16 v[198:199], v232 offset:49664
    s_waitcnt lgkmcnt(10)
    v_mfma_f32_32x32x16_bf16 v[164:179], v[200:203], v[96:99], v[164:179]
    s_waitcnt vmcnt(9)
    s_barrier
    ds_read_b64_tr_b16 v[200:201], v234 offset:49152
    ds_read_b64_tr_b16 v[202:203], v234 offset:49664
    s_waitcnt lgkmcnt(10)
    v_mfma_f32_32x32x16_bf16 v[164:179], v[180:183], v[100:103], v[164:179]
    ds_read_b64_tr_b16 v[180:181], v236 offset:49152
    ds_read_b64_tr_b16 v[182:183], v236 offset:49664
    s_waitcnt lgkmcnt(10)
    v_mfma_f32_32x32x16_bf16 v[164:179], v[184:187], v[104:107], v[164:179]
    ds_read_b64_tr_b16 v[184:185], v238 offset:49152
    ds_read_b64_tr_b16 v[186:187], v238 offset:49664
    s_waitcnt lgkmcnt(10)
    v_mfma_f32_32x32x16_bf16 v[164:179], v[188:191], v[108:111], v[164:179]
    ds_read_b64_tr_b16 v[188:189], v232 offset:57344
    ds_read_b64_tr_b16 v[190:191], v232 offset:57856
    s_waitcnt lgkmcnt(10)
    v_mfma_f32_32x32x16_bf16 v[164:179], v[192:195], v[112:115], v[164:179]
    ds_read_b64_tr_b16 v[192:193], v234 offset:57344
    ds_read_b64_tr_b16 v[194:195], v234 offset:57856
    s_waitcnt lgkmcnt(10)
    v_mfma_f32_32x32x16_bf16 v[164:179], v[196:199], v[116:119], v[164:179]
    ds_read_b64_tr_b16 v[196:197], v236 offset:57344
    ds_read_b64_tr_b16 v[198:199], v236 offset:57856
    s_waitcnt lgkmcnt(10)
    v_mfma_f32_32x32x16_bf16 v[164:179], v[200:203], v[120:123], v[164:179]
    ds_read_b64_tr_b16 v[200:201], v238 offset:57344
    ds_read_b64_tr_b16 v[202:203], v238 offset:57856
    s_waitcnt lgkmcnt(10)
    v_mfma_f32_32x32x16_bf16 v[164:179], v[180:183], v[124:127], v[164:179]
    s_waitcnt lgkmcnt(8)
    v_mfma_f32_32x32x16_bf16 v[164:179], v[184:187], v[128:131], v[164:179]
    s_waitcnt lgkmcnt(6)
    v_mfma_f32_32x32x16_bf16 v[164:179], v[188:191], v[132:135], v[164:179]
    s_waitcnt lgkmcnt(4)
    v_mfma_f32_32x32x16_bf16 v[164:179], v[192:195], v[136:139], v[164:179]
    s_waitcnt lgkmcnt(2)
    v_mfma_f32_32x32x16_bf16 v[164:179], v[196:199], v[140:143], v[164:179]
    s_waitcnt lgkmcnt(0)
    v_mfma_f32_32x32x16_bf16 v[164:179], v[200:203], v[144:147], v[164:179]
    s_waitcnt vmcnt(5)
    s_barrier
    s_cmp_eq_u32 s35, 3
    s_cbranch_scc1 p1_q6
    ds_read_b64_tr_b16 v[180:181], v233 offset:0
    ds_read_b64_tr_b16 v[182:183], v233 offset:512
    ds_read_b64_tr_b16 v[184:185], v235 offset:0
    ds_read_b64_tr_b16 v[186:187], v235 offset:512
    ds_read_b64_tr_b16 v[188:189], v237 offset:0
    ds_read_b64_tr_b16 v[190:191], v237 offset:512
    ds_read_b64_tr_b16 v[192:193], v239 offset:0
    ds_read_b64_tr_b16 v[194:195], v239 offset:512
    ds_read_b64_tr_b16 v[196:197], v233 offset:8192
    ds_read_b64_tr_b16 v[198:199], v233 offset:8704
    ds_read_b64_tr_b16 v[200:201], v235 offset:8192
    ds_read_b64_tr_b16 v[202:203], v235 offset:8704
    s_waitcnt lgkmcnt(10)
    v_mfma_f32_32x32x16_bf16 v[148:163], v[180:183], v[4:7], 0
    s_cmp_lt_i32 s50, 8
    s_cselect_b32 s49, 0x3eae1a93, 1.0
    v_mul_f32 v164, s49, v164
    v_mul_f32 v165, s49, v165
    ds_read_b64_tr_b16 v[180:181], v237 offset:8192
    ds_read_b64_tr_b16 v[182:183], v237 offset:8704
    s_waitcnt lgkmcnt(10)
    v_mfma_f32_32x32x16_bf16 v[148:163], v[184:187], v[8:11], v[148:163]
    v_mul_f32 v166, s49, v166
    v_mul_f32 v167, s49, v167
    ds_read_b64_tr_b16 v[184:185], v239 offset:8192
    ds_read_b64_tr_b16 v[186:187], v239 offset:8704
    s_waitcnt lgkmcnt(10)
    v_mfma_f32_32x32x16_bf16 v[148:163], v[188:191], v[12:15], v[148:163]
    v_mul_f32 v168, s49, v168
    v_mul_f32 v169, s49, v169
    v_mul_f32 v170, s49, v170
    ds_read_b64_tr_b16 v[188:189], v233 offset:24576
    ds_read_b64_tr_b16 v[190:191], v233 offset:25088
    s_waitcnt lgkmcnt(10)
    v_mfma_f32_32x32x16_bf16 v[148:163], v[192:195], v[16:19], v[148:163]
    v_mul_f32 v171, s49, v171
    v_mul_f32 v172, s49, v172
    ds_read_b64_tr_b16 v[192:193], v235 offset:24576
    ds_read_b64_tr_b16 v[194:195], v235 offset:25088
    s_waitcnt lgkmcnt(10)
    v_mfma_f32_32x32x16_bf16 v[148:163], v[196:199], v[20:23], v[148:163]
    v_mul_f32 v173, s49, v173
    v_mul_f32 v174, s49, v174
    v_mul_f32 v175, s49, v175
    ds_read_b64_tr_b16 v[196:197], v237 offset:24576
    ds_read_b64_tr_b16 v[198:199], v237 offset:25088
    s_waitcnt lgkmcnt(10)
    v_mfma_f32_32x32x16_bf16 v[148:163], v[200:203], v[24:27], v[148:163]
    v_mul_f32 v176, s49, v176
    v_mul_f32 v177, s49, v177
    ds_read_b64_tr_b16 v[200:201], v239 offset:24576
    ds_read_b64_tr_b16 v[202:203], v239 offset:25088
    s_waitcnt lgkmcnt(10)
    v_mfma_f32_32x32x16_bf16 v[148:163], v[180:183], v[28:31], v[148:163]
    v_mul_f32 v178, s49, v178
    v_mul_f32 v179, s49, v179
    v_cvt_pk_bf16_f32 v164, v164, v165
    ds_read_b64_tr_b16 v[180:181], v233 offset:32768
    ds_read_b64_tr_b16 v[182:183], v233 offset:33280
    s_waitcnt lgkmcnt(10)
    v_mfma_f32_32x32x16_bf16 v[148:163], v[184:187], v[32:35], v[148:163]
    v_cvt_pk_bf16_f32 v165, v166, v167
    v_cvt_pk_bf16_f32 v166, v168, v169
    ds_read_b64_tr_b16 v[184:185], v235 offset:32768
    ds_read_b64_tr_b16 v[186:187], v235 offset:33280
    s_waitcnt lgkmcnt(10)
    v_mfma_f32_32x32x16_bf16 v[148:163], v[188:191], v[36:39], v[148:163]
    v_cvt_pk_bf16_f32 v167, v170, v171
    buffer_store_dwordx4 v[164:167], v242, s[28:31], s48 offen offset:0 sc1
    v_cvt_pk_bf16_f32 v172, v172, v173
    v_cvt_pk_bf16_f32 v173, v174, v175
    ds_read_b64_tr_b16 v[188:189], v237 offset:32768
    ds_read_b64_tr_b16 v[190:191], v237 offset:33280
    s_waitcnt lgkmcnt(10)
    v_mfma_f32_32x32x16_bf16 v[148:163], v[192:195], v[40:43], v[148:163]
    v_cvt_pk_bf16_f32 v174, v176, v177
    v_cvt_pk_bf16_f32 v175, v178, v179
    buffer_store_dwordx4 v[172:175], v242, s[28:31], s48 offen offset:1024 sc1
    s_add_u32 s48, s48, 4096
    ds_read_b64_tr_b16 v[192:193], v239 offset:32768
    ds_read_b64_tr_b16 v[194:195], v239 offset:33280
    s_waitcnt lgkmcnt(10)
    v_mfma_f32_32x32x16_bf16 v[148:163], v[196:199], v[44:47], v[148:163]
    ds_read_b64_tr_b16 v[196:197], v233 offset:40960
    ds_read_b64_tr_b16 v[198:199], v233 offset:41472
    s_waitcnt lgkmcnt(10)
    v_mfma_f32_32x32x16_bf16 v[148:163], v[200:203], v[48:51], v[148:163]
    s_waitcnt vmcnt(4)
    s_barrier
    ds_read_b64_tr_b16 v[200:201], v235 offset:40960
    ds_read_b64_tr_b16 v[202:203], v235 offset:41472
    s_waitcnt lgkmcnt(10)
    v_mfma_f32_32x32x16_bf16 v[148:163], v[180:183], v[52:55], v[148:163]
    s_nop 0
    s_nop 0
    s_nop 0
    ds_read_b64_tr_b16 v[180:181], v237 offset:40960
    ds_read_b64_tr_b16 v[182:183], v237 offset:41472
    s_waitcnt lgkmcnt(10)
    v_mfma_f32_32x32x16_bf16 v[148:163], v[184:187], v[56:59], v[148:163]
    s_nop 0
    s_nop 0
    s_nop 0
    ds_read_b64_tr_b16 v[184:185], v239 offset:40960
    ds_read_b64_tr_b16 v[186:187], v239 offset:41472
    s_waitcnt lgkmcnt(10)
    v_mfma_f32_32x32x16_bf16 v[148:163], v[188:191], v[60:63], v[148:163]
    s_nop 0
    s_nop 0
    s_nop 0
    ds_read_b64_tr_b16 v[188:189], v233 offset:49152
    ds_read_b64_tr_b16 v[190:191], v233 offset:49664
    s_waitcnt lgkmcnt(10)
    v_mfma_f32_32x32x16_bf16 v[148:163], v[192:195], v[64:67], v[148:163]
    s_nop 0
    s_nop 0
    s_nop 0
    ds_read_b64_tr_b16 v[192:193], v235 offset:49152
    ds_read_b64_tr_b16 v[194:195], v235 offset:49664
    s_waitcnt lgkmcnt(10)
    v_mfma_f32_32x32x16_bf16 v[148:163], v[196:199], v[68:71], v[148:163]
    ds_read_b64_tr_b16 v[196:197], v237 offset:49152
    ds_read_b64_tr_b16 v[198:199], v237 offset:49664
    s_waitcnt lgkmcnt(10)
    v_mfma_f32_32x32x16_bf16 v[148:163], v[200:203], v[72:75], v[148:163]
    ds_read_b64_tr_b16 v[200:201], v239 offset:49152
    ds_read_b64_tr_b16 v[202:203], v239 offset:49664
    s_waitcnt lgkmcnt(10)
    v_mfma_f32_32x32x16_bf16 v[148:163], v[180:183], v[76:79], v[148:163]
    ds_read_b64_tr_b16 v[180:181], v233 offset:57344
    ds_read_b64_tr_b16 v[182:183], v233 offset:57856
    s_waitcnt lgkmcnt(10)
    v_mfma_f32_32x32x16_bf16 v[148:163], v[184:187], v[80:83], v[148:163]
    ds_read_b64_tr_b16 v[184:185], v235 offset:57344
    ds_read_b64_tr_b16 v[186:187], v235 offset:57856
    s_waitcnt lgkmcnt(10)
    v_mfma_f32_32x32x16_bf16 v[148:163], v[188:191], v[84:87], v[148:163]
    ds_read_b64_tr_b16 v[188:189], v237 offset:57344
    ds_read_b64_tr_b16 v[190:191], v237 offset:57856
    s_waitcnt lgkmcnt(10)
    v_mfma_f32_32x32x16_bf16 v[148:163], v[192:195], v[88:91], v[148:163]
    ds_read_b64_tr_b16 v[192:193], v239 offset:57344
    ds_read_b64_tr_b16 v[194:195], v239 offset:57856
    s_waitcnt lgkmcnt(10)
    v_mfma_f32_32x32x16_bf16 v[148:163], v[196:199], v[92:95], v[148:163]
    v_add_u32 v232, 0x20000, v232
    ds_read_b64_tr_b16 v[196:197], v232 offset:0
    ds_read_b64_tr_b16 v[198:199], v232 offset:512
    s_waitcnt lgkmcnt(10)
    v_mfma_f32_32x32x16_bf16 v[148:163], v[200:203], v[96:99], v[148:163]
    s_barrier
    v_add_u32 v234, 0x20000, v234
    ds_read_b64_tr_b16 v[200:201], v234 offset:0
    ds_read_b64_tr_b16 v[202:203], v234 offset:512
    s_waitcnt lgkmcnt(10)
    v_mfma_f32_32x32x16_bf16 v[148:163], v[180:183], v[100:103], v[148:163]
    v_add_u32 v236, 0x20000, v236
    ds_read_b64_tr_b16 v[180:181], v236 offset:0
    ds_read_b64_tr_b16 v[182:183], v236 offset:512
    s_waitcnt lgkmcnt(10)
    v_mfma_f32_32x32x16_bf16 v[148:163], v[184:187], v[104:107], v[148:163]
    v_add_u32 v238, 0x20000, v238
    ds_read_b64_tr_b16 v[184:185], v238 offset:0
    ds_read_b64_tr_b16 v[186:187], v238 offset:512
    s_waitcnt lgkmcnt(10)
    v_mfma_f32_32x32x16_bf16 v[148:163], v[188:191], v[108:111], v[148:163]
    ds_read_b64_tr_b16 v[188:189], v232 offset:8192
    ds_read_b64_tr_b16 v[190:191], v232 offset:8704
    s_waitcnt lgkmcnt(10)
    v_mfma_f32_32x32x16_bf16 v[148:163], v[192:195], v[112:115], v[148:163]
    ds_read_b64_tr_b16 v[192:193], v234 offset:8192
    ds_read_b64_tr_b16 v[194:195], v234 offset:8704
    s_waitcnt lgkmcnt(10)
    v_mfma_f32_32x32x16_bf16 v[148:163], v[196:199], v[116:119], v[148:163]
    ds_read_b64_tr_b16 v[196:197], v236 offset:8192
    ds_read_b64_tr_b16 v[198:199], v236 offset:8704
    s_waitcnt lgkmcnt(10)
    v_mfma_f32_32x32x16_bf16 v[148:163], v[200:203], v[120:123], v[148:163]
    ds_read_b64_tr_b16 v[200:201], v238 offset:8192
    ds_read_b64_tr_b16 v[202:203], v238 offset:8704
    s_waitcnt lgkmcnt(10)
    v_mfma_f32_32x32x16_bf16 v[148:163], v[180:183], v[124:127], v[148:163]
    s_waitcnt lgkmcnt(8)
    v_mfma_f32_32x32x16_bf16 v[148:163], v[184:187], v[128:131], v[148:163]
    s_waitcnt lgkmcnt(6)
    v_mfma_f32_32x32x16_bf16 v[148:163], v[188:191], v[132:135], v[148:163]
    s_waitcnt lgkmcnt(4)
    v_mfma_f32_32x32x16_bf16 v[148:163], v[192:195], v[136:139], v[148:163]
    s_waitcnt lgkmcnt(2)
    v_mfma_f32_32x32x16_bf16 v[148:163], v[196:199], v[140:143], v[148:163]
    s_waitcnt lgkmcnt(0)
    v_mfma_f32_32x32x16_bf16 v[148:163], v[200:203], v[144:147], v[148:163]
    s_barrier
    s_cmp_lt_i32 s50, 6
    s_cselect_b32 s49, 0x3eae1a93, 1.0
    s_nop 9
    v_mul_f32 v148, s49, v148
    v_mul_f32 v149, s49, v149
    v_mul_f32 v150, s49, v150
    v_mul_f32 v151, s49, v151
    v_mul_f32 v152, s49, v152
    v_mul_f32 v153, s49, v153
    v_mul_f32 v154, s49, v154
    v_mul_f32 v155, s49, v155
    v_mul_f32 v156, s49, v156
    v_mul_f32 v157, s49, v157
    v_mul_f32 v158, s49, v158
    v_mul_f32 v159, s49, v159
    v_mul_f32 v160, s49, v160
    v_mul_f32 v161, s49, v161
    v_mul_f32 v162, s49, v162
    v_mul_f32 v163, s49, v163
    v_cvt_pk_bf16_f32 v148, v148, v149
    v_cvt_pk_bf16_f32 v149, v150, v151
    v_cvt_pk_bf16_f32 v150, v152, v153
    v_cvt_pk_bf16_f32 v151, v154, v155
    buffer_store_dwordx4 v[148:151], v242, s[28:31], s48 offen offset:0 sc1
    v_cvt_pk_bf16_f32 v156, v156, v157
    v_cvt_pk_bf16_f32 v157, v158, v159
    v_cvt_pk_bf16_f32 v158, v160, v161
    v_cvt_pk_bf16_f32 v159, v162, v163
    buffer_store_dwordx4 v[156:159], v242, s[28:31], s48 offen offset:1024 sc1
    s_add_u32 s48, s48, 4096
    v_mov_b32 v230, 163328
    v_mov_b32 v231, 1
    s_waitcnt vmcnt(0)
    s_barrier
    s_cmp_lg_u32 s32, 0
    s_cbranch_scc1 ws_11
    s_mov_b64 exec, 1
    v_mov_b32 v228, 7
    buffer_store_dword v228, off, s[28:31], s14 sc1
    s_mov_b64 exec, -1
ws_11:
    s_cmp_ge_u32 s32, 4
    s_cbranch_scc1 qx_10
    s_mov_b64 exec, 1
    ds_add_u32 v230, v231 offset:4
    s_mov_b64 exec, -1
    v_and_b32 v230, 63, v0
    v_min_u32 v229, 11, v230
    v_lshrrev_b32 v231, 2, v229
    s_sub_u32 s40, s36, 2
    v_add_u32 v231, s40, v231
    v_max_i32 v231, 0, v231
    v_and_b32 v229, 3, v229
    v_lshlrev_b32 v231, 9, v231
    v_lshl_add_u32 v231, v229, 7, v231
    v_add_u32 v231, 0x2d6000c, v231
    v_lshlrev_b32 v230, 2, v230
    buffer_load_dword v253, v230, s[4:7], 0 offen sc1
    buffer_load_dword v254, v231, s[28:31], 0 offen sc1
    s_waitcnt vmcnt(0)
    s_branch p2_attn
qx_10:
    v_bfe_u32 v254, v0, 2, 2
    v_mul_u32_u24 v254, 1152, v254
    v_and_b32 v253, 3, v0
    v_lshl_add_u32 v254, v253, 4, v254
    v_bfe_u32 v253, v0, 4, 2
    v_lshl_add_u32 v254, v253, 6, v254
    v_bfe_u32 v253, v0, 1, 5
    v_mul_u32_u24 v253, 72, v253
    v_bfi_b32 v253, 1, v0, v253
    v_lshlrev_b32 v253, 4, v253
    s_mul_i32 s40, s37, -224
    s_add_u32 s40, s40, 1024
    v_add_u32 v253, s40, v253
    s_mul_i32 s8, s35, 1152
    s_mul_i32 s11, s35, 144
    s_lshl_b32 s40, s33, 4
    s_lshl_b32 s41, s37, 8
    s_add_u32 s8, s8, s40
    s_mul_i32 s8, s8, 1152
    s_add_u32 s8, s8, s41
    s_add_u32 s11, s11, s40
    s_mul_i32 s11, s11, 1152
    s_add_u32 s11, s11, s41
    s_mul_i32 s9, s33, 4608
    v_add_u32 v14, 14336, v254
    v_add_u32 v13, 10752, v254
    v_add_u32 v12, 7168, v254
    v_add_u32 v254, 3584, v254
    v_add_u32 v253, 4096, v253
    s_andn2_b32 s40, s14, 15
    v_and_b32 v8, 63, v0
    v_lshlrev_b32 v8, 2, v8
    buffer_load_dword v8, v8, s[4:7], 0 offen sc1
    buffer_load_dwordx4 v[4:7], off, s[28:31], s40 sc1
    s_add_u32 m0, s9, 81920
    s_add_u32 s10, s8, 0
    buffer_load_dwordx4 v254, s[16:19], s10 offen offset:512 lds
    buffer_load_dwordx4 v12, s[16:19], s10 offen offset:1536 lds
    buffer_load_dwordx4 v13, s[16:19], s10 offen offset:2560 lds
    buffer_load_dwordx4 v14, s[16:19], s10 offen offset:3584 lds
    s_mov_b32 exec_hi, 0
    buffer_load_dwordx4 v253, s[16:19], s10 offen lds
    s_mov_b32 exec_hi, -1
    s_add_u32 m0, s9, 100352
    s_add_u32 s10, s8, 442368
    buffer_load_dwordx4 v254, s[16:19], s10 offen offset:512 lds
    buffer_load_dwordx4 v12, s[16:19], s10 offen offset:1536 lds
    buffer_load_dwordx4 v13, s[16:19], s10 offen offset:2560 lds
    buffer_load_dwordx4 v14, s[16:19], s10 offen offset:3584 lds
    s_mov_b32 exec_hi, 0
    buffer_load_dwordx4 v253, s[16:19], s10 offen lds
    s_mov_b32 exec_hi, -1
    s_add_u32 m0, s9, 118784
    s_add_u32 s10, s8, 884736
    buffer_load_dwordx4 v254, s[16:19], s10 offen offset:512 lds
    buffer_load_dwordx4 v12, s[16:19], s10 offen offset:1536 lds
    buffer_load_dwordx4 v13, s[16:19], s10 offen offset:2560 lds
    buffer_load_dwordx4 v14, s[16:19], s10 offen offset:3584 lds
    s_mov_b32 exec_hi, 0
    buffer_load_dwordx4 v253, s[16:19], s10 offen lds
    s_mov_b32 exec_hi, -1
    s_branch p2_gemm
p1_q6:
    s_cmp_lt_i32 s50, 8
    s_cselect_b32 s49, 0x3eae1a93, 1.0
    s_nop 6
    v_mul_f32 v164, s49, v164
    v_mul_f32 v165, s49, v165
    v_mul_f32 v166, s49, v166
    v_mul_f32 v167, s49, v167
    v_mul_f32 v168, s49, v168
    v_mul_f32 v169, s49, v169
    v_mul_f32 v170, s49, v170
    v_mul_f32 v171, s49, v171
    v_mul_f32 v172, s49, v172
    v_mul_f32 v173, s49, v173
    v_mul_f32 v174, s49, v174
    v_mul_f32 v175, s49, v175
    v_mul_f32 v176, s49, v176
    v_mul_f32 v177, s49, v177
    v_mul_f32 v178, s49, v178
    v_mul_f32 v179, s49, v179
    v_cvt_pk_bf16_f32 v164, v164, v165
    v_cvt_pk_bf16_f32 v165, v166, v167
    v_cvt_pk_bf16_f32 v166, v168, v169
    v_cvt_pk_bf16_f32 v167, v170, v171
    buffer_store_dwordx4 v[164:167], v242, s[28:31], s48 offen offset:0 sc1
    v_cvt_pk_bf16_f32 v172, v172, v173
    v_cvt_pk_bf16_f32 v173, v174, v175
    v_cvt_pk_bf16_f32 v174, v176, v177
    v_cvt_pk_bf16_f32 v175, v178, v179
    buffer_store_dwordx4 v[172:175], v242, s[28:31], s48 offen offset:1024 sc1
    s_add_u32 s48, s48, 4096
    v_mov_b32 v230, 163328
    v_mov_b32 v231, 1
    s_waitcnt vmcnt(0)
    s_barrier
    s_cmp_lg_u32 s32, 0
    s_cbranch_scc1 ws_13
    s_mov_b64 exec, 1
    v_mov_b32 v228, 7
    buffer_store_dword v228, off, s[28:31], s14 sc1
    s_mov_b64 exec, -1
ws_13:
    s_cmp_ge_u32 s32, 4
    s_cbranch_scc1 qx_12
    s_mov_b64 exec, 1
    ds_add_u32 v230, v231 offset:4
    s_mov_b64 exec, -1
    v_and_b32 v230, 63, v0
    v_min_u32 v229, 11, v230
    v_lshrrev_b32 v231, 2, v229
    s_sub_u32 s40, s36, 2
    v_add_u32 v231, s40, v231
    v_max_i32 v231, 0, v231
    v_and_b32 v229, 3, v229
    v_lshlrev_b32 v231, 9, v231
    v_lshl_add_u32 v231, v229, 7, v231
    v_add_u32 v231, 0x2d6000c, v231
    v_lshlrev_b32 v230, 2, v230
    buffer_load_dword v253, v230, s[4:7], 0 offen sc1
    buffer_load_dword v254, v231, s[28:31], 0 offen sc1
    s_waitcnt vmcnt(0)
    s_branch p2_attn
qx_12:
    v_bfe_u32 v254, v0, 2, 2
    v_mul_u32_u24 v254, 1152, v254
    v_and_b32 v253, 3, v0
    v_lshl_add_u32 v254, v253, 4, v254
    v_bfe_u32 v253, v0, 4, 2
    v_lshl_add_u32 v254, v253, 6, v254
    v_bfe_u32 v253, v0, 1, 5
    v_mul_u32_u24 v253, 72, v253
    v_bfi_b32 v253, 1, v0, v253
    v_lshlrev_b32 v253, 4, v253
    s_mul_i32 s40, s37, -224
    s_add_u32 s40, s40, 1024
    v_add_u32 v253, s40, v253
    s_mul_i32 s8, s35, 1152
    s_mul_i32 s11, s35, 144
    s_lshl_b32 s40, s33, 4
    s_lshl_b32 s41, s37, 8
    s_add_u32 s8, s8, s40
    s_mul_i32 s8, s8, 1152
    s_add_u32 s8, s8, s41
    s_add_u32 s11, s11, s40
    s_mul_i32 s11, s11, 1152
    s_add_u32 s11, s11, s41
    s_mul_i32 s9, s33, 4608
    v_add_u32 v14, 14336, v254
    v_add_u32 v13, 10752, v254
    v_add_u32 v12, 7168, v254
    v_add_u32 v254, 3584, v254
    v_add_u32 v253, 4096, v253
    s_andn2_b32 s40, s14, 15
    v_and_b32 v8, 63, v0
    v_lshlrev_b32 v8, 2, v8
    buffer_load_dword v8, v8, s[4:7], 0 offen sc1
    buffer_load_dwordx4 v[4:7], off, s[28:31], s40 sc1
    s_add_u32 m0, s9, 81920
    s_add_u32 s10, s8, 0
    buffer_load_dwordx4 v254, s[16:19], s10 offen offset:512 lds
    buffer_load_dwordx4 v12, s[16:19], s10 offen offset:1536 lds
    buffer_load_dwordx4 v13, s[16:19], s10 offen offset:2560 lds
    buffer_load_dwordx4 v14, s[16:19], s10 offen offset:3584 lds
    s_mov_b32 exec_hi, 0
    buffer_load_dwordx4 v253, s[16:19], s10 offen lds
    s_mov_b32 exec_hi, -1
    s_add_u32 m0, s9, 100352
    s_add_u32 s10, s8, 442368
    buffer_load_dwordx4 v254, s[16:19], s10 offen offset:512 lds
    buffer_load_dwordx4 v12, s[16:19], s10 offen offset:1536 lds
    buffer_load_dwordx4 v13, s[16:19], s10 offen offset:2560 lds
    buffer_load_dwordx4 v14, s[16:19], s10 offen offset:3584 lds
    s_mov_b32 exec_hi, 0
    buffer_load_dwordx4 v253, s[16:19], s10 offen lds
    s_mov_b32 exec_hi, -1
    s_add_u32 m0, s9, 118784
    s_add_u32 s10, s8, 884736
    buffer_load_dwordx4 v254, s[16:19], s10 offen offset:512 lds
    buffer_load_dwordx4 v12, s[16:19], s10 offen offset:1536 lds
    buffer_load_dwordx4 v13, s[16:19], s10 offen offset:2560 lds
    buffer_load_dwordx4 v14, s[16:19], s10 offen offset:3584 lds
    s_mov_b32 exec_hi, 0
    buffer_load_dwordx4 v253, s[16:19], s10 offen lds
    s_mov_b32 exec_hi, -1
    s_branch p2_gemm
p2_gemm:
    s_setprio 1
    v_and_b32 v195, 63, v0
    v_lshlrev_b32 v194, 4, v195
    s_andn2_b32 s45, s14, 15
    s_lshl_b32 s51, s33, 4
    s_add_u32 s51, s51, s45
    v_lshlrev_b32 v180, 2, v195
    s_waitcnt vmcnt(15)
    v_mov_b32 v196, v8
    v_mov_b32 v184, v4
    v_mov_b32 v185, v5
    v_mov_b32 v186, v6
    v_mov_b32 v187, v7
    s_mul_i32 s44, s38, 288
    s_mul_i32 s40, s35, 72
    s_add_u32 s44, s44, s40
    s_lshl_b32 s44, s44, 10
    v_bfe_u32 v181, v195, 2, 2
    v_and_b32 v182, 3, v195
    v_lshrrev_b32 v183, 5, v195
    v_bfe_u32 v176, v195, 4, 1
    v_lshlrev_b32 v188, 6, v181
    v_lshl_add_u32 v188, v182, 3, v188
    v_lshl_add_u32 v188, v183, 10, v188
    v_lshl_add_u32 v188, v176, 5, v188
    v_add_u32 v188, 81920, v188
    v_add_u32 v189, 36864, v188
    v_mul_u32_u24 v190, 4608, v176
    v_lshl_add_u32 v190, v183, 7, v190
    v_lshl_add_u32 v190, v181, 5, v190
    v_lshl_add_u32 v190, v182, 3, v190
    v_add_u32 v190, 81920, v190
    v_add_u32 v191, 36864, v190
    v_and_b32 v200, 15, v195
    v_lshlrev_b32 v200, 4, v200
    v_lshl_add_u32 v200, v176, 9, v200
    v_lshl_add_u32 v200, v183, 3, v200
    v_mov_b32 v198, 163328
    v_mov_b32 v199, 1
    v_lshl_add_u32 v202, v195, 2, v198
    v_cmp_eq_u32 vcc, 0, v195
    s_nop 1
    v_cndmask_b32_e64 v203, 0, 1, vcc
    v_sub_f32 v255, 1.0, v255
    v_and_b32 v197, 31, v195
    s_lshl_b32 s40, s33, 7
    v_lshl_add_u32 v197, v197, 2, s40
    v_add_u32 v197, 161792, v197
    ds_write_b32 v197, v255
    v_mov_b32 v192, v255
    v_mov_b32 v193, v255
    s_nop 1
    v_permlane16_swap_b32 v192, v193
    v_mov_b32 v176, 0
    v_mov_b32 v177, 0
    v_mov_b32 v178, 0
    v_mov_b32 v179, 0
    v_mov_b32 v181, 0x01010101
    v_cmp_ne_u32 vcc, v196, v181
    s_nop 3
    s_cmp_eq_u64 vcc, 0
    s_cbranch_scc1 ready_15
    s_mov_b32 s42, 0x8000
spin_14:
    s_sub_u32 s42, s42, 1
    s_cbranch_scc1 ready_15
    s_sleep 4
    buffer_load_dword v196, v180, s[4:7], 0 offen sc1
    s_waitcnt vmcnt(0)
    v_mov_b32 v181, 0x01010101
    s_nop 4
    v_cmp_ne_u32 vcc, v196, v181
    s_nop 4
    s_cmp_eq_u64 vcc, 0
    s_nop 4
    s_cbranch_scc0 spin_14
ready_15:
    v_min3_u32 v181, v184, v185, v186
    s_nop 0
    v_readfirstlane_b32 s41, v181
    s_nop 3
    s_cmp_ge_u32 s41, 3
    s_cbranch_scc1 ready_17
    s_mov_b32 s42, 0x8000
spin_16:
    s_sub_u32 s42, s42, 1
    s_cbranch_scc1 ready_17
    s_sleep 4
    buffer_load_dwordx4 v[184:187], off, s[28:31], s45 sc1
    s_waitcnt vmcnt(0)
    v_min3_u32 v181, v184, v185, v186
    s_nop 4
    v_readfirstlane_b32 s41, v181
    s_nop 4
    s_cmp_ge_u32 s41, 3
    s_nop 4
    s_cbranch_scc0 spin_16
ready_17:
    s_add_u32 s50, s44, 0
    buffer_load_dwordx4 v[88:91], v194, s[28:31], s50 offen offset:0 sc1
    buffer_load_dwordx4 v[92:95], v194, s[28:31], s50 offen offset:1024 sc1
    buffer_load_dwordx4 v[96:99], v194, s[28:31], s50 offen offset:2048 sc1
    buffer_load_dwordx4 v[100:103], v194, s[28:31], s50 offen offset:3072 sc1
    s_add_u32 s50, s44, 24576
    buffer_load_dwordx4 v[104:107], v194, s[28:31], s50 offen offset:0 sc1
    buffer_load_dwordx4 v[108:111], v194, s[28:31], s50 offen offset:1024 sc1
    buffer_load_dwordx4 v[112:115], v194, s[28:31], s50 offen offset:2048 sc1
    buffer_load_dwordx4 v[116:119], v194, s[28:31], s50 offen offset:3072 sc1
    s_add_u32 s50, s44, 49152
    buffer_load_dwordx4 v[120:123], v194, s[28:31], s50 offen offset:0 sc1
    buffer_load_dwordx4 v[124:127], v194, s[28:31], s50 offen offset:1024 sc1
    buffer_load_dwordx4 v[128:131], v194, s[28:31], s50 offen offset:2048 sc1
    buffer_load_dwordx4 v[132:135], v194, s[28:31], s50 offen offset:3072 sc1
    s_waitcnt vmcnt(17)
    ds_add_u32 v202, v203 offset:0
    ds_read_b32 v197, v198
    s_waitcnt lgkmcnt(0)
    v_readfirstlane_b32 s42, v197
    s_nop 3
    s_cmp_ge_u32 s42, 4
    s_cbranch_scc1 lr_19
    s_mov_b32 s15, 0x80000
lw_18:
    s_sub_u32 s15, s15, 1
    s_cbranch_scc1 lr_19
    ds_read_b32 v197, v198
    s_waitcnt lgkmcnt(0)
    v_readfirstlane_b32 s42, v197
    s_nop 3
    s_cmp_ge_u32 s42, 4
    s_cbranch_scc0 lw_18
lr_19:
    ds_read_b64_tr_b16 v[136:137], v188 offset:512
    ds_read_b64_tr_b16 v[138:139], v188 offset:2560
    ds_read_b64_tr_b16 v[140:141], v188 offset:768
    ds_read_b64_tr_b16 v[142:143], v188 offset:2816
    ds_read_b64_tr_b16 v[144:145], v188 offset:1024
    ds_read_b64_tr_b16 v[146:147], v188 offset:3072
    ds_read_b64_tr_b16 v[148:149], v188 offset:1280
    ds_read_b64_tr_b16 v[150:151], v188 offset:3328
    ds_read_b64_tr_b16 v[152:153], v188 offset:5120
    ds_read_b64_tr_b16 v[154:155], v188 offset:7168
    ds_read_b64_tr_b16 v[168:169], v190 offset:0
    ds_read_b64_tr_b16 v[170:171], v190 offset:256
    ds_read_b64_tr_b16 v[156:157], v188 offset:5376
    ds_read_b64_tr_b16 v[158:159], v188 offset:7424
    s_waitcnt lgkmcnt(10)
    s_waitcnt vmcnt(11)
    v_mfma_f32_32x32x16_bf16 v[16:31], v[136:139], v[88:91], 0
    ds_add_u32 v202, v203 offset:8
    s_add_u32 m0, s9, 137216
    s_add_u32 s10, s8, 73728
    ds_read_b64_tr_b16 v[160:161], v188 offset:5632
    ds_read_b64_tr_b16 v[162:163], v188 offset:7680
    v_mfma_f32_32x32x16_bf16 v[32:47], v[140:143], v[88:91], 0
    buffer_load_dwordx4 v254, s[16:19], s10 offen offset:512 lds
    buffer_load_dwordx4 v12, s[16:19], s10 offen offset:1536 lds
    buffer_load_dwordx4 v13, s[16:19], s10 offen offset:2560 lds
    ds_read_b64_tr_b16 v[164:165], v188 offset:5888
    ds_read_b64_tr_b16 v[166:167], v188 offset:7936
    s_waitcnt lgkmcnt(11)
    v_mfma_f32_32x32x16_bf16 v[48:63], v[144:147], v[88:91], 0
    buffer_load_dwordx4 v14, s[16:19], s10 offen offset:3584 lds
    s_mov_b32 exec_hi, 0
    buffer_load_dwordx4 v253, s[16:19], s10 offen lds
    s_mov_b32 exec_hi, -1
    ds_read_b64_tr_b16 v[136:137], v188 offset:9728
    ds_read_b64_tr_b16 v[138:139], v188 offset:11776
    v_mfma_f32_32x32x16_bf16 v[64:79], v[148:151], v[88:91], 0
    ds_read_b64_tr_b16 v[172:173], v190 offset:9216
    ds_read_b64_tr_b16 v[174:175], v190 offset:9472
    ds_read_b64_tr_b16 v[140:141], v188 offset:9984
    ds_read_b64_tr_b16 v[142:143], v188 offset:12032
    s_waitcnt lgkmcnt(11)
    s_waitcnt vmcnt(15)
    v_mfma_f32_32x32x16_bf16 v[16:31], v[152:155], v[92:95], v[16:31]
    ds_read_b64_tr_b16 v[144:145], v188 offset:10240
    ds_read_b64_tr_b16 v[146:147], v188 offset:12288
    v_mfma_f32_32x32x16_bf16 v[32:47], v[156:159], v[92:95], v[32:47]
    ds_read_b64_tr_b16 v[148:149], v188 offset:10496
    ds_read_b64_tr_b16 v[150:151], v188 offset:12544
    s_waitcnt lgkmcnt(10)
    v_mfma_f32_32x32x16_bf16 v[48:63], v[160:163], v[92:95], v[48:63]
    ds_read_b64_tr_b16 v[152:153], v188 offset:14336
    ds_read_b64_tr_b16 v[154:155], v188 offset:16384
    v_mfma_f32_32x32x16_bf16 v[64:79], v[164:167], v[92:95], v[64:79]
    ds_read_b32 v196, v198 offset:8
    ds_read_b64_tr_b16 v[156:157], v188 offset:14592
    ds_read_b64_tr_b16 v[158:159], v188 offset:16640
    s_waitcnt lgkmcnt(9)
    s_waitcnt vmcnt(14)
    v_mfma_f32_32x32x16_bf16 v[16:31], v[136:139], v[96:99], v[16:31]
    v_permlane16_swap_b32 v88, v92
    v_permlane16_swap_b32 v89, v93
    ds_read_b64_tr_b16 v[160:161], v188 offset:14848
    ds_read_b64_tr_b16 v[162:163], v188 offset:16896
    v_mfma_f32_32x32x16_bf16 v[32:47], v[140:143], v[96:99], v[32:47]
    v_permlane16_swap_b32 v90, v94
    v_permlane16_swap_b32 v91, v95
    ds_read_b64_tr_b16 v[164:165], v188 offset:15104
    ds_read_b64_tr_b16 v[166:167], v188 offset:17152
    s_waitcnt lgkmcnt(9)
    v_mfma_f32_32x32x16_bf16 v[48:63], v[144:147], v[96:99], v[48:63]
    v_mfma_f32_16x16x32_bf16 v[80:83], v[168:171], v[88:91], 0
    v_mfma_f32_16x16x32_bf16 v[84:87], v[168:171], v[92:95], 0
    ds_read_b64_tr_b16 v[136:137], v188 offset:18944
    ds_read_b64_tr_b16 v[138:139], v188 offset:20992
    v_mfma_f32_32x32x16_bf16 v[64:79], v[148:151], v[96:99], v[64:79]
    ds_read_b64_tr_b16 v[168:169], v190 offset:18432
    ds_read_b64_tr_b16 v[170:171], v190 offset:18688
    s_add_u32 s50, s44, 4096
    ds_read_b64_tr_b16 v[140:141], v188 offset:19200
    ds_read_b64_tr_b16 v[142:143], v188 offset:21248
    s_waitcnt lgkmcnt(10)
    s_waitcnt vmcnt(13)
    v_mfma_f32_32x32x16_bf16 v[16:31], v[152:155], v[100:103], v[16:31]
    buffer_load_dwordx4 v[88:91], v194, s[28:31], s50 offen offset:0 sc1
    buffer_load_dwordx4 v[92:95], v194, s[28:31], s50 offen offset:1024 sc1
    ds_read_b64_tr_b16 v[144:145], v188 offset:19456
    ds_read_b64_tr_b16 v[146:147], v188 offset:21504
    v_mfma_f32_32x32x16_bf16 v[32:47], v[156:159], v[100:103], v[32:47]
    ds_read_b64_tr_b16 v[148:149], v188 offset:19712
    ds_read_b64_tr_b16 v[150:151], v188 offset:21760
    s_waitcnt lgkmcnt(10)
    v_mfma_f32_32x32x16_bf16 v[48:63], v[160:163], v[100:103], v[48:63]
    ds_add_u32 v202, v203 offset:0
    ds_read_b64_tr_b16 v[152:153], v188 offset:23552
    ds_read_b64_tr_b16 v[154:155], v188 offset:25600
    v_mfma_f32_32x32x16_bf16 v[64:79], v[164:167], v[100:103], v[64:79]
    ds_read_b32 v197, v198
    v_mov_b32 v181, v196
    s_cmp_lg_u32 s33, 0
    s_cbranch_scc1 nd_20
    v_readfirstlane_b32 s42, v196
    s_nop 3
    s_cmp_ge_u32 s42, 8
    s_cbranch_scc1 lr_22
    s_mov_b32 s15, 0x80000
lw_21:
    s_sub_u32 s15, s15, 1
    s_cbranch_scc1 lr_22
    ds_read_b32 v196, v198 offset:8
    s_waitcnt lgkmcnt(0)
    v_readfirstlane_b32 s42, v196
    s_nop 3
    s_cmp_ge_u32 s42, 8
    s_cbranch_scc0 lw_21
lr_22:
    s_mov_b64 exec, 1
    v_mov_b32 v181, 7
    buffer_store_dword v181, off, s[28:31], s14 sc1
    s_mov_b64 exec, -1
nd_20:
    ds_read_b64_tr_b16 v[156:157], v188 offset:23808
    ds_read_b64_tr_b16 v[158:159], v188 offset:25856
    s_waitcnt lgkmcnt(10)
    s_waitcnt vmcnt(14)
    v_mfma_f32_32x32x16_bf16 v[16:31], v[136:139], v[104:107], v[16:31]
    v_permlane16_swap_b32 v96, v100
    v_permlane16_swap_b32 v97, v101
    ds_read_b64_tr_b16 v[160:161], v188 offset:24064
    ds_read_b64_tr_b16 v[162:163], v188 offset:26112
    v_mfma_f32_32x32x16_bf16 v[32:47], v[140:143], v[104:107], v[32:47]
    v_permlane16_swap_b32 v98, v102
    v_permlane16_swap_b32 v99, v103
    ds_read_b64_tr_b16 v[164:165], v188 offset:24320
    ds_read_b64_tr_b16 v[166:167], v188 offset:26368
    s_waitcnt lgkmcnt(10)
    v_mfma_f32_32x32x16_bf16 v[48:63], v[144:147], v[104:107], v[48:63]
    v_mfma_f32_16x16x32_bf16 v[80:83], v[172:175], v[96:99], v[80:83]
    v_mfma_f32_16x16x32_bf16 v[84:87], v[172:175], v[100:103], v[84:87]
    ds_read_b64_tr_b16 v[136:137], v188 offset:28160
    ds_read_b64_tr_b16 v[138:139], v188 offset:30208
    v_mfma_f32_32x32x16_bf16 v[64:79], v[148:151], v[104:107], v[64:79]
    s_waitcnt lgkmcnt(8)
    v_readfirstlane_b32 s42, v197
    s_nop 3
    s_cmp_ge_u32 s42, 8
    s_cbranch_scc1 lr_24
    s_mov_b32 s15, 0x80000
lw_23:
    s_sub_u32 s15, s15, 1
    s_cbranch_scc1 lr_24
    ds_read_b32 v197, v198
    s_waitcnt lgkmcnt(0)
    v_readfirstlane_b32 s42, v197
    s_nop 3
    s_cmp_ge_u32 s42, 8
    s_cbranch_scc0 lw_23
lr_24:
    ds_read_b64_tr_b16 v[140:141], v188 offset:28416
    ds_read_b64_tr_b16 v[142:143], v188 offset:30464
    s_waitcnt lgkmcnt(8)
    s_waitcnt vmcnt(13)
    v_mfma_f32_32x32x16_bf16 v[16:31], v[152:155], v[108:111], v[16:31]
    ds_read_b64_tr_b16 v[172:173], v190 offset:27648
    ds_read_b64_tr_b16 v[174:175], v190 offset:27904
    ds_read_b64_tr_b16 v[144:145], v188 offset:28672
    ds_read_b64_tr_b16 v[146:147], v188 offset:30720
    v_mfma_f32_32x32x16_bf16 v[32:47], v[156:159], v[108:111], v[32:47]
    buffer_load_dwordx4 v[96:99], v194, s[28:31], s50 offen offset:2048 sc1
    buffer_load_dwordx4 v[100:103], v194, s[28:31], s50 offen offset:3072 sc1
    s_add_u32 m0, s9, 81920
    ds_read_b64_tr_b16 v[148:149], v188 offset:28928
    ds_read_b64_tr_b16 v[150:151], v188 offset:30976
    s_waitcnt lgkmcnt(10)
    v_mfma_f32_32x32x16_bf16 v[48:63], v[160:163], v[108:111], v[48:63]
    s_add_u32 s10, s8, 516096
    buffer_load_dwordx4 v254, s[16:19], s10 offen offset:512 lds
    ds_read_b64_tr_b16 v[152:153], v188 offset:32768
    ds_read_b64_tr_b16 v[154:155], v188 offset:34816
    v_mfma_f32_32x32x16_bf16 v[64:79], v[164:167], v[108:111], v[64:79]
    buffer_load_dwordx4 v12, s[16:19], s10 offen offset:1536 lds
    buffer_load_dwordx4 v13, s[16:19], s10 offen offset:2560 lds
    buffer_load_dwordx4 v14, s[16:19], s10 offen offset:3584 lds
    ds_read_b64_tr_b16 v[156:157], v188 offset:33024
    ds_read_b64_tr_b16 v[158:159], v188 offset:35072
    s_waitcnt lgkmcnt(10)
    s_waitcnt vmcnt(18)
    v_mfma_f32_32x32x16_bf16 v[16:31], v[136:139], v[112:115], v[16:31]
    v_permlane16_swap_b32 v104, v108
    v_permlane16_swap_b32 v105, v109
    ds_read_b64_tr_b16 v[160:161], v188 offset:33280
    ds_read_b64_tr_b16 v[162:163], v188 offset:35328
    v_mfma_f32_32x32x16_bf16 v[32:47], v[140:143], v[112:115], v[32:47]
    v_permlane16_swap_b32 v106, v110
    v_permlane16_swap_b32 v107, v111
    s_mov_b32 exec_hi, 0
    buffer_load_dwordx4 v253, s[16:19], s10 offen lds
    s_mov_b32 exec_hi, -1
    ds_read_b64_tr_b16 v[164:165], v188 offset:33536
    ds_read_b64_tr_b16 v[166:167], v188 offset:35584
    s_waitcnt lgkmcnt(8)
    v_mfma_f32_32x32x16_bf16 v[48:63], v[144:147], v[112:115], v[48:63]
    v_mfma_f32_16x16x32_bf16 v[80:83], v[168:171], v[104:107], v[80:83]
    v_mfma_f32_16x16x32_bf16 v[84:87], v[168:171], v[108:111], v[84:87]
    ds_read_b64_tr_b16 v[136:137], v189 offset:512
    ds_read_b64_tr_b16 v[138:139], v189 offset:2560
    v_mfma_f32_32x32x16_bf16 v[64:79], v[148:151], v[112:115], v[64:79]
    ds_read_b64_tr_b16 v[168:169], v191 offset:0
    ds_read_b64_tr_b16 v[170:171], v191 offset:256
    s_add_u32 s50, s44, 28672
    ds_read_b64_tr_b16 v[140:141], v189 offset:768
    ds_read_b64_tr_b16 v[142:143], v189 offset:2816
    s_waitcnt lgkmcnt(10)
    s_waitcnt vmcnt(18)
    v_mfma_f32_32x32x16_bf16 v[16:31], v[152:155], v[116:119], v[16:31]
    buffer_load_dwordx4 v[104:107], v194, s[28:31], s50 offen offset:0 sc1
    buffer_load_dwordx4 v[108:111], v194, s[28:31], s50 offen offset:1024 sc1
    ds_read_b64_tr_b16 v[144:145], v189 offset:1024
    ds_read_b64_tr_b16 v[146:147], v189 offset:3072
    v_mfma_f32_32x32x16_bf16 v[32:47], v[156:159], v[116:119], v[32:47]
    ds_read_b64_tr_b16 v[148:149], v189 offset:1280
    ds_read_b64_tr_b16 v[150:151], v189 offset:3328
    s_waitcnt lgkmcnt(10)
    v_mfma_f32_32x32x16_bf16 v[48:63], v[160:163], v[116:119], v[48:63]
    s_waitcnt vmcnt(11)
    ds_add_u32 v202, v203 offset:0
    ds_read_b64_tr_b16 v[152:153], v189 offset:5120
    ds_read_b64_tr_b16 v[154:155], v189 offset:7168
    v_mfma_f32_32x32x16_bf16 v[64:79], v[164:167], v[116:119], v[64:79]
    ds_read_b32 v197, v198
    ds_read_b64_tr_b16 v[156:157], v189 offset:5376
    ds_read_b64_tr_b16 v[158:159], v189 offset:7424
    s_waitcnt lgkmcnt(10)
    v_mfma_f32_32x32x16_bf16 v[16:31], v[136:139], v[120:123], v[16:31]
    v_permlane16_swap_b32 v112, v116
    v_permlane16_swap_b32 v113, v117
    ds_read_b64_tr_b16 v[160:161], v189 offset:5632
    ds_read_b64_tr_b16 v[162:163], v189 offset:7680
    v_mfma_f32_32x32x16_bf16 v[32:47], v[140:143], v[120:123], v[32:47]
    v_permlane16_swap_b32 v114, v118
    v_permlane16_swap_b32 v115, v119
    ds_read_b64_tr_b16 v[164:165], v189 offset:5888
    ds_read_b64_tr_b16 v[166:167], v189 offset:7936
    s_waitcnt lgkmcnt(10)
    v_mfma_f32_32x32x16_bf16 v[48:63], v[144:147], v[120:123], v[48:63]
    v_mfma_f32_16x16x32_bf16 v[80:83], v[172:175], v[112:115], v[80:83]
    v_mfma_f32_16x16x32_bf16 v[84:87], v[172:175], v[116:119], v[84:87]
    ds_read_b64_tr_b16 v[136:137], v189 offset:9728
    ds_read_b64_tr_b16 v[138:139], v189 offset:11776
    v_mfma_f32_32x32x16_bf16 v[64:79], v[148:151], v[120:123], v[64:79]
    s_waitcnt lgkmcnt(8)
    v_readfirstlane_b32 s42, v197
    s_nop 3
    s_cmp_ge_u32 s42, 12
    s_cbranch_scc1 lr_26
    s_mov_b32 s15, 0x80000
lw_25:
    s_sub_u32 s15, s15, 1
    s_cbranch_scc1 lr_26
    ds_read_b32 v197, v198
    s_waitcnt lgkmcnt(0)
    v_readfirstlane_b32 s42, v197
    s_nop 3
    s_cmp_ge_u32 s42, 12
    s_cbranch_scc0 lw_25
lr_26:
    ds_read_b64_tr_b16 v[140:141], v189 offset:9984
    ds_read_b64_tr_b16 v[142:143], v189 offset:12032
    s_waitcnt lgkmcnt(8)
    v_mfma_f32_32x32x16_bf16 v[16:31], v[152:155], v[124:127], v[16:31]
    ds_read_b64_tr_b16 v[172:173], v191 offset:9216
    ds_read_b64_tr_b16 v[174:175], v191 offset:9472
    ds_read_b64_tr_b16 v[144:145], v189 offset:10240
    ds_read_b64_tr_b16 v[146:147], v189 offset:12288
    v_mfma_f32_32x32x16_bf16 v[32:47], v[156:159], v[124:127], v[32:47]
    buffer_load_dwordx4 v[112:115], v194, s[28:31], s50 offen offset:2048 sc1
    buffer_load_dwordx4 v[116:119], v194, s[28:31], s50 offen offset:3072 sc1
    s_add_u32 m0, s9, 100352
    ds_read_b64_tr_b16 v[148:149], v189 offset:10496
    ds_read_b64_tr_b16 v[150:151], v189 offset:12544
    s_waitcnt lgkmcnt(10)
    v_mfma_f32_32x32x16_bf16 v[48:63], v[160:163], v[124:127], v[48:63]
    s_add_u32 s10, s8, 958464
    buffer_load_dwordx4 v254, s[16:19], s10 offen offset:512 lds
    ds_read_b64_tr_b16 v[152:153], v189 offset:14336
    ds_read_b64_tr_b16 v[154:155], v189 offset:16384
    v_mfma_f32_32x32x16_bf16 v[64:79], v[164:167], v[124:127], v[64:79]
    buffer_load_dwordx4 v12, s[16:19], s10 offen offset:1536 lds
    buffer_load_dwordx4 v13, s[16:19], s10 offen offset:2560 lds
    buffer_load_dwordx4 v14, s[16:19], s10 offen offset:3584 lds
    ds_read_b64_tr_b16 v[156:157], v189 offset:14592
    ds_read_b64_tr_b16 v[158:159], v189 offset:16640
    s_waitcnt lgkmcnt(10)
    v_mfma_f32_32x32x16_bf16 v[16:31], v[136:139], v[128:131], v[16:31]
    v_permlane16_swap_b32 v120, v124
    v_permlane16_swap_b32 v121, v125
    ds_read_b64_tr_b16 v[160:161], v189 offset:14848
    ds_read_b64_tr_b16 v[162:163], v189 offset:16896
    v_mfma_f32_32x32x16_bf16 v[32:47], v[140:143], v[128:131], v[32:47]
    v_permlane16_swap_b32 v122, v126
    v_permlane16_swap_b32 v123, v127
    s_mov_b32 exec_hi, 0
    buffer_load_dwordx4 v253, s[16:19], s10 offen lds
    s_mov_b32 exec_hi, -1
    ds_read_b64_tr_b16 v[164:165], v189 offset:15104
    ds_read_b64_tr_b16 v[166:167], v189 offset:17152
    s_waitcnt lgkmcnt(8)
    v_mfma_f32_32x32x16_bf16 v[48:63], v[144:147], v[128:131], v[48:63]
    v_mfma_f32_16x16x32_bf16 v[80:83], v[168:171], v[120:123], v[80:83]
    v_mfma_f32_16x16x32_bf16 v[84:87], v[168:171], v[124:127], v[84:87]
    ds_read_b64_tr_b16 v[136:137], v189 offset:18944
    ds_read_b64_tr_b16 v[138:139], v189 offset:20992
    v_mfma_f32_32x32x16_bf16 v[64:79], v[148:151], v[128:131], v[64:79]
    ds_read_b64_tr_b16 v[168:169], v191 offset:18432
    ds_read_b64_tr_b16 v[170:171], v191 offset:18688
    s_add_u32 s50, s44, 53248
    ds_read_b64_tr_b16 v[140:141], v189 offset:19200
    ds_read_b64_tr_b16 v[142:143], v189 offset:21248
    s_waitcnt lgkmcnt(10)
    v_mfma_f32_32x32x16_bf16 v[16:31], v[152:155], v[132:135], v[16:31]
    buffer_load_dwordx4 v[120:123], v194, s[28:31], s50 offen offset:0 sc1
    buffer_load_dwordx4 v[124:127], v194, s[28:31], s50 offen offset:1024 sc1
    ds_read_b64_tr_b16 v[144:145], v189 offset:19456
    ds_read_b64_tr_b16 v[146:147], v189 offset:21504
    v_mfma_f32_32x32x16_bf16 v[32:47], v[156:159], v[132:135], v[32:47]
    ds_read_b64_tr_b16 v[148:149], v189 offset:19712
    ds_read_b64_tr_b16 v[150:151], v189 offset:21760
    s_waitcnt lgkmcnt(10)
    v_mfma_f32_32x32x16_bf16 v[48:63], v[160:163], v[132:135], v[48:63]
    s_waitcnt vmcnt(11)
    ds_add_u32 v202, v203 offset:0
    ds_read_b64_tr_b16 v[152:153], v189 offset:23552
    ds_read_b64_tr_b16 v[154:155], v189 offset:25600
    v_mfma_f32_32x32x16_bf16 v[64:79], v[164:167], v[132:135], v[64:79]
    ds_read_b32 v197, v198
    ds_read_b64_tr_b16 v[156:157], v189 offset:23808
    ds_read_b64_tr_b16 v[158:159], v189 offset:25856
    s_waitcnt lgkmcnt(10)
    v_mfma_f32_32x32x16_bf16 v[16:31], v[136:139], v[88:91], v[16:31]
    v_permlane16_swap_b32 v128, v132
    v_permlane16_swap_b32 v129, v133
    ds_read_b64_tr_b16 v[160:161], v189 offset:24064
    ds_read_b64_tr_b16 v[162:163], v189 offset:26112
    v_mfma_f32_32x32x16_bf16 v[32:47], v[140:143], v[88:91], v[32:47]
    v_permlane16_swap_b32 v130, v134
    v_permlane16_swap_b32 v131, v135
    ds_read_b64_tr_b16 v[164:165], v189 offset:24320
    ds_read_b64_tr_b16 v[166:167], v189 offset:26368
    s_waitcnt lgkmcnt(10)
    v_mfma_f32_32x32x16_bf16 v[48:63], v[144:147], v[88:91], v[48:63]
    v_mfma_f32_16x16x32_bf16 v[80:83], v[172:175], v[128:131], v[80:83]
    v_mfma_f32_16x16x32_bf16 v[84:87], v[172:175], v[132:135], v[84:87]
    ds_read_b64_tr_b16 v[136:137], v189 offset:28160
    ds_read_b64_tr_b16 v[138:139], v189 offset:30208
    v_mfma_f32_32x32x16_bf16 v[64:79], v[148:151], v[88:91], v[64:79]
    s_waitcnt lgkmcnt(8)
    v_readfirstlane_b32 s42, v197
    s_nop 3
    s_cmp_ge_u32 s42, 16
    s_cbranch_scc1 lr_28
    s_mov_b32 s15, 0x80000
lw_27:
    s_sub_u32 s15, s15, 1
    s_cbranch_scc1 lr_28
    ds_read_b32 v197, v198
    s_waitcnt lgkmcnt(0)
    v_readfirstlane_b32 s42, v197
    s_nop 3
    s_cmp_ge_u32 s42, 16
    s_cbranch_scc0 lw_27
lr_28:
    ds_read_b64_tr_b16 v[140:141], v189 offset:28416
    ds_read_b64_tr_b16 v[142:143], v189 offset:30464
    s_waitcnt lgkmcnt(8)
    v_mfma_f32_32x32x16_bf16 v[16:31], v[152:155], v[92:95], v[16:31]
    ds_read_b64_tr_b16 v[172:173], v191 offset:27648
    ds_read_b64_tr_b16 v[174:175], v191 offset:27904
    ds_read_b64_tr_b16 v[144:145], v189 offset:28672
    ds_read_b64_tr_b16 v[146:147], v189 offset:30720
    v_mfma_f32_32x32x16_bf16 v[32:47], v[156:159], v[92:95], v[32:47]
    buffer_load_dwordx4 v[128:131], v194, s[28:31], s50 offen offset:2048 sc1
    buffer_load_dwordx4 v[132:135], v194, s[28:31], s50 offen offset:3072 sc1
    s_add_u32 m0, s9, 118784
    ds_read_b64_tr_b16 v[148:149], v189 offset:28928
    ds_read_b64_tr_b16 v[150:151], v189 offset:30976
    s_waitcnt lgkmcnt(10)
    v_mfma_f32_32x32x16_bf16 v[48:63], v[160:163], v[92:95], v[48:63]
    s_add_u32 s10, s8, 147456
    buffer_load_dwordx4 v254, s[16:19], s10 offen offset:512 lds
    ds_read_b64_tr_b16 v[152:153], v189 offset:32768
    ds_read_b64_tr_b16 v[154:155], v189 offset:34816
    v_mfma_f32_32x32x16_bf16 v[64:79], v[164:167], v[92:95], v[64:79]
    buffer_load_dwordx4 v12, s[16:19], s10 offen offset:1536 lds
    buffer_load_dwordx4 v13, s[16:19], s10 offen offset:2560 lds
    buffer_load_dwordx4 v14, s[16:19], s10 offen offset:3584 lds
    ds_read_b64_tr_b16 v[156:157], v189 offset:33024
    ds_read_b64_tr_b16 v[158:159], v189 offset:35072
    s_waitcnt lgkmcnt(10)
    v_mfma_f32_32x32x16_bf16 v[16:31], v[136:139], v[96:99], v[16:31]
    v_permlane16_swap_b32 v88, v92
    v_permlane16_swap_b32 v89, v93
    ds_read_b64_tr_b16 v[160:161], v189 offset:33280
    ds_read_b64_tr_b16 v[162:163], v189 offset:35328
    v_mfma_f32_32x32x16_bf16 v[32:47], v[140:143], v[96:99], v[32:47]
    v_permlane16_swap_b32 v90, v94
    v_permlane16_swap_b32 v91, v95
    s_mov_b32 exec_hi, 0
    buffer_load_dwordx4 v253, s[16:19], s10 offen lds
    s_mov_b32 exec_hi, -1
    ds_read_b64_tr_b16 v[164:165], v189 offset:33536
    ds_read_b64_tr_b16 v[166:167], v189 offset:35584
    s_waitcnt lgkmcnt(8)
    v_mfma_f32_32x32x16_bf16 v[48:63], v[144:147], v[96:99], v[48:63]
    v_mfma_f32_16x16x32_bf16 v[80:83], v[168:171], v[88:91], v[80:83]
    v_mfma_f32_16x16x32_bf16 v[84:87], v[168:171], v[92:95], v[84:87]
    ds_read_b64_tr_b16 v[136:137], v188 offset:512
    ds_read_b64_tr_b16 v[138:139], v188 offset:2560
    v_mfma_f32_32x32x16_bf16 v[64:79], v[148:151], v[96:99], v[64:79]
    ds_read_b64_tr_b16 v[168:169], v190 offset:0
    ds_read_b64_tr_b16 v[170:171], v190 offset:256
    s_add_u32 s50, s44, 8192
    ds_read_b64_tr_b16 v[140:141], v188 offset:768
    ds_read_b64_tr_b16 v[142:143], v188 offset:2816
    s_waitcnt lgkmcnt(10)
    v_mfma_f32_32x32x16_bf16 v[16:31], v[152:155], v[100:103], v[16:31]
    buffer_load_dwordx4 v[88:91], v194, s[28:31], s50 offen offset:0 sc1
    buffer_load_dwordx4 v[92:95], v194, s[28:31], s50 offen offset:1024 sc1
    ds_read_b64_tr_b16 v[144:145], v188 offset:1024
    ds_read_b64_tr_b16 v[146:147], v188 offset:3072
    v_mfma_f32_32x32x16_bf16 v[32:47], v[156:159], v[100:103], v[32:47]
    ds_read_b64_tr_b16 v[148:149], v188 offset:1280
    ds_read_b64_tr_b16 v[150:151], v188 offset:3328
    s_waitcnt lgkmcnt(10)
    v_mfma_f32_32x32x16_bf16 v[48:63], v[160:163], v[100:103], v[48:63]
    s_waitcnt vmcnt(11)
    ds_add_u32 v202, v203 offset:0
    ds_read_b64_tr_b16 v[152:153], v188 offset:5120
    ds_read_b64_tr_b16 v[154:155], v188 offset:7168
    v_mfma_f32_32x32x16_bf16 v[64:79], v[164:167], v[100:103], v[64:79]
    ds_read_b32 v197, v198
    ds_read_b64_tr_b16 v[156:157], v188 offset:5376
    ds_read_b64_tr_b16 v[158:159], v188 offset:7424
    s_waitcnt lgkmcnt(10)
    v_mfma_f32_32x32x16_bf16 v[16:31], v[136:139], v[104:107], v[16:31]
    v_permlane16_swap_b32 v96, v100
    v_permlane16_swap_b32 v97, v101
    ds_read_b64_tr_b16 v[160:161], v188 offset:5632
    ds_read_b64_tr_b16 v[162:163], v188 offset:7680
    v_mfma_f32_32x32x16_bf16 v[32:47], v[140:143], v[104:107], v[32:47]
    v_permlane16_swap_b32 v98, v102
    v_permlane16_swap_b32 v99, v103
    buffer_load_dwordx4 v[184:187], off, s[28:31], s45 sc1
    ds_read_b64_tr_b16 v[164:165], v188 offset:5888
    ds_read_b64_tr_b16 v[166:167], v188 offset:7936
    s_waitcnt lgkmcnt(10)
    v_mfma_f32_32x32x16_bf16 v[48:63], v[144:147], v[104:107], v[48:63]
    v_mfma_f32_16x16x32_bf16 v[80:83], v[172:175], v[96:99], v[80:83]
    v_mfma_f32_16x16x32_bf16 v[84:87], v[172:175], v[100:103], v[84:87]
    ds_read_b64_tr_b16 v[136:137], v188 offset:9728
    ds_read_b64_tr_b16 v[138:139], v188 offset:11776
    v_mfma_f32_32x32x16_bf16 v[64:79], v[148:151], v[104:107], v[64:79]
    s_waitcnt lgkmcnt(8)
    v_readfirstlane_b32 s42, v197
    s_nop 3
    s_cmp_ge_u32 s42, 20
    s_cbranch_scc1 lr_30
    s_mov_b32 s15, 0x80000
lw_29:
    s_sub_u32 s15, s15, 1
    s_cbranch_scc1 lr_30
    ds_read_b32 v197, v198
    s_waitcnt lgkmcnt(0)
    v_readfirstlane_b32 s42, v197
    s_nop 3
    s_cmp_ge_u32 s42, 20
    s_cbranch_scc0 lw_29
lr_30:
    ds_read_b64_tr_b16 v[140:141], v188 offset:9984
    ds_read_b64_tr_b16 v[142:143], v188 offset:12032
    s_waitcnt lgkmcnt(8)
    v_mfma_f32_32x32x16_bf16 v[16:31], v[152:155], v[108:111], v[16:31]
    ds_read_b64_tr_b16 v[172:173], v190 offset:9216
    ds_read_b64_tr_b16 v[174:175], v190 offset:9472
    ds_read_b64_tr_b16 v[144:145], v188 offset:10240
    ds_read_b64_tr_b16 v[146:147], v188 offset:12288
    v_mfma_f32_32x32x16_bf16 v[32:47], v[156:159], v[108:111], v[32:47]
    buffer_load_dwordx4 v[96:99], v194, s[28:31], s50 offen offset:2048 sc1
    buffer_load_dwordx4 v[100:103], v194, s[28:31], s50 offen offset:3072 sc1
    s_add_u32 m0, s9, 137216
    ds_read_b64_tr_b16 v[148:149], v188 offset:10496
    ds_read_b64_tr_b16 v[150:151], v188 offset:12544
    s_waitcnt lgkmcnt(10)
    v_mfma_f32_32x32x16_bf16 v[48:63], v[160:163], v[108:111], v[48:63]
    s_add_u32 s10, s8, 589824
    buffer_load_dwordx4 v254, s[16:19], s10 offen offset:512 lds
    ds_read_b64_tr_b16 v[152:153], v188 offset:14336
    ds_read_b64_tr_b16 v[154:155], v188 offset:16384
    v_mfma_f32_32x32x16_bf16 v[64:79], v[164:167], v[108:111], v[64:79]
    buffer_load_dwordx4 v12, s[16:19], s10 offen offset:1536 lds
    buffer_load_dwordx4 v13, s[16:19], s10 offen offset:2560 lds
    buffer_load_dwordx4 v14, s[16:19], s10 offen offset:3584 lds
    ds_read_b64_tr_b16 v[156:157], v188 offset:14592
    ds_read_b64_tr_b16 v[158:159], v188 offset:16640
    s_waitcnt lgkmcnt(10)
    v_mfma_f32_32x32x16_bf16 v[16:31], v[136:139], v[112:115], v[16:31]
    v_permlane16_swap_b32 v104, v108
    v_permlane16_swap_b32 v105, v109
    ds_read_b64_tr_b16 v[160:161], v188 offset:14848
    ds_read_b64_tr_b16 v[162:163], v188 offset:16896
    v_mfma_f32_32x32x16_bf16 v[32:47], v[140:143], v[112:115], v[32:47]
    v_permlane16_swap_b32 v106, v110
    v_permlane16_swap_b32 v107, v111
    s_mov_b32 exec_hi, 0
    buffer_load_dwordx4 v253, s[16:19], s10 offen lds
    s_mov_b32 exec_hi, -1
    ds_read_b64_tr_b16 v[164:165], v188 offset:15104
    ds_read_b64_tr_b16 v[166:167], v188 offset:17152
    s_waitcnt lgkmcnt(8)
    v_mfma_f32_32x32x16_bf16 v[48:63], v[144:147], v[112:115], v[48:63]
    v_mfma_f32_16x16x32_bf16 v[80:83], v[168:171], v[104:107], v[80:83]
    v_mfma_f32_16x16x32_bf16 v[84:87], v[168:171], v[108:111], v[84:87]
    ds_read_b64_tr_b16 v[136:137], v188 offset:18944
    ds_read_b64_tr_b16 v[138:139], v188 offset:20992
    v_mfma_f32_32x32x16_bf16 v[64:79], v[148:151], v[112:115], v[64:79]
    ds_read_b64_tr_b16 v[168:169], v190 offset:18432
    ds_read_b64_tr_b16 v[170:171], v190 offset:18688
    s_add_u32 s50, s44, 32768
    ds_read_b64_tr_b16 v[140:141], v188 offset:19200
    ds_read_b64_tr_b16 v[142:143], v188 offset:21248
    s_waitcnt lgkmcnt(10)
    v_mfma_f32_32x32x16_bf16 v[16:31], v[152:155], v[116:119], v[16:31]
    buffer_load_dwordx4 v[104:107], v194, s[28:31], s50 offen offset:0 sc1
    buffer_load_dwordx4 v[108:111], v194, s[28:31], s50 offen offset:1024 sc1
    ds_read_b64_tr_b16 v[144:145], v188 offset:19456
    ds_read_b64_tr_b16 v[146:147], v188 offset:21504
    v_mfma_f32_32x32x16_bf16 v[32:47], v[156:159], v[116:119], v[32:47]
    ds_read_b64_tr_b16 v[148:149], v188 offset:19712
    ds_read_b64_tr_b16 v[150:151], v188 offset:21760
    s_waitcnt lgkmcnt(10)
    v_mfma_f32_32x32x16_bf16 v[48:63], v[160:163], v[116:119], v[48:63]
    s_waitcnt vmcnt(12)
    ds_add_u32 v202, v203 offset:0
    ds_read_b64_tr_b16 v[152:153], v188 offset:23552
    ds_read_b64_tr_b16 v[154:155], v188 offset:25600
    v_mfma_f32_32x32x16_bf16 v[64:79], v[164:167], v[116:119], v[64:79]
    ds_read_b32 v197, v198
    ds_read_b64_tr_b16 v[156:157], v188 offset:23808
    ds_read_b64_tr_b16 v[158:159], v188 offset:25856
    s_waitcnt lgkmcnt(10)
    v_mfma_f32_32x32x16_bf16 v[16:31], v[136:139], v[120:123], v[16:31]
    v_permlane16_swap_b32 v112, v116
    v_permlane16_swap_b32 v113, v117
    ds_read_b64_tr_b16 v[160:161], v188 offset:24064
    ds_read_b64_tr_b16 v[162:163], v188 offset:26112
    v_mfma_f32_32x32x16_bf16 v[32:47], v[140:143], v[120:123], v[32:47]
    v_permlane16_swap_b32 v114, v118
    v_permlane16_swap_b32 v115, v119
    ds_read_b64_tr_b16 v[164:165], v188 offset:24320
    ds_read_b64_tr_b16 v[166:167], v188 offset:26368
    s_waitcnt lgkmcnt(10)
    v_mfma_f32_32x32x16_bf16 v[48:63], v[144:147], v[120:123], v[48:63]
    v_mfma_f32_16x16x32_bf16 v[80:83], v[172:175], v[112:115], v[80:83]
    v_mfma_f32_16x16x32_bf16 v[84:87], v[172:175], v[116:119], v[84:87]
    ds_read_b64_tr_b16 v[136:137], v188 offset:28160
    ds_read_b64_tr_b16 v[138:139], v188 offset:30208
    v_mfma_f32_32x32x16_bf16 v[64:79], v[148:151], v[120:123], v[64:79]
    s_waitcnt lgkmcnt(8)
    v_readfirstlane_b32 s42, v197
    s_nop 3
    s_cmp_ge_u32 s42, 24
    s_cbranch_scc1 lr_32
    s_mov_b32 s15, 0x80000
lw_31:
    s_sub_u32 s15, s15, 1
    s_cbranch_scc1 lr_32
    ds_read_b32 v197, v198
    s_waitcnt lgkmcnt(0)
    v_readfirstlane_b32 s42, v197
    s_nop 3
    s_cmp_ge_u32 s42, 24
    s_cbranch_scc0 lw_31
lr_32:
    ds_read_b64_tr_b16 v[140:141], v188 offset:28416
    ds_read_b64_tr_b16 v[142:143], v188 offset:30464
    s_waitcnt lgkmcnt(8)
    v_mfma_f32_32x32x16_bf16 v[16:31], v[152:155], v[124:127], v[16:31]
    ds_read_b64_tr_b16 v[172:173], v190 offset:27648
    ds_read_b64_tr_b16 v[174:175], v190 offset:27904
    ds_read_b64_tr_b16 v[144:145], v188 offset:28672
    ds_read_b64_tr_b16 v[146:147], v188 offset:30720
    v_mfma_f32_32x32x16_bf16 v[32:47], v[156:159], v[124:127], v[32:47]
    buffer_load_dwordx4 v[112:115], v194, s[28:31], s50 offen offset:2048 sc1
    buffer_load_dwordx4 v[116:119], v194, s[28:31], s50 offen offset:3072 sc1
    s_add_u32 m0, s9, 81920
    ds_read_b64_tr_b16 v[148:149], v188 offset:28928
    ds_read_b64_tr_b16 v[150:151], v188 offset:30976
    s_waitcnt lgkmcnt(10)
    v_mfma_f32_32x32x16_bf16 v[48:63], v[160:163], v[124:127], v[48:63]
    s_add_u32 s10, s8, 1032192
    buffer_load_dwordx4 v254, s[16:19], s10 offen offset:512 lds
    ds_read_b64_tr_b16 v[152:153], v188 offset:32768
    ds_read_b64_tr_b16 v[154:155], v188 offset:34816
    v_mfma_f32_32x32x16_bf16 v[64:79], v[164:167], v[124:127], v[64:79]
    buffer_load_dwordx4 v12, s[16:19], s10 offen offset:1536 lds
    buffer_load_dwordx4 v13, s[16:19], s10 offen offset:2560 lds
    buffer_load_dwordx4 v14, s[16:19], s10 offen offset:3584 lds
    ds_read_b64_tr_b16 v[156:157], v188 offset:33024
    ds_read_b64_tr_b16 v[158:159], v188 offset:35072
    s_waitcnt lgkmcnt(10)
    v_mfma_f32_32x32x16_bf16 v[16:31], v[136:139], v[128:131], v[16:31]
    v_permlane16_swap_b32 v120, v124
    v_permlane16_swap_b32 v121, v125
    ds_read_b64_tr_b16 v[160:161], v188 offset:33280
    ds_read_b64_tr_b16 v[162:163], v188 offset:35328
    v_mfma_f32_32x32x16_bf16 v[32:47], v[140:143], v[128:131], v[32:47]
    v_permlane16_swap_b32 v122, v126
    v_permlane16_swap_b32 v123, v127
    s_mov_b32 exec_hi, 0
    buffer_load_dwordx4 v253, s[16:19], s10 offen lds
    s_mov_b32 exec_hi, -1
    ds_read_b64_tr_b16 v[164:165], v188 offset:33536
    ds_read_b64_tr_b16 v[166:167], v188 offset:35584
    s_waitcnt lgkmcnt(8)
    v_mfma_f32_32x32x16_bf16 v[48:63], v[144:147], v[128:131], v[48:63]
    v_mfma_f32_16x16x32_bf16 v[80:83], v[168:171], v[120:123], v[80:83]
    v_mfma_f32_16x16x32_bf16 v[84:87], v[168:171], v[124:127], v[84:87]
    ds_read_b64_tr_b16 v[136:137], v189 offset:512
    ds_read_b64_tr_b16 v[138:139], v189 offset:2560
    v_mfma_f32_32x32x16_bf16 v[64:79], v[148:151], v[128:131], v[64:79]
    ds_read_b64_tr_b16 v[168:169], v191 offset:0
    ds_read_b64_tr_b16 v[170:171], v191 offset:256
    s_add_u32 s50, s44, 57344
    ds_read_b64_tr_b16 v[140:141], v189 offset:768
    ds_read_b64_tr_b16 v[142:143], v189 offset:2816
    s_waitcnt lgkmcnt(10)
    v_mfma_f32_32x32x16_bf16 v[16:31], v[152:155], v[132:135], v[16:31]
    buffer_load_dwordx4 v[120:123], v194, s[28:31], s50 offen offset:0 sc1
    buffer_load_dwordx4 v[124:127], v194, s[28:31], s50 offen offset:1024 sc1
    ds_read_b64_tr_b16 v[144:145], v189 offset:1024
    ds_read_b64_tr_b16 v[146:147], v189 offset:3072
    v_mfma_f32_32x32x16_bf16 v[32:47], v[156:159], v[132:135], v[32:47]
    ds_read_b64_tr_b16 v[148:149], v189 offset:1280
    ds_read_b64_tr_b16 v[150:151], v189 offset:3328
    s_waitcnt lgkmcnt(10)
    v_mfma_f32_32x32x16_bf16 v[48:63], v[160:163], v[132:135], v[48:63]
    s_waitcnt vmcnt(11)
    ds_add_u32 v202, v203 offset:0
    ds_read_b64_tr_b16 v[152:153], v189 offset:5120
    ds_read_b64_tr_b16 v[154:155], v189 offset:7168
    v_mfma_f32_32x32x16_bf16 v[64:79], v[164:167], v[132:135], v[64:79]
    ds_read_b32 v197, v198
    ds_read_b64_tr_b16 v[156:157], v189 offset:5376
    ds_read_b64_tr_b16 v[158:159], v189 offset:7424
    s_waitcnt lgkmcnt(10)
    v_mfma_f32_32x32x16_bf16 v[16:31], v[136:139], v[88:91], v[16:31]
    v_permlane16_swap_b32 v128, v132
    v_permlane16_swap_b32 v129, v133
    ds_read_b64_tr_b16 v[160:161], v189 offset:5632
    ds_read_b64_tr_b16 v[162:163], v189 offset:7680
    v_mfma_f32_32x32x16_bf16 v[32:47], v[140:143], v[88:91], v[32:47]
    v_permlane16_swap_b32 v130, v134
    v_permlane16_swap_b32 v131, v135
    ds_read_b64_tr_b16 v[164:165], v189 offset:5888
    ds_read_b64_tr_b16 v[166:167], v189 offset:7936
    s_waitcnt lgkmcnt(10)
    v_mfma_f32_32x32x16_bf16 v[48:63], v[144:147], v[88:91], v[48:63]
    v_mfma_f32_16x16x32_bf16 v[80:83], v[172:175], v[128:131], v[80:83]
    v_mfma_f32_16x16x32_bf16 v[84:87], v[172:175], v[132:135], v[84:87]
    ds_read_b64_tr_b16 v[136:137], v189 offset:9728
    ds_read_b64_tr_b16 v[138:139], v189 offset:11776
    v_mfma_f32_32x32x16_bf16 v[64:79], v[148:151], v[88:91], v[64:79]
    s_waitcnt lgkmcnt(8)
    v_readfirstlane_b32 s42, v197
    s_nop 3
    s_cmp_ge_u32 s42, 28
    s_cbranch_scc1 lr_34
    s_mov_b32 s15, 0x80000
lw_33:
    s_sub_u32 s15, s15, 1
    s_cbranch_scc1 lr_34
    ds_read_b32 v197, v198
    s_waitcnt lgkmcnt(0)
    v_readfirstlane_b32 s42, v197
    s_nop 3
    s_cmp_ge_u32 s42, 28
    s_cbranch_scc0 lw_33
lr_34:
    ds_read_b64_tr_b16 v[140:141], v189 offset:9984
    ds_read_b64_tr_b16 v[142:143], v189 offset:12032
    s_waitcnt lgkmcnt(8)
    v_mfma_f32_32x32x16_bf16 v[16:31], v[152:155], v[92:95], v[16:31]
    ds_read_b64_tr_b16 v[172:173], v191 offset:9216
    ds_read_b64_tr_b16 v[174:175], v191 offset:9472
    ds_read_b64_tr_b16 v[144:145], v189 offset:10240
    ds_read_b64_tr_b16 v[146:147], v189 offset:12288
    v_mfma_f32_32x32x16_bf16 v[32:47], v[156:159], v[92:95], v[32:47]
    buffer_load_dwordx4 v[128:131], v194, s[28:31], s50 offen offset:2048 sc1
    buffer_load_dwordx4 v[132:135], v194, s[28:31], s50 offen offset:3072 sc1
    s_add_u32 m0, s9, 100352
    ds_read_b64_tr_b16 v[148:149], v189 offset:10496
    ds_read_b64_tr_b16 v[150:151], v189 offset:12544
    s_waitcnt lgkmcnt(10)
    v_mfma_f32_32x32x16_bf16 v[48:63], v[160:163], v[92:95], v[48:63]
    s_add_u32 s10, s8, 221184
    buffer_load_dwordx4 v254, s[16:19], s10 offen offset:512 lds
    ds_read_b64_tr_b16 v[152:153], v189 offset:14336
    ds_read_b64_tr_b16 v[154:155], v189 offset:16384
    v_mfma_f32_32x32x16_bf16 v[64:79], v[164:167], v[92:95], v[64:79]
    buffer_load_dwordx4 v12, s[16:19], s10 offen offset:1536 lds
    buffer_load_dwordx4 v13, s[16:19], s10 offen offset:2560 lds
    buffer_load_dwordx4 v14, s[16:19], s10 offen offset:3584 lds
    ds_read_b64_tr_b16 v[156:157], v189 offset:14592
    ds_read_b64_tr_b16 v[158:159], v189 offset:16640
    s_waitcnt lgkmcnt(10)
    v_mfma_f32_32x32x16_bf16 v[16:31], v[136:139], v[96:99], v[16:31]
    v_permlane16_swap_b32 v88, v92
    v_permlane16_swap_b32 v89, v93
    ds_read_b64_tr_b16 v[160:161], v189 offset:14848
    ds_read_b64_tr_b16 v[162:163], v189 offset:16896
    v_mfma_f32_32x32x16_bf16 v[32:47], v[140:143], v[96:99], v[32:47]
    v_permlane16_swap_b32 v90, v94
    v_permlane16_swap_b32 v91, v95
    s_mov_b32 exec_hi, 0
    buffer_load_dwordx4 v253, s[16:19], s10 offen lds
    s_mov_b32 exec_hi, -1
    ds_read_b64_tr_b16 v[164:165], v189 offset:15104
    ds_read_b64_tr_b16 v[166:167], v189 offset:17152
    s_waitcnt lgkmcnt(8)
    v_mfma_f32_32x32x16_bf16 v[48:63], v[144:147], v[96:99], v[48:63]
    v_mfma_f32_16x16x32_bf16 v[80:83], v[168:171], v[88:91], v[80:83]
    v_mfma_f32_16x16x32_bf16 v[84:87], v[168:171], v[92:95], v[84:87]
    ds_read_b64_tr_b16 v[136:137], v189 offset:18944
    ds_read_b64_tr_b16 v[138:139], v189 offset:20992
    v_mfma_f32_32x32x16_bf16 v[64:79], v[148:151], v[96:99], v[64:79]
    ds_read_b64_tr_b16 v[168:169], v191 offset:18432
    ds_read_b64_tr_b16 v[170:171], v191 offset:18688
    v_min3_u32 v181, v184, v185, v186
    s_nop 0
    v_readfirstlane_b32 s41, v181
    s_nop 3
    s_cmp_ge_u32 s41, 7
    s_cbranch_scc1 ready_36
    s_mov_b32 s42, 0x8000
spin_35:
    s_sub_u32 s42, s42, 1
    s_cbranch_scc1 ready_36
    s_sleep 4
    buffer_load_dwordx4 v[184:187], off, s[28:31], s45 sc1
    s_waitcnt vmcnt(0)
    v_min3_u32 v181, v184, v185, v186
    s_nop 4
    v_readfirstlane_b32 s41, v181
    s_nop 4
    s_cmp_ge_u32 s41, 7
    s_nop 4
    s_cbranch_scc0 spin_35
ready_36:
    ds_read_b64_tr_b16 v[140:141], v189 offset:19200
    ds_read_b64_tr_b16 v[142:143], v189 offset:21248
    s_waitcnt lgkmcnt(10)
    v_mfma_f32_32x32x16_bf16 v[16:31], v[152:155], v[100:103], v[16:31]
    s_add_u32 s50, s44, 12288
    buffer_load_dwordx4 v[88:91], v194, s[28:31], s50 offen offset:0 sc1
    ds_read_b64_tr_b16 v[144:145], v189 offset:19456
    ds_read_b64_tr_b16 v[146:147], v189 offset:21504
    v_mfma_f32_32x32x16_bf16 v[32:47], v[156:159], v[100:103], v[32:47]
    buffer_load_dwordx4 v[92:95], v194, s[28:31], s50 offen offset:1024 sc1
    ds_read_b64_tr_b16 v[148:149], v189 offset:19712
    ds_read_b64_tr_b16 v[150:151], v189 offset:21760
    s_waitcnt lgkmcnt(10)
    v_mfma_f32_32x32x16_bf16 v[48:63], v[160:163], v[100:103], v[48:63]
    s_waitcnt vmcnt(11)
    ds_add_u32 v202, v203 offset:0
    ds_read_b64_tr_b16 v[152:153], v189 offset:23552
    ds_read_b64_tr_b16 v[154:155], v189 offset:25600
    v_mfma_f32_32x32x16_bf16 v[64:79], v[164:167], v[100:103], v[64:79]
    ds_read_b32 v197, v198
    ds_read_b64_tr_b16 v[156:157], v189 offset:23808
    ds_read_b64_tr_b16 v[158:159], v189 offset:25856
    s_waitcnt lgkmcnt(10)
    v_mfma_f32_32x32x16_bf16 v[16:31], v[136:139], v[104:107], v[16:31]
    v_permlane16_swap_b32 v96, v100
    v_permlane16_swap_b32 v97, v101
    ds_read_b64_tr_b16 v[160:161], v189 offset:24064
    ds_read_b64_tr_b16 v[162:163], v189 offset:26112
    v_mfma_f32_32x32x16_bf16 v[32:47], v[140:143], v[104:107], v[32:47]
    v_permlane16_swap_b32 v98, v102
    v_permlane16_swap_b32 v99, v103
    ds_read_b64_tr_b16 v[164:165], v189 offset:24320
    ds_read_b64_tr_b16 v[166:167], v189 offset:26368
    s_waitcnt lgkmcnt(10)
    v_mfma_f32_32x32x16_bf16 v[48:63], v[144:147], v[104:107], v[48:63]
    v_mfma_f32_16x16x32_bf16 v[80:83], v[172:175], v[96:99], v[80:83]
    v_mfma_f32_16x16x32_bf16 v[84:87], v[172:175], v[100:103], v[84:87]
    ds_read_b64_tr_b16 v[136:137], v189 offset:28160
    ds_read_b64_tr_b16 v[138:139], v189 offset:30208
    v_mfma_f32_32x32x16_bf16 v[64:79], v[148:151], v[104:107], v[64:79]
    s_waitcnt lgkmcnt(8)
    v_readfirstlane_b32 s42, v197
    s_nop 3
    s_cmp_ge_u32 s42, 32
    s_cbranch_scc1 lr_38
    s_mov_b32 s15, 0x80000
lw_37:
    s_sub_u32 s15, s15, 1
    s_cbranch_scc1 lr_38
    ds_read_b32 v197, v198
    s_waitcnt lgkmcnt(0)
    v_readfirstlane_b32 s42, v197
    s_nop 3
    s_cmp_ge_u32 s42, 32
    s_cbranch_scc0 lw_37
lr_38:
    ds_read_b64_tr_b16 v[140:141], v189 offset:28416
    ds_read_b64_tr_b16 v[142:143], v189 offset:30464
    s_waitcnt lgkmcnt(8)
    v_mfma_f32_32x32x16_bf16 v[16:31], v[152:155], v[108:111], v[16:31]
    ds_read_b64_tr_b16 v[172:173], v191 offset:27648
    ds_read_b64_tr_b16 v[174:175], v191 offset:27904
    ds_read_b64_tr_b16 v[144:145], v189 offset:28672
    ds_read_b64_tr_b16 v[146:147], v189 offset:30720
    v_mfma_f32_32x32x16_bf16 v[32:47], v[156:159], v[108:111], v[32:47]
    buffer_load_dwordx4 v[96:99], v194, s[28:31], s50 offen offset:2048 sc1
    buffer_load_dwordx4 v[100:103], v194, s[28:31], s50 offen offset:3072 sc1
    s_add_u32 m0, s9, 118784
    ds_read_b64_tr_b16 v[148:149], v189 offset:28928
    ds_read_b64_tr_b16 v[150:151], v189 offset:30976
    s_waitcnt lgkmcnt(10)
    v_mfma_f32_32x32x16_bf16 v[48:63], v[160:163], v[108:111], v[48:63]
    s_add_u32 s10, s8, 663552
    buffer_load_dwordx4 v254, s[16:19], s10 offen offset:512 lds
    ds_read_b64_tr_b16 v[152:153], v189 offset:32768
    ds_read_b64_tr_b16 v[154:155], v189 offset:34816
    v_mfma_f32_32x32x16_bf16 v[64:79], v[164:167], v[108:111], v[64:79]
    buffer_load_dwordx4 v12, s[16:19], s10 offen offset:1536 lds
    buffer_load_dwordx4 v13, s[16:19], s10 offen offset:2560 lds
    buffer_load_dwordx4 v14, s[16:19], s10 offen offset:3584 lds
    ds_read_b64_tr_b16 v[156:157], v189 offset:33024
    ds_read_b64_tr_b16 v[158:159], v189 offset:35072
    s_waitcnt lgkmcnt(10)
    v_mfma_f32_32x32x16_bf16 v[16:31], v[136:139], v[112:115], v[16:31]
    v_permlane16_swap_b32 v104, v108
    v_permlane16_swap_b32 v105, v109
    ds_read_b64_tr_b16 v[160:161], v189 offset:33280
    ds_read_b64_tr_b16 v[162:163], v189 offset:35328
    v_mfma_f32_32x32x16_bf16 v[32:47], v[140:143], v[112:115], v[32:47]
    v_permlane16_swap_b32 v106, v110
    v_permlane16_swap_b32 v107, v111
    s_mov_b32 exec_hi, 0
    buffer_load_dwordx4 v253, s[16:19], s10 offen lds
    s_mov_b32 exec_hi, -1
    ds_read_b64_tr_b16 v[164:165], v189 offset:33536
    ds_read_b64_tr_b16 v[166:167], v189 offset:35584
    s_waitcnt lgkmcnt(8)
    v_mfma_f32_32x32x16_bf16 v[48:63], v[144:147], v[112:115], v[48:63]
    v_mfma_f32_16x16x32_bf16 v[80:83], v[168:171], v[104:107], v[80:83]
    v_mfma_f32_16x16x32_bf16 v[84:87], v[168:171], v[108:111], v[84:87]
    ds_read_b64_tr_b16 v[136:137], v188 offset:512
    ds_read_b64_tr_b16 v[138:139], v188 offset:2560
    v_mfma_f32_32x32x16_bf16 v[64:79], v[148:151], v[112:115], v[64:79]
    ds_read_b64_tr_b16 v[168:169], v190 offset:0
    ds_read_b64_tr_b16 v[170:171], v190 offset:256
    s_add_u32 s50, s44, 36864
    ds_read_b64_tr_b16 v[140:141], v188 offset:768
    ds_read_b64_tr_b16 v[142:143], v188 offset:2816
    s_waitcnt lgkmcnt(10)
    v_mfma_f32_32x32x16_bf16 v[16:31], v[152:155], v[116:119], v[16:31]
    buffer_load_dwordx4 v[104:107], v194, s[28:31], s50 offen offset:0 sc1
    buffer_load_dwordx4 v[108:111], v194, s[28:31], s50 offen offset:1024 sc1
    ds_read_b64_tr_b16 v[144:145], v188 offset:1024
    ds_read_b64_tr_b16 v[146:147], v188 offset:3072
    v_mfma_f32_32x32x16_bf16 v[32:47], v[156:159], v[116:119], v[32:47]
    ds_read_b64_tr_b16 v[148:149], v188 offset:1280
    ds_read_b64_tr_b16 v[150:151], v188 offset:3328
    s_waitcnt lgkmcnt(10)
    v_mfma_f32_32x32x16_bf16 v[48:63], v[160:163], v[116:119], v[48:63]
    s_waitcnt vmcnt(11)
    ds_add_u32 v202, v203 offset:0
    ds_read_b64_tr_b16 v[152:153], v188 offset:5120
    ds_read_b64_tr_b16 v[154:155], v188 offset:7168
    v_mfma_f32_32x32x16_bf16 v[64:79], v[164:167], v[116:119], v[64:79]
    ds_read_b32 v197, v198
    ds_read_b64_tr_b16 v[156:157], v188 offset:5376
    ds_read_b64_tr_b16 v[158:159], v188 offset:7424
    s_waitcnt lgkmcnt(10)
    v_mfma_f32_32x32x16_bf16 v[16:31], v[136:139], v[120:123], v[16:31]
    v_permlane16_swap_b32 v112, v116
    v_permlane16_swap_b32 v113, v117
    ds_read_b64_tr_b16 v[160:161], v188 offset:5632
    ds_read_b64_tr_b16 v[162:163], v188 offset:7680
    v_mfma_f32_32x32x16_bf16 v[32:47], v[140:143], v[120:123], v[32:47]
    v_permlane16_swap_b32 v114, v118
    v_permlane16_swap_b32 v115, v119
    ds_read_b64_tr_b16 v[164:165], v188 offset:5888
    ds_read_b64_tr_b16 v[166:167], v188 offset:7936
    s_waitcnt lgkmcnt(10)
    v_mfma_f32_32x32x16_bf16 v[48:63], v[144:147], v[120:123], v[48:63]
    v_mfma_f32_16x16x32_bf16 v[80:83], v[172:175], v[112:115], v[80:83]
    v_mfma_f32_16x16x32_bf16 v[84:87], v[172:175], v[116:119], v[84:87]
    ds_read_b64_tr_b16 v[136:137], v188 offset:9728
    ds_read_b64_tr_b16 v[138:139], v188 offset:11776
    v_mfma_f32_32x32x16_bf16 v[64:79], v[148:151], v[120:123], v[64:79]
    s_waitcnt lgkmcnt(8)
    v_readfirstlane_b32 s42, v197
    s_nop 3
    s_cmp_ge_u32 s42, 36
    s_cbranch_scc1 lr_40
    s_mov_b32 s15, 0x80000
lw_39:
    s_sub_u32 s15, s15, 1
    s_cbranch_scc1 lr_40
    ds_read_b32 v197, v198
    s_waitcnt lgkmcnt(0)
    v_readfirstlane_b32 s42, v197
    s_nop 3
    s_cmp_ge_u32 s42, 36
    s_cbranch_scc0 lw_39
lr_40:
    ds_read_b64_tr_b16 v[140:141], v188 offset:9984
    ds_read_b64_tr_b16 v[142:143], v188 offset:12032
    s_waitcnt lgkmcnt(8)
    v_mfma_f32_32x32x16_bf16 v[16:31], v[152:155], v[124:127], v[16:31]
    ds_read_b64_tr_b16 v[172:173], v190 offset:9216
    ds_read_b64_tr_b16 v[174:175], v190 offset:9472
    ds_read_b64_tr_b16 v[144:145], v188 offset:10240
    ds_read_b64_tr_b16 v[146:147], v188 offset:12288
    v_mfma_f32_32x32x16_bf16 v[32:47], v[156:159], v[124:127], v[32:47]
    buffer_load_dwordx4 v[112:115], v194, s[28:31], s50 offen offset:2048 sc1
    buffer_load_dwordx4 v[116:119], v194, s[28:31], s50 offen offset:3072 sc1
    s_add_u32 m0, s9, 137216
    ds_read_b64_tr_b16 v[148:149], v188 offset:10496
    ds_read_b64_tr_b16 v[150:151], v188 offset:12544
    s_waitcnt lgkmcnt(10)
    v_mfma_f32_32x32x16_bf16 v[48:63], v[160:163], v[124:127], v[48:63]
    s_add_u32 s10, s8, 1105920
    buffer_load_dwordx4 v254, s[16:19], s10 offen offset:512 lds
    ds_read_b64_tr_b16 v[152:153], v188 offset:14336
    ds_read_b64_tr_b16 v[154:155], v188 offset:16384
    v_mfma_f32_32x32x16_bf16 v[64:79], v[164:167], v[124:127], v[64:79]
    buffer_load_dwordx4 v12, s[16:19], s10 offen offset:1536 lds
    buffer_load_dwordx4 v13, s[16:19], s10 offen offset:2560 lds
    buffer_load_dwordx4 v14, s[16:19], s10 offen offset:3584 lds
    ds_read_b64_tr_b16 v[156:157], v188 offset:14592
    ds_read_b64_tr_b16 v[158:159], v188 offset:16640
    s_waitcnt lgkmcnt(10)
    v_mfma_f32_32x32x16_bf16 v[16:31], v[136:139], v[128:131], v[16:31]
    v_permlane16_swap_b32 v120, v124
    v_permlane16_swap_b32 v121, v125
    ds_read_b64_tr_b16 v[160:161], v188 offset:14848
    ds_read_b64_tr_b16 v[162:163], v188 offset:16896
    v_mfma_f32_32x32x16_bf16 v[32:47], v[140:143], v[128:131], v[32:47]
    v_permlane16_swap_b32 v122, v126
    v_permlane16_swap_b32 v123, v127
    s_mov_b32 exec_hi, 0
    buffer_load_dwordx4 v253, s[16:19], s10 offen lds
    s_mov_b32 exec_hi, -1
    ds_read_b64_tr_b16 v[164:165], v188 offset:15104
    ds_read_b64_tr_b16 v[166:167], v188 offset:17152
    s_waitcnt lgkmcnt(8)
    v_mfma_f32_32x32x16_bf16 v[48:63], v[144:147], v[128:131], v[48:63]
    v_mfma_f32_16x16x32_bf16 v[80:83], v[168:171], v[120:123], v[80:83]
    v_mfma_f32_16x16x32_bf16 v[84:87], v[168:171], v[124:127], v[84:87]
    ds_read_b64_tr_b16 v[136:137], v188 offset:18944
    ds_read_b64_tr_b16 v[138:139], v188 offset:20992
    v_mfma_f32_32x32x16_bf16 v[64:79], v[148:151], v[128:131], v[64:79]
    ds_read_b64_tr_b16 v[168:169], v190 offset:18432
    ds_read_b64_tr_b16 v[170:171], v190 offset:18688
    s_add_u32 s50, s44, 61440
    ds_read_b64_tr_b16 v[140:141], v188 offset:19200
    ds_read_b64_tr_b16 v[142:143], v188 offset:21248
    s_waitcnt lgkmcnt(10)
    v_mfma_f32_32x32x16_bf16 v[16:31], v[152:155], v[132:135], v[16:31]
    buffer_load_dwordx4 v[120:123], v194, s[28:31], s50 offen offset:0 sc1
    buffer_load_dwordx4 v[124:127], v194, s[28:31], s50 offen offset:1024 sc1
    ds_read_b64_tr_b16 v[144:145], v188 offset:19456
    ds_read_b64_tr_b16 v[146:147], v188 offset:21504
    v_mfma_f32_32x32x16_bf16 v[32:47], v[156:159], v[132:135], v[32:47]
    ds_read_b64_tr_b16 v[148:149], v188 offset:19712
    ds_read_b64_tr_b16 v[150:151], v188 offset:21760
    s_waitcnt lgkmcnt(10)
    v_mfma_f32_32x32x16_bf16 v[48:63], v[160:163], v[132:135], v[48:63]
    s_waitcnt vmcnt(11)
    ds_add_u32 v202, v203 offset:0
    ds_read_b64_tr_b16 v[152:153], v188 offset:23552
    ds_read_b64_tr_b16 v[154:155], v188 offset:25600
    v_mfma_f32_32x32x16_bf16 v[64:79], v[164:167], v[132:135], v[64:79]
    ds_read_b32 v197, v198
    ds_read_b64_tr_b16 v[156:157], v188 offset:23808
    ds_read_b64_tr_b16 v[158:159], v188 offset:25856
    s_waitcnt lgkmcnt(10)
    v_mfma_f32_32x32x16_bf16 v[16:31], v[136:139], v[88:91], v[16:31]
    v_permlane16_swap_b32 v128, v132
    v_permlane16_swap_b32 v129, v133
    ds_read_b64_tr_b16 v[160:161], v188 offset:24064
    ds_read_b64_tr_b16 v[162:163], v188 offset:26112
    v_mfma_f32_32x32x16_bf16 v[32:47], v[140:143], v[88:91], v[32:47]
    v_permlane16_swap_b32 v130, v134
    v_permlane16_swap_b32 v131, v135
    ds_read_b64_tr_b16 v[164:165], v188 offset:24320
    ds_read_b64_tr_b16 v[166:167], v188 offset:26368
    s_waitcnt lgkmcnt(10)
    v_mfma_f32_32x32x16_bf16 v[48:63], v[144:147], v[88:91], v[48:63]
    v_mfma_f32_16x16x32_bf16 v[80:83], v[172:175], v[128:131], v[80:83]
    v_mfma_f32_16x16x32_bf16 v[84:87], v[172:175], v[132:135], v[84:87]
    ds_read_b64_tr_b16 v[136:137], v188 offset:28160
    ds_read_b64_tr_b16 v[138:139], v188 offset:30208
    v_mfma_f32_32x32x16_bf16 v[64:79], v[148:151], v[88:91], v[64:79]
    s_waitcnt lgkmcnt(8)
    v_readfirstlane_b32 s42, v197
    s_nop 3
    s_cmp_ge_u32 s42, 40
    s_cbranch_scc1 lr_42
    s_mov_b32 s15, 0x80000
lw_41:
    s_sub_u32 s15, s15, 1
    s_cbranch_scc1 lr_42
    ds_read_b32 v197, v198
    s_waitcnt lgkmcnt(0)
    v_readfirstlane_b32 s42, v197
    s_nop 3
    s_cmp_ge_u32 s42, 40
    s_cbranch_scc0 lw_41
lr_42:
    ds_read_b64_tr_b16 v[140:141], v188 offset:28416
    ds_read_b64_tr_b16 v[142:143], v188 offset:30464
    s_waitcnt lgkmcnt(8)
    v_mfma_f32_32x32x16_bf16 v[16:31], v[152:155], v[92:95], v[16:31]
    ds_read_b64_tr_b16 v[172:173], v190 offset:27648
    ds_read_b64_tr_b16 v[174:175], v190 offset:27904
    ds_read_b64_tr_b16 v[144:145], v188 offset:28672
    ds_read_b64_tr_b16 v[146:147], v188 offset:30720
    v_mfma_f32_32x32x16_bf16 v[32:47], v[156:159], v[92:95], v[32:47]
    buffer_load_dwordx4 v[128:131], v194, s[28:31], s50 offen offset:2048 sc1
    buffer_load_dwordx4 v[132:135], v194, s[28:31], s50 offen offset:3072 sc1
    s_add_u32 m0, s9, 81920
    ds_read_b64_tr_b16 v[148:149], v188 offset:28928
    ds_read_b64_tr_b16 v[150:151], v188 offset:30976
    s_waitcnt lgkmcnt(10)
    v_mfma_f32_32x32x16_bf16 v[48:63], v[160:163], v[92:95], v[48:63]
    s_add_u32 s10, s8, 294912
    buffer_load_dwordx4 v254, s[16:19], s10 offen offset:512 lds
    ds_read_b64_tr_b16 v[152:153], v188 offset:32768
    ds_read_b64_tr_b16 v[154:155], v188 offset:34816
    v_mfma_f32_32x32x16_bf16 v[64:79], v[164:167], v[92:95], v[64:79]
    buffer_load_dwordx4 v12, s[16:19], s10 offen offset:1536 lds
    buffer_load_dwordx4 v13, s[16:19], s10 offen offset:2560 lds
    buffer_load_dwordx4 v14, s[16:19], s10 offen offset:3584 lds
    ds_read_b64_tr_b16 v[156:157], v188 offset:33024
    ds_read_b64_tr_b16 v[158:159], v188 offset:35072
    s_waitcnt lgkmcnt(10)
    v_mfma_f32_32x32x16_bf16 v[16:31], v[136:139], v[96:99], v[16:31]
    v_permlane16_swap_b32 v88, v92
    v_permlane16_swap_b32 v89, v93
    ds_read_b64_tr_b16 v[160:161], v188 offset:33280
    ds_read_b64_tr_b16 v[162:163], v188 offset:35328
    v_mfma_f32_32x32x16_bf16 v[32:47], v[140:143], v[96:99], v[32:47]
    v_permlane16_swap_b32 v90, v94
    v_permlane16_swap_b32 v91, v95
    s_mov_b32 exec_hi, 0
    buffer_load_dwordx4 v253, s[16:19], s10 offen lds
    s_mov_b32 exec_hi, -1
    ds_read_b64_tr_b16 v[164:165], v188 offset:33536
    ds_read_b64_tr_b16 v[166:167], v188 offset:35584
    s_waitcnt lgkmcnt(8)
    v_mfma_f32_32x32x16_bf16 v[48:63], v[144:147], v[96:99], v[48:63]
    v_mfma_f32_16x16x32_bf16 v[80:83], v[168:171], v[88:91], v[80:83]
    v_mfma_f32_16x16x32_bf16 v[84:87], v[168:171], v[92:95], v[84:87]
    ds_read_b64_tr_b16 v[136:137], v189 offset:512
    ds_read_b64_tr_b16 v[138:139], v189 offset:2560
    v_mfma_f32_32x32x16_bf16 v[64:79], v[148:151], v[96:99], v[64:79]
    ds_read_b64_tr_b16 v[168:169], v191 offset:0
    ds_read_b64_tr_b16 v[170:171], v191 offset:256
    s_add_u32 s50, s44, 16384
    ds_read_b64_tr_b16 v[140:141], v189 offset:768
    ds_read_b64_tr_b16 v[142:143], v189 offset:2816
    s_waitcnt lgkmcnt(10)
    v_mfma_f32_32x32x16_bf16 v[16:31], v[152:155], v[100:103], v[16:31]
    buffer_load_dwordx4 v[88:91], v194, s[28:31], s50 offen offset:0 sc1
    buffer_load_dwordx4 v[92:95], v194, s[28:31], s50 offen offset:1024 sc1
    ds_read_b64_tr_b16 v[144:145], v189 offset:1024
    ds_read_b64_tr_b16 v[146:147], v189 offset:3072
    v_mfma_f32_32x32x16_bf16 v[32:47], v[156:159], v[100:103], v[32:47]
    ds_read_b64_tr_b16 v[148:149], v189 offset:1280
    ds_read_b64_tr_b16 v[150:151], v189 offset:3328
    s_waitcnt lgkmcnt(10)
    v_mfma_f32_32x32x16_bf16 v[48:63], v[160:163], v[100:103], v[48:63]
    s_waitcnt vmcnt(11)
    ds_add_u32 v202, v203 offset:0
    ds_read_b64_tr_b16 v[152:153], v189 offset:5120
    ds_read_b64_tr_b16 v[154:155], v189 offset:7168
    v_mfma_f32_32x32x16_bf16 v[64:79], v[164:167], v[100:103], v[64:79]
    ds_read_b32 v197, v198
    ds_read_b64_tr_b16 v[156:157], v189 offset:5376
    ds_read_b64_tr_b16 v[158:159], v189 offset:7424
    s_waitcnt lgkmcnt(10)
    v_mfma_f32_32x32x16_bf16 v[16:31], v[136:139], v[104:107], v[16:31]
    v_permlane16_swap_b32 v96, v100
    v_permlane16_swap_b32 v97, v101
    ds_read_b64_tr_b16 v[160:161], v189 offset:5632
    ds_read_b64_tr_b16 v[162:163], v189 offset:7680
    v_mfma_f32_32x32x16_bf16 v[32:47], v[140:143], v[104:107], v[32:47]
    v_permlane16_swap_b32 v98, v102
    v_permlane16_swap_b32 v99, v103
    ds_read_b64_tr_b16 v[164:165], v189 offset:5888
    ds_read_b64_tr_b16 v[166:167], v189 offset:7936
    s_waitcnt lgkmcnt(10)
    v_mfma_f32_32x32x16_bf16 v[48:63], v[144:147], v[104:107], v[48:63]
    v_mfma_f32_16x16x32_bf16 v[80:83], v[172:175], v[96:99], v[80:83]
    v_mfma_f32_16x16x32_bf16 v[84:87], v[172:175], v[100:103], v[84:87]
    ds_read_b64_tr_b16 v[136:137], v189 offset:9728
    ds_read_b64_tr_b16 v[138:139], v189 offset:11776
    v_mfma_f32_32x32x16_bf16 v[64:79], v[148:151], v[104:107], v[64:79]
    s_waitcnt lgkmcnt(8)
    v_readfirstlane_b32 s42, v197
    s_nop 3
    s_cmp_ge_u32 s42, 44
    s_cbranch_scc1 lr_44
    s_mov_b32 s15, 0x80000
lw_43:
    s_sub_u32 s15, s15, 1
    s_cbranch_scc1 lr_44
    ds_read_b32 v197, v198
    s_waitcnt lgkmcnt(0)
    v_readfirstlane_b32 s42, v197
    s_nop 3
    s_cmp_ge_u32 s42, 44
    s_cbranch_scc0 lw_43
lr_44:
    ds_read_b64_tr_b16 v[140:141], v189 offset:9984
    ds_read_b64_tr_b16 v[142:143], v189 offset:12032
    s_waitcnt lgkmcnt(8)
    v_mfma_f32_32x32x16_bf16 v[16:31], v[152:155], v[108:111], v[16:31]
    ds_read_b64_tr_b16 v[172:173], v191 offset:9216
    ds_read_b64_tr_b16 v[174:175], v191 offset:9472
    ds_read_b64_tr_b16 v[144:145], v189 offset:10240
    ds_read_b64_tr_b16 v[146:147], v189 offset:12288
    v_mfma_f32_32x32x16_bf16 v[32:47], v[156:159], v[108:111], v[32:47]
    buffer_load_dwordx4 v[96:99], v194, s[28:31], s50 offen offset:2048 sc1
    buffer_load_dwordx4 v[100:103], v194, s[28:31], s50 offen offset:3072 sc1
    s_add_u32 m0, s9, 100352
    ds_read_b64_tr_b16 v[148:149], v189 offset:10496
    ds_read_b64_tr_b16 v[150:151], v189 offset:12544
    s_waitcnt lgkmcnt(10)
    v_mfma_f32_32x32x16_bf16 v[48:63], v[160:163], v[108:111], v[48:63]
    s_add_u32 s10, s8, 737280
    buffer_load_dwordx4 v254, s[16:19], s10 offen offset:512 lds
    ds_read_b64_tr_b16 v[152:153], v189 offset:14336
    ds_read_b64_tr_b16 v[154:155], v189 offset:16384
    v_mfma_f32_32x32x16_bf16 v[64:79], v[164:167], v[108:111], v[64:79]
    buffer_load_dwordx4 v12, s[16:19], s10 offen offset:1536 lds
    buffer_load_dwordx4 v13, s[16:19], s10 offen offset:2560 lds
    buffer_load_dwordx4 v14, s[16:19], s10 offen offset:3584 lds
    ds_read_b64_tr_b16 v[156:157], v189 offset:14592
    ds_read_b64_tr_b16 v[158:159], v189 offset:16640
    s_waitcnt lgkmcnt(10)
    v_mfma_f32_32x32x16_bf16 v[16:31], v[136:139], v[112:115], v[16:31]
    v_permlane16_swap_b32 v104, v108
    v_permlane16_swap_b32 v105, v109
    ds_read_b64_tr_b16 v[160:161], v189 offset:14848
    ds_read_b64_tr_b16 v[162:163], v189 offset:16896
    v_mfma_f32_32x32x16_bf16 v[32:47], v[140:143], v[112:115], v[32:47]
    v_permlane16_swap_b32 v106, v110
    v_permlane16_swap_b32 v107, v111
    s_mov_b32 exec_hi, 0
    buffer_load_dwordx4 v253, s[16:19], s10 offen lds
    s_mov_b32 exec_hi, -1
    ds_read_b64_tr_b16 v[164:165], v189 offset:15104
    ds_read_b64_tr_b16 v[166:167], v189 offset:17152
    s_waitcnt lgkmcnt(8)
    v_mfma_f32_32x32x16_bf16 v[48:63], v[144:147], v[112:115], v[48:63]
    v_mfma_f32_16x16x32_bf16 v[80:83], v[168:171], v[104:107], v[80:83]
    v_mfma_f32_16x16x32_bf16 v[84:87], v[168:171], v[108:111], v[84:87]
    ds_read_b64_tr_b16 v[136:137], v189 offset:18944
    ds_read_b64_tr_b16 v[138:139], v189 offset:20992
    v_mfma_f32_32x32x16_bf16 v[64:79], v[148:151], v[112:115], v[64:79]
    ds_read_b64_tr_b16 v[168:169], v191 offset:18432
    ds_read_b64_tr_b16 v[170:171], v191 offset:18688
    s_add_u32 s50, s44, 40960
    ds_read_b64_tr_b16 v[140:141], v189 offset:19200
    ds_read_b64_tr_b16 v[142:143], v189 offset:21248
    s_waitcnt lgkmcnt(10)
    v_mfma_f32_32x32x16_bf16 v[16:31], v[152:155], v[116:119], v[16:31]
    buffer_load_dwordx4 v[104:107], v194, s[28:31], s50 offen offset:0 sc1
    buffer_load_dwordx4 v[108:111], v194, s[28:31], s50 offen offset:1024 sc1
    ds_read_b64_tr_b16 v[144:145], v189 offset:19456
    ds_read_b64_tr_b16 v[146:147], v189 offset:21504
    v_mfma_f32_32x32x16_bf16 v[32:47], v[156:159], v[116:119], v[32:47]
    ds_read_b64_tr_b16 v[148:149], v189 offset:19712
    ds_read_b64_tr_b16 v[150:151], v189 offset:21760
    s_waitcnt lgkmcnt(10)
    v_mfma_f32_32x32x16_bf16 v[48:63], v[160:163], v[116:119], v[48:63]
    s_waitcnt vmcnt(11)
    ds_add_u32 v202, v203 offset:0
    ds_read_b64_tr_b16 v[152:153], v189 offset:23552
    ds_read_b64_tr_b16 v[154:155], v189 offset:25600
    v_mfma_f32_32x32x16_bf16 v[64:79], v[164:167], v[116:119], v[64:79]
    ds_read_b32 v197, v198
    ds_read_b64_tr_b16 v[156:157], v189 offset:23808
    ds_read_b64_tr_b16 v[158:159], v189 offset:25856
    s_waitcnt lgkmcnt(10)
    v_mfma_f32_32x32x16_bf16 v[16:31], v[136:139], v[120:123], v[16:31]
    v_permlane16_swap_b32 v112, v116
    v_permlane16_swap_b32 v113, v117
    ds_read_b64_tr_b16 v[160:161], v189 offset:24064
    ds_read_b64_tr_b16 v[162:163], v189 offset:26112
    v_mfma_f32_32x32x16_bf16 v[32:47], v[140:143], v[120:123], v[32:47]
    v_permlane16_swap_b32 v114, v118
    v_permlane16_swap_b32 v115, v119
    ds_read_b64_tr_b16 v[164:165], v189 offset:24320
    ds_read_b64_tr_b16 v[166:167], v189 offset:26368
    s_waitcnt lgkmcnt(10)
    v_mfma_f32_32x32x16_bf16 v[48:63], v[144:147], v[120:123], v[48:63]
    v_mfma_f32_16x16x32_bf16 v[80:83], v[172:175], v[112:115], v[80:83]
    v_mfma_f32_16x16x32_bf16 v[84:87], v[172:175], v[116:119], v[84:87]
    ds_read_b64_tr_b16 v[136:137], v189 offset:28160
    ds_read_b64_tr_b16 v[138:139], v189 offset:30208
    v_mfma_f32_32x32x16_bf16 v[64:79], v[148:151], v[120:123], v[64:79]
    s_waitcnt lgkmcnt(8)
    v_readfirstlane_b32 s42, v197
    s_nop 3
    s_cmp_ge_u32 s42, 48
    s_cbranch_scc1 lr_46
    s_mov_b32 s15, 0x80000
lw_45:
    s_sub_u32 s15, s15, 1
    s_cbranch_scc1 lr_46
    ds_read_b32 v197, v198
    s_waitcnt lgkmcnt(0)
    v_readfirstlane_b32 s42, v197
    s_nop 3
    s_cmp_ge_u32 s42, 48
    s_cbranch_scc0 lw_45
lr_46:
    ds_read_b64_tr_b16 v[140:141], v189 offset:28416
    ds_read_b64_tr_b16 v[142:143], v189 offset:30464
    s_waitcnt lgkmcnt(8)
    v_mfma_f32_32x32x16_bf16 v[16:31], v[152:155], v[124:127], v[16:31]
    ds_read_b64_tr_b16 v[172:173], v191 offset:27648
    ds_read_b64_tr_b16 v[174:175], v191 offset:27904
    ds_read_b64_tr_b16 v[144:145], v189 offset:28672
    ds_read_b64_tr_b16 v[146:147], v189 offset:30720
    v_mfma_f32_32x32x16_bf16 v[32:47], v[156:159], v[124:127], v[32:47]
    buffer_load_dwordx4 v[112:115], v194, s[28:31], s50 offen offset:2048 sc1
    buffer_load_dwordx4 v[116:119], v194, s[28:31], s50 offen offset:3072 sc1
    s_add_u32 m0, s9, 118784
    ds_read_b64_tr_b16 v[148:149], v189 offset:28928
    ds_read_b64_tr_b16 v[150:151], v189 offset:30976
    s_waitcnt lgkmcnt(10)
    v_mfma_f32_32x32x16_bf16 v[48:63], v[160:163], v[124:127], v[48:63]
    s_add_u32 s10, s8, 1179648
    buffer_load_dwordx4 v254, s[16:19], s10 offen offset:512 lds
    ds_read_b64_tr_b16 v[152:153], v189 offset:32768
    ds_read_b64_tr_b16 v[154:155], v189 offset:34816
    v_mfma_f32_32x32x16_bf16 v[64:79], v[164:167], v[124:127], v[64:79]
    buffer_load_dwordx4 v12, s[16:19], s10 offen offset:1536 lds
    buffer_load_dwordx4 v13, s[16:19], s10 offen offset:2560 lds
    buffer_load_dwordx4 v14, s[16:19], s10 offen offset:3584 lds
    ds_read_b64_tr_b16 v[156:157], v189 offset:33024
    ds_read_b64_tr_b16 v[158:159], v189 offset:35072
    s_waitcnt lgkmcnt(10)
    v_mfma_f32_32x32x16_bf16 v[16:31], v[136:139], v[128:131], v[16:31]
    v_permlane16_swap_b32 v120, v124
    v_permlane16_swap_b32 v121, v125
    ds_read_b64_tr_b16 v[160:161], v189 offset:33280
    ds_read_b64_tr_b16 v[162:163], v189 offset:35328
    v_mfma_f32_32x32x16_bf16 v[32:47], v[140:143], v[128:131], v[32:47]
    v_permlane16_swap_b32 v122, v126
    v_permlane16_swap_b32 v123, v127
    s_mov_b32 exec_hi, 0
    buffer_load_dwordx4 v253, s[16:19], s10 offen lds
    s_mov_b32 exec_hi, -1
    ds_read_b64_tr_b16 v[164:165], v189 offset:33536
    ds_read_b64_tr_b16 v[166:167], v189 offset:35584
    s_waitcnt lgkmcnt(8)
    v_mfma_f32_32x32x16_bf16 v[48:63], v[144:147], v[128:131], v[48:63]
    v_mfma_f32_16x16x32_bf16 v[80:83], v[168:171], v[120:123], v[80:83]
    v_mfma_f32_16x16x32_bf16 v[84:87], v[168:171], v[124:127], v[84:87]
    ds_read_b64_tr_b16 v[136:137], v188 offset:512
    ds_read_b64_tr_b16 v[138:139], v188 offset:2560
    v_mfma_f32_32x32x16_bf16 v[64:79], v[148:151], v[128:131], v[64:79]
    ds_read_b64_tr_b16 v[168:169], v190 offset:0
    ds_read_b64_tr_b16 v[170:171], v190 offset:256
    s_add_u32 s50, s44, 65536
    ds_read_b64_tr_b16 v[140:141], v188 offset:768
    ds_read_b64_tr_b16 v[142:143], v188 offset:2816
    s_waitcnt lgkmcnt(10)
    v_mfma_f32_32x32x16_bf16 v[16:31], v[152:155], v[132:135], v[16:31]
    buffer_load_dwordx4 v[120:123], v194, s[28:31], s50 offen offset:0 sc1
    buffer_load_dwordx4 v[124:127], v194, s[28:31], s50 offen offset:1024 sc1
    ds_read_b64_tr_b16 v[144:145], v188 offset:1024
    ds_read_b64_tr_b16 v[146:147], v188 offset:3072
    v_mfma_f32_32x32x16_bf16 v[32:47], v[156:159], v[132:135], v[32:47]
    ds_read_b64_tr_b16 v[148:149], v188 offset:1280
    ds_read_b64_tr_b16 v[150:151], v188 offset:3328
    s_waitcnt lgkmcnt(10)
    v_mfma_f32_32x32x16_bf16 v[48:63], v[160:163], v[132:135], v[48:63]
    s_waitcnt vmcnt(11)
    ds_add_u32 v202, v203 offset:0
    ds_read_b64_tr_b16 v[152:153], v188 offset:5120
    ds_read_b64_tr_b16 v[154:155], v188 offset:7168
    v_mfma_f32_32x32x16_bf16 v[64:79], v[164:167], v[132:135], v[64:79]
    ds_read_b32 v197, v198
    ds_read_b64_tr_b16 v[156:157], v188 offset:5376
    ds_read_b64_tr_b16 v[158:159], v188 offset:7424
    s_waitcnt lgkmcnt(10)
    v_mfma_f32_32x32x16_bf16 v[16:31], v[136:139], v[88:91], v[16:31]
    v_permlane16_swap_b32 v128, v132
    v_permlane16_swap_b32 v129, v133
    ds_read_b64_tr_b16 v[160:161], v188 offset:5632
    ds_read_b64_tr_b16 v[162:163], v188 offset:7680
    v_mfma_f32_32x32x16_bf16 v[32:47], v[140:143], v[88:91], v[32:47]
    v_permlane16_swap_b32 v130, v134
    v_permlane16_swap_b32 v131, v135
    ds_read_b64_tr_b16 v[164:165], v188 offset:5888
    ds_read_b64_tr_b16 v[166:167], v188 offset:7936
    s_waitcnt lgkmcnt(10)
    v_mfma_f32_32x32x16_bf16 v[48:63], v[144:147], v[88:91], v[48:63]
    v_mfma_f32_16x16x32_bf16 v[80:83], v[172:175], v[128:131], v[80:83]
    v_mfma_f32_16x16x32_bf16 v[84:87], v[172:175], v[132:135], v[84:87]
    ds_read_b64_tr_b16 v[136:137], v188 offset:9728
    ds_read_b64_tr_b16 v[138:139], v188 offset:11776
    v_mfma_f32_32x32x16_bf16 v[64:79], v[148:151], v[88:91], v[64:79]
    s_waitcnt lgkmcnt(8)
    v_readfirstlane_b32 s42, v197
    s_nop 3
    s_cmp_ge_u32 s42, 52
    s_cbranch_scc1 lr_48
    s_mov_b32 s15, 0x80000
lw_47:
    s_sub_u32 s15, s15, 1
    s_cbranch_scc1 lr_48
    ds_read_b32 v197, v198
    s_waitcnt lgkmcnt(0)
    v_readfirstlane_b32 s42, v197
    s_nop 3
    s_cmp_ge_u32 s42, 52
    s_cbranch_scc0 lw_47
lr_48:
    ds_read_b64_tr_b16 v[140:141], v188 offset:9984
    ds_read_b64_tr_b16 v[142:143], v188 offset:12032
    s_waitcnt lgkmcnt(8)
    v_mfma_f32_32x32x16_bf16 v[16:31], v[152:155], v[92:95], v[16:31]
    ds_read_b64_tr_b16 v[172:173], v190 offset:9216
    ds_read_b64_tr_b16 v[174:175], v190 offset:9472
    ds_read_b64_tr_b16 v[144:145], v188 offset:10240
    ds_read_b64_tr_b16 v[146:147], v188 offset:12288
    v_mfma_f32_32x32x16_bf16 v[32:47], v[156:159], v[92:95], v[32:47]
    buffer_load_dwordx4 v[128:131], v194, s[28:31], s50 offen offset:2048 sc1
    buffer_load_dwordx4 v[132:135], v194, s[28:31], s50 offen offset:3072 sc1
    s_add_u32 m0, s9, 137216
    ds_read_b64_tr_b16 v[148:149], v188 offset:10496
    ds_read_b64_tr_b16 v[150:151], v188 offset:12544
    s_waitcnt lgkmcnt(10)
    v_mfma_f32_32x32x16_bf16 v[48:63], v[160:163], v[92:95], v[48:63]
    s_add_u32 s10, s8, 368640
    buffer_load_dwordx4 v254, s[16:19], s10 offen offset:512 lds
    ds_read_b64_tr_b16 v[152:153], v188 offset:14336
    ds_read_b64_tr_b16 v[154:155], v188 offset:16384
    v_mfma_f32_32x32x16_bf16 v[64:79], v[164:167], v[92:95], v[64:79]
    buffer_load_dwordx4 v12, s[16:19], s10 offen offset:1536 lds
    buffer_load_dwordx4 v13, s[16:19], s10 offen offset:2560 lds
    buffer_load_dwordx4 v14, s[16:19], s10 offen offset:3584 lds
    ds_read_b64_tr_b16 v[156:157], v188 offset:14592
    ds_read_b64_tr_b16 v[158:159], v188 offset:16640
    s_waitcnt lgkmcnt(10)
    v_mfma_f32_32x32x16_bf16 v[16:31], v[136:139], v[96:99], v[16:31]
    v_permlane16_swap_b32 v88, v92
    v_permlane16_swap_b32 v89, v93
    ds_read_b64_tr_b16 v[160:161], v188 offset:14848
    ds_read_b64_tr_b16 v[162:163], v188 offset:16896
    v_mfma_f32_32x32x16_bf16 v[32:47], v[140:143], v[96:99], v[32:47]
    v_permlane16_swap_b32 v90, v94
    v_permlane16_swap_b32 v91, v95
    s_mov_b32 exec_hi, 0
    buffer_load_dwordx4 v253, s[16:19], s10 offen lds
    s_mov_b32 exec_hi, -1
    ds_read_b64_tr_b16 v[164:165], v188 offset:15104
    ds_read_b64_tr_b16 v[166:167], v188 offset:17152
    s_waitcnt lgkmcnt(8)
    v_mfma_f32_32x32x16_bf16 v[48:63], v[144:147], v[96:99], v[48:63]
    v_mfma_f32_16x16x32_bf16 v[80:83], v[168:171], v[88:91], v[80:83]
    v_mfma_f32_16x16x32_bf16 v[84:87], v[168:171], v[92:95], v[84:87]
    ds_read_b64_tr_b16 v[136:137], v188 offset:18944
    ds_read_b64_tr_b16 v[138:139], v188 offset:20992
    v_mfma_f32_32x32x16_bf16 v[64:79], v[148:151], v[96:99], v[64:79]
    ds_read_b64_tr_b16 v[168:169], v190 offset:18432
    ds_read_b64_tr_b16 v[170:171], v190 offset:18688
    s_add_u32 s50, s44, 20480
    ds_read_b64_tr_b16 v[140:141], v188 offset:19200
    ds_read_b64_tr_b16 v[142:143], v188 offset:21248
    s_waitcnt lgkmcnt(10)
    v_mfma_f32_32x32x16_bf16 v[16:31], v[152:155], v[100:103], v[16:31]
    buffer_load_dwordx4 v[88:91], v194, s[28:31], s50 offen offset:0 sc1
    buffer_load_dwordx4 v[92:95], v194, s[28:31], s50 offen offset:1024 sc1
    ds_read_b64_tr_b16 v[144:145], v188 offset:19456
    ds_read_b64_tr_b16 v[146:147], v188 offset:21504
    v_mfma_f32_32x32x16_bf16 v[32:47], v[156:159], v[100:103], v[32:47]
    ds_read_b64_tr_b16 v[148:149], v188 offset:19712
    ds_read_b64_tr_b16 v[150:151], v188 offset:21760
    s_waitcnt lgkmcnt(10)
    v_mfma_f32_32x32x16_bf16 v[48:63], v[160:163], v[100:103], v[48:63]
    s_waitcnt vmcnt(11)
    ds_add_u32 v202, v203 offset:0
    ds_read_b64_tr_b16 v[152:153], v188 offset:23552
    ds_read_b64_tr_b16 v[154:155], v188 offset:25600
    v_mfma_f32_32x32x16_bf16 v[64:79], v[164:167], v[100:103], v[64:79]
    ds_read_b32 v197, v198
    ds_read_b64_tr_b16 v[156:157], v188 offset:23808
    ds_read_b64_tr_b16 v[158:159], v188 offset:25856
    s_waitcnt lgkmcnt(10)
    v_mfma_f32_32x32x16_bf16 v[16:31], v[136:139], v[104:107], v[16:31]
    v_permlane16_swap_b32 v96, v100
    v_permlane16_swap_b32 v97, v101
    ds_read_b64_tr_b16 v[160:161], v188 offset:24064
    ds_read_b64_tr_b16 v[162:163], v188 offset:26112
    v_mfma_f32_32x32x16_bf16 v[32:47], v[140:143], v[104:107], v[32:47]
    v_permlane16_swap_b32 v98, v102
    v_permlane16_swap_b32 v99, v103
    ds_read_b64_tr_b16 v[164:165], v188 offset:24320
    ds_read_b64_tr_b16 v[166:167], v188 offset:26368
    s_waitcnt lgkmcnt(10)
    v_mfma_f32_32x32x16_bf16 v[48:63], v[144:147], v[104:107], v[48:63]
    v_mfma_f32_16x16x32_bf16 v[80:83], v[172:175], v[96:99], v[80:83]
    v_mfma_f32_16x16x32_bf16 v[84:87], v[172:175], v[100:103], v[84:87]
    ds_read_b64_tr_b16 v[136:137], v188 offset:28160
    ds_read_b64_tr_b16 v[138:139], v188 offset:30208
    v_mfma_f32_32x32x16_bf16 v[64:79], v[148:151], v[104:107], v[64:79]
    s_waitcnt lgkmcnt(8)
    v_readfirstlane_b32 s42, v197
    s_nop 3
    s_cmp_ge_u32 s42, 56
    s_cbranch_scc1 lr_50
    s_mov_b32 s15, 0x80000
lw_49:
    s_sub_u32 s15, s15, 1
    s_cbranch_scc1 lr_50
    ds_read_b32 v197, v198
    s_waitcnt lgkmcnt(0)
    v_readfirstlane_b32 s42, v197
    s_nop 3
    s_cmp_ge_u32 s42, 56
    s_cbranch_scc0 lw_49
lr_50:
    ds_read_b64_tr_b16 v[140:141], v188 offset:28416
    ds_read_b64_tr_b16 v[142:143], v188 offset:30464
    s_waitcnt lgkmcnt(8)
    v_mfma_f32_32x32x16_bf16 v[16:31], v[152:155], v[108:111], v[16:31]
    ds_read_b64_tr_b16 v[172:173], v190 offset:27648
    ds_read_b64_tr_b16 v[174:175], v190 offset:27904
    ds_read_b64_tr_b16 v[144:145], v188 offset:28672
    ds_read_b64_tr_b16 v[146:147], v188 offset:30720
    v_mfma_f32_32x32x16_bf16 v[32:47], v[156:159], v[108:111], v[32:47]
    buffer_load_dwordx4 v[96:99], v194, s[28:31], s50 offen offset:2048 sc1
    buffer_load_dwordx4 v[100:103], v194, s[28:31], s50 offen offset:3072 sc1
    s_add_u32 m0, s9, 81920
    ds_read_b64_tr_b16 v[148:149], v188 offset:28928
    ds_read_b64_tr_b16 v[150:151], v188 offset:30976
    s_waitcnt lgkmcnt(10)
    v_mfma_f32_32x32x16_bf16 v[48:63], v[160:163], v[108:111], v[48:63]
    s_add_u32 s10, s8, 811008
    buffer_load_dwordx4 v254, s[16:19], s10 offen offset:512 lds
    ds_read_b64_tr_b16 v[152:153], v188 offset:32768
    ds_read_b64_tr_b16 v[154:155], v188 offset:34816
    v_mfma_f32_32x32x16_bf16 v[64:79], v[164:167], v[108:111], v[64:79]
    buffer_load_dwordx4 v12, s[16:19], s10 offen offset:1536 lds
    buffer_load_dwordx4 v13, s[16:19], s10 offen offset:2560 lds
    buffer_load_dwordx4 v14, s[16:19], s10 offen offset:3584 lds
    ds_read_b64_tr_b16 v[156:157], v188 offset:33024
    ds_read_b64_tr_b16 v[158:159], v188 offset:35072
    s_waitcnt lgkmcnt(10)
    v_mfma_f32_32x32x16_bf16 v[16:31], v[136:139], v[112:115], v[16:31]
    v_permlane16_swap_b32 v104, v108
    v_permlane16_swap_b32 v105, v109
    ds_read_b64_tr_b16 v[160:161], v188 offset:33280
    ds_read_b64_tr_b16 v[162:163], v188 offset:35328
    v_mfma_f32_32x32x16_bf16 v[32:47], v[140:143], v[112:115], v[32:47]
    v_permlane16_swap_b32 v106, v110
    v_permlane16_swap_b32 v107, v111
    s_mov_b32 exec_hi, 0
    buffer_load_dwordx4 v253, s[16:19], s10 offen lds
    s_mov_b32 exec_hi, -1
    ds_read_b64_tr_b16 v[164:165], v188 offset:33536
    ds_read_b64_tr_b16 v[166:167], v188 offset:35584
    s_waitcnt lgkmcnt(8)
    v_mfma_f32_32x32x16_bf16 v[48:63], v[144:147], v[112:115], v[48:63]
    v_mfma_f32_16x16x32_bf16 v[80:83], v[168:171], v[104:107], v[80:83]
    v_mfma_f32_16x16x32_bf16 v[84:87], v[168:171], v[108:111], v[84:87]
    ds_read_b64_tr_b16 v[136:137], v189 offset:512
    ds_read_b64_tr_b16 v[138:139], v189 offset:2560
    v_mfma_f32_32x32x16_bf16 v[64:79], v[148:151], v[112:115], v[64:79]
    ds_read_b64_tr_b16 v[168:169], v191 offset:0
    ds_read_b64_tr_b16 v[170:171], v191 offset:256
    s_add_u32 s50, s44, 45056
    ds_read_b64_tr_b16 v[140:141], v189 offset:768
    ds_read_b64_tr_b16 v[142:143], v189 offset:2816
    s_waitcnt lgkmcnt(10)
    v_mfma_f32_32x32x16_bf16 v[16:31], v[152:155], v[116:119], v[16:31]
    buffer_load_dwordx4 v[104:107], v194, s[28:31], s50 offen offset:0 sc1
    buffer_load_dwordx4 v[108:111], v194, s[28:31], s50 offen offset:1024 sc1
    ds_read_b64_tr_b16 v[144:145], v189 offset:1024
    ds_read_b64_tr_b16 v[146:147], v189 offset:3072
    v_mfma_f32_32x32x16_bf16 v[32:47], v[156:159], v[116:119], v[32:47]
    ds_read_b64_tr_b16 v[148:149], v189 offset:1280
    ds_read_b64_tr_b16 v[150:151], v189 offset:3328
    s_waitcnt lgkmcnt(10)
    v_mfma_f32_32x32x16_bf16 v[48:63], v[160:163], v[116:119], v[48:63]
    s_waitcnt vmcnt(11)
    ds_add_u32 v202, v203 offset:0
    ds_read_b64_tr_b16 v[152:153], v189 offset:5120
    ds_read_b64_tr_b16 v[154:155], v189 offset:7168
    v_mfma_f32_32x32x16_bf16 v[64:79], v[164:167], v[116:119], v[64:79]
    ds_read_b32 v197, v198
    ds_read_b64_tr_b16 v[156:157], v189 offset:5376
    ds_read_b64_tr_b16 v[158:159], v189 offset:7424
    s_waitcnt lgkmcnt(10)
    v_mfma_f32_32x32x16_bf16 v[16:31], v[136:139], v[120:123], v[16:31]
    v_permlane16_swap_b32 v112, v116
    v_permlane16_swap_b32 v113, v117
    ds_read_b64_tr_b16 v[160:161], v189 offset:5632
    ds_read_b64_tr_b16 v[162:163], v189 offset:7680
    v_mfma_f32_32x32x16_bf16 v[32:47], v[140:143], v[120:123], v[32:47]
    v_permlane16_swap_b32 v114, v118
    v_permlane16_swap_b32 v115, v119
    ds_read_b64_tr_b16 v[164:165], v189 offset:5888
    ds_read_b64_tr_b16 v[166:167], v189 offset:7936
    s_waitcnt lgkmcnt(10)
    v_mfma_f32_32x32x16_bf16 v[48:63], v[144:147], v[120:123], v[48:63]
    v_mfma_f32_16x16x32_bf16 v[80:83], v[172:175], v[112:115], v[80:83]
    v_mfma_f32_16x16x32_bf16 v[84:87], v[172:175], v[116:119], v[84:87]
    ds_read_b64_tr_b16 v[136:137], v189 offset:9728
    ds_read_b64_tr_b16 v[138:139], v189 offset:11776
    v_mfma_f32_32x32x16_bf16 v[64:79], v[148:151], v[120:123], v[64:79]
    s_waitcnt lgkmcnt(8)
    v_readfirstlane_b32 s42, v197
    s_nop 3
    s_cmp_ge_u32 s42, 60
    s_cbranch_scc1 lr_52
    s_mov_b32 s15, 0x80000
lw_51:
    s_sub_u32 s15, s15, 1
    s_cbranch_scc1 lr_52
    ds_read_b32 v197, v198
    s_waitcnt lgkmcnt(0)
    v_readfirstlane_b32 s42, v197
    s_nop 3
    s_cmp_ge_u32 s42, 60
    s_cbranch_scc0 lw_51
lr_52:
    ds_read_b64_tr_b16 v[140:141], v189 offset:9984
    ds_read_b64_tr_b16 v[142:143], v189 offset:12032
    s_waitcnt lgkmcnt(8)
    v_mfma_f32_32x32x16_bf16 v[16:31], v[152:155], v[124:127], v[16:31]
    ds_read_b64_tr_b16 v[172:173], v191 offset:9216
    ds_read_b64_tr_b16 v[174:175], v191 offset:9472
    ds_read_b64_tr_b16 v[144:145], v189 offset:10240
    ds_read_b64_tr_b16 v[146:147], v189 offset:12288
    v_mfma_f32_32x32x16_bf16 v[32:47], v[156:159], v[124:127], v[32:47]
    buffer_load_dwordx4 v[112:115], v194, s[28:31], s50 offen offset:2048 sc1
    buffer_load_dwordx4 v[116:119], v194, s[28:31], s50 offen offset:3072 sc1
    s_add_u32 m0, s9, 100352
    ds_read_b64_tr_b16 v[148:149], v189 offset:10496
    ds_read_b64_tr_b16 v[150:151], v189 offset:12544
    s_waitcnt lgkmcnt(10)
    v_mfma_f32_32x32x16_bf16 v[48:63], v[160:163], v[124:127], v[48:63]
    s_add_u32 s10, s8, 1253376
    buffer_load_dwordx4 v254, s[16:19], s10 offen offset:512 lds
    ds_read_b64_tr_b16 v[152:153], v189 offset:14336
    ds_read_b64_tr_b16 v[154:155], v189 offset:16384
    v_mfma_f32_32x32x16_bf16 v[64:79], v[164:167], v[124:127], v[64:79]
    buffer_load_dwordx4 v12, s[16:19], s10 offen offset:1536 lds
    buffer_load_dwordx4 v13, s[16:19], s10 offen offset:2560 lds
    buffer_load_dwordx4 v14, s[16:19], s10 offen offset:3584 lds
    ds_read_b64_tr_b16 v[156:157], v189 offset:14592
    ds_read_b64_tr_b16 v[158:159], v189 offset:16640
    s_waitcnt lgkmcnt(10)
    v_mfma_f32_32x32x16_bf16 v[16:31], v[136:139], v[128:131], v[16:31]
    v_permlane16_swap_b32 v120, v124
    v_permlane16_swap_b32 v121, v125
    ds_read_b64_tr_b16 v[160:161], v189 offset:14848
    ds_read_b64_tr_b16 v[162:163], v189 offset:16896
    v_mfma_f32_32x32x16_bf16 v[32:47], v[140:143], v[128:131], v[32:47]
    v_permlane16_swap_b32 v122, v126
    v_permlane16_swap_b32 v123, v127
    s_mov_b32 exec_hi, 0
    buffer_load_dwordx4 v253, s[16:19], s10 offen lds
    s_mov_b32 exec_hi, -1
    ds_read_b64_tr_b16 v[164:165], v189 offset:15104
    ds_read_b64_tr_b16 v[166:167], v189 offset:17152
    s_waitcnt lgkmcnt(8)
    v_mfma_f32_32x32x16_bf16 v[48:63], v[144:147], v[128:131], v[48:63]
    v_mfma_f32_16x16x32_bf16 v[80:83], v[168:171], v[120:123], v[80:83]
    v_mfma_f32_16x16x32_bf16 v[84:87], v[168:171], v[124:127], v[84:87]
    ds_read_b64_tr_b16 v[136:137], v189 offset:18944
    ds_read_b64_tr_b16 v[138:139], v189 offset:20992
    v_mfma_f32_32x32x16_bf16 v[64:79], v[148:151], v[128:131], v[64:79]
    ds_read_b64_tr_b16 v[168:169], v191 offset:18432
    ds_read_b64_tr_b16 v[170:171], v191 offset:18688
    s_add_u32 s50, s44, 69632
    ds_read_b64_tr_b16 v[140:141], v189 offset:19200
    ds_read_b64_tr_b16 v[142:143], v189 offset:21248
    s_waitcnt lgkmcnt(10)
    v_mfma_f32_32x32x16_bf16 v[16:31], v[152:155], v[132:135], v[16:31]
    buffer_load_dwordx4 v[120:123], v194, s[28:31], s50 offen offset:0 sc1
    buffer_load_dwordx4 v[124:127], v194, s[28:31], s50 offen offset:1024 sc1
    ds_read_b64_tr_b16 v[144:145], v189 offset:19456
    ds_read_b64_tr_b16 v[146:147], v189 offset:21504
    v_mfma_f32_32x32x16_bf16 v[32:47], v[156:159], v[132:135], v[32:47]
    buffer_load_dwordx4 v[184:187], off, s[28:31], s51 offset:64 sc1
    ds_read_b64_tr_b16 v[148:149], v189 offset:19712
    ds_read_b64_tr_b16 v[150:151], v189 offset:21760
    s_waitcnt lgkmcnt(10)
    v_mfma_f32_32x32x16_bf16 v[48:63], v[160:163], v[132:135], v[48:63]
    s_waitcnt vmcnt(12)
    ds_add_u32 v202, v203 offset:0
    ds_read_b64_tr_b16 v[152:153], v189 offset:23552
    ds_read_b64_tr_b16 v[154:155], v189 offset:25600
    v_mfma_f32_32x32x16_bf16 v[64:79], v[164:167], v[132:135], v[64:79]
    ds_read_b32 v197, v198
    ds_read_b64_tr_b16 v[156:157], v189 offset:23808
    ds_read_b64_tr_b16 v[158:159], v189 offset:25856
    s_waitcnt lgkmcnt(10)
    v_mfma_f32_32x32x16_bf16 v[16:31], v[136:139], v[88:91], v[16:31]
    v_permlane16_swap_b32 v128, v132
    v_permlane16_swap_b32 v129, v133
    ds_read_b64_tr_b16 v[160:161], v189 offset:24064
    ds_read_b64_tr_b16 v[162:163], v189 offset:26112
    v_mfma_f32_32x32x16_bf16 v[32:47], v[140:143], v[88:91], v[32:47]
    v_permlane16_swap_b32 v130, v134
    v_permlane16_swap_b32 v131, v135
    ds_read_b64_tr_b16 v[164:165], v189 offset:24320
    ds_read_b64_tr_b16 v[166:167], v189 offset:26368
    s_waitcnt lgkmcnt(10)
    v_mfma_f32_32x32x16_bf16 v[48:63], v[144:147], v[88:91], v[48:63]
    v_mfma_f32_16x16x32_bf16 v[80:83], v[172:175], v[128:131], v[80:83]
    v_mfma_f32_16x16x32_bf16 v[84:87], v[172:175], v[132:135], v[84:87]
    ds_read_b64_tr_b16 v[136:137], v189 offset:28160
    ds_read_b64_tr_b16 v[138:139], v189 offset:30208
    v_mfma_f32_32x32x16_bf16 v[64:79], v[148:151], v[88:91], v[64:79]
    s_waitcnt lgkmcnt(8)
    v_readfirstlane_b32 s42, v197
    s_nop 3
    s_cmp_ge_u32 s42, 64
    s_cbranch_scc1 lr_54
    s_mov_b32 s15, 0x80000
lw_53:
    s_sub_u32 s15, s15, 1
    s_cbranch_scc1 lr_54
    ds_read_b32 v197, v198
    s_waitcnt lgkmcnt(0)
    v_readfirstlane_b32 s42, v197
    s_nop 3
    s_cmp_ge_u32 s42, 64
    s_cbranch_scc0 lw_53
lr_54:
    ds_read_b64_tr_b16 v[140:141], v189 offset:28416
    ds_read_b64_tr_b16 v[142:143], v189 offset:30464
    s_waitcnt lgkmcnt(8)
    v_mfma_f32_32x32x16_bf16 v[16:31], v[152:155], v[92:95], v[16:31]
    ds_read_b64_tr_b16 v[172:173], v191 offset:27648
    ds_read_b64_tr_b16 v[174:175], v191 offset:27904
    ds_read_b64_tr_b16 v[144:145], v189 offset:28672
    ds_read_b64_tr_b16 v[146:147], v189 offset:30720
    v_mfma_f32_32x32x16_bf16 v[32:47], v[156:159], v[92:95], v[32:47]
    buffer_load_dwordx4 v[128:131], v194, s[28:31], s50 offen offset:2048 sc1
    buffer_load_dwordx4 v[132:135], v194, s[28:31], s50 offen offset:3072 sc1
    s_add_u32 m0, s9, 118784
    ds_read_b64_tr_b16 v[148:149], v189 offset:28928
    ds_read_b64_tr_b16 v[150:151], v189 offset:30976
    s_waitcnt lgkmcnt(10)
    v_mfma_f32_32x32x16_bf16 v[48:63], v[160:163], v[92:95], v[48:63]
    s_add_u32 s10, s11, 0
    buffer_load_dwordx4 v254, s[24:27], s10 offen offset:512 lds
    ds_read_b64_tr_b16 v[152:153], v189 offset:32768
    ds_read_b64_tr_b16 v[154:155], v189 offset:34816
    v_mfma_f32_32x32x16_bf16 v[64:79], v[164:167], v[92:95], v[64:79]
    buffer_load_dwordx4 v12, s[24:27], s10 offen offset:1536 lds
    buffer_load_dwordx4 v13, s[24:27], s10 offen offset:2560 lds
    buffer_load_dwordx4 v14, s[24:27], s10 offen offset:3584 lds
    ds_read_b64_tr_b16 v[156:157], v189 offset:33024
    ds_read_b64_tr_b16 v[158:159], v189 offset:35072
    s_waitcnt lgkmcnt(10)
    v_mfma_f32_32x32x16_bf16 v[16:31], v[136:139], v[96:99], v[16:31]
    v_permlane16_swap_b32 v88, v92
    v_permlane16_swap_b32 v89, v93
    ds_read_b64_tr_b16 v[160:161], v189 offset:33280
    ds_read_b64_tr_b16 v[162:163], v189 offset:35328
    v_mfma_f32_32x32x16_bf16 v[32:47], v[140:143], v[96:99], v[32:47]
    v_permlane16_swap_b32 v90, v94
    v_permlane16_swap_b32 v91, v95
    s_mov_b32 exec_hi, 0
    buffer_load_dwordx4 v253, s[24:27], s10 offen lds
    s_mov_b32 exec_hi, -1
    ds_read_b64_tr_b16 v[164:165], v189 offset:33536
    ds_read_b64_tr_b16 v[166:167], v189 offset:35584
    s_waitcnt lgkmcnt(8)
    v_mfma_f32_32x32x16_bf16 v[48:63], v[144:147], v[96:99], v[48:63]
    v_mfma_f32_16x16x32_bf16 v[80:83], v[168:171], v[88:91], v[80:83]
    v_mfma_f32_16x16x32_bf16 v[84:87], v[168:171], v[92:95], v[84:87]
    ds_read_b64_tr_b16 v[136:137], v188 offset:512
    ds_read_b64_tr_b16 v[138:139], v188 offset:2560
    v_mfma_f32_32x32x16_bf16 v[64:79], v[148:151], v[96:99], v[64:79]
    ds_read_b64_tr_b16 v[168:169], v190 offset:0
    ds_read_b64_tr_b16 v[170:171], v190 offset:256
    s_waitcnt vmcnt(7)
    v_and_b32 v181, v184, v185
    v_and_b32 v182, v186, v187
    v_and_b32 v181, v181, v182
    s_nop 0
    v_readfirstlane_b32 s41, v181
    s_nop 3
    s_cmp_eq_u32 s41, 1
    s_cbranch_scc1 ready_56
    s_mov_b32 s42, 0x8000
spin_55:
    s_sub_u32 s42, s42, 1
    s_cbranch_scc1 ready_56
    s_sleep 1
    buffer_load_dwordx4 v[184:187], off, s[28:31], s51 offset:64 sc1
    s_waitcnt vmcnt(0)
    v_and_b32 v181, v184, v185
    s_nop 4
    v_and_b32 v182, v186, v187
    s_nop 4
    v_and_b32 v181, v181, v182
    s_nop 4
    v_readfirstlane_b32 s41, v181
    s_nop 4
    s_cmp_eq_u32 s41, 1
    s_nop 4
    s_cbranch_scc0 spin_55
ready_56:
    ds_read_b64_tr_b16 v[140:141], v188 offset:768
    ds_read_b64_tr_b16 v[142:143], v188 offset:2816
    s_waitcnt lgkmcnt(10)
    v_mfma_f32_32x32x16_bf16 v[16:31], v[152:155], v[100:103], v[16:31]
    s_mul_i32 s44, s38, 36
    s_mul_i32 s41, s35, 9
    ds_read_b64_tr_b16 v[144:145], v188 offset:1024
    ds_read_b64_tr_b16 v[146:147], v188 offset:3072
    v_mfma_f32_32x32x16_bf16 v[32:47], v[156:159], v[100:103], v[32:47]
    s_add_u32 s44, s44, s41
    s_lshl_b32 s44, s44, 10
    s_add_u32 s44, s44, 0x18c0000
    ds_read_b64_tr_b16 v[148:149], v188 offset:1280
    ds_read_b64_tr_b16 v[150:151], v188 offset:3328
    s_waitcnt lgkmcnt(10)
    v_mfma_f32_32x32x16_bf16 v[48:63], v[160:163], v[100:103], v[48:63]
    ds_add_u32 v202, v203 offset:0
    ds_read_b64_tr_b16 v[152:153], v188 offset:5120
    ds_read_b64_tr_b16 v[154:155], v188 offset:7168
    v_mfma_f32_32x32x16_bf16 v[64:79], v[164:167], v[100:103], v[64:79]
    ds_read_b32 v197, v198
    s_add_u32 s50, s44, 0
    buffer_load_dwordx4 v[88:91], v194, s[28:31], s50 offen offset:0 sc1
    buffer_load_dwordx4 v[92:95], v194, s[28:31], s50 offen offset:1024 sc1
    ds_read_b64_tr_b16 v[156:157], v188 offset:5376
    ds_read_b64_tr_b16 v[158:159], v188 offset:7424
    s_waitcnt lgkmcnt(10)
    v_mfma_f32_32x32x16_bf16 v[16:31], v[136:139], v[104:107], v[16:31]
    v_permlane16_swap_b32 v96, v100
    v_permlane16_swap_b32 v97, v101
    ds_read_b64_tr_b16 v[160:161], v188 offset:5632
    ds_read_b64_tr_b16 v[162:163], v188 offset:7680
    v_mfma_f32_32x32x16_bf16 v[32:47], v[140:143], v[104:107], v[32:47]
    v_permlane16_swap_b32 v98, v102
    v_permlane16_swap_b32 v99, v103
    ds_read_b64_tr_b16 v[164:165], v188 offset:5888
    ds_read_b64_tr_b16 v[166:167], v188 offset:7936
    s_waitcnt lgkmcnt(10)
    v_mfma_f32_32x32x16_bf16 v[48:63], v[144:147], v[104:107], v[48:63]
    v_mfma_f32_16x16x32_bf16 v[80:83], v[172:175], v[96:99], v[80:83]
    v_mfma_f32_16x16x32_bf16 v[84:87], v[172:175], v[100:103], v[84:87]
    ds_read_b64_tr_b16 v[136:137], v188 offset:9728
    ds_read_b64_tr_b16 v[138:139], v188 offset:11776
    v_mfma_f32_32x32x16_bf16 v[64:79], v[148:151], v[104:107], v[64:79]
    s_waitcnt lgkmcnt(8)
    v_readfirstlane_b32 s42, v197
    s_nop 3
    s_cmp_ge_u32 s42, 68
    s_cbranch_scc1 lr_58
    s_mov_b32 s15, 0x80000
lw_57:
    s_sub_u32 s15, s15, 1
    s_cbranch_scc1 lr_58
    ds_read_b32 v197, v198
    s_waitcnt lgkmcnt(0)
    v_readfirstlane_b32 s42, v197
    s_nop 3
    s_cmp_ge_u32 s42, 68
    s_cbranch_scc0 lw_57
lr_58:
    ds_read_b64_tr_b16 v[140:141], v188 offset:9984
    ds_read_b64_tr_b16 v[142:143], v188 offset:12032
    s_waitcnt lgkmcnt(8)
    v_mfma_f32_32x32x16_bf16 v[16:31], v[152:155], v[108:111], v[16:31]
    ds_read_b64_tr_b16 v[172:173], v190 offset:9216
    ds_read_b64_tr_b16 v[174:175], v190 offset:9472
    ds_read_b64_tr_b16 v[144:145], v188 offset:10240
    ds_read_b64_tr_b16 v[146:147], v188 offset:12288
    v_mfma_f32_32x32x16_bf16 v[32:47], v[156:159], v[108:111], v[32:47]
    buffer_load_dwordx4 v[96:99], v194, s[28:31], s50 offen offset:2048 sc1
    buffer_load_dwordx4 v[100:103], v194, s[28:31], s50 offen offset:3072 sc1
    s_add_u32 m0, s9, 137216
    ds_read_b64_tr_b16 v[148:149], v188 offset:10496
    ds_read_b64_tr_b16 v[150:151], v188 offset:12544
    s_waitcnt lgkmcnt(10)
    v_mfma_f32_32x32x16_bf16 v[48:63], v[160:163], v[108:111], v[48:63]
    s_add_u32 s10, s11, 73728
    buffer_load_dwordx4 v254, s[24:27], s10 offen offset:512 lds
    ds_read_b64_tr_b16 v[152:153], v188 offset:14336
    ds_read_b64_tr_b16 v[154:155], v188 offset:16384
    v_mfma_f32_32x32x16_bf16 v[64:79], v[164:167], v[108:111], v[64:79]
    buffer_load_dwordx4 v12, s[24:27], s10 offen offset:1536 lds
    buffer_load_dwordx4 v13, s[24:27], s10 offen offset:2560 lds
    buffer_load_dwordx4 v14, s[24:27], s10 offen offset:3584 lds
    ds_read_b64_tr_b16 v[156:157], v188 offset:14592
    ds_read_b64_tr_b16 v[158:159], v188 offset:16640
    s_waitcnt lgkmcnt(10)
    v_mfma_f32_32x32x16_bf16 v[16:31], v[136:139], v[112:115], v[16:31]
    v_permlane16_swap_b32 v104, v108
    v_permlane16_swap_b32 v105, v109
    ds_read_b64_tr_b16 v[160:161], v188 offset:14848
    ds_read_b64_tr_b16 v[162:163], v188 offset:16896
    v_mfma_f32_32x32x16_bf16 v[32:47], v[140:143], v[112:115], v[32:47]
    v_permlane16_swap_b32 v106, v110
    v_permlane16_swap_b32 v107, v111
    s_mov_b32 exec_hi, 0
    buffer_load_dwordx4 v253, s[24:27], s10 offen lds
    s_mov_b32 exec_hi, -1
    ds_read_b64_tr_b16 v[164:165], v188 offset:15104
    ds_read_b64_tr_b16 v[166:167], v188 offset:17152
    s_waitcnt lgkmcnt(8)
    v_mfma_f32_32x32x16_bf16 v[48:63], v[144:147], v[112:115], v[48:63]
    v_mfma_f32_16x16x32_bf16 v[80:83], v[168:171], v[104:107], v[80:83]
    v_mfma_f32_16x16x32_bf16 v[84:87], v[168:171], v[108:111], v[84:87]
    ds_read_b64_tr_b16 v[136:137], v188 offset:18944
    ds_read_b64_tr_b16 v[138:139], v188 offset:20992
    v_mfma_f32_32x32x16_bf16 v[64:79], v[148:151], v[112:115], v[64:79]
    ds_read_b64_tr_b16 v[168:169], v190 offset:18432
    ds_read_b64_tr_b16 v[170:171], v190 offset:18688
    s_add_u32 s50, s44, 4096
    ds_read_b64_tr_b16 v[140:141], v188 offset:19200
    ds_read_b64_tr_b16 v[142:143], v188 offset:21248
    s_waitcnt lgkmcnt(10)
    v_mfma_f32_32x32x16_bf16 v[16:31], v[152:155], v[116:119], v[16:31]
    buffer_load_dwordx4 v[104:107], v194, s[28:31], s50 offen offset:0 sc1
    buffer_load_dwordx4 v[108:111], v194, s[28:31], s50 offen offset:1024 sc1
    ds_read_b64_tr_b16 v[144:145], v188 offset:19456
    ds_read_b64_tr_b16 v[146:147], v188 offset:21504
    v_mfma_f32_32x32x16_bf16 v[32:47], v[156:159], v[116:119], v[32:47]
    ds_read_b64_tr_b16 v[148:149], v188 offset:19712
    ds_read_b64_tr_b16 v[150:151], v188 offset:21760
    s_waitcnt lgkmcnt(10)
    v_mfma_f32_32x32x16_bf16 v[48:63], v[160:163], v[116:119], v[48:63]
    s_waitcnt vmcnt(11)
    ds_add_u32 v202, v203 offset:0
    ds_read_b64_tr_b16 v[152:153], v188 offset:23552
    ds_read_b64_tr_b16 v[154:155], v188 offset:25600
    v_mfma_f32_32x32x16_bf16 v[64:79], v[164:167], v[116:119], v[64:79]
    ds_read_b32 v197, v198
    ds_read_b64_tr_b16 v[156:157], v188 offset:23808
    ds_read_b64_tr_b16 v[158:159], v188 offset:25856
    s_waitcnt lgkmcnt(10)
    v_mfma_f32_32x32x16_bf16 v[16:31], v[136:139], v[120:123], v[16:31]
    v_permlane16_swap_b32 v112, v116
    v_permlane16_swap_b32 v113, v117
    ds_read_b64_tr_b16 v[160:161], v188 offset:24064
    ds_read_b64_tr_b16 v[162:163], v188 offset:26112
    v_mfma_f32_32x32x16_bf16 v[32:47], v[140:143], v[120:123], v[32:47]
    v_permlane16_swap_b32 v114, v118
    v_permlane16_swap_b32 v115, v119
    ds_read_b64_tr_b16 v[164:165], v188 offset:24320
    ds_read_b64_tr_b16 v[166:167], v188 offset:26368
    s_waitcnt lgkmcnt(10)
    v_mfma_f32_32x32x16_bf16 v[48:63], v[144:147], v[120:123], v[48:63]
    v_mfma_f32_16x16x32_bf16 v[80:83], v[172:175], v[112:115], v[80:83]
    v_mfma_f32_16x16x32_bf16 v[84:87], v[172:175], v[116:119], v[84:87]
    ds_read_b64_tr_b16 v[136:137], v188 offset:28160
    ds_read_b64_tr_b16 v[138:139], v188 offset:30208
    v_mfma_f32_32x32x16_bf16 v[64:79], v[148:151], v[120:123], v[64:79]
    s_waitcnt lgkmcnt(8)
    v_readfirstlane_b32 s42, v197
    s_nop 3
    s_cmp_ge_u32 s42, 72
    s_cbranch_scc1 lr_60
    s_mov_b32 s15, 0x80000
lw_59:
    s_sub_u32 s15, s15, 1
    s_cbranch_scc1 lr_60
    ds_read_b32 v197, v198
    s_waitcnt lgkmcnt(0)
    v_readfirstlane_b32 s42, v197
    s_nop 3
    s_cmp_ge_u32 s42, 72
    s_cbranch_scc0 lw_59
lr_60:
    ds_read_b64_tr_b16 v[140:141], v188 offset:28416
    ds_read_b64_tr_b16 v[142:143], v188 offset:30464
    s_waitcnt lgkmcnt(8)
    v_mfma_f32_32x32x16_bf16 v[16:31], v[152:155], v[124:127], v[16:31]
    ds_read_b64_tr_b16 v[172:173], v190 offset:27648
    ds_read_b64_tr_b16 v[174:175], v190 offset:27904
    ds_read_b64_tr_b16 v[144:145], v188 offset:28672
    ds_read_b64_tr_b16 v[146:147], v188 offset:30720
    v_mfma_f32_32x32x16_bf16 v[32:47], v[156:159], v[124:127], v[32:47]
    buffer_load_dwordx4 v[112:115], v194, s[28:31], s50 offen offset:2048 sc1
    buffer_load_dwordx4 v[116:119], v194, s[28:31], s50 offen offset:3072 sc1
    s_add_u32 m0, s9, 81920
    ds_read_b64_tr_b16 v[148:149], v188 offset:28928
    ds_read_b64_tr_b16 v[150:151], v188 offset:30976
    s_waitcnt lgkmcnt(10)
    v_mfma_f32_32x32x16_bf16 v[48:63], v[160:163], v[124:127], v[48:63]
    s_add_u32 s10, s11, 147456
    buffer_load_dwordx4 v254, s[24:27], s10 offen offset:512 lds
    ds_read_b64_tr_b16 v[152:153], v188 offset:32768
    ds_read_b64_tr_b16 v[154:155], v188 offset:34816
    v_mfma_f32_32x32x16_bf16 v[64:79], v[164:167], v[124:127], v[64:79]
    buffer_load_dwordx4 v12, s[24:27], s10 offen offset:1536 lds
    buffer_load_dwordx4 v13, s[24:27], s10 offen offset:2560 lds
    buffer_load_dwordx4 v14, s[24:27], s10 offen offset:3584 lds
    ds_read_b64_tr_b16 v[156:157], v188 offset:33024
    ds_read_b64_tr_b16 v[158:159], v188 offset:35072
    s_waitcnt lgkmcnt(10)
    v_mfma_f32_32x32x16_bf16 v[16:31], v[136:139], v[128:131], v[16:31]
    v_permlane16_swap_b32 v120, v124
    v_permlane16_swap_b32 v121, v125
    ds_read_b64_tr_b16 v[160:161], v188 offset:33280
    ds_read_b64_tr_b16 v[162:163], v188 offset:35328
    v_mfma_f32_32x32x16_bf16 v[32:47], v[140:143], v[128:131], v[32:47]
    v_permlane16_swap_b32 v122, v126
    v_permlane16_swap_b32 v123, v127
    s_mov_b32 exec_hi, 0
    buffer_load_dwordx4 v253, s[24:27], s10 offen lds
    s_mov_b32 exec_hi, -1
    ds_read_b64_tr_b16 v[164:165], v188 offset:33536
    ds_read_b64_tr_b16 v[166:167], v188 offset:35584
    s_waitcnt lgkmcnt(8)
    v_mfma_f32_32x32x16_bf16 v[48:63], v[144:147], v[128:131], v[48:63]
    v_mfma_f32_16x16x32_bf16 v[80:83], v[168:171], v[120:123], v[80:83]
    v_mfma_f32_16x16x32_bf16 v[84:87], v[168:171], v[124:127], v[84:87]
    ds_read_b64_tr_b16 v[136:137], v189 offset:512
    ds_read_b64_tr_b16 v[138:139], v189 offset:2560
    v_mfma_f32_32x32x16_bf16 v[64:79], v[148:151], v[128:131], v[64:79]
    ds_read_b64_tr_b16 v[168:169], v191 offset:0
    ds_read_b64_tr_b16 v[170:171], v191 offset:256
    s_add_u32 s50, s44, 8192
    ds_read_b64_tr_b16 v[140:141], v189 offset:768
    ds_read_b64_tr_b16 v[142:143], v189 offset:2816
    s_waitcnt lgkmcnt(10)
    v_mfma_f32_32x32x16_bf16 v[16:31], v[152:155], v[132:135], v[16:31]
    buffer_load_dwordx4 v[120:123], v194, s[28:31], s50 offen offset:0 sc1
    ds_read_b64_tr_b16 v[144:145], v189 offset:1024
    ds_read_b64_tr_b16 v[146:147], v189 offset:3072
    v_mfma_f32_32x32x16_bf16 v[32:47], v[156:159], v[132:135], v[32:47]
    ds_read_b64_tr_b16 v[148:149], v189 offset:1280
    ds_read_b64_tr_b16 v[150:151], v189 offset:3328
    s_waitcnt lgkmcnt(10)
    v_mfma_f32_32x32x16_bf16 v[48:63], v[160:163], v[132:135], v[48:63]
    s_waitcnt vmcnt(10)
    ds_add_u32 v202, v203 offset:0
    ds_read_b64_tr_b16 v[152:153], v189 offset:5120
    ds_read_b64_tr_b16 v[154:155], v189 offset:7168
    v_mfma_f32_32x32x16_bf16 v[64:79], v[164:167], v[132:135], v[64:79]
    ds_read_b32 v197, v198
    v_permlane16_swap_b32 v128, v132
    v_permlane16_swap_b32 v129, v133
    v_permlane16_swap_b32 v130, v134
    v_permlane16_swap_b32 v131, v135
    s_nop 1
    v_mfma_f32_16x16x32_bf16 v[80:83], v[172:175], v[128:131], v[80:83]
    v_mfma_f32_16x16x32_bf16 v[84:87], v[172:175], v[132:135], v[84:87]
    v_mul_f32 v16, v16, v255
    v_mul_f32 v17, v17, v255
    v_mul_f32 v18, v18, v255
    v_mul_f32 v19, v19, v255
    v_mul_f32 v20, v20, v255
    v_mul_f32 v21, v21, v255
    v_mul_f32 v22, v22, v255
    v_mul_f32 v23, v23, v255
    v_mul_f32 v24, v24, v255
    v_mul_f32 v25, v25, v255
    v_mul_f32 v26, v26, v255
    v_mul_f32 v27, v27, v255
    v_mul_f32 v28, v28, v255
    v_mul_f32 v29, v29, v255
    v_mul_f32 v30, v30, v255
    v_mul_f32 v31, v31, v255
    v_mul_f32 v32, v32, v255
    v_mul_f32 v33, v33, v255
    v_mul_f32 v34, v34, v255
    v_mul_f32 v35, v35, v255
    v_mul_f32 v36, v36, v255
    v_mul_f32 v37, v37, v255
    v_mul_f32 v38, v38, v255
    v_mul_f32 v39, v39, v255
    v_mul_f32 v40, v40, v255
    v_mul_f32 v41, v41, v255
    v_mul_f32 v42, v42, v255
    v_mul_f32 v43, v43, v255
    v_mul_f32 v44, v44, v255
    v_mul_f32 v45, v45, v255
    v_mul_f32 v46, v46, v255
    v_mul_f32 v47, v47, v255
    v_mul_f32 v48, v48, v255
    v_mul_f32 v49, v49, v255
    v_mul_f32 v50, v50, v255
    v_mul_f32 v51, v51, v255
    v_mul_f32 v52, v52, v255
    v_mul_f32 v53, v53, v255
    v_mul_f32 v54, v54, v255
    v_mul_f32 v55, v55, v255
    v_mul_f32 v56, v56, v255
    v_mul_f32 v57, v57, v255
    v_mul_f32 v58, v58, v255
    v_mul_f32 v59, v59, v255
    v_mul_f32 v60, v60, v255
    v_mul_f32 v61, v61, v255
    v_mul_f32 v62, v62, v255
    v_mul_f32 v63, v63, v255
    v_mul_f32 v64, v64, v255
    v_mul_f32 v65, v65, v255
    v_mul_f32 v66, v66, v255
    v_mul_f32 v67, v67, v255
    v_mul_f32 v68, v68, v255
    v_mul_f32 v69, v69, v255
    v_mul_f32 v70, v70, v255
    v_mul_f32 v71, v71, v255
    v_mul_f32 v72, v72, v255
    v_mul_f32 v73, v73, v255
    v_mul_f32 v74, v74, v255
    v_mul_f32 v75, v75, v255
    v_mul_f32 v76, v76, v255
    v_mul_f32 v77, v77, v255
    v_mul_f32 v78, v78, v255
    v_mul_f32 v79, v79, v255
    v_mul_f32 v80, v80, v192
    v_mul_f32 v81, v81, v192
    v_mul_f32 v82, v82, v192
    v_mul_f32 v83, v83, v192
    v_mul_f32 v84, v84, v193
    v_mul_f32 v85, v85, v193
    v_mul_f32 v86, v86, v193
    v_mul_f32 v87, v87, v193
    ds_read_b64_tr_b16 v[156:157], v189 offset:5376
    ds_read_b64_tr_b16 v[158:159], v189 offset:7424
    s_waitcnt lgkmcnt(10)
    v_mfma_f32_32x32x16_bf16 v[16:31], v[136:139], v[88:91], v[16:31]
    ds_read_b64_tr_b16 v[160:161], v189 offset:5632
    ds_read_b64_tr_b16 v[162:163], v189 offset:7680
    v_mfma_f32_32x32x16_bf16 v[32:47], v[140:143], v[88:91], v[32:47]
    ds_read_b64_tr_b16 v[164:165], v189 offset:5888
    ds_read_b64_tr_b16 v[166:167], v189 offset:7936
    s_waitcnt lgkmcnt(10)
    v_mfma_f32_32x32x16_bf16 v[48:63], v[144:147], v[88:91], v[48:63]
    ds_read_b64_tr_b16 v[136:137], v189 offset:9728
    ds_read_b64_tr_b16 v[138:139], v189 offset:11776
    v_mfma_f32_32x32x16_bf16 v[64:79], v[148:151], v[88:91], v[64:79]
    s_waitcnt lgkmcnt(8)
    v_readfirstlane_b32 s42, v197
    s_nop 3
    s_cmp_ge_u32 s42, 76
    s_cbranch_scc1 lr_62
    s_mov_b32 s15, 0x80000
lw_61:
    s_sub_u32 s15, s15, 1
    s_cbranch_scc1 lr_62
    ds_read_b32 v197, v198
    s_waitcnt lgkmcnt(0)
    v_readfirstlane_b32 s42, v197
    s_nop 3
    s_cmp_ge_u32 s42, 76
    s_cbranch_scc0 lw_61
lr_62:
    ds_read_b64_tr_b16 v[140:141], v189 offset:9984
    ds_read_b64_tr_b16 v[142:143], v189 offset:12032
    s_waitcnt lgkmcnt(8)
    v_mfma_f32_32x32x16_bf16 v[16:31], v[152:155], v[92:95], v[16:31]
    ds_read_b64_tr_b16 v[172:173], v191 offset:9216
    ds_read_b64_tr_b16 v[174:175], v191 offset:9472
    ds_read_b64_tr_b16 v[144:145], v189 offset:10240
    ds_read_b64_tr_b16 v[146:147], v189 offset:12288
    v_mfma_f32_32x32x16_bf16 v[32:47], v[156:159], v[92:95], v[32:47]
    ds_read_b64_tr_b16 v[148:149], v189 offset:10496
    ds_read_b64_tr_b16 v[150:151], v189 offset:12544
    s_waitcnt lgkmcnt(10)
    v_mfma_f32_32x32x16_bf16 v[48:63], v[160:163], v[92:95], v[48:63]
    ds_read_b64_tr_b16 v[152:153], v189 offset:14336
    ds_read_b64_tr_b16 v[154:155], v189 offset:16384
    v_mfma_f32_32x32x16_bf16 v[64:79], v[164:167], v[92:95], v[64:79]
    ds_read_b64_tr_b16 v[156:157], v189 offset:14592
    ds_read_b64_tr_b16 v[158:159], v189 offset:16640
    s_waitcnt lgkmcnt(10)
    v_mfma_f32_32x32x16_bf16 v[16:31], v[136:139], v[96:99], v[16:31]
    v_permlane16_swap_b32 v88, v92
    v_permlane16_swap_b32 v89, v93
    ds_read_b64_tr_b16 v[160:161], v189 offset:14848
    ds_read_b64_tr_b16 v[162:163], v189 offset:16896
    v_mfma_f32_32x32x16_bf16 v[32:47], v[140:143], v[96:99], v[32:47]
    v_permlane16_swap_b32 v90, v94
    v_permlane16_swap_b32 v91, v95
    ds_read_b64_tr_b16 v[164:165], v189 offset:15104
    ds_read_b64_tr_b16 v[166:167], v189 offset:17152
    s_waitcnt lgkmcnt(8)
    v_mfma_f32_32x32x16_bf16 v[48:63], v[144:147], v[96:99], v[48:63]
    v_mfma_f32_16x16x32_bf16 v[80:83], v[168:171], v[88:91], v[80:83]
    v_mfma_f32_16x16x32_bf16 v[84:87], v[168:171], v[92:95], v[84:87]
    ds_read_b64_tr_b16 v[136:137], v189 offset:18944
    ds_read_b64_tr_b16 v[138:139], v189 offset:20992
    v_mfma_f32_32x32x16_bf16 v[64:79], v[148:151], v[96:99], v[64:79]
    ds_read_b64_tr_b16 v[168:169], v191 offset:18432
    ds_read_b64_tr_b16 v[170:171], v191 offset:18688
    ds_read_b64_tr_b16 v[140:141], v189 offset:19200
    ds_read_b64_tr_b16 v[142:143], v189 offset:21248
    s_waitcnt lgkmcnt(10)
    v_mfma_f32_32x32x16_bf16 v[16:31], v[152:155], v[100:103], v[16:31]
    ds_read_b64_tr_b16 v[144:145], v189 offset:19456
    ds_read_b64_tr_b16 v[146:147], v189 offset:21504
    v_mfma_f32_32x32x16_bf16 v[32:47], v[156:159], v[100:103], v[32:47]
    ds_read_b64_tr_b16 v[148:149], v189 offset:19712
    ds_read_b64_tr_b16 v[150:151], v189 offset:21760
    s_waitcnt lgkmcnt(10)
    v_mfma_f32_32x32x16_bf16 v[48:63], v[160:163], v[100:103], v[48:63]
    s_waitcnt vmcnt(1)
    ds_add_u32 v202, v203 offset:0
    ds_read_b64_tr_b16 v[152:153], v189 offset:23552
    ds_read_b64_tr_b16 v[154:155], v189 offset:25600
    v_mfma_f32_32x32x16_bf16 v[64:79], v[164:167], v[100:103], v[64:79]
    ds_read_b32 v197, v198
    ds_read_b64_tr_b16 v[156:157], v189 offset:23808
    ds_read_b64_tr_b16 v[158:159], v189 offset:25856
    s_waitcnt lgkmcnt(10)
    v_mfma_f32_32x32x16_bf16 v[16:31], v[136:139], v[104:107], v[16:31]
    v_permlane16_swap_b32 v96, v100
    v_permlane16_swap_b32 v97, v101
    ds_read_b64_tr_b16 v[160:161], v189 offset:24064
    ds_read_b64_tr_b16 v[162:163], v189 offset:26112
    v_mfma_f32_32x32x16_bf16 v[32:47], v[140:143], v[104:107], v[32:47]
    v_permlane16_swap_b32 v98, v102
    v_permlane16_swap_b32 v99, v103
    ds_read_b64_tr_b16 v[164:165], v189 offset:24320
    ds_read_b64_tr_b16 v[166:167], v189 offset:26368
    s_waitcnt lgkmcnt(10)
    v_mfma_f32_32x32x16_bf16 v[48:63], v[144:147], v[104:107], v[48:63]
    v_mfma_f32_16x16x32_bf16 v[80:83], v[172:175], v[96:99], v[80:83]
    v_mfma_f32_16x16x32_bf16 v[84:87], v[172:175], v[100:103], v[84:87]
    ds_read_b64_tr_b16 v[136:137], v189 offset:28160
    ds_read_b64_tr_b16 v[138:139], v189 offset:30208
    v_mfma_f32_32x32x16_bf16 v[64:79], v[148:151], v[104:107], v[64:79]
    s_waitcnt lgkmcnt(8)
    v_readfirstlane_b32 s42, v197
    s_nop 3
    s_cmp_ge_u32 s42, 80
    s_cbranch_scc1 lr_64
    s_mov_b32 s15, 0x80000
lw_63:
    s_sub_u32 s15, s15, 1
    s_cbranch_scc1 lr_64
    ds_read_b32 v197, v198
    s_waitcnt lgkmcnt(0)
    v_readfirstlane_b32 s42, v197
    s_nop 3
    s_cmp_ge_u32 s42, 80
    s_cbranch_scc0 lw_63
lr_64:
    ds_read_b64_tr_b16 v[140:141], v189 offset:28416
    ds_read_b64_tr_b16 v[142:143], v189 offset:30464
    s_waitcnt lgkmcnt(8)
    v_mfma_f32_32x32x16_bf16 v[16:31], v[152:155], v[108:111], v[16:31]
    ds_read_b64_tr_b16 v[172:173], v191 offset:27648
    ds_read_b64_tr_b16 v[174:175], v191 offset:27904
    ds_read_b64_tr_b16 v[144:145], v189 offset:28672
    ds_read_b64_tr_b16 v[146:147], v189 offset:30720
    v_mfma_f32_32x32x16_bf16 v[32:47], v[156:159], v[108:111], v[32:47]
    ds_read_b64_tr_b16 v[148:149], v189 offset:28928
    ds_read_b64_tr_b16 v[150:151], v189 offset:30976
    s_waitcnt lgkmcnt(10)
    v_mfma_f32_32x32x16_bf16 v[48:63], v[160:163], v[108:111], v[48:63]
    ds_read_b64_tr_b16 v[152:153], v189 offset:32768
    ds_read_b64_tr_b16 v[154:155], v189 offset:34816
    v_mfma_f32_32x32x16_bf16 v[64:79], v[164:167], v[108:111], v[64:79]
    ds_read_b64_tr_b16 v[156:157], v189 offset:33024
    ds_read_b64_tr_b16 v[158:159], v189 offset:35072
    s_waitcnt lgkmcnt(10)
    v_mfma_f32_32x32x16_bf16 v[16:31], v[136:139], v[112:115], v[16:31]
    v_permlane16_swap_b32 v104, v108
    v_permlane16_swap_b32 v105, v109
    ds_read_b64_tr_b16 v[160:161], v189 offset:33280
    ds_read_b64_tr_b16 v[162:163], v189 offset:35328
    v_mfma_f32_32x32x16_bf16 v[32:47], v[140:143], v[112:115], v[32:47]
    v_permlane16_swap_b32 v106, v110
    v_permlane16_swap_b32 v107, v111
    ds_read_b64_tr_b16 v[164:165], v189 offset:33536
    ds_read_b64_tr_b16 v[166:167], v189 offset:35584
    s_waitcnt lgkmcnt(8)
    v_mfma_f32_32x32x16_bf16 v[48:63], v[144:147], v[112:115], v[48:63]
    v_mfma_f32_16x16x32_bf16 v[80:83], v[168:171], v[104:107], v[80:83]
    v_mfma_f32_16x16x32_bf16 v[84:87], v[168:171], v[108:111], v[84:87]
    ds_read_b64_tr_b16 v[136:137], v188 offset:512
    ds_read_b64_tr_b16 v[138:139], v188 offset:2560
    v_mfma_f32_32x32x16_bf16 v[64:79], v[148:151], v[112:115], v[64:79]
    ds_read_b64_tr_b16 v[168:169], v190 offset:0
    ds_read_b64_tr_b16 v[170:171], v190 offset:256
    ds_read_b64_tr_b16 v[140:141], v188 offset:768
    ds_read_b64_tr_b16 v[142:143], v188 offset:2816
    s_waitcnt lgkmcnt(10)
    v_mfma_f32_32x32x16_bf16 v[16:31], v[152:155], v[116:119], v[16:31]
    ds_read_b64_tr_b16 v[144:145], v188 offset:1024
    ds_read_b64_tr_b16 v[146:147], v188 offset:3072
    v_mfma_f32_32x32x16_bf16 v[32:47], v[156:159], v[116:119], v[32:47]
    ds_read_b64_tr_b16 v[148:149], v188 offset:1280
    ds_read_b64_tr_b16 v[150:151], v188 offset:3328
    s_waitcnt lgkmcnt(10)
    v_mfma_f32_32x32x16_bf16 v[48:63], v[160:163], v[116:119], v[48:63]
    v_mfma_f32_32x32x16_bf16 v[64:79], v[164:167], v[116:119], v[64:79]
    ds_read_b32 v197, v198
    s_waitcnt lgkmcnt(5)
    s_waitcnt vmcnt(0)
    v_mfma_f32_32x32x16_bf16 v[16:31], v[136:139], v[120:123], v[16:31]
    v_permlane16_swap_b32 v112, v116
    v_permlane16_swap_b32 v113, v117
    v_mfma_f32_32x32x16_bf16 v[32:47], v[140:143], v[120:123], v[32:47]
    v_permlane16_swap_b32 v114, v118
    v_permlane16_swap_b32 v115, v119
    s_waitcnt lgkmcnt(1)
    v_mfma_f32_32x32x16_bf16 v[48:63], v[144:147], v[120:123], v[48:63]
    v_mfma_f32_16x16x32_bf16 v[80:83], v[172:175], v[112:115], v[80:83]
    v_mfma_f32_16x16x32_bf16 v[84:87], v[172:175], v[116:119], v[84:87]
    v_mfma_f32_32x32x16_bf16 v[64:79], v[148:151], v[120:123], v[64:79]
    v_permlane16_swap_b32 v120, v176
    v_permlane16_swap_b32 v121, v177
    v_permlane16_swap_b32 v122, v178
    v_permlane16_swap_b32 v123, v179
    s_nop 1
    v_mfma_f32_16x16x32_bf16 v[80:83], v[168:171], v[120:123], v[80:83]
    v_mfma_f32_16x16x32_bf16 v[84:87], v[168:171], v[176:179], v[84:87]
    s_waitcnt lgkmcnt(0)
    ds_read_b32 v197, v198 offset:4
    s_waitcnt lgkmcnt(0)
    v_readfirstlane_b32 s42, v197
    s_nop 3
    s_cmp_ge_u32 s42, 16
    s_cbranch_scc1 lr_66
    s_mov_b32 s15, 0x80000
lw_65:
    s_sub_u32 s15, s15, 1
    s_cbranch_scc1 lr_66
    ds_read_b32 v197, v198 offset:4
    s_waitcnt lgkmcnt(0)
    v_readfirstlane_b32 s42, v197
    s_nop 3
    s_cmp_ge_u32 s42, 16
    s_cbranch_scc0 lw_65
lr_66:
    s_lshl_b32 s40, s36, 2
    s_add_u32 s40, s40, s37
    s_lshl_b32 s40, s40, 2
    s_add_u32 s40, s40, s33
    s_lshl_b32 s40, s40, 2
    s_add_u32 s40, s40, s35
    s_mul_i32 s40, s40, 9216
    s_add_u32 s40, s40, 0x1b00000
    s_cmp_eq_u32 s33, s35
    s_cselect_b32 s40, 0x40000000, s40
    s_add_u32 s41, s40, 4096
    s_mul_i32 s42, s33, 9216
    v_add_u32 v180, s42, v194
    v_add_u32 v181, s42, v200
    v_cvt_pk_bf16_f32 v16, v16, v17
    v_cvt_pk_bf16_f32 v17, v18, v19
    v_cvt_pk_bf16_f32 v18, v20, v21
    v_cvt_pk_bf16_f32 v19, v22, v23
    buffer_store_dwordx4 v[16:19], v194, s[28:31], s40 offen offset:0 sc1
    ds_write_b128 v180, v[16:19] offset:0
    v_cvt_pk_bf16_f32 v24, v24, v25
    v_cvt_pk_bf16_f32 v25, v26, v27
    v_cvt_pk_bf16_f32 v26, v28, v29
    v_cvt_pk_bf16_f32 v27, v30, v31
    buffer_store_dwordx4 v[24:27], v194, s[28:31], s40 offen offset:1024 sc1
    ds_write_b128 v180, v[24:27] offset:1024
    v_cvt_pk_bf16_f32 v32, v32, v33
    v_cvt_pk_bf16_f32 v33, v34, v35
    v_cvt_pk_bf16_f32 v34, v36, v37
    v_cvt_pk_bf16_f32 v35, v38, v39
    buffer_store_dwordx4 v[32:35], v194, s[28:31], s40 offen offset:2048 sc1
    ds_write_b128 v180, v[32:35] offset:2048
    v_cvt_pk_bf16_f32 v40, v40, v41
    v_cvt_pk_bf16_f32 v41, v42, v43
    v_cvt_pk_bf16_f32 v42, v44, v45
    v_cvt_pk_bf16_f32 v43, v46, v47
    buffer_store_dwordx4 v[40:43], v194, s[28:31], s40 offen offset:3072 sc1
    ds_write_b128 v180, v[40:43] offset:3072
    v_cvt_pk_bf16_f32 v48, v48, v49
    v_cvt_pk_bf16_f32 v49, v50, v51
    v_cvt_pk_bf16_f32 v50, v52, v53
    v_cvt_pk_bf16_f32 v51, v54, v55
    buffer_store_dwordx4 v[48:51], v194, s[28:31], s41 offen offset:0 sc1
    ds_write_b128 v180, v[48:51] offset:4096
    v_cvt_pk_bf16_f32 v56, v56, v57
    v_cvt_pk_bf16_f32 v57, v58, v59
    v_cvt_pk_bf16_f32 v58, v60, v61
    v_cvt_pk_bf16_f32 v59, v62, v63
    buffer_store_dwordx4 v[56:59], v194, s[28:31], s41 offen offset:1024 sc1
    ds_write_b128 v180, v[56:59] offset:5120
    v_cvt_pk_bf16_f32 v64, v64, v65
    v_cvt_pk_bf16_f32 v65, v66, v67
    v_cvt_pk_bf16_f32 v66, v68, v69
    v_cvt_pk_bf16_f32 v67, v70, v71
    buffer_store_dwordx4 v[64:67], v194, s[28:31], s41 offen offset:2048 sc1
    ds_write_b128 v180, v[64:67] offset:6144
    v_cvt_pk_bf16_f32 v72, v72, v73
    v_cvt_pk_bf16_f32 v73, v74, v75
    v_cvt_pk_bf16_f32 v74, v76, v77
    v_cvt_pk_bf16_f32 v75, v78, v79
    buffer_store_dwordx4 v[72:75], v194, s[28:31], s41 offen offset:3072 sc1
    ds_write_b128 v180, v[72:75] offset:7168
    s_add_u32 s41, s41, 4096
    v_cvt_pk_bf16_f32 v80, v80, v81
    v_cvt_pk_bf16_f32 v81, v82, v83
    buffer_store_dwordx2 v[80:81], v200, s[28:31], s41 offen offset:0 sc1
    ds_write_b64 v181, v[80:81] offset:8192
    v_cvt_pk_bf16_f32 v84, v84, v85
    v_cvt_pk_bf16_f32 v85, v86, v87
    buffer_store_dwordx2 v[84:85], v200, s[28:31], s41 offen offset:256 sc1
    ds_write_b64 v181, v[84:85] offset:8448
    s_waitcnt lgkmcnt(0)
    ds_add_u32 v202, v203 offset:12
    s_lshl_b32 s40, s36, 2
    s_add_u32 s40, s40, s37
    s_lshl_b32 s40, s40, 2
    s_add_u32 s40, s40, s33
    s_lshl_b32 s40, s40, 5
    s_add_u32 s40, s40, s35
    s_lshl_b32 s40, s40, 2
    s_add_u32 s40, s40, 0x2d62000
    s_waitcnt vmcnt(0)
    s_mov_b64 exec, 1
    buffer_store_dword v199, off, s[28:31], s40 sc1
    s_mov_b64 exec, -1
    s_endpgm
p2_attn:
    v_and_b32 v233, 63, v0
    v_lshlrev_b32 v234, 4, v233
    v_mov_b32 v237, 163328
    v_mov_b32 v238, 1
    s_mul_i32 s44, s35, 9
    s_lshl_b32 s40, s37, 1
    s_add_u32 s44, s44, s40
    s_mul_i32 s40, s33, 3
    s_lshl_b32 s41, s36, 2
    s_add_u32 s40, s40, s41
    s_add_i32 s40, s40, -8
    s_mul_i32 s41, s40, 108
    s_add_u32 s41, s41, s44
    s_lshl_b32 s41, s41, 10
    s_add_u32 s41, s41, 0x1209000
    s_cmp_lt_i32 s40, 0
    s_cselect_b32 s47, 0x40000000, s41
    s_mul_i32 s40, s33, 3
    s_lshl_b32 s41, s36, 2
    s_add_u32 s40, s40, s41
    s_add_i32 s40, s40, -7
    s_mul_i32 s41, s40, 108
    s_add_u32 s41, s41, s44
    s_lshl_b32 s41, s41, 10
    s_add_u32 s41, s41, 0x1209000
    s_cmp_lt_i32 s40, 0
    s_cselect_b32 s48, 0x40000000, s41
    s_mul_i32 s40, s33, 3
    s_lshl_b32 s41, s36, 2
    s_add_u32 s40, s40, s41
    s_add_i32 s40, s40, -6
    s_mul_i32 s41, s40, 108
    s_add_u32 s41, s41, s44
    s_lshl_b32 s41, s41, 10
    s_add_u32 s41, s41, 0x1209000
    s_cmp_lt_i32 s40, 0
    s_cselect_b32 s49, 0x40000000, s41
    s_waitcnt vmcnt(2)
    v_mov_b32 v224, 0x01010101
    v_cmp_ne_u32 vcc, v253, v224
    v_cmp_ne_u32 s[52:53], 7, v254
    s_nop 3
    s_or_b64 vcc, vcc, s[52:53]
    s_cmp_eq_u64 vcc, 0
    s_cbranch_scc1 aok_67
    s_mov_b32 s42, 0x8000
asp_68:
    v_and_b32 v226, 63, v0
    v_min_u32 v225, 11, v226
    v_lshrrev_b32 v227, 2, v225
    s_sub_u32 s40, s36, 2
    v_add_u32 v227, s40, v227
    v_max_i32 v227, 0, v227
    v_and_b32 v225, 3, v225
    v_lshlrev_b32 v227, 9, v227
    v_lshl_add_u32 v227, v225, 7, v227
    v_add_u32 v227, 0x2d6000c, v227
    v_lshlrev_b32 v226, 2, v226
    buffer_load_dword v253, v226, s[4:7], 0 offen sc1
    buffer_load_dword v254, v227, s[28:31], 0 offen sc1
    s_waitcnt vmcnt(0)
    v_mov_b32 v224, 0x01010101
    s_nop 4
    v_cmp_ne_u32 vcc, v253, v224
    s_nop 4
    v_cmp_ne_u32 s[52:53], 7, v254
    s_nop 4
    s_or_b64 vcc, vcc, s[52:53]
    s_nop 4
    s_cmp_eq_u64 vcc, 0
    s_nop 4
    s_cbranch_scc1 aok_67
    s_sleep 2
    s_sub_u32 s42, s42, 1
    s_cbranch_scc0 asp_68
aok_67:
    buffer_load_dwordx4 v[20:23], v234, s[28:31], s47 offen offset:0 sc1
    buffer_load_dwordx4 v[24:27], v234, s[28:31], s47 offen offset:1024 sc1
    buffer_load_dwordx4 v[28:31], v234, s[28:31], s47 offen offset:2048 sc1
    buffer_load_dwordx4 v[32:35], v234, s[28:31], s48 offen offset:0 sc1
    buffer_load_dwordx4 v[36:39], v234, s[28:31], s48 offen offset:1024 sc1
    buffer_load_dwordx4 v[40:43], v234, s[28:31], s48 offen offset:2048 sc1
    buffer_load_dwordx4 v[44:47], v234, s[28:31], s49 offen offset:0 sc1
    buffer_load_dwordx4 v[48:51], v234, s[28:31], s49 offen offset:1024 sc1
    buffer_load_dwordx4 v[52:55], v234, s[28:31], s49 offen offset:2048 sc1
    s_mul_i32 s40, s38, 108
    s_add_u32 s40, s40, s44
    s_lshl_b32 s40, s40, 10
    s_add_u32 s40, s40, 0x1200000
    buffer_load_dwordx4 v[188:191], v234, s[28:31], s40 offen offset:0 sc1
    buffer_load_dwordx4 v[192:195], v234, s[28:31], s40 offen offset:1024 sc1
    buffer_load_dwordx4 v[196:199], v234, s[28:31], s40 offen offset:2048 sc1
    s_add_u32 s40, s47, 36864
    buffer_load_dwordx4 v[84:87], v234, s[28:31], s40 offen offset:0 sc1
    buffer_load_dwordx4 v[88:91], v234, s[28:31], s40 offen offset:1024 sc1
    buffer_load_dwordx4 v[92:95], v234, s[28:31], s40 offen offset:2048 sc1
    s_add_u32 s40, s48, 36864
    buffer_load_dwordx4 v[96:99], v234, s[28:31], s40 offen offset:0 sc1
    buffer_load_dwordx4 v[100:103], v234, s[28:31], s40 offen offset:1024 sc1
    buffer_load_dwordx4 v[104:107], v234, s[28:31], s40 offen offset:2048 sc1
    s_add_u32 s40, s49, 36864
    buffer_load_dwordx4 v[108:111], v234, s[28:31], s40 offen offset:0 sc1
    buffer_load_dwordx4 v[112:115], v234, s[28:31], s40 offen offset:1024 sc1
    buffer_load_dwordx4 v[116:119], v234, s[28:31], s40 offen offset:2048 sc1
    v_and_b32 v224, 31, v233
    v_lshrrev_b32 v229, 5, v233
    v_lshlrev_b32 v239, 5, v224
    v_lshl_add_u32 v239, v229, 4, v239
    s_mul_i32 s40, s33, 10752
    s_add_u32 s40, s40, 36864
    v_add_u32 v239, s40, v239
    v_lshlrev_b32 v229, 2, v229
    v_sub_u32 v224, v224, v229
    v_cmp_le_i32 s[56:57], 0, v224
    v_cmp_le_i32 s[58:59], 1, v224
    v_cmp_le_i32 s[60:61], 2, v224
    v_cmp_le_i32 s[62:63], 3, v224
    v_cmp_le_i32 s[64:65], 8, v224
    v_cmp_le_i32 s[66:67], 9, v224
    v_cmp_le_i32 s[68:69], 10, v224
    v_cmp_le_i32 s[70:71], 11, v224
    v_cmp_le_i32 s[72:73], 16, v224
    v_cmp_le_i32 s[74:75], 17, v224
    v_cmp_le_i32 s[76:77], 18, v224
    v_cmp_le_i32 s[78:79], 19, v224
    v_cmp_le_i32 s[80:81], 24, v224
    v_cmp_le_i32 s[82:83], 25, v224
    v_cmp_le_i32 s[84:85], 26, v224
    v_cmp_le_i32 s[86:87], 27, v224
    v_mov_b32 v225, 0xffff
    v_mov_b32 v226, 0xffff0000
    v_cndmask_b32 v208, 0, v225, s[56:57]
    v_cndmask_b32 v227, 0, v226, s[58:59]
    v_or_b32 v208, v208, v227
    v_cndmask_b32 v209, 0, v225, s[60:61]
    v_cndmask_b32 v227, 0, v226, s[62:63]
    v_or_b32 v209, v209, v227
    v_cndmask_b32 v210, 0, v225, s[64:65]
    v_cndmask_b32 v227, 0, v226, s[66:67]
    v_or_b32 v210, v210, v227
    v_cndmask_b32 v211, 0, v225, s[68:69]
    v_cndmask_b32 v227, 0, v226, s[70:71]
    v_or_b32 v211, v211, v227
    v_cndmask_b32 v212, 0, v225, s[72:73]
    v_cndmask_b32 v227, 0, v226, s[74:75]
    v_or_b32 v212, v212, v227
    v_cndmask_b32 v213, 0, v225, s[76:77]
    v_cndmask_b32 v227, 0, v226, s[78:79]
    v_or_b32 v213, v213, v227
    v_cndmask_b32 v214, 0, v225, s[80:81]
    v_cndmask_b32 v227, 0, v226, s[82:83]
    v_or_b32 v214, v214, v227
    v_cndmask_b32 v215, 0, v225, s[84:85]
    v_cndmask_b32 v227, 0, v226, s[86:87]
    v_or_b32 v215, v215, v227
    s_mul_i32 s40, s33, 3072
    v_add_u32 v228, s40, v234
    v_bfe_u32 v224, v233, 2, 2
    v_add_u32 v224, v224, v229
    v_lshlrev_b32 v230, 5, v224
    v_and_b32 v224, 1, v233
    v_lshl_add_u32 v230, v224, 4, v230
    v_bfe_u32 v224, v233, 1, 1
    v_lshl_add_u32 v230, v224, 3, v230
    v_bfe_u32 v224, v233, 4, 1
    v_mul_u32_u24 v224, 1152, v224
    v_add_u32 v230, v230, v224
    s_mul_i32 s40, s33, 3584
    s_add_u32 s40, s40, 36864
    v_add_u32 v230, s40, v230
    s_add_u32 s40, s40, 3456
    v_mov_b32 v231, s40
    s_cmp_eq_u32 s37, 3
    s_cselect_b32 s40, 0, 19
    v_and_b32 v224, 19, v233
    v_cmp_eq_u32 s[50:51], s40, v224
    v_mov_b32 v232, 0xff7fffff
    s_mul_i32 s46, s38, 36
    s_add_u32 s46, s46, s44
    s_lshl_b32 s46, s46, 10
    s_add_u32 s46, s46, 0x18c0000
    s_mul_i32 s40, s33, 6144
    v_add_u32 v224, s40, v228
    s_waitcnt vmcnt(20)
    ds_write_b128 v224, v[20:23] offset:0
    s_waitcnt vmcnt(19)
    ds_write_b128 v224, v[24:27] offset:1024
    s_waitcnt vmcnt(18)
    ds_write_b128 v224, v[28:31] offset:2048
    s_waitcnt vmcnt(17)
    ds_write_b128 v224, v[32:35] offset:3072
    s_waitcnt vmcnt(16)
    ds_write_b128 v224, v[36:39] offset:4096
    s_waitcnt vmcnt(15)
    ds_write_b128 v224, v[40:43] offset:5120
    s_waitcnt vmcnt(14)
    ds_write_b128 v224, v[44:47] offset:6144
    s_waitcnt vmcnt(13)
    ds_write_b128 v224, v[48:51] offset:7168
    s_waitcnt vmcnt(12)
    ds_write_b128 v224, v[52:55] offset:8192
    s_mov_b64 exec, 1
    ds_add_u32 v237, v238 offset:8
    s_mov_b64 exec, -1
    v_min_u32 v225, 11, v233
    v_mul_u32_u24 v225, 3584, v225
    s_lshl_b32 s40, s36, 2
    s_sub_i32 s40, 8, s40
    v_cmp_le_i32 vcc, s40, v233
    v_mov_b32 v226, 0x3f803f80
    s_nop 0
    v_cndmask_b32_e64 v226, 0, v226, vcc
    v_mov_b32 v227, v226
    ds_write_b64 v225, v[226:227] offset:40320
    s_waitcnt lgkmcnt(0)
    s_mov_b64 exec, 1
    ds_add_u32 v237, v238 offset:4
    s_mov_b64 exec, -1
    ds_read_b32 v236, v237 offset:4
    s_lshl_b32 s45, s37, 2
    v_subrev_u32 v224, s45, v229
    v_add_u32 v225, 0, v224
    v_cmp_gt_u32 vcc, 18, v225
    s_waitcnt vmcnt(11)
    s_nop 0
    v_cndmask_b32_e64 v200, 0, v188, vcc
    v_add_u32 v226, 2, v224
    v_cmp_gt_u32 vcc, 18, v226
    s_nop 1
    v_cndmask_b32_e64 v201, 0, v189, vcc
    v_add_u32 v225, 8, v224
    v_cmp_gt_u32 vcc, 18, v225
    s_nop 1
    v_cndmask_b32_e64 v202, 0, v190, vcc
    v_add_u32 v226, 10, v224
    v_cmp_gt_u32 vcc, 18, v226
    s_nop 1
    v_cndmask_b32_e64 v203, 0, v191, vcc
    v_add_u32 v225, 16, v224
    v_cmp_gt_u32 vcc, 18, v225
    s_waitcnt vmcnt(10)
    s_nop 0
    v_cndmask_b32_e64 v204, 0, v192, vcc
    v_add_u32 v226, 18, v224
    v_cmp_gt_u32 vcc, 18, v226
    s_nop 1
    v_cndmask_b32_e64 v205, 0, v193, vcc
    v_add_u32 v225, 24, v224
    v_cmp_gt_u32 vcc, 18, v225
    s_nop 1
    v_cndmask_b32_e64 v206, 0, v194, vcc
    v_add_u32 v226, 26, v224
    v_cmp_gt_u32 vcc, 18, v226
    s_nop 1
    v_cndmask_b32_e64 v207, 0, v195, vcc
    v_add_u32 v220, 0, v230
    v_cndmask_b32 v220, v220, v231, s[50:51]
    v_add_u32 v221, 256, v230
    v_cndmask_b32 v221, v221, v231, s[50:51]
    v_add_u32 v222, 512, v230
    v_cndmask_b32 v222, v222, v231, s[50:51]
    v_add_u32 v223, 768, v230
    v_cndmask_b32 v223, v223, v231, s[50:51]
    s_waitcnt lgkmcnt(0)
    v_readfirstlane_b32 s42, v236
    s_nop 3
    s_cmp_ge_u32 s42, 8
    s_cbranch_scc1 lr_72
    s_mov_b32 s15, 0x80000
lw_71:
    s_sub_u32 s15, s15, 1
    s_cbranch_scc1 lr_72
    ds_read_b32 v236, v237 offset:4
    s_waitcnt lgkmcnt(0)
    v_readfirstlane_b32 s42, v236
    s_nop 3
    s_cmp_ge_u32 s42, 8
    s_cbranch_scc0 lw_71
lr_72:
    ds_read_b128 v[68:71], v228 offset:24576
    ds_read_b128 v[72:75], v228 offset:25600
    ds_read_b128 v[76:79], v228 offset:0
    ds_read_b128 v[80:83], v228 offset:1024
    ds_read_b128 v[180:183], v228 offset:3072
    ds_read_b128 v[184:187], v228 offset:4096
    s_setprio 3
    s_waitcnt lgkmcnt(5)
    v_mfma_f32_32x32x16_bf16 v[132:147], v[68:71], v[200:203], 0
    s_waitcnt lgkmcnt(4)
    v_mfma_f32_32x32x16_bf16 v[132:147], v[72:75], v[204:207], v[132:147]
    s_setprio 0
    s_setprio 3
    s_waitcnt lgkmcnt(3)
    v_mfma_f32_32x32x16_bf16 v[4:19], v[76:79], v[200:203], 0
    s_waitcnt lgkmcnt(2)
    v_mfma_f32_32x32x16_bf16 v[4:19], v[80:83], v[204:207], v[4:19]
    s_setprio 0
    ds_read_b128 v[68:71], v228 offset:6144
    ds_read_b128 v[72:75], v228 offset:7168
    ds_read_b128 v[76:79], v228 offset:9216
    ds_read_b128 v[80:83], v228 offset:10240
    v_mov_b32 v240, v232
    v_mov_b32 v241, v232
    s_waitcnt vmcnt(8)
    ds_write_b128 v239, v[84:87] offset:0
    s_waitcnt vmcnt(7)
    ds_write_b128 v239, v[88:91] offset:1152
    s_waitcnt vmcnt(6)
    ds_write_b128 v239, v[92:95] offset:2304
    s_waitcnt vmcnt(5)
    ds_write_b128 v239, v[96:99] offset:3584
    s_waitcnt vmcnt(4)
    ds_write_b128 v239, v[100:103] offset:4736
    s_waitcnt vmcnt(3)
    ds_write_b128 v239, v[104:107] offset:5888
    s_waitcnt vmcnt(2)
    ds_write_b128 v239, v[108:111] offset:7168
    s_waitcnt vmcnt(1)
    ds_write_b128 v239, v[112:115] offset:8320
    s_waitcnt vmcnt(0)
    ds_write_b128 v239, v[116:119] offset:9472
    s_waitcnt lgkmcnt(0)
    s_mov_b64 exec, 1
    ds_add_u32 v237, v238 offset:4
    s_mov_b64 exec, -1
    ds_read_b32 v236, v237 offset:4
    v_cndmask_b32 v132, v4, v132, s[56:57]
    v_cndmask_b32 v133, v5, v133, s[58:59]
    v_cndmask_b32 v134, v6, v134, s[60:61]
    v_cndmask_b32 v135, v7, v135, s[62:63]
    v_cndmask_b32 v136, v8, v136, s[64:65]
    v_cndmask_b32 v137, v9, v137, s[66:67]
    v_cndmask_b32 v138, v10, v138, s[68:69]
    v_cndmask_b32 v139, v11, v139, s[70:71]
    v_cndmask_b32 v140, v12, v140, s[72:73]
    v_cndmask_b32 v141, v13, v141, s[74:75]
    v_cndmask_b32 v142, v14, v142, s[76:77]
    v_cndmask_b32 v143, v15, v143, s[78:79]
    v_cndmask_b32 v144, v16, v144, s[80:81]
    v_cndmask_b32 v145, v17, v145, s[82:83]
    v_cndmask_b32 v146, v18, v146, s[84:85]
    v_cndmask_b32 v147, v19, v147, s[86:87]
    v_max3_f32 v240, v132, v133, v240
    v_max3_f32 v241, v134, v135, v241
    v_max3_f32 v240, v136, v137, v240
    v_max3_f32 v241, v138, v139, v241
    v_max3_f32 v240, v140, v141, v240
    v_max3_f32 v241, v142, v143, v241
    v_max3_f32 v240, v144, v145, v240
    v_max3_f32 v241, v146, v147, v241
    v_max_f32 v224, v240, v241
    v_mov_b32 v225, v224
    s_nop 1
    v_permlane32_swap_b32 v224, v225
    v_max_f32 v240, v224, v225
    v_sub_f32 v52, 0, v240
    v_sub_f32 v53, 0, v240
    v_sub_f32 v54, 0, v240
    v_sub_f32 v55, 0, v240
    v_sub_f32 v56, 0, v240
    v_sub_f32 v57, 0, v240
    v_sub_f32 v58, 0, v240
    v_sub_f32 v59, 0, v240
    v_sub_f32 v60, 0, v240
    v_sub_f32 v61, 0, v240
    v_sub_f32 v62, 0, v240
    v_sub_f32 v63, 0, v240
    v_sub_f32 v64, 0, v240
    v_sub_f32 v65, 0, v240
    v_sub_f32 v66, 0, v240
    v_sub_f32 v67, 0, v240
    s_setprio 3
    s_nop 0
    v_mfma_f32_32x32x16_bf16 v[20:35], v[180:183], v[200:203], v[52:67]
    v_mfma_f32_32x32x16_bf16 v[20:35], v[184:187], v[204:207], v[20:35]
    s_setprio 0
    v_sub_f32 v132, v132, v240
    v_sub_f32 v133, v133, v240
    v_sub_f32 v134, v134, v240
    v_sub_f32 v135, v135, v240
    v_sub_f32 v136, v136, v240
    v_sub_f32 v137, v137, v240
    v_sub_f32 v138, v138, v240
    v_sub_f32 v139, v139, v240
    v_exp_f32 v132, v132
    v_exp_f32 v133, v133
    v_exp_f32 v134, v134
    v_exp_f32 v135, v135
    v_exp_f32 v136, v136
    v_exp_f32 v137, v137
    v_exp_f32 v138, v138
    v_exp_f32 v139, v139
    v_cvt_pk_bf16_f32 v132, v132, v133
    v_cvt_pk_bf16_f32 v133, v134, v135
    v_cvt_pk_bf16_f32 v134, v136, v137
    v_cvt_pk_bf16_f32 v135, v138, v139
    v_sub_f32 v140, v140, v240
    v_sub_f32 v141, v141, v240
    v_sub_f32 v142, v142, v240
    v_sub_f32 v143, v143, v240
    v_sub_f32 v144, v144, v240
    v_sub_f32 v145, v145, v240
    v_sub_f32 v146, v146, v240
    v_sub_f32 v147, v147, v240
    v_exp_f32 v140, v140
    v_exp_f32 v141, v141
    v_exp_f32 v142, v142
    v_exp_f32 v143, v143
    v_exp_f32 v144, v144
    v_exp_f32 v145, v145
    v_exp_f32 v146, v146
    v_exp_f32 v147, v147
    v_cvt_pk_bf16_f32 v136, v140, v141
    v_cvt_pk_bf16_f32 v137, v142, v143
    v_cvt_pk_bf16_f32 v138, v144, v145
    v_cvt_pk_bf16_f32 v139, v146, v147
    v_bfi_b32 v4, v208, 0, v132
    v_bfi_b32 v5, v209, 0, v133
    v_bfi_b32 v6, v210, 0, v134
    v_bfi_b32 v7, v211, 0, v135
    v_bfi_b32 v8, v212, 0, v136
    v_bfi_b32 v9, v213, 0, v137
    v_bfi_b32 v10, v214, 0, v138
    v_bfi_b32 v11, v215, 0, v139
    v_and_b32 v132, v208, v132
    v_and_b32 v133, v209, v133
    v_and_b32 v134, v210, v134
    v_and_b32 v135, v211, v135
    v_and_b32 v136, v212, v136
    v_and_b32 v137, v213, v137
    v_and_b32 v138, v214, v138
    v_and_b32 v139, v215, v139
    s_waitcnt lgkmcnt(0)
    v_readfirstlane_b32 s42, v236
    s_nop 3
    s_cmp_ge_u32 s42, 12
    s_cbranch_scc1 lr_74
    s_mov_b32 s15, 0x80000
lw_73:
    s_sub_u32 s15, s15, 1
    s_cbranch_scc1 lr_74
    ds_read_b32 v236, v237 offset:4
    s_waitcnt lgkmcnt(0)
    v_readfirstlane_b32 s42, v236
    s_nop 3
    s_cmp_ge_u32 s42, 12
    s_cbranch_scc0 lw_73
lr_74:
    ds_read_b64_tr_b16 v[164:165], v220 offset:28672
    ds_read_b64_tr_b16 v[166:167], v221 offset:28672
    ds_read_b64_tr_b16 v[168:169], v222 offset:28672
    ds_read_b64_tr_b16 v[170:171], v223 offset:28672
    ds_read_b64_tr_b16 v[172:173], v220 offset:0
    ds_read_b64_tr_b16 v[174:175], v221 offset:0
    ds_read_b64_tr_b16 v[176:177], v222 offset:0
    ds_read_b64_tr_b16 v[178:179], v223 offset:0
    s_setprio 3
    v_mfma_f32_32x32x16_bf16 v[36:51], v[68:71], v[200:203], v[52:67]
    v_mfma_f32_32x32x16_bf16 v[36:51], v[72:75], v[204:207], v[36:51]
    s_setprio 0
    ds_read_b128 v[180:183], v228 offset:12288
    ds_read_b128 v[184:187], v228 offset:13312
    s_setprio 3
    s_waitcnt lgkmcnt(8)
    v_mfma_f32_32x32x16_bf16 v[148:163], v[164:167], v[132:135], 0
    s_waitcnt lgkmcnt(6)
    v_mfma_f32_32x32x16_bf16 v[148:163], v[168:171], v[136:139], v[148:163]
    s_setprio 0
    ds_read_b64_tr_b16 v[164:165], v220 offset:3584
    ds_read_b64_tr_b16 v[166:167], v221 offset:3584
    ds_read_b64_tr_b16 v[168:169], v222 offset:3584
    ds_read_b64_tr_b16 v[170:171], v223 offset:3584
    s_setprio 3
    s_waitcnt lgkmcnt(8)
    v_mfma_f32_32x32x16_bf16 v[148:163], v[172:175], v[4:7], v[148:163]
    s_waitcnt lgkmcnt(6)
    v_mfma_f32_32x32x16_bf16 v[148:163], v[176:179], v[8:11], v[148:163]
    s_setprio 0
    ds_read_b64_tr_b16 v[172:173], v220 offset:7168
    ds_read_b64_tr_b16 v[174:175], v221 offset:7168
    ds_read_b64_tr_b16 v[176:177], v222 offset:7168
    ds_read_b64_tr_b16 v[178:179], v223 offset:7168
    v_exp_f32 v20, v20
    v_exp_f32 v21, v21
    v_exp_f32 v22, v22
    v_exp_f32 v23, v23
    v_exp_f32 v24, v24
    v_exp_f32 v25, v25
    v_exp_f32 v26, v26
    v_exp_f32 v27, v27
    v_cvt_pk_bf16_f32 v20, v20, v21
    v_cvt_pk_bf16_f32 v21, v22, v23
    v_cvt_pk_bf16_f32 v22, v24, v25
    v_cvt_pk_bf16_f32 v23, v26, v27
    v_exp_f32 v28, v28
    v_exp_f32 v29, v29
    v_exp_f32 v30, v30
    v_exp_f32 v31, v31
    v_exp_f32 v32, v32
    v_exp_f32 v33, v33
    v_exp_f32 v34, v34
    v_exp_f32 v35, v35
    v_cvt_pk_bf16_f32 v24, v28, v29
    v_cvt_pk_bf16_f32 v25, v30, v31
    v_cvt_pk_bf16_f32 v26, v32, v33
    v_cvt_pk_bf16_f32 v27, v34, v35
    s_setprio 3
    s_waitcnt lgkmcnt(6)
    v_mfma_f32_32x32x16_bf16 v[148:163], v[164:167], v[20:23], v[148:163]
    s_waitcnt lgkmcnt(4)
    v_mfma_f32_32x32x16_bf16 v[148:163], v[168:171], v[24:27], v[148:163]
    s_setprio 0
    ds_read_b64_tr_b16 v[164:165], v220 offset:10752
    ds_read_b64_tr_b16 v[166:167], v221 offset:10752
    ds_read_b64_tr_b16 v[168:169], v222 offset:10752
    ds_read_b64_tr_b16 v[170:171], v223 offset:10752
    s_setprio 3
    v_mfma_f32_32x32x16_bf16 v[20:35], v[76:79], v[200:203], v[52:67]
    v_mfma_f32_32x32x16_bf16 v[20:35], v[80:83], v[204:207], v[20:35]
    s_setprio 0
    ds_read_b128 v[68:71], v228 offset:15360
    ds_read_b128 v[72:75], v228 offset:16384
    v_exp_f32 v36, v36
    v_exp_f32 v37, v37
    v_exp_f32 v38, v38
    v_exp_f32 v39, v39
    v_exp_f32 v40, v40
    v_exp_f32 v41, v41
    v_exp_f32 v42, v42
    v_exp_f32 v43, v43
    v_cvt_pk_bf16_f32 v36, v36, v37
    v_cvt_pk_bf16_f32 v37, v38, v39
    v_cvt_pk_bf16_f32 v38, v40, v41
    v_cvt_pk_bf16_f32 v39, v42, v43
    v_exp_f32 v44, v44
    v_exp_f32 v45, v45
    v_exp_f32 v46, v46
    v_exp_f32 v47, v47
    v_exp_f32 v48, v48
    v_exp_f32 v49, v49
    v_exp_f32 v50, v50
    v_exp_f32 v51, v51
    v_cvt_pk_bf16_f32 v40, v44, v45
    v_cvt_pk_bf16_f32 v41, v46, v47
    v_cvt_pk_bf16_f32 v42, v48, v49
    v_cvt_pk_bf16_f32 v43, v50, v51
    s_setprio 3
    s_waitcnt lgkmcnt(8)
    v_mfma_f32_32x32x16_bf16 v[148:163], v[172:175], v[36:39], v[148:163]
    s_waitcnt lgkmcnt(6)
    v_mfma_f32_32x32x16_bf16 v[148:163], v[176:179], v[40:43], v[148:163]
    s_setprio 0
    ds_read_b64_tr_b16 v[172:173], v220 offset:14336
    ds_read_b64_tr_b16 v[174:175], v221 offset:14336
    ds_read_b64_tr_b16 v[176:177], v222 offset:14336
    ds_read_b64_tr_b16 v[178:179], v223 offset:14336
    s_setprio 3
    v_mfma_f32_32x32x16_bf16 v[36:51], v[180:183], v[200:203], v[52:67]
    v_mfma_f32_32x32x16_bf16 v[36:51], v[184:187], v[204:207], v[36:51]
    s_setprio 0
    ds_read_b128 v[76:79], v228 offset:18432
    ds_read_b128 v[80:83], v228 offset:19456
    v_exp_f32 v20, v20
    v_exp_f32 v21, v21
    v_exp_f32 v22, v22
    v_exp_f32 v23, v23
    v_exp_f32 v24, v24
    v_exp_f32 v25, v25
    v_exp_f32 v26, v26
    v_exp_f32 v27, v27
    v_cvt_pk_bf16_f32 v20, v20, v21
    v_cvt_pk_bf16_f32 v21, v22, v23
    v_cvt_pk_bf16_f32 v22, v24, v25
    v_cvt_pk_bf16_f32 v23, v26, v27
    v_exp_f32 v28, v28
    v_exp_f32 v29, v29
    v_exp_f32 v30, v30
    v_exp_f32 v31, v31
    v_exp_f32 v32, v32
    v_exp_f32 v33, v33
    v_exp_f32 v34, v34
    v_exp_f32 v35, v35
    v_cvt_pk_bf16_f32 v24, v28, v29
    v_cvt_pk_bf16_f32 v25, v30, v31
    v_cvt_pk_bf16_f32 v26, v32, v33
    v_cvt_pk_bf16_f32 v27, v34, v35
    s_setprio 3
    s_waitcnt lgkmcnt(10)
    v_mfma_f32_32x32x16_bf16 v[148:163], v[164:167], v[20:23], v[148:163]
    s_waitcnt lgkmcnt(8)
    v_mfma_f32_32x32x16_bf16 v[148:163], v[168:171], v[24:27], v[148:163]
    s_setprio 0
    ds_read_b64_tr_b16 v[164:165], v220 offset:17920
    ds_read_b64_tr_b16 v[166:167], v221 offset:17920
    ds_read_b64_tr_b16 v[168:169], v222 offset:17920
    ds_read_b64_tr_b16 v[170:171], v223 offset:17920
    s_setprio 3
    s_waitcnt lgkmcnt(11)
    v_mfma_f32_32x32x16_bf16 v[20:35], v[68:71], v[200:203], v[52:67]
    s_waitcnt lgkmcnt(10)
    v_mfma_f32_32x32x16_bf16 v[20:35], v[72:75], v[204:207], v[20:35]
    s_setprio 0
    ds_read_b128 v[180:183], v228 offset:21504
    ds_read_b128 v[184:187], v228 offset:22528
    v_exp_f32 v36, v36
    v_exp_f32 v37, v37
    v_exp_f32 v38, v38
    v_exp_f32 v39, v39
    v_exp_f32 v40, v40
    v_exp_f32 v41, v41
    v_exp_f32 v42, v42
    v_exp_f32 v43, v43
    v_cvt_pk_bf16_f32 v36, v36, v37
    v_cvt_pk_bf16_f32 v37, v38, v39
    v_cvt_pk_bf16_f32 v38, v40, v41
    v_cvt_pk_bf16_f32 v39, v42, v43
    v_exp_f32 v44, v44
    v_exp_f32 v45, v45
    v_exp_f32 v46, v46
    v_exp_f32 v47, v47
    v_exp_f32 v48, v48
    v_exp_f32 v49, v49
    v_exp_f32 v50, v50
    v_exp_f32 v51, v51
    v_cvt_pk_bf16_f32 v40, v44, v45
    v_cvt_pk_bf16_f32 v41, v46, v47
    v_cvt_pk_bf16_f32 v42, v48, v49
    v_cvt_pk_bf16_f32 v43, v50, v51
    s_setprio 3
    s_waitcnt lgkmcnt(10)
    v_mfma_f32_32x32x16_bf16 v[148:163], v[172:175], v[36:39], v[148:163]
    s_waitcnt lgkmcnt(8)
    v_mfma_f32_32x32x16_bf16 v[148:163], v[176:179], v[40:43], v[148:163]
    s_setprio 0
    ds_read_b64_tr_b16 v[172:173], v220 offset:21504
    ds_read_b64_tr_b16 v[174:175], v221 offset:21504
    ds_read_b64_tr_b16 v[176:177], v222 offset:21504
    ds_read_b64_tr_b16 v[178:179], v223 offset:21504
    s_setprio 3
    s_waitcnt lgkmcnt(11)
    v_mfma_f32_32x32x16_bf16 v[36:51], v[76:79], v[200:203], v[52:67]
    s_waitcnt lgkmcnt(10)
    v_mfma_f32_32x32x16_bf16 v[36:51], v[80:83], v[204:207], v[36:51]
    s_setprio 0
    v_exp_f32 v20, v20
    v_exp_f32 v21, v21
    v_exp_f32 v22, v22
    v_exp_f32 v23, v23
    v_exp_f32 v24, v24
    v_exp_f32 v25, v25
    v_exp_f32 v26, v26
    v_exp_f32 v27, v27
    v_cvt_pk_bf16_f32 v20, v20, v21
    v_cvt_pk_bf16_f32 v21, v22, v23
    v_cvt_pk_bf16_f32 v22, v24, v25
    v_cvt_pk_bf16_f32 v23, v26, v27
    v_exp_f32 v28, v28
    v_exp_f32 v29, v29
    v_exp_f32 v30, v30
    v_exp_f32 v31, v31
    v_exp_f32 v32, v32
    v_exp_f32 v33, v33
    v_exp_f32 v34, v34
    v_exp_f32 v35, v35
    v_cvt_pk_bf16_f32 v24, v28, v29
    v_cvt_pk_bf16_f32 v25, v30, v31
    v_cvt_pk_bf16_f32 v26, v32, v33
    v_cvt_pk_bf16_f32 v27, v34, v35
    s_setprio 3
    s_waitcnt lgkmcnt(8)
    v_mfma_f32_32x32x16_bf16 v[148:163], v[164:167], v[20:23], v[148:163]
    s_waitcnt lgkmcnt(6)
    v_mfma_f32_32x32x16_bf16 v[148:163], v[168:171], v[24:27], v[148:163]
    s_setprio 0
    ds_read_b64_tr_b16 v[164:165], v220 offset:25088
    ds_read_b64_tr_b16 v[166:167], v221 offset:25088
    ds_read_b64_tr_b16 v[168:169], v222 offset:25088
    ds_read_b64_tr_b16 v[170:171], v223 offset:25088
    s_setprio 3
    s_waitcnt lgkmcnt(9)
    v_mfma_f32_32x32x16_bf16 v[20:35], v[180:183], v[200:203], v[52:67]
    s_waitcnt lgkmcnt(8)
    v_mfma_f32_32x32x16_bf16 v[20:35], v[184:187], v[204:207], v[20:35]
    s_setprio 0
    v_exp_f32 v36, v36
    v_exp_f32 v37, v37
    v_exp_f32 v38, v38
    v_exp_f32 v39, v39
    v_exp_f32 v40, v40
    v_exp_f32 v41, v41
    v_exp_f32 v42, v42
    v_exp_f32 v43, v43
    v_cvt_pk_bf16_f32 v36, v36, v37
    v_cvt_pk_bf16_f32 v37, v38, v39
    v_cvt_pk_bf16_f32 v38, v40, v41
    v_cvt_pk_bf16_f32 v39, v42, v43
    v_exp_f32 v44, v44
    v_exp_f32 v45, v45
    v_exp_f32 v46, v46
    v_exp_f32 v47, v47
    v_exp_f32 v48, v48
    v_exp_f32 v49, v49
    v_exp_f32 v50, v50
    v_exp_f32 v51, v51
    v_cvt_pk_bf16_f32 v40, v44, v45
    v_cvt_pk_bf16_f32 v41, v46, v47
    v_cvt_pk_bf16_f32 v42, v48, v49
    v_cvt_pk_bf16_f32 v43, v50, v51
    s_setprio 3
    s_waitcnt lgkmcnt(6)
    v_mfma_f32_32x32x16_bf16 v[148:163], v[172:175], v[36:39], v[148:163]
    s_waitcnt lgkmcnt(4)
    v_mfma_f32_32x32x16_bf16 v[148:163], v[176:179], v[40:43], v[148:163]
    s_setprio 0
    v_exp_f32 v20, v20
    v_exp_f32 v21, v21
    v_exp_f32 v22, v22
    v_exp_f32 v23, v23
    v_exp_f32 v24, v24
    v_exp_f32 v25, v25
    v_exp_f32 v26, v26
    v_exp_f32 v27, v27
    v_cvt_pk_bf16_f32 v20, v20, v21
    v_cvt_pk_bf16_f32 v21, v22, v23
    v_cvt_pk_bf16_f32 v22, v24, v25
    v_cvt_pk_bf16_f32 v23, v26, v27
    v_exp_f32 v28, v28
    v_exp_f32 v29, v29
    v_exp_f32 v30, v30
    v_exp_f32 v31, v31
    v_exp_f32 v32, v32
    v_exp_f32 v33, v33
    v_exp_f32 v34, v34
    v_exp_f32 v35, v35
    v_cvt_pk_bf16_f32 v24, v28, v29
    v_cvt_pk_bf16_f32 v25, v30, v31
    v_cvt_pk_bf16_f32 v26, v32, v33
    v_cvt_pk_bf16_f32 v27, v34, v35
    s_setprio 3
    s_waitcnt lgkmcnt(2)
    v_mfma_f32_32x32x16_bf16 v[148:163], v[164:167], v[20:23], v[148:163]
    s_waitcnt lgkmcnt(0)
    v_mfma_f32_32x32x16_bf16 v[148:163], v[168:171], v[24:27], v[148:163]
    s_setprio 0
    s_cmp_eq_u32 s37, 3
    s_cselect_b64 vcc, -1, 0
    s_nop 8
    v_cndmask_b32_e64 v224, v160, v148, vcc
    v_mov_b32 v225, v224
    s_nop 1
    v_permlane32_swap_b32 v224, v225
    v_cndmask_b32_e64 v224, v225, v224, vcc
    v_mov_b32 v225, 0x53800000
    v_mov_b32 v226, 0x2b800000
    v_cmp_nle_f32 vcc, v224, v225
    v_cmp_nge_f32 s[48:49], v224, v226
    s_nop 3
    s_or_b64 vcc, vcc, s[48:49]
    s_cmp_eq_u64 vcc, 0
    s_cbranch_scc1 joined_70
exact_69:
    s_waitcnt vmcnt(0) lgkmcnt(0)
    s_nop 11
    v_mov_b32 v240, v232
    v_mov_b32 v241, v232
    ds_read_b128 v[164:167], v228 offset:24576
    ds_read_b128 v[168:171], v228 offset:25600
    ds_read_b128 v[172:175], v228 offset:0
    ds_read_b128 v[176:179], v228 offset:1024
    ds_read_b128 v[180:183], v228 offset:3072
    ds_read_b128 v[184:187], v228 offset:4096
    s_setprio 3
    s_waitcnt lgkmcnt(5)
    v_mfma_f32_32x32x16_bf16 v[132:147], v[164:167], v[200:203], 0
    s_waitcnt lgkmcnt(4)
    v_mfma_f32_32x32x16_bf16 v[132:147], v[168:171], v[204:207], v[132:147]
    s_setprio 0
    ds_read_b128 v[164:167], v228 offset:6144
    ds_read_b128 v[168:171], v228 offset:7168
    s_setprio 3
    s_waitcnt lgkmcnt(5)
    v_mfma_f32_32x32x16_bf16 v[4:19], v[172:175], v[200:203], 0
    s_waitcnt lgkmcnt(4)
    v_mfma_f32_32x32x16_bf16 v[4:19], v[176:179], v[204:207], v[4:19]
    s_setprio 0
    ds_read_b128 v[172:175], v228 offset:9216
    ds_read_b128 v[176:179], v228 offset:10240
    s_setprio 3
    s_waitcnt lgkmcnt(5)
    v_mfma_f32_32x32x16_bf16 v[20:35], v[180:183], v[200:203], 0
    s_waitcnt lgkmcnt(4)
    v_mfma_f32_32x32x16_bf16 v[20:35], v[184:187], v[204:207], v[20:35]
    s_setprio 0
    ds_read_b128 v[180:183], v228 offset:12288
    ds_read_b128 v[184:187], v228 offset:13312
    s_setprio 3
    s_waitcnt lgkmcnt(5)
    v_mfma_f32_32x32x16_bf16 v[36:51], v[164:167], v[200:203], 0
    s_waitcnt lgkmcnt(4)
    v_mfma_f32_32x32x16_bf16 v[36:51], v[168:171], v[204:207], v[36:51]
    s_setprio 0
    ds_read_b128 v[164:167], v228 offset:15360
    ds_read_b128 v[168:171], v228 offset:16384
    s_setprio 3
    s_waitcnt lgkmcnt(5)
    v_mfma_f32_32x32x16_bf16 v[52:67], v[172:175], v[200:203], 0
    s_waitcnt lgkmcnt(4)
    v_mfma_f32_32x32x16_bf16 v[52:67], v[176:179], v[204:207], v[52:67]
    s_setprio 0
    ds_read_b128 v[172:175], v228 offset:18432
    ds_read_b128 v[176:179], v228 offset:19456
    s_setprio 3
    s_waitcnt lgkmcnt(5)
    v_mfma_f32_32x32x16_bf16 v[68:83], v[180:183], v[200:203], 0
    s_waitcnt lgkmcnt(4)
    v_mfma_f32_32x32x16_bf16 v[68:83], v[184:187], v[204:207], v[68:83]
    s_setprio 0
    ds_read_b128 v[180:183], v228 offset:21504
    ds_read_b128 v[184:187], v228 offset:22528
    s_setprio 3
    s_waitcnt lgkmcnt(5)
    v_mfma_f32_32x32x16_bf16 v[84:99], v[164:167], v[200:203], 0
    s_waitcnt lgkmcnt(4)
    v_mfma_f32_32x32x16_bf16 v[84:99], v[168:171], v[204:207], v[84:99]
    s_setprio 0
    s_setprio 3
    s_waitcnt lgkmcnt(3)
    v_mfma_f32_32x32x16_bf16 v[100:115], v[172:175], v[200:203], 0
    s_waitcnt lgkmcnt(2)
    v_mfma_f32_32x32x16_bf16 v[100:115], v[176:179], v[204:207], v[100:115]
    s_setprio 0
    s_setprio 3
    s_waitcnt lgkmcnt(1)
    v_mfma_f32_32x32x16_bf16 v[116:131], v[180:183], v[200:203], 0
    s_waitcnt lgkmcnt(0)
    v_mfma_f32_32x32x16_bf16 v[116:131], v[184:187], v[204:207], v[116:131]
    s_setprio 0
    v_cndmask_b32 v132, v4, v132, s[56:57]
    v_cndmask_b32 v133, v5, v133, s[58:59]
    v_cndmask_b32 v134, v6, v134, s[60:61]
    v_cndmask_b32 v135, v7, v135, s[62:63]
    v_cndmask_b32 v136, v8, v136, s[64:65]
    v_cndmask_b32 v137, v9, v137, s[66:67]
    v_cndmask_b32 v138, v10, v138, s[68:69]
    v_cndmask_b32 v139, v11, v139, s[70:71]
    v_cndmask_b32 v140, v12, v140, s[72:73]
    v_cndmask_b32 v141, v13, v141, s[74:75]
    v_cndmask_b32 v142, v14, v142, s[76:77]
    v_cndmask_b32 v143, v15, v143, s[78:79]
    v_cndmask_b32 v144, v16, v144, s[80:81]
    v_cndmask_b32 v145, v17, v145, s[82:83]
    v_cndmask_b32 v146, v18, v146, s[84:85]
    v_cndmask_b32 v147, v19, v147, s[86:87]
    s_cmp_ge_u32 s38, 8
    s_cbranch_scc1 nofix_75
    s_nop 11
    v_cndmask_b32 v132, v232, v132, s[56:57]
    v_cndmask_b32 v133, v232, v133, s[58:59]
    v_cndmask_b32 v134, v232, v134, s[60:61]
    v_cndmask_b32 v135, v232, v135, s[62:63]
    v_cndmask_b32 v136, v232, v136, s[64:65]
    v_cndmask_b32 v137, v232, v137, s[66:67]
    v_cndmask_b32 v138, v232, v138, s[68:69]
    v_cndmask_b32 v139, v232, v139, s[70:71]
    v_cndmask_b32 v140, v232, v140, s[72:73]
    v_cndmask_b32 v141, v232, v141, s[74:75]
    v_cndmask_b32 v142, v232, v142, s[76:77]
    v_cndmask_b32 v143, v232, v143, s[78:79]
    v_cndmask_b32 v144, v232, v144, s[80:81]
    v_cndmask_b32 v145, v232, v145, s[82:83]
    v_cndmask_b32 v146, v232, v146, s[84:85]
    v_cndmask_b32 v147, v232, v147, s[86:87]
    s_cmp_ge_u32 s38, 7
    s_cbranch_scc1 nofix_75
    v_mov_b32 v20, v232
    v_mov_b32 v21, v232
    v_mov_b32 v22, v232
    v_mov_b32 v23, v232
    v_mov_b32 v24, v232
    v_mov_b32 v25, v232
    v_mov_b32 v26, v232
    v_mov_b32 v27, v232
    v_mov_b32 v28, v232
    v_mov_b32 v29, v232
    v_mov_b32 v30, v232
    v_mov_b32 v31, v232
    v_mov_b32 v32, v232
    v_mov_b32 v33, v232
    v_mov_b32 v34, v232
    v_mov_b32 v35, v232
    s_cmp_ge_u32 s38, 6
    s_cbranch_scc1 nofix_75
    v_mov_b32 v36, v232
    v_mov_b32 v37, v232
    v_mov_b32 v38, v232
    v_mov_b32 v39, v232
    v_mov_b32 v40, v232
    v_mov_b32 v41, v232
    v_mov_b32 v42, v232
    v_mov_b32 v43, v232
    v_mov_b32 v44, v232
    v_mov_b32 v45, v232
    v_mov_b32 v46, v232
    v_mov_b32 v47, v232
    v_mov_b32 v48, v232
    v_mov_b32 v49, v232
    v_mov_b32 v50, v232
    v_mov_b32 v51, v232
    s_cmp_ge_u32 s38, 5
    s_cbranch_scc1 nofix_75
    v_mov_b32 v52, v232
    v_mov_b32 v53, v232
    v_mov_b32 v54, v232
    v_mov_b32 v55, v232
    v_mov_b32 v56, v232
    v_mov_b32 v57, v232
    v_mov_b32 v58, v232
    v_mov_b32 v59, v232
    v_mov_b32 v60, v232
    v_mov_b32 v61, v232
    v_mov_b32 v62, v232
    v_mov_b32 v63, v232
    v_mov_b32 v64, v232
    v_mov_b32 v65, v232
    v_mov_b32 v66, v232
    v_mov_b32 v67, v232
    s_cmp_ge_u32 s38, 4
    s_cbranch_scc1 nofix_75
    v_mov_b32 v68, v232
    v_mov_b32 v69, v232
    v_mov_b32 v70, v232
    v_mov_b32 v71, v232
    v_mov_b32 v72, v232
    v_mov_b32 v73, v232
    v_mov_b32 v74, v232
    v_mov_b32 v75, v232
    v_mov_b32 v76, v232
    v_mov_b32 v77, v232
    v_mov_b32 v78, v232
    v_mov_b32 v79, v232
    v_mov_b32 v80, v232
    v_mov_b32 v81, v232
    v_mov_b32 v82, v232
    v_mov_b32 v83, v232
    s_cmp_ge_u32 s38, 3
    s_cbranch_scc1 nofix_75
    v_mov_b32 v84, v232
    v_mov_b32 v85, v232
    v_mov_b32 v86, v232
    v_mov_b32 v87, v232
    v_mov_b32 v88, v232
    v_mov_b32 v89, v232
    v_mov_b32 v90, v232
    v_mov_b32 v91, v232
    v_mov_b32 v92, v232
    v_mov_b32 v93, v232
    v_mov_b32 v94, v232
    v_mov_b32 v95, v232
    v_mov_b32 v96, v232
    v_mov_b32 v97, v232
    v_mov_b32 v98, v232
    v_mov_b32 v99, v232
    s_cmp_ge_u32 s38, 2
    s_cbranch_scc1 nofix_75
    v_mov_b32 v100, v232
    v_mov_b32 v101, v232
    v_mov_b32 v102, v232
    v_mov_b32 v103, v232
    v_mov_b32 v104, v232
    v_mov_b32 v105, v232
    v_mov_b32 v106, v232
    v_mov_b32 v107, v232
    v_mov_b32 v108, v232
    v_mov_b32 v109, v232
    v_mov_b32 v110, v232
    v_mov_b32 v111, v232
    v_mov_b32 v112, v232
    v_mov_b32 v113, v232
    v_mov_b32 v114, v232
    v_mov_b32 v115, v232
    s_cmp_ge_u32 s38, 1
    s_cbranch_scc1 nofix_75
    v_mov_b32 v116, v232
    v_mov_b32 v117, v232
    v_mov_b32 v118, v232
    v_mov_b32 v119, v232
    v_mov_b32 v120, v232
    v_mov_b32 v121, v232
    v_mov_b32 v122, v232
    v_mov_b32 v123, v232
    v_mov_b32 v124, v232
    v_mov_b32 v125, v232
    v_mov_b32 v126, v232
    v_mov_b32 v127, v232
    v_mov_b32 v128, v232
    v_mov_b32 v129, v232
    v_mov_b32 v130, v232
    v_mov_b32 v131, v232
nofix_75:
    s_nop 1
    v_max3_f32 v240, v132, v133, v240
    v_max3_f32 v241, v134, v135, v241
    v_max3_f32 v240, v136, v137, v240
    v_max3_f32 v241, v138, v139, v241
    v_max3_f32 v240, v140, v141, v240
    v_max3_f32 v241, v142, v143, v241
    v_max3_f32 v240, v144, v145, v240
    v_max3_f32 v241, v146, v147, v241
    v_max3_f32 v240, v20, v21, v240
    v_max3_f32 v241, v22, v23, v241
    v_max3_f32 v240, v24, v25, v240
    v_max3_f32 v241, v26, v27, v241
    v_max3_f32 v240, v28, v29, v240
    v_max3_f32 v241, v30, v31, v241
    v_max3_f32 v240, v32, v33, v240
    v_max3_f32 v241, v34, v35, v241
    v_max3_f32 v240, v36, v37, v240
    v_max3_f32 v241, v38, v39, v241
    v_max3_f32 v240, v40, v41, v240
    v_max3_f32 v241, v42, v43, v241
    v_max3_f32 v240, v44, v45, v240
    v_max3_f32 v241, v46, v47, v241
    v_max3_f32 v240, v48, v49, v240
    v_max3_f32 v241, v50, v51, v241
    v_max3_f32 v240, v52, v53, v240
    v_max3_f32 v241, v54, v55, v241
    v_max3_f32 v240, v56, v57, v240
    v_max3_f32 v241, v58, v59, v241
    v_max3_f32 v240, v60, v61, v240
    v_max3_f32 v241, v62, v63, v241
    v_max3_f32 v240, v64, v65, v240
    v_max3_f32 v241, v66, v67, v241
    v_max3_f32 v240, v68, v69, v240
    v_max3_f32 v241, v70, v71, v241
    v_max3_f32 v240, v72, v73, v240
    v_max3_f32 v241, v74, v75, v241
    v_max3_f32 v240, v76, v77, v240
    v_max3_f32 v241, v78, v79, v241
    v_max3_f32 v240, v80, v81, v240
    v_max3_f32 v241, v82, v83, v241
    v_max3_f32 v240, v84, v85, v240
    v_max3_f32 v241, v86, v87, v241
    v_max3_f32 v240, v88, v89, v240
    v_max3_f32 v241, v90, v91, v241
    v_max3_f32 v240, v92, v93, v240
    v_max3_f32 v241, v94, v95, v241
    v_max3_f32 v240, v96, v97, v240
    v_max3_f32 v241, v98, v99, v241
    v_max3_f32 v240, v100, v101, v240
    v_max3_f32 v241, v102, v103, v241
    v_max3_f32 v240, v104, v105, v240
    v_max3_f32 v241, v106, v107, v241
    v_max3_f32 v240, v108, v109, v240
    v_max3_f32 v241, v110, v111, v241
    v_max3_f32 v240, v112, v113, v240
    v_max3_f32 v241, v114, v115, v241
    v_max3_f32 v240, v116, v117, v240
    v_max3_f32 v241, v118, v119, v241
    v_max3_f32 v240, v120, v121, v240
    v_max3_f32 v241, v122, v123, v241
    v_max3_f32 v240, v124, v125, v240
    v_max3_f32 v241, v126, v127, v241
    v_max3_f32 v240, v128, v129, v240
    v_max3_f32 v241, v130, v131, v241
    v_max_f32 v224, v240, v241
    v_mov_b32 v225, v224
    s_nop 1
    v_permlane32_swap_b32 v224, v225
    v_max_f32 v240, v224, v225
    ds_read_b64_tr_b16 v[164:165], v220 offset:3584
    ds_read_b64_tr_b16 v[166:167], v221 offset:3584
    ds_read_b64_tr_b16 v[168:169], v222 offset:3584
    ds_read_b64_tr_b16 v[170:171], v223 offset:3584
    ds_read_b64_tr_b16 v[172:173], v220 offset:7168
    ds_read_b64_tr_b16 v[174:175], v221 offset:7168
    ds_read_b64_tr_b16 v[176:177], v222 offset:7168
    ds_read_b64_tr_b16 v[178:179], v223 offset:7168
    v_sub_f32 v20, v20, v240
    v_sub_f32 v21, v21, v240
    v_sub_f32 v22, v22, v240
    v_sub_f32 v23, v23, v240
    v_sub_f32 v24, v24, v240
    v_sub_f32 v25, v25, v240
    v_sub_f32 v26, v26, v240
    v_sub_f32 v27, v27, v240
    v_exp_f32 v20, v20
    v_exp_f32 v21, v21
    v_exp_f32 v22, v22
    v_exp_f32 v23, v23
    v_exp_f32 v24, v24
    v_exp_f32 v25, v25
    v_exp_f32 v26, v26
    v_exp_f32 v27, v27
    v_cvt_pk_bf16_f32 v20, v20, v21
    v_cvt_pk_bf16_f32 v21, v22, v23
    v_cvt_pk_bf16_f32 v22, v24, v25
    v_cvt_pk_bf16_f32 v23, v26, v27
    v_sub_f32 v28, v28, v240
    v_sub_f32 v29, v29, v240
    v_sub_f32 v30, v30, v240
    v_sub_f32 v31, v31, v240
    v_sub_f32 v32, v32, v240
    v_sub_f32 v33, v33, v240
    v_sub_f32 v34, v34, v240
    v_sub_f32 v35, v35, v240
    v_exp_f32 v28, v28
    v_exp_f32 v29, v29
    v_exp_f32 v30, v30
    v_exp_f32 v31, v31
    v_exp_f32 v32, v32
    v_exp_f32 v33, v33
    v_exp_f32 v34, v34
    v_exp_f32 v35, v35
    v_cvt_pk_bf16_f32 v24, v28, v29
    v_cvt_pk_bf16_f32 v25, v30, v31
    v_cvt_pk_bf16_f32 v26, v32, v33
    v_cvt_pk_bf16_f32 v27, v34, v35
    v_sub_f32 v36, v36, v240
    v_sub_f32 v37, v37, v240
    v_sub_f32 v38, v38, v240
    v_sub_f32 v39, v39, v240
    v_sub_f32 v40, v40, v240
    v_sub_f32 v41, v41, v240
    ds_read_b64_tr_b16 v[180:181], v220 offset:10752
    ds_read_b64_tr_b16 v[182:183], v221 offset:10752
    ds_read_b64_tr_b16 v[184:185], v222 offset:10752
    ds_read_b64_tr_b16 v[186:187], v223 offset:10752
    s_setprio 3
    s_waitcnt lgkmcnt(10)
    v_mfma_f32_32x32x16_bf16 v[148:163], v[164:167], v[20:23], 0
    s_waitcnt lgkmcnt(8)
    v_mfma_f32_32x32x16_bf16 v[148:163], v[168:171], v[24:27], v[148:163]
    s_setprio 0
    v_sub_f32 v42, v42, v240
    v_sub_f32 v43, v43, v240
    v_exp_f32 v36, v36
    v_exp_f32 v37, v37
    v_exp_f32 v38, v38
    v_exp_f32 v39, v39
    v_exp_f32 v40, v40
    v_exp_f32 v41, v41
    v_exp_f32 v42, v42
    v_exp_f32 v43, v43
    v_cvt_pk_bf16_f32 v36, v36, v37
    v_cvt_pk_bf16_f32 v37, v38, v39
    v_cvt_pk_bf16_f32 v38, v40, v41
    v_cvt_pk_bf16_f32 v39, v42, v43
    v_sub_f32 v44, v44, v240
    v_sub_f32 v45, v45, v240
    v_sub_f32 v46, v46, v240
    v_sub_f32 v47, v47, v240
    v_sub_f32 v48, v48, v240
    v_sub_f32 v49, v49, v240
    v_sub_f32 v50, v50, v240
    v_sub_f32 v51, v51, v240
    v_exp_f32 v44, v44
    v_exp_f32 v45, v45
    v_exp_f32 v46, v46
    v_exp_f32 v47, v47
    v_exp_f32 v48, v48
    v_exp_f32 v49, v49
    v_exp_f32 v50, v50
    v_exp_f32 v51, v51
    v_cvt_pk_bf16_f32 v40, v44, v45
    v_cvt_pk_bf16_f32 v41, v46, v47
    v_cvt_pk_bf16_f32 v42, v48, v49
    v_cvt_pk_bf16_f32 v43, v50, v51
    v_sub_f32 v52, v52, v240
    v_sub_f32 v53, v53, v240
    v_sub_f32 v54, v54, v240
    v_sub_f32 v55, v55, v240
    v_sub_f32 v56, v56, v240
    v_sub_f32 v57, v57, v240
    ds_read_b64_tr_b16 v[164:165], v220 offset:14336
    ds_read_b64_tr_b16 v[166:167], v221 offset:14336
    ds_read_b64_tr_b16 v[168:169], v222 offset:14336
    ds_read_b64_tr_b16 v[170:171], v223 offset:14336
    s_setprio 3
    s_waitcnt lgkmcnt(10)
    v_mfma_f32_32x32x16_bf16 v[148:163], v[172:175], v[36:39], v[148:163]
    s_waitcnt lgkmcnt(8)
    v_mfma_f32_32x32x16_bf16 v[148:163], v[176:179], v[40:43], v[148:163]
    s_setprio 0
    v_sub_f32 v58, v58, v240
    v_sub_f32 v59, v59, v240
    v_exp_f32 v52, v52
    v_exp_f32 v53, v53
    v_exp_f32 v54, v54
    v_exp_f32 v55, v55
    v_exp_f32 v56, v56
    v_exp_f32 v57, v57
    v_exp_f32 v58, v58
    v_exp_f32 v59, v59
    v_cvt_pk_bf16_f32 v52, v52, v53
    v_cvt_pk_bf16_f32 v53, v54, v55
    v_cvt_pk_bf16_f32 v54, v56, v57
    v_cvt_pk_bf16_f32 v55, v58, v59
    v_sub_f32 v60, v60, v240
    v_sub_f32 v61, v61, v240
    v_sub_f32 v62, v62, v240
    v_sub_f32 v63, v63, v240
    v_sub_f32 v64, v64, v240
    v_sub_f32 v65, v65, v240
    v_sub_f32 v66, v66, v240
    v_sub_f32 v67, v67, v240
    v_exp_f32 v60, v60
    v_exp_f32 v61, v61
    v_exp_f32 v62, v62
    v_exp_f32 v63, v63
    v_exp_f32 v64, v64
    v_exp_f32 v65, v65
    v_exp_f32 v66, v66
    v_exp_f32 v67, v67
    v_cvt_pk_bf16_f32 v56, v60, v61
    v_cvt_pk_bf16_f32 v57, v62, v63
    v_cvt_pk_bf16_f32 v58, v64, v65
    v_cvt_pk_bf16_f32 v59, v66, v67
    v_sub_f32 v68, v68, v240
    v_sub_f32 v69, v69, v240
    v_sub_f32 v70, v70, v240
    v_sub_f32 v71, v71, v240
    v_sub_f32 v72, v72, v240
    v_sub_f32 v73, v73, v240
    ds_read_b64_tr_b16 v[172:173], v220 offset:17920
    ds_read_b64_tr_b16 v[174:175], v221 offset:17920
    ds_read_b64_tr_b16 v[176:177], v222 offset:17920
    ds_read_b64_tr_b16 v[178:179], v223 offset:17920
    s_setprio 3
    s_waitcnt lgkmcnt(10)
    v_mfma_f32_32x32x16_bf16 v[148:163], v[180:183], v[52:55], v[148:163]
    s_waitcnt lgkmcnt(8)
    v_mfma_f32_32x32x16_bf16 v[148:163], v[184:187], v[56:59], v[148:163]
    s_setprio 0
    v_sub_f32 v74, v74, v240
    v_sub_f32 v75, v75, v240
    v_exp_f32 v68, v68
    v_exp_f32 v69, v69
    v_exp_f32 v70, v70
    v_exp_f32 v71, v71
    v_exp_f32 v72, v72
    v_exp_f32 v73, v73
    v_exp_f32 v74, v74
    v_exp_f32 v75, v75
    v_cvt_pk_bf16_f32 v68, v68, v69
    v_cvt_pk_bf16_f32 v69, v70, v71
    v_cvt_pk_bf16_f32 v70, v72, v73
    v_cvt_pk_bf16_f32 v71, v74, v75
    v_sub_f32 v76, v76, v240
    v_sub_f32 v77, v77, v240
    v_sub_f32 v78, v78, v240
    v_sub_f32 v79, v79, v240
    v_sub_f32 v80, v80, v240
    v_sub_f32 v81, v81, v240
    v_sub_f32 v82, v82, v240
    v_sub_f32 v83, v83, v240
    v_exp_f32 v76, v76
    v_exp_f32 v77, v77
    v_exp_f32 v78, v78
    v_exp_f32 v79, v79
    v_exp_f32 v80, v80
    v_exp_f32 v81, v81
    v_exp_f32 v82, v82
    v_exp_f32 v83, v83
    v_cvt_pk_bf16_f32 v72, v76, v77
    v_cvt_pk_bf16_f32 v73, v78, v79
    v_cvt_pk_bf16_f32 v74, v80, v81
    v_cvt_pk_bf16_f32 v75, v82, v83
    v_sub_f32 v84, v84, v240
    v_sub_f32 v85, v85, v240
    v_sub_f32 v86, v86, v240
    v_sub_f32 v87, v87, v240
    v_sub_f32 v88, v88, v240
    v_sub_f32 v89, v89, v240
    ds_read_b64_tr_b16 v[180:181], v220 offset:21504
    ds_read_b64_tr_b16 v[182:183], v221 offset:21504
    ds_read_b64_tr_b16 v[184:185], v222 offset:21504
    ds_read_b64_tr_b16 v[186:187], v223 offset:21504
    s_setprio 3
    s_waitcnt lgkmcnt(10)
    v_mfma_f32_32x32x16_bf16 v[148:163], v[164:167], v[68:71], v[148:163]
    s_waitcnt lgkmcnt(8)
    v_mfma_f32_32x32x16_bf16 v[148:163], v[168:171], v[72:75], v[148:163]
    s_setprio 0
    v_sub_f32 v90, v90, v240
    v_sub_f32 v91, v91, v240
    v_exp_f32 v84, v84
    v_exp_f32 v85, v85
    v_exp_f32 v86, v86
    v_exp_f32 v87, v87
    v_exp_f32 v88, v88
    v_exp_f32 v89, v89
    v_exp_f32 v90, v90
    v_exp_f32 v91, v91
    v_cvt_pk_bf16_f32 v84, v84, v85
    v_cvt_pk_bf16_f32 v85, v86, v87
    v_cvt_pk_bf16_f32 v86, v88, v89
    v_cvt_pk_bf16_f32 v87, v90, v91
    v_sub_f32 v92, v92, v240
    v_sub_f32 v93, v93, v240
    v_sub_f32 v94, v94, v240
    v_sub_f32 v95, v95, v240
    v_sub_f32 v96, v96, v240
    v_sub_f32 v97, v97, v240
    v_sub_f32 v98, v98, v240
    v_sub_f32 v99, v99, v240
    v_exp_f32 v92, v92
    v_exp_f32 v93, v93
    v_exp_f32 v94, v94
    v_exp_f32 v95, v95
    v_exp_f32 v96, v96
    v_exp_f32 v97, v97
    v_exp_f32 v98, v98
    v_exp_f32 v99, v99
    v_cvt_pk_bf16_f32 v88, v92, v93
    v_cvt_pk_bf16_f32 v89, v94, v95
    v_cvt_pk_bf16_f32 v90, v96, v97
    v_cvt_pk_bf16_f32 v91, v98, v99
    v_sub_f32 v100, v100, v240
    v_sub_f32 v101, v101, v240
    v_sub_f32 v102, v102, v240
    v_sub_f32 v103, v103, v240
    v_sub_f32 v104, v104, v240
    v_sub_f32 v105, v105, v240
    ds_read_b64_tr_b16 v[164:165], v220 offset:25088
    ds_read_b64_tr_b16 v[166:167], v221 offset:25088
    ds_read_b64_tr_b16 v[168:169], v222 offset:25088
    ds_read_b64_tr_b16 v[170:171], v223 offset:25088
    s_setprio 3
    s_waitcnt lgkmcnt(10)
    v_mfma_f32_32x32x16_bf16 v[148:163], v[172:175], v[84:87], v[148:163]
    s_waitcnt lgkmcnt(8)
    v_mfma_f32_32x32x16_bf16 v[148:163], v[176:179], v[88:91], v[148:163]
    s_setprio 0
    v_sub_f32 v106, v106, v240
    v_sub_f32 v107, v107, v240
    v_exp_f32 v100, v100
    v_exp_f32 v101, v101
    v_exp_f32 v102, v102
    v_exp_f32 v103, v103
    v_exp_f32 v104, v104
    v_exp_f32 v105, v105
    v_exp_f32 v106, v106
    v_exp_f32 v107, v107
    v_cvt_pk_bf16_f32 v100, v100, v101
    v_cvt_pk_bf16_f32 v101, v102, v103
    v_cvt_pk_bf16_f32 v102, v104, v105
    v_cvt_pk_bf16_f32 v103, v106, v107
    v_sub_f32 v108, v108, v240
    v_sub_f32 v109, v109, v240
    v_sub_f32 v110, v110, v240
    v_sub_f32 v111, v111, v240
    v_sub_f32 v112, v112, v240
    v_sub_f32 v113, v113, v240
    v_sub_f32 v114, v114, v240
    v_sub_f32 v115, v115, v240
    v_exp_f32 v108, v108
    v_exp_f32 v109, v109
    v_exp_f32 v110, v110
    v_exp_f32 v111, v111
    v_exp_f32 v112, v112
    v_exp_f32 v113, v113
    v_exp_f32 v114, v114
    v_exp_f32 v115, v115
    v_cvt_pk_bf16_f32 v104, v108, v109
    v_cvt_pk_bf16_f32 v105, v110, v111
    v_cvt_pk_bf16_f32 v106, v112, v113
    v_cvt_pk_bf16_f32 v107, v114, v115
    v_sub_f32 v116, v116, v240
    v_sub_f32 v117, v117, v240
    v_sub_f32 v118, v118, v240
    v_sub_f32 v119, v119, v240
    v_sub_f32 v120, v120, v240
    v_sub_f32 v121, v121, v240
    ds_read_b64_tr_b16 v[172:173], v220 offset:28672
    ds_read_b64_tr_b16 v[174:175], v221 offset:28672
    ds_read_b64_tr_b16 v[176:177], v222 offset:28672
    ds_read_b64_tr_b16 v[178:179], v223 offset:28672
    s_setprio 3
    s_waitcnt lgkmcnt(10)
    v_mfma_f32_32x32x16_bf16 v[148:163], v[180:183], v[100:103], v[148:163]
    s_waitcnt lgkmcnt(8)
    v_mfma_f32_32x32x16_bf16 v[148:163], v[184:187], v[104:107], v[148:163]
    s_setprio 0
    v_sub_f32 v122, v122, v240
    v_sub_f32 v123, v123, v240
    v_exp_f32 v116, v116
    v_exp_f32 v117, v117
    v_exp_f32 v118, v118
    v_exp_f32 v119, v119
    v_exp_f32 v120, v120
    v_exp_f32 v121, v121
    v_exp_f32 v122, v122
    v_exp_f32 v123, v123
    v_cvt_pk_bf16_f32 v116, v116, v117
    v_cvt_pk_bf16_f32 v117, v118, v119
    v_cvt_pk_bf16_f32 v118, v120, v121
    v_cvt_pk_bf16_f32 v119, v122, v123
    v_sub_f32 v124, v124, v240
    v_sub_f32 v125, v125, v240
    v_sub_f32 v126, v126, v240
    v_sub_f32 v127, v127, v240
    v_sub_f32 v128, v128, v240
    v_sub_f32 v129, v129, v240
    v_sub_f32 v130, v130, v240
    v_sub_f32 v131, v131, v240
    v_exp_f32 v124, v124
    v_exp_f32 v125, v125
    v_exp_f32 v126, v126
    v_exp_f32 v127, v127
    v_exp_f32 v128, v128
    v_exp_f32 v129, v129
    v_exp_f32 v130, v130
    v_exp_f32 v131, v131
    v_cvt_pk_bf16_f32 v120, v124, v125
    v_cvt_pk_bf16_f32 v121, v126, v127
    v_cvt_pk_bf16_f32 v122, v128, v129
    v_cvt_pk_bf16_f32 v123, v130, v131
    v_sub_f32 v132, v132, v240
    v_sub_f32 v133, v133, v240
    v_sub_f32 v134, v134, v240
    v_sub_f32 v135, v135, v240
    v_sub_f32 v136, v136, v240
    v_sub_f32 v137, v137, v240
    ds_read_b64_tr_b16 v[180:181], v220 offset:0
    ds_read_b64_tr_b16 v[182:183], v221 offset:0
    ds_read_b64_tr_b16 v[184:185], v222 offset:0
    ds_read_b64_tr_b16 v[186:187], v223 offset:0
    s_setprio 3
    s_waitcnt lgkmcnt(10)
    v_mfma_f32_32x32x16_bf16 v[148:163], v[164:167], v[116:119], v[148:163]
    s_waitcnt lgkmcnt(8)
    v_mfma_f32_32x32x16_bf16 v[148:163], v[168:171], v[120:123], v[148:163]
    s_setprio 0
    v_sub_f32 v138, v138, v240
    v_sub_f32 v139, v139, v240
    v_exp_f32 v132, v132
    v_exp_f32 v133, v133
    v_exp_f32 v134, v134
    v_exp_f32 v135, v135
    v_exp_f32 v136, v136
    v_exp_f32 v137, v137
    v_exp_f32 v138, v138
    v_exp_f32 v139, v139
    v_cvt_pk_bf16_f32 v132, v132, v133
    v_cvt_pk_bf16_f32 v133, v134, v135
    v_cvt_pk_bf16_f32 v134, v136, v137
    v_cvt_pk_bf16_f32 v135, v138, v139
    v_sub_f32 v140, v140, v240
    v_sub_f32 v141, v141, v240
    v_sub_f32 v142, v142, v240
    v_sub_f32 v143, v143, v240
    v_sub_f32 v144, v144, v240
    v_sub_f32 v145, v145, v240
    v_sub_f32 v146, v146, v240
    v_sub_f32 v147, v147, v240
    v_exp_f32 v140, v140
    v_exp_f32 v141, v141
    v_exp_f32 v142, v142
    v_exp_f32 v143, v143
    v_exp_f32 v144, v144
    v_exp_f32 v145, v145
    v_exp_f32 v146, v146
    v_exp_f32 v147, v147
    v_cvt_pk_bf16_f32 v136, v140, v141
    v_cvt_pk_bf16_f32 v137, v142, v143
    v_cvt_pk_bf16_f32 v138, v144, v145
    v_cvt_pk_bf16_f32 v139, v146, v147
    v_bfi_b32 v4, v208, 0, v132
    v_bfi_b32 v5, v209, 0, v133
    v_bfi_b32 v6, v210, 0, v134
    v_bfi_b32 v7, v211, 0, v135
    v_bfi_b32 v8, v212, 0, v136
    v_bfi_b32 v9, v213, 0, v137
    v_bfi_b32 v10, v214, 0, v138
    v_bfi_b32 v11, v215, 0, v139
    v_and_b32 v132, v208, v132
    v_and_b32 v133, v209, v133
    v_and_b32 v134, v210, v134
    v_and_b32 v135, v211, v135
    v_and_b32 v136, v212, v136
    v_and_b32 v137, v213, v137
    v_and_b32 v138, v214, v138
    v_and_b32 v139, v215, v139
    s_setprio 3
    s_waitcnt lgkmcnt(6)
    v_mfma_f32_32x32x16_bf16 v[148:163], v[172:175], v[132:135], v[148:163]
    s_waitcnt lgkmcnt(4)
    v_mfma_f32_32x32x16_bf16 v[148:163], v[176:179], v[136:139], v[148:163]
    s_setprio 0
    s_setprio 3
    s_waitcnt lgkmcnt(2)
    v_mfma_f32_32x32x16_bf16 v[148:163], v[180:183], v[4:7], v[148:163]
    s_waitcnt lgkmcnt(0)
    v_mfma_f32_32x32x16_bf16 v[148:163], v[184:187], v[8:11], v[148:163]
    s_setprio 0
    s_cmp_eq_u32 s37, 3
    s_cselect_b64 vcc, -1, 0
    s_nop 8
    v_cndmask_b32_e64 v224, v160, v148, vcc
    v_mov_b32 v225, v224
    s_nop 1
    v_permlane32_swap_b32 v224, v225
    v_cndmask_b32_e64 v224, v225, v224, vcc
    s_waitcnt vmcnt(0) lgkmcnt(0)
    s_nop 11
joined_70:
    v_rcp_f32 v224, v224
    s_nop 0
    v_mul_f32 v224, v224, v255
    v_mul_f32 v148, v148, v224
    v_mul_f32 v149, v149, v224
    v_mul_f32 v150, v150, v224
    v_mul_f32 v151, v151, v224
    v_mul_f32 v152, v152, v224
    v_mul_f32 v153, v153, v224
    v_mul_f32 v154, v154, v224
    v_mul_f32 v155, v155, v224
    v_mul_f32 v156, v156, v224
    v_mul_f32 v157, v157, v224
    v_mul_f32 v158, v158, v224
    v_mul_f32 v159, v159, v224
    v_mul_f32 v160, v160, v224
    v_mul_f32 v161, v161, v224
    v_mul_f32 v162, v162, v224
    v_mul_f32 v163, v163, v224
    v_cvt_pk_bf16_f32 v148, v148, v149
    v_cvt_pk_bf16_f32 v149, v150, v151
    v_cvt_pk_bf16_f32 v150, v152, v153
    v_cvt_pk_bf16_f32 v151, v154, v155
    v_cvt_pk_bf16_f32 v152, v156, v157
    v_cvt_pk_bf16_f32 v153, v158, v159
    v_cvt_pk_bf16_f32 v154, v160, v161
    v_cvt_pk_bf16_f32 v155, v162, v163
    s_lshl_b32 s45, s37, 2
    v_mov_b32 v227, 0x40000000
    v_add_u32 v225, 0, v229
    v_cmp_le_u32 vcc, s45, v225
    s_nop 1
    v_cndmask_b32_e64 v225, v227, v234, vcc
    buffer_store_dwordx2 v[148:149], v225, s[28:31], s46 offen offset:0 sc1
    v_add_u32 v225, 8, v229
    v_cmp_le_u32 vcc, s45, v225
    s_nop 1
    v_cndmask_b32_e64 v226, v227, v234, vcc
    buffer_store_dwordx2 v[150:151], v226, s[28:31], s46 offen offset:8 sc1
    v_mov_b32 v216, v152
    v_mov_b32 v217, v153
    v_mov_b32 v218, v154
    v_mov_b32 v219, v155
    s_lshl_b32 s45, s37, 2
    s_add_u32 s45, s45, 2
    v_subrev_u32 v224, s45, v229
    v_add_u32 v225, 0, v224
    v_cmp_gt_u32 vcc, 18, v225
    s_nop 1
    v_cndmask_b32_e64 v200, 0, v192, vcc
    v_add_u32 v226, 2, v224
    v_cmp_gt_u32 vcc, 18, v226
    s_nop 1
    v_cndmask_b32_e64 v201, 0, v193, vcc
    v_add_u32 v225, 8, v224
    v_cmp_gt_u32 vcc, 18, v225
    s_nop 1
    v_cndmask_b32_e64 v202, 0, v194, vcc
    v_add_u32 v226, 10, v224
    v_cmp_gt_u32 vcc, 18, v226
    s_nop 1
    v_cndmask_b32_e64 v203, 0, v195, vcc
    v_add_u32 v225, 16, v224
    v_cmp_gt_u32 vcc, 18, v225
    s_nop 1
    v_cndmask_b32_e64 v204, 0, v196, vcc
    v_add_u32 v226, 18, v224
    v_cmp_gt_u32 vcc, 18, v226
    s_nop 1
    v_cndmask_b32_e64 v205, 0, v197, vcc
    v_add_u32 v225, 24, v224
    v_cmp_gt_u32 vcc, 18, v225
    s_nop 1
    v_cndmask_b32_e64 v206, 0, v198, vcc
    v_add_u32 v226, 26, v224
    v_cmp_gt_u32 vcc, 18, v226
    s_nop 1
    v_cndmask_b32_e64 v207, 0, v199, vcc
    v_add_u32 v220, 1152, v230
    v_cndmask_b32 v220, v220, v231, s[50:51]
    v_add_u32 v221, 1408, v230
    v_cndmask_b32 v221, v221, v231, s[50:51]
    v_add_u32 v222, 1664, v230
    v_cndmask_b32 v222, v222, v231, s[50:51]
    v_add_u32 v223, 1920, v230
    v_cndmask_b32 v223, v223, v231, s[50:51]
    ds_read_b128 v[68:71], v228 offset:25600
    ds_read_b128 v[72:75], v228 offset:26624
    ds_read_b128 v[76:79], v228 offset:1024
    ds_read_b128 v[80:83], v228 offset:2048
    ds_read_b128 v[180:183], v228 offset:4096
    ds_read_b128 v[184:187], v228 offset:5120
    s_setprio 3
    s_waitcnt lgkmcnt(5)
    v_mfma_f32_32x32x16_bf16 v[132:147], v[68:71], v[200:203], 0
    s_waitcnt lgkmcnt(4)
    v_mfma_f32_32x32x16_bf16 v[132:147], v[72:75], v[204:207], v[132:147]
    s_setprio 0
    s_setprio 3
    s_waitcnt lgkmcnt(3)
    v_mfma_f32_32x32x16_bf16 v[4:19], v[76:79], v[200:203], 0
    s_waitcnt lgkmcnt(2)
    v_mfma_f32_32x32x16_bf16 v[4:19], v[80:83], v[204:207], v[4:19]
    s_setprio 0
    ds_read_b128 v[68:71], v228 offset:7168
    ds_read_b128 v[72:75], v228 offset:8192
    ds_read_b128 v[76:79], v228 offset:10240
    ds_read_b128 v[80:83], v228 offset:11264
    v_mov_b32 v240, v232
    v_mov_b32 v241, v232
    s_nop 4
    v_cndmask_b32 v132, v4, v132, s[56:57]
    v_cndmask_b32 v133, v5, v133, s[58:59]
    v_cndmask_b32 v134, v6, v134, s[60:61]
    v_cndmask_b32 v135, v7, v135, s[62:63]
    v_cndmask_b32 v136, v8, v136, s[64:65]
    v_cndmask_b32 v137, v9, v137, s[66:67]
    v_cndmask_b32 v138, v10, v138, s[68:69]
    v_cndmask_b32 v139, v11, v139, s[70:71]
    v_cndmask_b32 v140, v12, v140, s[72:73]
    v_cndmask_b32 v141, v13, v141, s[74:75]
    v_cndmask_b32 v142, v14, v142, s[76:77]
    v_cndmask_b32 v143, v15, v143, s[78:79]
    v_cndmask_b32 v144, v16, v144, s[80:81]
    v_cndmask_b32 v145, v17, v145, s[82:83]
    v_cndmask_b32 v146, v18, v146, s[84:85]
    v_cndmask_b32 v147, v19, v147, s[86:87]
    v_max3_f32 v240, v132, v133, v240
    v_max3_f32 v241, v134, v135, v241
    v_max3_f32 v240, v136, v137, v240
    v_max3_f32 v241, v138, v139, v241
    v_max3_f32 v240, v140, v141, v240
    v_max3_f32 v241, v142, v143, v241
    v_max3_f32 v240, v144, v145, v240
    v_max3_f32 v241, v146, v147, v241
    v_max_f32 v224, v240, v241
    v_mov_b32 v225, v224
    s_nop 1
    v_permlane32_swap_b32 v224, v225
    v_max_f32 v240, v224, v225
    v_sub_f32 v52, 0, v240
    v_sub_f32 v53, 0, v240
    v_sub_f32 v54, 0, v240
    v_sub_f32 v55, 0, v240
    v_sub_f32 v56, 0, v240
    v_sub_f32 v57, 0, v240
    v_sub_f32 v58, 0, v240
    v_sub_f32 v59, 0, v240
    v_sub_f32 v60, 0, v240
    v_sub_f32 v61, 0, v240
    v_sub_f32 v62, 0, v240
    v_sub_f32 v63, 0, v240
    v_sub_f32 v64, 0, v240
    v_sub_f32 v65, 0, v240
    v_sub_f32 v66, 0, v240
    v_sub_f32 v67, 0, v240
    s_setprio 3
    s_waitcnt lgkmcnt(5)
    v_mfma_f32_32x32x16_bf16 v[20:35], v[180:183], v[200:203], v[52:67]
    s_waitcnt lgkmcnt(4)
    v_mfma_f32_32x32x16_bf16 v[20:35], v[184:187], v[204:207], v[20:35]
    s_setprio 0
    v_sub_f32 v132, v132, v240
    v_sub_f32 v133, v133, v240
    v_sub_f32 v134, v134, v240
    v_sub_f32 v135, v135, v240
    v_sub_f32 v136, v136, v240
    v_sub_f32 v137, v137, v240
    v_sub_f32 v138, v138, v240
    v_sub_f32 v139, v139, v240
    v_exp_f32 v132, v132
    v_exp_f32 v133, v133
    v_exp_f32 v134, v134
    v_exp_f32 v135, v135
    v_exp_f32 v136, v136
    v_exp_f32 v137, v137
    v_exp_f32 v138, v138
    v_exp_f32 v139, v139
    v_cvt_pk_bf16_f32 v132, v132, v133
    v_cvt_pk_bf16_f32 v133, v134, v135
    v_cvt_pk_bf16_f32 v134, v136, v137
    v_cvt_pk_bf16_f32 v135, v138, v139
    v_sub_f32 v140, v140, v240
    v_sub_f32 v141, v141, v240
    v_sub_f32 v142, v142, v240
    v_sub_f32 v143, v143, v240
    v_sub_f32 v144, v144, v240
    v_sub_f32 v145, v145, v240
    v_sub_f32 v146, v146, v240
    v_sub_f32 v147, v147, v240
    v_exp_f32 v140, v140
    v_exp_f32 v141, v141
    v_exp_f32 v142, v142
    v_exp_f32 v143, v143
    v_exp_f32 v144, v144
    v_exp_f32 v145, v145
    v_exp_f32 v146, v146
    v_exp_f32 v147, v147
    v_cvt_pk_bf16_f32 v136, v140, v141
    v_cvt_pk_bf16_f32 v137, v142, v143
    v_cvt_pk_bf16_f32 v138, v144, v145
    v_cvt_pk_bf16_f32 v139, v146, v147
    v_bfi_b32 v4, v208, 0, v132
    v_bfi_b32 v5, v209, 0, v133
    v_bfi_b32 v6, v210, 0, v134
    v_bfi_b32 v7, v211, 0, v135
    v_bfi_b32 v8, v212, 0, v136
    v_bfi_b32 v9, v213, 0, v137
    v_bfi_b32 v10, v214, 0, v138
    v_bfi_b32 v11, v215, 0, v139
    v_and_b32 v132, v208, v132
    v_and_b32 v133, v209, v133
    v_and_b32 v134, v210, v134
    v_and_b32 v135, v211, v135
    v_and_b32 v136, v212, v136
    v_and_b32 v137, v213, v137
    v_and_b32 v138, v214, v138
    v_and_b32 v139, v215, v139
    ds_read_b64_tr_b16 v[164:165], v220 offset:28672
    ds_read_b64_tr_b16 v[166:167], v221 offset:28672
    ds_read_b64_tr_b16 v[168:169], v222 offset:28672
    ds_read_b64_tr_b16 v[170:171], v223 offset:28672
    ds_read_b64_tr_b16 v[172:173], v220 offset:0
    ds_read_b64_tr_b16 v[174:175], v221 offset:0
    ds_read_b64_tr_b16 v[176:177], v222 offset:0
    ds_read_b64_tr_b16 v[178:179], v223 offset:0
    s_setprio 3
    s_waitcnt lgkmcnt(11)
    v_mfma_f32_32x32x16_bf16 v[36:51], v[68:71], v[200:203], v[52:67]
    s_waitcnt lgkmcnt(10)
    v_mfma_f32_32x32x16_bf16 v[36:51], v[72:75], v[204:207], v[36:51]
    s_setprio 0
    ds_read_b128 v[180:183], v228 offset:13312
    ds_read_b128 v[184:187], v228 offset:14336
    s_setprio 3
    s_waitcnt lgkmcnt(8)
    v_mfma_f32_32x32x16_bf16 v[148:163], v[164:167], v[132:135], 0
    s_waitcnt lgkmcnt(6)
    v_mfma_f32_32x32x16_bf16 v[148:163], v[168:171], v[136:139], v[148:163]
    s_setprio 0
    ds_read_b64_tr_b16 v[164:165], v220 offset:3584
    ds_read_b64_tr_b16 v[166:167], v221 offset:3584
    ds_read_b64_tr_b16 v[168:169], v222 offset:3584
    ds_read_b64_tr_b16 v[170:171], v223 offset:3584
    s_setprio 3
    s_waitcnt lgkmcnt(8)
    v_mfma_f32_32x32x16_bf16 v[148:163], v[172:175], v[4:7], v[148:163]
    s_waitcnt lgkmcnt(6)
    v_mfma_f32_32x32x16_bf16 v[148:163], v[176:179], v[8:11], v[148:163]
    s_setprio 0
    ds_read_b64_tr_b16 v[172:173], v220 offset:7168
    ds_read_b64_tr_b16 v[174:175], v221 offset:7168
    ds_read_b64_tr_b16 v[176:177], v222 offset:7168
    ds_read_b64_tr_b16 v[178:179], v223 offset:7168
    v_exp_f32 v20, v20
    v_exp_f32 v21, v21
    v_exp_f32 v22, v22
    v_exp_f32 v23, v23
    v_exp_f32 v24, v24
    v_exp_f32 v25, v25
    v_exp_f32 v26, v26
    v_exp_f32 v27, v27
    v_cvt_pk_bf16_f32 v20, v20, v21
    v_cvt_pk_bf16_f32 v21, v22, v23
    v_cvt_pk_bf16_f32 v22, v24, v25
    v_cvt_pk_bf16_f32 v23, v26, v27
    v_exp_f32 v28, v28
    v_exp_f32 v29, v29
    v_exp_f32 v30, v30
    v_exp_f32 v31, v31
    v_exp_f32 v32, v32
    v_exp_f32 v33, v33
    v_exp_f32 v34, v34
    v_exp_f32 v35, v35
    v_cvt_pk_bf16_f32 v24, v28, v29
    v_cvt_pk_bf16_f32 v25, v30, v31
    v_cvt_pk_bf16_f32 v26, v32, v33
    v_cvt_pk_bf16_f32 v27, v34, v35
    s_setprio 3
    s_waitcnt lgkmcnt(6)
    v_mfma_f32_32x32x16_bf16 v[148:163], v[164:167], v[20:23], v[148:163]
    s_waitcnt lgkmcnt(4)
    v_mfma_f32_32x32x16_bf16 v[148:163], v[168:171], v[24:27], v[148:163]
    s_setprio 0
    ds_read_b64_tr_b16 v[164:165], v220 offset:10752
    ds_read_b64_tr_b16 v[166:167], v221 offset:10752
    ds_read_b64_tr_b16 v[168:169], v222 offset:10752
    ds_read_b64_tr_b16 v[170:171], v223 offset:10752
    s_setprio 3
    v_mfma_f32_32x32x16_bf16 v[20:35], v[76:79], v[200:203], v[52:67]
    v_mfma_f32_32x32x16_bf16 v[20:35], v[80:83], v[204:207], v[20:35]
    s_setprio 0
    ds_read_b128 v[68:71], v228 offset:16384
    ds_read_b128 v[72:75], v228 offset:17408
    v_exp_f32 v36, v36
    v_exp_f32 v37, v37
    v_exp_f32 v38, v38
    v_exp_f32 v39, v39
    v_exp_f32 v40, v40
    v_exp_f32 v41, v41
    v_exp_f32 v42, v42
    v_exp_f32 v43, v43
    v_cvt_pk_bf16_f32 v36, v36, v37
    v_cvt_pk_bf16_f32 v37, v38, v39
    v_cvt_pk_bf16_f32 v38, v40, v41
    v_cvt_pk_bf16_f32 v39, v42, v43
    v_exp_f32 v44, v44
    v_exp_f32 v45, v45
    v_exp_f32 v46, v46
    v_exp_f32 v47, v47
    v_exp_f32 v48, v48
    v_exp_f32 v49, v49
    v_exp_f32 v50, v50
    v_exp_f32 v51, v51
    v_cvt_pk_bf16_f32 v40, v44, v45
    v_cvt_pk_bf16_f32 v41, v46, v47
    v_cvt_pk_bf16_f32 v42, v48, v49
    v_cvt_pk_bf16_f32 v43, v50, v51
    s_setprio 3
    s_waitcnt lgkmcnt(8)
    v_mfma_f32_32x32x16_bf16 v[148:163], v[172:175], v[36:39], v[148:163]
    s_waitcnt lgkmcnt(6)
    v_mfma_f32_32x32x16_bf16 v[148:163], v[176:179], v[40:43], v[148:163]
    s_setprio 0
    ds_read_b64_tr_b16 v[172:173], v220 offset:14336
    ds_read_b64_tr_b16 v[174:175], v221 offset:14336
    ds_read_b64_tr_b16 v[176:177], v222 offset:14336
    ds_read_b64_tr_b16 v[178:179], v223 offset:14336
    s_setprio 3
    v_mfma_f32_32x32x16_bf16 v[36:51], v[180:183], v[200:203], v[52:67]
    v_mfma_f32_32x32x16_bf16 v[36:51], v[184:187], v[204:207], v[36:51]
    s_setprio 0
    ds_read_b128 v[76:79], v228 offset:19456
    ds_read_b128 v[80:83], v228 offset:20480
    v_exp_f32 v20, v20
    v_exp_f32 v21, v21
    v_exp_f32 v22, v22
    v_exp_f32 v23, v23
    v_exp_f32 v24, v24
    v_exp_f32 v25, v25
    v_exp_f32 v26, v26
    v_exp_f32 v27, v27
    v_cvt_pk_bf16_f32 v20, v20, v21
    v_cvt_pk_bf16_f32 v21, v22, v23
    v_cvt_pk_bf16_f32 v22, v24, v25
    v_cvt_pk_bf16_f32 v23, v26, v27
    v_exp_f32 v28, v28
    v_exp_f32 v29, v29
    v_exp_f32 v30, v30
    v_exp_f32 v31, v31
    v_exp_f32 v32, v32
    v_exp_f32 v33, v33
    v_exp_f32 v34, v34
    v_exp_f32 v35, v35
    v_cvt_pk_bf16_f32 v24, v28, v29
    v_cvt_pk_bf16_f32 v25, v30, v31
    v_cvt_pk_bf16_f32 v26, v32, v33
    v_cvt_pk_bf16_f32 v27, v34, v35
    s_setprio 3
    s_waitcnt lgkmcnt(10)
    v_mfma_f32_32x32x16_bf16 v[148:163], v[164:167], v[20:23], v[148:163]
    s_waitcnt lgkmcnt(8)
    v_mfma_f32_32x32x16_bf16 v[148:163], v[168:171], v[24:27], v[148:163]
    s_setprio 0
    ds_read_b64_tr_b16 v[164:165], v220 offset:17920
    ds_read_b64_tr_b16 v[166:167], v221 offset:17920
    ds_read_b64_tr_b16 v[168:169], v222 offset:17920
    ds_read_b64_tr_b16 v[170:171], v223 offset:17920
    s_setprio 3
    s_waitcnt lgkmcnt(11)
    v_mfma_f32_32x32x16_bf16 v[20:35], v[68:71], v[200:203], v[52:67]
    s_waitcnt lgkmcnt(10)
    v_mfma_f32_32x32x16_bf16 v[20:35], v[72:75], v[204:207], v[20:35]
    s_setprio 0
    ds_read_b128 v[180:183], v228 offset:22528
    ds_read_b128 v[184:187], v228 offset:23552
    v_exp_f32 v36, v36
    v_exp_f32 v37, v37
    v_exp_f32 v38, v38
    v_exp_f32 v39, v39
    v_exp_f32 v40, v40
    v_exp_f32 v41, v41
    v_exp_f32 v42, v42
    v_exp_f32 v43, v43
    v_cvt_pk_bf16_f32 v36, v36, v37
    v_cvt_pk_bf16_f32 v37, v38, v39
    v_cvt_pk_bf16_f32 v38, v40, v41
    v_cvt_pk_bf16_f32 v39, v42, v43
    v_exp_f32 v44, v44
    v_exp_f32 v45, v45
    v_exp_f32 v46, v46
    v_exp_f32 v47, v47
    v_exp_f32 v48, v48
    v_exp_f32 v49, v49
    v_exp_f32 v50, v50
    v_exp_f32 v51, v51
    v_cvt_pk_bf16_f32 v40, v44, v45
    v_cvt_pk_bf16_f32 v41, v46, v47
    v_cvt_pk_bf16_f32 v42, v48, v49
    v_cvt_pk_bf16_f32 v43, v50, v51
    s_setprio 3
    s_waitcnt lgkmcnt(10)
    v_mfma_f32_32x32x16_bf16 v[148:163], v[172:175], v[36:39], v[148:163]
    s_waitcnt lgkmcnt(8)
    v_mfma_f32_32x32x16_bf16 v[148:163], v[176:179], v[40:43], v[148:163]
    s_setprio 0
    ds_read_b64_tr_b16 v[172:173], v220 offset:21504
    ds_read_b64_tr_b16 v[174:175], v221 offset:21504
    ds_read_b64_tr_b16 v[176:177], v222 offset:21504
    ds_read_b64_tr_b16 v[178:179], v223 offset:21504
    s_setprio 3
    s_waitcnt lgkmcnt(11)
    v_mfma_f32_32x32x16_bf16 v[36:51], v[76:79], v[200:203], v[52:67]
    s_waitcnt lgkmcnt(10)
    v_mfma_f32_32x32x16_bf16 v[36:51], v[80:83], v[204:207], v[36:51]
    s_setprio 0
    v_exp_f32 v20, v20
    v_exp_f32 v21, v21
    v_exp_f32 v22, v22
    v_exp_f32 v23, v23
    v_exp_f32 v24, v24
    v_exp_f32 v25, v25
    v_exp_f32 v26, v26
    v_exp_f32 v27, v27
    v_cvt_pk_bf16_f32 v20, v20, v21
    v_cvt_pk_bf16_f32 v21, v22, v23
    v_cvt_pk_bf16_f32 v22, v24, v25
    v_cvt_pk_bf16_f32 v23, v26, v27
    v_exp_f32 v28, v28
    v_exp_f32 v29, v29
    v_exp_f32 v30, v30
    v_exp_f32 v31, v31
    v_exp_f32 v32, v32
    v_exp_f32 v33, v33
    v_exp_f32 v34, v34
    v_exp_f32 v35, v35
    v_cvt_pk_bf16_f32 v24, v28, v29
    v_cvt_pk_bf16_f32 v25, v30, v31
    v_cvt_pk_bf16_f32 v26, v32, v33
    v_cvt_pk_bf16_f32 v27, v34, v35
    s_setprio 3
    s_waitcnt lgkmcnt(8)
    v_mfma_f32_32x32x16_bf16 v[148:163], v[164:167], v[20:23], v[148:163]
    s_waitcnt lgkmcnt(6)
    v_mfma_f32_32x32x16_bf16 v[148:163], v[168:171], v[24:27], v[148:163]
    s_setprio 0
    ds_read_b64_tr_b16 v[164:165], v220 offset:25088
    ds_read_b64_tr_b16 v[166:167], v221 offset:25088
    ds_read_b64_tr_b16 v[168:169], v222 offset:25088
    ds_read_b64_tr_b16 v[170:171], v223 offset:25088
    s_setprio 3
    s_waitcnt lgkmcnt(9)
    v_mfma_f32_32x32x16_bf16 v[20:35], v[180:183], v[200:203], v[52:67]
    s_waitcnt lgkmcnt(8)
    v_mfma_f32_32x32x16_bf16 v[20:35], v[184:187], v[204:207], v[20:35]
    s_setprio 0
    v_exp_f32 v36, v36
    v_exp_f32 v37, v37
    v_exp_f32 v38, v38
    v_exp_f32 v39, v39
    v_exp_f32 v40, v40
    v_exp_f32 v41, v41
    v_exp_f32 v42, v42
    v_exp_f32 v43, v43
    v_cvt_pk_bf16_f32 v36, v36, v37
    v_cvt_pk_bf16_f32 v37, v38, v39
    v_cvt_pk_bf16_f32 v38, v40, v41
    v_cvt_pk_bf16_f32 v39, v42, v43
    v_exp_f32 v44, v44
    v_exp_f32 v45, v45
    v_exp_f32 v46, v46
    v_exp_f32 v47, v47
    v_exp_f32 v48, v48
    v_exp_f32 v49, v49
    v_exp_f32 v50, v50
    v_exp_f32 v51, v51
    v_cvt_pk_bf16_f32 v40, v44, v45
    v_cvt_pk_bf16_f32 v41, v46, v47
    v_cvt_pk_bf16_f32 v42, v48, v49
    v_cvt_pk_bf16_f32 v43, v50, v51
    s_setprio 3
    s_waitcnt lgkmcnt(6)
    v_mfma_f32_32x32x16_bf16 v[148:163], v[172:175], v[36:39], v[148:163]
    s_waitcnt lgkmcnt(4)
    v_mfma_f32_32x32x16_bf16 v[148:163], v[176:179], v[40:43], v[148:163]
    s_setprio 0
    v_exp_f32 v20, v20
    v_exp_f32 v21, v21
    v_exp_f32 v22, v22
    v_exp_f32 v23, v23
    v_exp_f32 v24, v24
    v_exp_f32 v25, v25
    v_exp_f32 v26, v26
    v_exp_f32 v27, v27
    v_cvt_pk_bf16_f32 v20, v20, v21
    v_cvt_pk_bf16_f32 v21, v22, v23
    v_cvt_pk_bf16_f32 v22, v24, v25
    v_cvt_pk_bf16_f32 v23, v26, v27
    v_exp_f32 v28, v28
    v_exp_f32 v29, v29
    v_exp_f32 v30, v30
    v_exp_f32 v31, v31
    v_exp_f32 v32, v32
    v_exp_f32 v33, v33
    v_exp_f32 v34, v34
    v_exp_f32 v35, v35
    v_cvt_pk_bf16_f32 v24, v28, v29
    v_cvt_pk_bf16_f32 v25, v30, v31
    v_cvt_pk_bf16_f32 v26, v32, v33
    v_cvt_pk_bf16_f32 v27, v34, v35
    s_setprio 3
    s_waitcnt lgkmcnt(2)
    v_mfma_f32_32x32x16_bf16 v[148:163], v[164:167], v[20:23], v[148:163]
    s_waitcnt lgkmcnt(0)
    v_mfma_f32_32x32x16_bf16 v[148:163], v[168:171], v[24:27], v[148:163]
    s_setprio 0
    s_cmp_eq_u32 s37, 3
    s_cselect_b64 vcc, -1, 0
    s_nop 8
    v_cndmask_b32_e64 v224, v160, v148, vcc
    v_mov_b32 v225, v224
    s_nop 1
    v_permlane32_swap_b32 v224, v225
    v_cndmask_b32_e64 v224, v225, v224, vcc
    v_mov_b32 v225, 0x53800000
    v_mov_b32 v226, 0x2b800000
    v_cmp_nle_f32 vcc, v224, v225
    v_cmp_nge_f32 s[48:49], v224, v226
    s_nop 3
    s_or_b64 vcc, vcc, s[48:49]
    s_cmp_eq_u64 vcc, 0
    s_cbranch_scc1 joined_77
exact_76:
    s_waitcnt vmcnt(0) lgkmcnt(0)
    s_nop 11
    v_mov_b32 v240, v232
    v_mov_b32 v241, v232
    ds_read_b128 v[164:167], v228 offset:25600
    ds_read_b128 v[168:171], v228 offset:26624
    ds_read_b128 v[172:175], v228 offset:1024
    ds_read_b128 v[176:179], v228 offset:2048
    ds_read_b128 v[180:183], v228 offset:4096
    ds_read_b128 v[184:187], v228 offset:5120
    s_setprio 3
    s_waitcnt lgkmcnt(5)
    v_mfma_f32_32x32x16_bf16 v[132:147], v[164:167], v[200:203], 0
    s_waitcnt lgkmcnt(4)
    v_mfma_f32_32x32x16_bf16 v[132:147], v[168:171], v[204:207], v[132:147]
    s_setprio 0
    ds_read_b128 v[164:167], v228 offset:7168
    ds_read_b128 v[168:171], v228 offset:8192
    s_setprio 3
    s_waitcnt lgkmcnt(5)
    v_mfma_f32_32x32x16_bf16 v[4:19], v[172:175], v[200:203], 0
    s_waitcnt lgkmcnt(4)
    v_mfma_f32_32x32x16_bf16 v[4:19], v[176:179], v[204:207], v[4:19]
    s_setprio 0
    ds_read_b128 v[172:175], v228 offset:10240
    ds_read_b128 v[176:179], v228 offset:11264
    s_setprio 3
    s_waitcnt lgkmcnt(5)
    v_mfma_f32_32x32x16_bf16 v[20:35], v[180:183], v[200:203], 0
    s_waitcnt lgkmcnt(4)
    v_mfma_f32_32x32x16_bf16 v[20:35], v[184:187], v[204:207], v[20:35]
    s_setprio 0
    ds_read_b128 v[180:183], v228 offset:13312
    ds_read_b128 v[184:187], v228 offset:14336
    s_setprio 3
    s_waitcnt lgkmcnt(5)
    v_mfma_f32_32x32x16_bf16 v[36:51], v[164:167], v[200:203], 0
    s_waitcnt lgkmcnt(4)
    v_mfma_f32_32x32x16_bf16 v[36:51], v[168:171], v[204:207], v[36:51]
    s_setprio 0
    ds_read_b128 v[164:167], v228 offset:16384
    ds_read_b128 v[168:171], v228 offset:17408
    s_setprio 3
    s_waitcnt lgkmcnt(5)
    v_mfma_f32_32x32x16_bf16 v[52:67], v[172:175], v[200:203], 0
    s_waitcnt lgkmcnt(4)
    v_mfma_f32_32x32x16_bf16 v[52:67], v[176:179], v[204:207], v[52:67]
    s_setprio 0
    ds_read_b128 v[172:175], v228 offset:19456
    ds_read_b128 v[176:179], v228 offset:20480
    s_setprio 3
    s_waitcnt lgkmcnt(5)
    v_mfma_f32_32x32x16_bf16 v[68:83], v[180:183], v[200:203], 0
    s_waitcnt lgkmcnt(4)
    v_mfma_f32_32x32x16_bf16 v[68:83], v[184:187], v[204:207], v[68:83]
    s_setprio 0
    ds_read_b128 v[180:183], v228 offset:22528
    ds_read_b128 v[184:187], v228 offset:23552
    s_setprio 3
    s_waitcnt lgkmcnt(5)
    v_mfma_f32_32x32x16_bf16 v[84:99], v[164:167], v[200:203], 0
    s_waitcnt lgkmcnt(4)
    v_mfma_f32_32x32x16_bf16 v[84:99], v[168:171], v[204:207], v[84:99]
    s_setprio 0
    s_setprio 3
    s_waitcnt lgkmcnt(3)
    v_mfma_f32_32x32x16_bf16 v[100:115], v[172:175], v[200:203], 0
    s_waitcnt lgkmcnt(2)
    v_mfma_f32_32x32x16_bf16 v[100:115], v[176:179], v[204:207], v[100:115]
    s_setprio 0
    s_setprio 3
    s_waitcnt lgkmcnt(1)
    v_mfma_f32_32x32x16_bf16 v[116:131], v[180:183], v[200:203], 0
    s_waitcnt lgkmcnt(0)
    v_mfma_f32_32x32x16_bf16 v[116:131], v[184:187], v[204:207], v[116:131]
    s_setprio 0
    v_cndmask_b32 v132, v4, v132, s[56:57]
    v_cndmask_b32 v133, v5, v133, s[58:59]
    v_cndmask_b32 v134, v6, v134, s[60:61]
    v_cndmask_b32 v135, v7, v135, s[62:63]
    v_cndmask_b32 v136, v8, v136, s[64:65]
    v_cndmask_b32 v137, v9, v137, s[66:67]
    v_cndmask_b32 v138, v10, v138, s[68:69]
    v_cndmask_b32 v139, v11, v139, s[70:71]
    v_cndmask_b32 v140, v12, v140, s[72:73]
    v_cndmask_b32 v141, v13, v141, s[74:75]
    v_cndmask_b32 v142, v14, v142, s[76:77]
    v_cndmask_b32 v143, v15, v143, s[78:79]
    v_cndmask_b32 v144, v16, v144, s[80:81]
    v_cndmask_b32 v145, v17, v145, s[82:83]
    v_cndmask_b32 v146, v18, v146, s[84:85]
    v_cndmask_b32 v147, v19, v147, s[86:87]
    s_cmp_ge_u32 s38, 8
    s_cbranch_scc1 nofix_78
    s_nop 11
    v_cndmask_b32 v132, v232, v132, s[56:57]
    v_cndmask_b32 v133, v232, v133, s[58:59]
    v_cndmask_b32 v134, v232, v134, s[60:61]
    v_cndmask_b32 v135, v232, v135, s[62:63]
    v_cndmask_b32 v136, v232, v136, s[64:65]
    v_cndmask_b32 v137, v232, v137, s[66:67]
    v_cndmask_b32 v138, v232, v138, s[68:69]
    v_cndmask_b32 v139, v232, v139, s[70:71]
    v_cndmask_b32 v140, v232, v140, s[72:73]
    v_cndmask_b32 v141, v232, v141, s[74:75]
    v_cndmask_b32 v142, v232, v142, s[76:77]
    v_cndmask_b32 v143, v232, v143, s[78:79]
    v_cndmask_b32 v144, v232, v144, s[80:81]
    v_cndmask_b32 v145, v232, v145, s[82:83]
    v_cndmask_b32 v146, v232, v146, s[84:85]
    v_cndmask_b32 v147, v232, v147, s[86:87]
    s_cmp_ge_u32 s38, 7
    s_cbranch_scc1 nofix_78
    v_mov_b32 v20, v232
    v_mov_b32 v21, v232
    v_mov_b32 v22, v232
    v_mov_b32 v23, v232
    v_mov_b32 v24, v232
    v_mov_b32 v25, v232
    v_mov_b32 v26, v232
    v_mov_b32 v27, v232
    v_mov_b32 v28, v232
    v_mov_b32 v29, v232
    v_mov_b32 v30, v232
    v_mov_b32 v31, v232
    v_mov_b32 v32, v232
    v_mov_b32 v33, v232
    v_mov_b32 v34, v232
    v_mov_b32 v35, v232
    s_cmp_ge_u32 s38, 6
    s_cbranch_scc1 nofix_78
    v_mov_b32 v36, v232
    v_mov_b32 v37, v232
    v_mov_b32 v38, v232
    v_mov_b32 v39, v232
    v_mov_b32 v40, v232
    v_mov_b32 v41, v232
    v_mov_b32 v42, v232
    v_mov_b32 v43, v232
    v_mov_b32 v44, v232
    v_mov_b32 v45, v232
    v_mov_b32 v46, v232
    v_mov_b32 v47, v232
    v_mov_b32 v48, v232
    v_mov_b32 v49, v232
    v_mov_b32 v50, v232
    v_mov_b32 v51, v232
    s_cmp_ge_u32 s38, 5
    s_cbranch_scc1 nofix_78
    v_mov_b32 v52, v232
    v_mov_b32 v53, v232
    v_mov_b32 v54, v232
    v_mov_b32 v55, v232
    v_mov_b32 v56, v232
    v_mov_b32 v57, v232
    v_mov_b32 v58, v232
    v_mov_b32 v59, v232
    v_mov_b32 v60, v232
    v_mov_b32 v61, v232
    v_mov_b32 v62, v232
    v_mov_b32 v63, v232
    v_mov_b32 v64, v232
    v_mov_b32 v65, v232
    v_mov_b32 v66, v232
    v_mov_b32 v67, v232
    s_cmp_ge_u32 s38, 4
    s_cbranch_scc1 nofix_78
    v_mov_b32 v68, v232
    v_mov_b32 v69, v232
    v_mov_b32 v70, v232
    v_mov_b32 v71, v232
    v_mov_b32 v72, v232
    v_mov_b32 v73, v232
    v_mov_b32 v74, v232
    v_mov_b32 v75, v232
    v_mov_b32 v76, v232
    v_mov_b32 v77, v232
    v_mov_b32 v78, v232
    v_mov_b32 v79, v232
    v_mov_b32 v80, v232
    v_mov_b32 v81, v232
    v_mov_b32 v82, v232
    v_mov_b32 v83, v232
    s_cmp_ge_u32 s38, 3
    s_cbranch_scc1 nofix_78
    v_mov_b32 v84, v232
    v_mov_b32 v85, v232
    v_mov_b32 v86, v232
    v_mov_b32 v87, v232
    v_mov_b32 v88, v232
    v_mov_b32 v89, v232
    v_mov_b32 v90, v232
    v_mov_b32 v91, v232
    v_mov_b32 v92, v232
    v_mov_b32 v93, v232
    v_mov_b32 v94, v232
    v_mov_b32 v95, v232
    v_mov_b32 v96, v232
    v_mov_b32 v97, v232
    v_mov_b32 v98, v232
    v_mov_b32 v99, v232
    s_cmp_ge_u32 s38, 2
    s_cbranch_scc1 nofix_78
    v_mov_b32 v100, v232
    v_mov_b32 v101, v232
    v_mov_b32 v102, v232
    v_mov_b32 v103, v232
    v_mov_b32 v104, v232
    v_mov_b32 v105, v232
    v_mov_b32 v106, v232
    v_mov_b32 v107, v232
    v_mov_b32 v108, v232
    v_mov_b32 v109, v232
    v_mov_b32 v110, v232
    v_mov_b32 v111, v232
    v_mov_b32 v112, v232
    v_mov_b32 v113, v232
    v_mov_b32 v114, v232
    v_mov_b32 v115, v232
    s_cmp_ge_u32 s38, 1
    s_cbranch_scc1 nofix_78
    v_mov_b32 v116, v232
    v_mov_b32 v117, v232
    v_mov_b32 v118, v232
    v_mov_b32 v119, v232
    v_mov_b32 v120, v232
    v_mov_b32 v121, v232
    v_mov_b32 v122, v232
    v_mov_b32 v123, v232
    v_mov_b32 v124, v232
    v_mov_b32 v125, v232
    v_mov_b32 v126, v232
    v_mov_b32 v127, v232
    v_mov_b32 v128, v232
    v_mov_b32 v129, v232
    v_mov_b32 v130, v232
    v_mov_b32 v131, v232
nofix_78:
    s_nop 1
    v_max3_f32 v240, v132, v133, v240
    v_max3_f32 v241, v134, v135, v241
    v_max3_f32 v240, v136, v137, v240
    v_max3_f32 v241, v138, v139, v241
    v_max3_f32 v240, v140, v141, v240
    v_max3_f32 v241, v142, v143, v241
    v_max3_f32 v240, v144, v145, v240
    v_max3_f32 v241, v146, v147, v241
    v_max3_f32 v240, v20, v21, v240
    v_max3_f32 v241, v22, v23, v241
    v_max3_f32 v240, v24, v25, v240
    v_max3_f32 v241, v26, v27, v241
    v_max3_f32 v240, v28, v29, v240
    v_max3_f32 v241, v30, v31, v241
    v_max3_f32 v240, v32, v33, v240
    v_max3_f32 v241, v34, v35, v241
    v_max3_f32 v240, v36, v37, v240
    v_max3_f32 v241, v38, v39, v241
    v_max3_f32 v240, v40, v41, v240
    v_max3_f32 v241, v42, v43, v241
    v_max3_f32 v240, v44, v45, v240
    v_max3_f32 v241, v46, v47, v241
    v_max3_f32 v240, v48, v49, v240
    v_max3_f32 v241, v50, v51, v241
    v_max3_f32 v240, v52, v53, v240
    v_max3_f32 v241, v54, v55, v241
    v_max3_f32 v240, v56, v57, v240
    v_max3_f32 v241, v58, v59, v241
    v_max3_f32 v240, v60, v61, v240
    v_max3_f32 v241, v62, v63, v241
    v_max3_f32 v240, v64, v65, v240
    v_max3_f32 v241, v66, v67, v241
    v_max3_f32 v240, v68, v69, v240
    v_max3_f32 v241, v70, v71, v241
    v_max3_f32 v240, v72, v73, v240
    v_max3_f32 v241, v74, v75, v241
    v_max3_f32 v240, v76, v77, v240
    v_max3_f32 v241, v78, v79, v241
    v_max3_f32 v240, v80, v81, v240
    v_max3_f32 v241, v82, v83, v241
    v_max3_f32 v240, v84, v85, v240
    v_max3_f32 v241, v86, v87, v241
    v_max3_f32 v240, v88, v89, v240
    v_max3_f32 v241, v90, v91, v241
    v_max3_f32 v240, v92, v93, v240
    v_max3_f32 v241, v94, v95, v241
    v_max3_f32 v240, v96, v97, v240
    v_max3_f32 v241, v98, v99, v241
    v_max3_f32 v240, v100, v101, v240
    v_max3_f32 v241, v102, v103, v241
    v_max3_f32 v240, v104, v105, v240
    v_max3_f32 v241, v106, v107, v241
    v_max3_f32 v240, v108, v109, v240
    v_max3_f32 v241, v110, v111, v241
    v_max3_f32 v240, v112, v113, v240
    v_max3_f32 v241, v114, v115, v241
    v_max3_f32 v240, v116, v117, v240
    v_max3_f32 v241, v118, v119, v241
    v_max3_f32 v240, v120, v121, v240
    v_max3_f32 v241, v122, v123, v241
    v_max3_f32 v240, v124, v125, v240
    v_max3_f32 v241, v126, v127, v241
    v_max3_f32 v240, v128, v129, v240
    v_max3_f32 v241, v130, v131, v241
    v_max_f32 v224, v240, v241
    v_mov_b32 v225, v224
    s_nop 1
    v_permlane32_swap_b32 v224, v225
    v_max_f32 v240, v224, v225
    ds_read_b64_tr_b16 v[164:165], v220 offset:3584
    ds_read_b64_tr_b16 v[166:167], v221 offset:3584
    ds_read_b64_tr_b16 v[168:169], v222 offset:3584
    ds_read_b64_tr_b16 v[170:171], v223 offset:3584
    ds_read_b64_tr_b16 v[172:173], v220 offset:7168
    ds_read_b64_tr_b16 v[174:175], v221 offset:7168
    ds_read_b64_tr_b16 v[176:177], v222 offset:7168
    ds_read_b64_tr_b16 v[178:179], v223 offset:7168
    v_sub_f32 v20, v20, v240
    v_sub_f32 v21, v21, v240
    v_sub_f32 v22, v22, v240
    v_sub_f32 v23, v23, v240
    v_sub_f32 v24, v24, v240
    v_sub_f32 v25, v25, v240
    v_sub_f32 v26, v26, v240
    v_sub_f32 v27, v27, v240
    v_exp_f32 v20, v20
    v_exp_f32 v21, v21
    v_exp_f32 v22, v22
    v_exp_f32 v23, v23
    v_exp_f32 v24, v24
    v_exp_f32 v25, v25
    v_exp_f32 v26, v26
    v_exp_f32 v27, v27
    v_cvt_pk_bf16_f32 v20, v20, v21
    v_cvt_pk_bf16_f32 v21, v22, v23
    v_cvt_pk_bf16_f32 v22, v24, v25
    v_cvt_pk_bf16_f32 v23, v26, v27
    v_sub_f32 v28, v28, v240
    v_sub_f32 v29, v29, v240
    v_sub_f32 v30, v30, v240
    v_sub_f32 v31, v31, v240
    v_sub_f32 v32, v32, v240
    v_sub_f32 v33, v33, v240
    v_sub_f32 v34, v34, v240
    v_sub_f32 v35, v35, v240
    v_exp_f32 v28, v28
    v_exp_f32 v29, v29
    v_exp_f32 v30, v30
    v_exp_f32 v31, v31
    v_exp_f32 v32, v32
    v_exp_f32 v33, v33
    v_exp_f32 v34, v34
    v_exp_f32 v35, v35
    v_cvt_pk_bf16_f32 v24, v28, v29
    v_cvt_pk_bf16_f32 v25, v30, v31
    v_cvt_pk_bf16_f32 v26, v32, v33
    v_cvt_pk_bf16_f32 v27, v34, v35
    v_sub_f32 v36, v36, v240
    v_sub_f32 v37, v37, v240
    v_sub_f32 v38, v38, v240
    v_sub_f32 v39, v39, v240
    v_sub_f32 v40, v40, v240
    v_sub_f32 v41, v41, v240
    ds_read_b64_tr_b16 v[180:181], v220 offset:10752
    ds_read_b64_tr_b16 v[182:183], v221 offset:10752
    ds_read_b64_tr_b16 v[184:185], v222 offset:10752
    ds_read_b64_tr_b16 v[186:187], v223 offset:10752
    s_setprio 3
    s_waitcnt lgkmcnt(10)
    v_mfma_f32_32x32x16_bf16 v[148:163], v[164:167], v[20:23], 0
    s_waitcnt lgkmcnt(8)
    v_mfma_f32_32x32x16_bf16 v[148:163], v[168:171], v[24:27], v[148:163]
    s_setprio 0
    v_sub_f32 v42, v42, v240
    v_sub_f32 v43, v43, v240
    v_exp_f32 v36, v36
    v_exp_f32 v37, v37
    v_exp_f32 v38, v38
    v_exp_f32 v39, v39
    v_exp_f32 v40, v40
    v_exp_f32 v41, v41
    v_exp_f32 v42, v42
    v_exp_f32 v43, v43
    v_cvt_pk_bf16_f32 v36, v36, v37
    v_cvt_pk_bf16_f32 v37, v38, v39
    v_cvt_pk_bf16_f32 v38, v40, v41
    v_cvt_pk_bf16_f32 v39, v42, v43
    v_sub_f32 v44, v44, v240
    v_sub_f32 v45, v45, v240
    v_sub_f32 v46, v46, v240
    v_sub_f32 v47, v47, v240
    v_sub_f32 v48, v48, v240
    v_sub_f32 v49, v49, v240
    v_sub_f32 v50, v50, v240
    v_sub_f32 v51, v51, v240
    v_exp_f32 v44, v44
    v_exp_f32 v45, v45
    v_exp_f32 v46, v46
    v_exp_f32 v47, v47
    v_exp_f32 v48, v48
    v_exp_f32 v49, v49
    v_exp_f32 v50, v50
    v_exp_f32 v51, v51
    v_cvt_pk_bf16_f32 v40, v44, v45
    v_cvt_pk_bf16_f32 v41, v46, v47
    v_cvt_pk_bf16_f32 v42, v48, v49
    v_cvt_pk_bf16_f32 v43, v50, v51
    v_sub_f32 v52, v52, v240
    v_sub_f32 v53, v53, v240
    v_sub_f32 v54, v54, v240
    v_sub_f32 v55, v55, v240
    v_sub_f32 v56, v56, v240
    v_sub_f32 v57, v57, v240
    ds_read_b64_tr_b16 v[164:165], v220 offset:14336
    ds_read_b64_tr_b16 v[166:167], v221 offset:14336
    ds_read_b64_tr_b16 v[168:169], v222 offset:14336
    ds_read_b64_tr_b16 v[170:171], v223 offset:14336
    s_setprio 3
    s_waitcnt lgkmcnt(10)
    v_mfma_f32_32x32x16_bf16 v[148:163], v[172:175], v[36:39], v[148:163]
    s_waitcnt lgkmcnt(8)
    v_mfma_f32_32x32x16_bf16 v[148:163], v[176:179], v[40:43], v[148:163]
    s_setprio 0
    v_sub_f32 v58, v58, v240
    v_sub_f32 v59, v59, v240
    v_exp_f32 v52, v52
    v_exp_f32 v53, v53
    v_exp_f32 v54, v54
    v_exp_f32 v55, v55
    v_exp_f32 v56, v56
    v_exp_f32 v57, v57
    v_exp_f32 v58, v58
    v_exp_f32 v59, v59
    v_cvt_pk_bf16_f32 v52, v52, v53
    v_cvt_pk_bf16_f32 v53, v54, v55
    v_cvt_pk_bf16_f32 v54, v56, v57
    v_cvt_pk_bf16_f32 v55, v58, v59
    v_sub_f32 v60, v60, v240
    v_sub_f32 v61, v61, v240
    v_sub_f32 v62, v62, v240
    v_sub_f32 v63, v63, v240
    v_sub_f32 v64, v64, v240
    v_sub_f32 v65, v65, v240
    v_sub_f32 v66, v66, v240
    v_sub_f32 v67, v67, v240
    v_exp_f32 v60, v60
    v_exp_f32 v61, v61
    v_exp_f32 v62, v62
    v_exp_f32 v63, v63
    v_exp_f32 v64, v64
    v_exp_f32 v65, v65
    v_exp_f32 v66, v66
    v_exp_f32 v67, v67
    v_cvt_pk_bf16_f32 v56, v60, v61
    v_cvt_pk_bf16_f32 v57, v62, v63
    v_cvt_pk_bf16_f32 v58, v64, v65
    v_cvt_pk_bf16_f32 v59, v66, v67
    v_sub_f32 v68, v68, v240
    v_sub_f32 v69, v69, v240
    v_sub_f32 v70, v70, v240
    v_sub_f32 v71, v71, v240
    v_sub_f32 v72, v72, v240
    v_sub_f32 v73, v73, v240
    ds_read_b64_tr_b16 v[172:173], v220 offset:17920
    ds_read_b64_tr_b16 v[174:175], v221 offset:17920
    ds_read_b64_tr_b16 v[176:177], v222 offset:17920
    ds_read_b64_tr_b16 v[178:179], v223 offset:17920
    s_setprio 3
    s_waitcnt lgkmcnt(10)
    v_mfma_f32_32x32x16_bf16 v[148:163], v[180:183], v[52:55], v[148:163]
    s_waitcnt lgkmcnt(8)
    v_mfma_f32_32x32x16_bf16 v[148:163], v[184:187], v[56:59], v[148:163]
    s_setprio 0
    v_sub_f32 v74, v74, v240
    v_sub_f32 v75, v75, v240
    v_exp_f32 v68, v68
    v_exp_f32 v69, v69
    v_exp_f32 v70, v70
    v_exp_f32 v71, v71
    v_exp_f32 v72, v72
    v_exp_f32 v73, v73
    v_exp_f32 v74, v74
    v_exp_f32 v75, v75
    v_cvt_pk_bf16_f32 v68, v68, v69
    v_cvt_pk_bf16_f32 v69, v70, v71
    v_cvt_pk_bf16_f32 v70, v72, v73
    v_cvt_pk_bf16_f32 v71, v74, v75
    v_sub_f32 v76, v76, v240
    v_sub_f32 v77, v77, v240
    v_sub_f32 v78, v78, v240
    v_sub_f32 v79, v79, v240
    v_sub_f32 v80, v80, v240
    v_sub_f32 v81, v81, v240
    v_sub_f32 v82, v82, v240
    v_sub_f32 v83, v83, v240
    v_exp_f32 v76, v76
    v_exp_f32 v77, v77
    v_exp_f32 v78, v78
    v_exp_f32 v79, v79
    v_exp_f32 v80, v80
    v_exp_f32 v81, v81
    v_exp_f32 v82, v82
    v_exp_f32 v83, v83
    v_cvt_pk_bf16_f32 v72, v76, v77
    v_cvt_pk_bf16_f32 v73, v78, v79
    v_cvt_pk_bf16_f32 v74, v80, v81
    v_cvt_pk_bf16_f32 v75, v82, v83
    v_sub_f32 v84, v84, v240
    v_sub_f32 v85, v85, v240
    v_sub_f32 v86, v86, v240
    v_sub_f32 v87, v87, v240
    v_sub_f32 v88, v88, v240
    v_sub_f32 v89, v89, v240
    ds_read_b64_tr_b16 v[180:181], v220 offset:21504
    ds_read_b64_tr_b16 v[182:183], v221 offset:21504
    ds_read_b64_tr_b16 v[184:185], v222 offset:21504
    ds_read_b64_tr_b16 v[186:187], v223 offset:21504
    s_setprio 3
    s_waitcnt lgkmcnt(10)
    v_mfma_f32_32x32x16_bf16 v[148:163], v[164:167], v[68:71], v[148:163]
    s_waitcnt lgkmcnt(8)
    v_mfma_f32_32x32x16_bf16 v[148:163], v[168:171], v[72:75], v[148:163]
    s_setprio 0
    v_sub_f32 v90, v90, v240
    v_sub_f32 v91, v91, v240
    v_exp_f32 v84, v84
    v_exp_f32 v85, v85
    v_exp_f32 v86, v86
    v_exp_f32 v87, v87
    v_exp_f32 v88, v88
    v_exp_f32 v89, v89
    v_exp_f32 v90, v90
    v_exp_f32 v91, v91
    v_cvt_pk_bf16_f32 v84, v84, v85
    v_cvt_pk_bf16_f32 v85, v86, v87
    v_cvt_pk_bf16_f32 v86, v88, v89
    v_cvt_pk_bf16_f32 v87, v90, v91
    v_sub_f32 v92, v92, v240
    v_sub_f32 v93, v93, v240
    v_sub_f32 v94, v94, v240
    v_sub_f32 v95, v95, v240
    v_sub_f32 v96, v96, v240
    v_sub_f32 v97, v97, v240
    v_sub_f32 v98, v98, v240
    v_sub_f32 v99, v99, v240
    v_exp_f32 v92, v92
    v_exp_f32 v93, v93
    v_exp_f32 v94, v94
    v_exp_f32 v95, v95
    v_exp_f32 v96, v96
    v_exp_f32 v97, v97
    v_exp_f32 v98, v98
    v_exp_f32 v99, v99
    v_cvt_pk_bf16_f32 v88, v92, v93
    v_cvt_pk_bf16_f32 v89, v94, v95
    v_cvt_pk_bf16_f32 v90, v96, v97
    v_cvt_pk_bf16_f32 v91, v98, v99
    v_sub_f32 v100, v100, v240
    v_sub_f32 v101, v101, v240
    v_sub_f32 v102, v102, v240
    v_sub_f32 v103, v103, v240
    v_sub_f32 v104, v104, v240
    v_sub_f32 v105, v105, v240
    ds_read_b64_tr_b16 v[164:165], v220 offset:25088
    ds_read_b64_tr_b16 v[166:167], v221 offset:25088
    ds_read_b64_tr_b16 v[168:169], v222 offset:25088
    ds_read_b64_tr_b16 v[170:171], v223 offset:25088
    s_setprio 3
    s_waitcnt lgkmcnt(10)
    v_mfma_f32_32x32x16_bf16 v[148:163], v[172:175], v[84:87], v[148:163]
    s_waitcnt lgkmcnt(8)
    v_mfma_f32_32x32x16_bf16 v[148:163], v[176:179], v[88:91], v[148:163]
    s_setprio 0
    v_sub_f32 v106, v106, v240
    v_sub_f32 v107, v107, v240
    v_exp_f32 v100, v100
    v_exp_f32 v101, v101
    v_exp_f32 v102, v102
    v_exp_f32 v103, v103
    v_exp_f32 v104, v104
    v_exp_f32 v105, v105
    v_exp_f32 v106, v106
    v_exp_f32 v107, v107
    v_cvt_pk_bf16_f32 v100, v100, v101
    v_cvt_pk_bf16_f32 v101, v102, v103
    v_cvt_pk_bf16_f32 v102, v104, v105
    v_cvt_pk_bf16_f32 v103, v106, v107
    v_sub_f32 v108, v108, v240
    v_sub_f32 v109, v109, v240
    v_sub_f32 v110, v110, v240
    v_sub_f32 v111, v111, v240
    v_sub_f32 v112, v112, v240
    v_sub_f32 v113, v113, v240
    v_sub_f32 v114, v114, v240
    v_sub_f32 v115, v115, v240
    v_exp_f32 v108, v108
    v_exp_f32 v109, v109
    v_exp_f32 v110, v110
    v_exp_f32 v111, v111
    v_exp_f32 v112, v112
    v_exp_f32 v113, v113
    v_exp_f32 v114, v114
    v_exp_f32 v115, v115
    v_cvt_pk_bf16_f32 v104, v108, v109
    v_cvt_pk_bf16_f32 v105, v110, v111
    v_cvt_pk_bf16_f32 v106, v112, v113
    v_cvt_pk_bf16_f32 v107, v114, v115
    v_sub_f32 v116, v116, v240
    v_sub_f32 v117, v117, v240
    v_sub_f32 v118, v118, v240
    v_sub_f32 v119, v119, v240
    v_sub_f32 v120, v120, v240
    v_sub_f32 v121, v121, v240
    ds_read_b64_tr_b16 v[172:173], v220 offset:28672
    ds_read_b64_tr_b16 v[174:175], v221 offset:28672
    ds_read_b64_tr_b16 v[176:177], v222 offset:28672
    ds_read_b64_tr_b16 v[178:179], v223 offset:28672
    s_setprio 3
    s_waitcnt lgkmcnt(10)
    v_mfma_f32_32x32x16_bf16 v[148:163], v[180:183], v[100:103], v[148:163]
    s_waitcnt lgkmcnt(8)
    v_mfma_f32_32x32x16_bf16 v[148:163], v[184:187], v[104:107], v[148:163]
    s_setprio 0
    v_sub_f32 v122, v122, v240
    v_sub_f32 v123, v123, v240
    v_exp_f32 v116, v116
    v_exp_f32 v117, v117
    v_exp_f32 v118, v118
    v_exp_f32 v119, v119
    v_exp_f32 v120, v120
    v_exp_f32 v121, v121
    v_exp_f32 v122, v122
    v_exp_f32 v123, v123
    v_cvt_pk_bf16_f32 v116, v116, v117
    v_cvt_pk_bf16_f32 v117, v118, v119
    v_cvt_pk_bf16_f32 v118, v120, v121
    v_cvt_pk_bf16_f32 v119, v122, v123
    v_sub_f32 v124, v124, v240
    v_sub_f32 v125, v125, v240
    v_sub_f32 v126, v126, v240
    v_sub_f32 v127, v127, v240
    v_sub_f32 v128, v128, v240
    v_sub_f32 v129, v129, v240
    v_sub_f32 v130, v130, v240
    v_sub_f32 v131, v131, v240
    v_exp_f32 v124, v124
    v_exp_f32 v125, v125
    v_exp_f32 v126, v126
    v_exp_f32 v127, v127
    v_exp_f32 v128, v128
    v_exp_f32 v129, v129
    v_exp_f32 v130, v130
    v_exp_f32 v131, v131
    v_cvt_pk_bf16_f32 v120, v124, v125
    v_cvt_pk_bf16_f32 v121, v126, v127
    v_cvt_pk_bf16_f32 v122, v128, v129
    v_cvt_pk_bf16_f32 v123, v130, v131
    v_sub_f32 v132, v132, v240
    v_sub_f32 v133, v133, v240
    v_sub_f32 v134, v134, v240
    v_sub_f32 v135, v135, v240
    v_sub_f32 v136, v136, v240
    v_sub_f32 v137, v137, v240
    ds_read_b64_tr_b16 v[180:181], v220 offset:0
    ds_read_b64_tr_b16 v[182:183], v221 offset:0
    ds_read_b64_tr_b16 v[184:185], v222 offset:0
    ds_read_b64_tr_b16 v[186:187], v223 offset:0
    s_setprio 3
    s_waitcnt lgkmcnt(10)
    v_mfma_f32_32x32x16_bf16 v[148:163], v[164:167], v[116:119], v[148:163]
    s_waitcnt lgkmcnt(8)
    v_mfma_f32_32x32x16_bf16 v[148:163], v[168:171], v[120:123], v[148:163]
    s_setprio 0
    v_sub_f32 v138, v138, v240
    v_sub_f32 v139, v139, v240
    v_exp_f32 v132, v132
    v_exp_f32 v133, v133
    v_exp_f32 v134, v134
    v_exp_f32 v135, v135
    v_exp_f32 v136, v136
    v_exp_f32 v137, v137
    v_exp_f32 v138, v138
    v_exp_f32 v139, v139
    v_cvt_pk_bf16_f32 v132, v132, v133
    v_cvt_pk_bf16_f32 v133, v134, v135
    v_cvt_pk_bf16_f32 v134, v136, v137
    v_cvt_pk_bf16_f32 v135, v138, v139
    v_sub_f32 v140, v140, v240
    v_sub_f32 v141, v141, v240
    v_sub_f32 v142, v142, v240
    v_sub_f32 v143, v143, v240
    v_sub_f32 v144, v144, v240
    v_sub_f32 v145, v145, v240
    v_sub_f32 v146, v146, v240
    v_sub_f32 v147, v147, v240
    v_exp_f32 v140, v140
    v_exp_f32 v141, v141
    v_exp_f32 v142, v142
    v_exp_f32 v143, v143
    v_exp_f32 v144, v144
    v_exp_f32 v145, v145
    v_exp_f32 v146, v146
    v_exp_f32 v147, v147
    v_cvt_pk_bf16_f32 v136, v140, v141
    v_cvt_pk_bf16_f32 v137, v142, v143
    v_cvt_pk_bf16_f32 v138, v144, v145
    v_cvt_pk_bf16_f32 v139, v146, v147
    v_bfi_b32 v4, v208, 0, v132
    v_bfi_b32 v5, v209, 0, v133
    v_bfi_b32 v6, v210, 0, v134
    v_bfi_b32 v7, v211, 0, v135
    v_bfi_b32 v8, v212, 0, v136
    v_bfi_b32 v9, v213, 0, v137
    v_bfi_b32 v10, v214, 0, v138
    v_bfi_b32 v11, v215, 0, v139
    v_and_b32 v132, v208, v132
    v_and_b32 v133, v209, v133
    v_and_b32 v134, v210, v134
    v_and_b32 v135, v211, v135
    v_and_b32 v136, v212, v136
    v_and_b32 v137, v213, v137
    v_and_b32 v138, v214, v138
    v_and_b32 v139, v215, v139
    s_setprio 3
    s_waitcnt lgkmcnt(6)
    v_mfma_f32_32x32x16_bf16 v[148:163], v[172:175], v[132:135], v[148:163]
    s_waitcnt lgkmcnt(4)
    v_mfma_f32_32x32x16_bf16 v[148:163], v[176:179], v[136:139], v[148:163]
    s_setprio 0
    s_setprio 3
    s_waitcnt lgkmcnt(2)
    v_mfma_f32_32x32x16_bf16 v[148:163], v[180:183], v[4:7], v[148:163]
    s_waitcnt lgkmcnt(0)
    v_mfma_f32_32x32x16_bf16 v[148:163], v[184:187], v[8:11], v[148:163]
    s_setprio 0
    s_cmp_eq_u32 s37, 3
    s_cselect_b64 vcc, -1, 0
    s_nop 8
    v_cndmask_b32_e64 v224, v160, v148, vcc
    v_mov_b32 v225, v224
    s_nop 1
    v_permlane32_swap_b32 v224, v225
    v_cndmask_b32_e64 v224, v225, v224, vcc
    s_waitcnt vmcnt(0) lgkmcnt(0)
    s_nop 11
joined_77:
    v_rcp_f32 v224, v224
    s_nop 0
    v_mul_f32 v224, v224, v255
    v_mul_f32 v148, v148, v224
    v_mul_f32 v149, v149, v224
    v_mul_f32 v150, v150, v224
    v_mul_f32 v151, v151, v224
    v_mul_f32 v152, v152, v224
    v_mul_f32 v153, v153, v224
    v_mul_f32 v154, v154, v224
    v_mul_f32 v155, v155, v224
    v_mul_f32 v156, v156, v224
    v_mul_f32 v157, v157, v224
    v_mul_f32 v158, v158, v224
    v_mul_f32 v159, v159, v224
    v_mul_f32 v160, v160, v224
    v_mul_f32 v161, v161, v224
    v_mul_f32 v162, v162, v224
    v_mul_f32 v163, v163, v224
    v_cvt_pk_bf16_f32 v148, v148, v149
    v_cvt_pk_bf16_f32 v149, v150, v151
    v_cvt_pk_bf16_f32 v150, v152, v153
    v_cvt_pk_bf16_f32 v151, v154, v155
    v_cvt_pk_bf16_f32 v152, v156, v157
    v_cvt_pk_bf16_f32 v153, v158, v159
    v_cvt_pk_bf16_f32 v154, v160, v161
    v_cvt_pk_bf16_f32 v155, v162, v163
    s_lshl_b32 s45, s37, 2
    v_mov_b32 v227, 0x40000000
    v_add_u32 v225, -2, v229
    v_cmp_gt_i32 vcc, s45, v225
    s_nop 1
    v_cndmask_b32_e64 v216, v148, v216, vcc
    v_add_u32 v225, 0, v229
    v_cmp_gt_i32 vcc, s45, v225
    s_nop 1
    v_cndmask_b32_e64 v217, v149, v217, vcc
    v_add_u32 v225, 6, v229
    v_cmp_gt_i32 vcc, s45, v225
    s_nop 1
    v_cndmask_b32_e64 v218, v150, v218, vcc
    v_add_u32 v225, 8, v229
    v_cmp_gt_i32 vcc, s45, v225
    s_nop 1
    v_cndmask_b32_e64 v219, v151, v219, vcc
    buffer_store_dwordx4 v[216:219], v234, s[28:31], s46 offen offset:1024 sc1
    v_add_u32 v225, -4, v229
    v_cmp_gt_i32 vcc, s45, v225
    s_nop 1
    v_cndmask_b32_e64 v225, v227, v234, vcc
    buffer_store_dwordx2 v[152:153], v225, s[28:31], s46 offen offset:2048 sc1
    v_add_u32 v225, 4, v229
    v_cmp_gt_i32 vcc, s45, v225
    s_nop 1
    v_cndmask_b32_e64 v226, v227, v234, vcc
    buffer_store_dwordx2 v[154:155], v226, s[28:31], s46 offen offset:2056 sc1
    s_lshl_b32 s40, s33, 4
    s_add_u32 s40, s40, s14
    s_waitcnt vmcnt(0)
    s_mov_b64 exec, 1
    buffer_store_dword v238, off, s[28:31], s40 offset:64 sc1
    s_mov_b64 exec, -1
    s_mov_b64 exec, 1
    ds_add_u32 v237, v238 offset:4
    s_mov_b64 exec, -1
p2_attn_done:
    s_waitcnt vmcnt(0) lgkmcnt(0)
    s_nop 11
    v_and_b32 v106, 63, v0
    v_lshlrev_b32 v105, 4, v106
    v_mov_b32 v108, 163328
    s_load_dwordx2 s[94:95], s[0:1], 56
    s_load_dwordx2 s[98:99], s[0:1], 72
    s_waitcnt lgkmcnt(0)
    s_mov_b32 s20, s98
    s_and_b32 s21, s99, 0xffff
    s_mov_b32 s22, 0x240000
    s_mov_b32 s23, 0x20000
    s_and_b32 s40, s33, 1
    s_lshr_b32 s41, s33, 1
    s_lshl_b32 s41, s41, 2
    s_add_u32 s40, s40, s41
    s_lshl_b32 s41, s37, 3
    s_add_u32 s41, s41, s40
    s_lshl_b32 s41, s41, 5
    s_lshl_b32 s42, s37, 5
    s_add_u32 s42, s42, 1024
    s_add_u32 s12, s94, s41
    s_addc_u32 s13, s95, 0
    s_load_dwordx8 s[56:63], s[12:13], 0
    s_load_dwordx8 s[64:71], s[12:13], 64
    s_add_u32 s12, s94, s42
    s_addc_u32 s13, s95, 0
    s_load_dwordx8 s[72:79], s[12:13], 0
    v_lshrrev_b32 v103, 5, v106
    s_and_b32 s40, s33, 1
    s_lshr_b32 s41, s33, 1
    s_lshl_b32 s41, s41, 2
    s_add_u32 s40, s40, s41
    s_lshl_b32 s41, s37, 3
    s_add_u32 s41, s41, s40
    s_lshl_b32 s41, s41, 5
    s_lshl_b32 s42, s37, 5
    s_add_u32 s42, s42, 1024
    s_lshl_b32 s52, s36, 2
    s_add_u32 s52, s52, s35
    s_mul_i32 s52, s52, 36864
    s_add_u32 s53, s52, s42
    s_add_u32 s52, s52, s41
    s_cmp_eq_u32 s33, 0
    s_cselect_b32 s42, 0, 0x40000000
    s_add_u32 s53, s53, s42
    s_lshl_b32 s41, s36, 2
    s_add_u32 s41, s41, s37
    s_lshl_b32 s41, s41, 2
    s_add_u32 s41, s41, s35
    s_mul_i32 s41, s41, 36864
    s_add_u32 s41, s41, 0x1b00000
    s_lshl_b32 s40, s40, 10
    s_add_u32 s44, s41, 0
    s_cmp_eq_u32 s35, 0
    s_cselect_b32 s44, 0x40000000, s44
    s_add_u32 s48, s44, s42
    s_add_u32 s48, s48, 8192
    s_add_u32 s44, s44, s40
    s_add_u32 s45, s41, 9216
    s_cmp_eq_u32 s35, 1
    s_cselect_b32 s45, 0x40000000, s45
    s_add_u32 s49, s45, s42
    s_add_u32 s49, s49, 8192
    s_add_u32 s45, s45, s40
    s_add_u32 s46, s41, 18432
    s_cmp_eq_u32 s35, 2
    s_cselect_b32 s46, 0x40000000, s46
    s_add_u32 s50, s46, s42
    s_add_u32 s50, s50, 8192
    s_add_u32 s46, s46, s40
    s_add_u32 s47, s41, 27648
    s_cmp_eq_u32 s35, 3
    s_cselect_b32 s47, 0x40000000, s47
    s_add_u32 s51, s47, s42
    s_add_u32 s51, s51, 8192
    s_add_u32 s47, s47, s40
    s_mul_i32 s41, s35, 9216
    v_add_u32 v111, s41, v105
    v_add_u32 v110, s40, v111
    v_and_b32 v112, 31, v106
    s_lshl_b32 s41, s35, 7
    s_add_u32 s41, s41, 161792
    v_lshl_add_u32 v109, v112, 2, s41
    v_mul_u32_u24 v112, 1152, v112
    v_lshl_add_u32 v112, v103, 4, v112
    v_cmp_gt_u32 vcc, 32, v106
    s_waitcnt lgkmcnt(0)
    v_mov_b32 v88, s58
    v_mov_b32 v102, s56
    v_cndmask_b32_e64 v88, v88, v102, vcc
    v_mov_b32 v89, s59
    v_mov_b32 v102, s57
    v_cndmask_b32_e64 v89, v89, v102, vcc
    v_mov_b32 v90, s62
    v_mov_b32 v102, s60
    v_cndmask_b32_e64 v90, v90, v102, vcc
    v_mov_b32 v91, s63
    v_mov_b32 v102, s61
    v_cndmask_b32_e64 v91, v91, v102, vcc
    v_mov_b32 v92, s66
    v_mov_b32 v102, s64
    v_cndmask_b32_e64 v92, v92, v102, vcc
    v_mov_b32 v93, s67
    v_mov_b32 v102, s65
    v_cndmask_b32_e64 v93, v93, v102, vcc
    v_mov_b32 v94, s70
    v_mov_b32 v102, s68
    v_cndmask_b32_e64 v94, v94, v102, vcc
    v_mov_b32 v95, s71
    v_mov_b32 v102, s69
    v_cndmask_b32_e64 v95, v95, v102, vcc
    v_mov_b32 v96, s74
    v_mov_b32 v102, s72
    v_cndmask_b32_e64 v96, v96, v102, vcc
    v_mov_b32 v97, s75
    v_mov_b32 v102, s73
    v_cndmask_b32_e64 v97, v97, v102, vcc
    v_mov_b32 v98, s78
    v_mov_b32 v102, s76
    v_cndmask_b32_e64 v98, v98, v102, vcc
    v_mov_b32 v99, s79
    v_mov_b32 v102, s77
    v_cndmask_b32_e64 v99, v99, v102, vcc
    s_lshl_b32 s54, s36, 2
    s_add_u32 s54, s54, s37
    s_lshl_b32 s54, s54, 2
    s_add_u32 s54, s54, s35
    s_lshl_b32 s54, s54, 7
    s_add_u32 s54, s54, 0x2d62000
    s_mov_b32 s15, 0x40000
fw_79:
    ds_read_b32 v107, v108 offset:12
    s_waitcnt lgkmcnt(0)
    v_readfirstlane_b32 s42, v107
    s_nop 3
    s_cmp_ge_u32 s42, 4
    s_cbranch_scc1 fr_80
    s_sleep 8
    s_sub_u32 s15, s15, 1
    s_cbranch_scc0 fw_79
fr_80:
    buffer_load_dwordx4 v[100:103], off, s[28:31], s54 sc1
    ds_read_b32 v104, v109
    ds_read_b128 v[52:55], v110 offset:0
    ds_read_b128 v[56:59], v110 offset:2048
    ds_read_b128 v[60:63], v111 offset:8192
    s_waitcnt vmcnt(0)
    v_and_b32 v107, v100, v101
    v_and_b32 v107, v107, v102
    v_and_b32 v107, v107, v103
    s_nop 0
    v_readfirstlane_b32 s41, v107
    s_nop 3
    s_cmp_eq_u32 s41, 1
    s_cbranch_scc1 ready_82
    s_mov_b32 s42, 0x8000
spin_81:
    s_sub_u32 s42, s42, 1
    s_cbranch_scc1 ready_82
    s_sleep 1
    buffer_load_dwordx4 v[100:103], off, s[28:31], s54 sc1
    s_waitcnt vmcnt(0)
    v_and_b32 v107, v100, v101
    s_nop 4
    v_and_b32 v107, v107, v102
    s_nop 4
    v_and_b32 v107, v107, v103
    s_nop 4
    v_readfirstlane_b32 s41, v107
    s_nop 4
    s_cmp_eq_u32 s41, 1
    s_nop 4
    s_cbranch_scc0 spin_81
ready_82:
    buffer_load_dwordx4 v[4:7], v105, s[28:31], s44 offen offset:0 sc1
    buffer_load_dwordx4 v[8:11], v105, s[28:31], s45 offen offset:0 sc1
    buffer_load_dwordx4 v[12:15], v105, s[28:31], s46 offen offset:0 sc1
    buffer_load_dwordx4 v[16:19], v105, s[28:31], s47 offen offset:0 sc1
    buffer_load_dwordx4 v[20:23], v105, s[28:31], s44 offen offset:2048 sc1
    buffer_load_dwordx4 v[24:27], v105, s[28:31], s45 offen offset:2048 sc1
    buffer_load_dwordx4 v[28:31], v105, s[28:31], s46 offen offset:2048 sc1
    buffer_load_dwordx4 v[32:35], v105, s[28:31], s47 offen offset:2048 sc1
    buffer_load_dwordx4 v[36:39], v105, s[28:31], s48 offen offset:0 sc1
    buffer_load_dwordx4 v[40:43], v105, s[28:31], s49 offen offset:0 sc1
    buffer_load_dwordx4 v[44:47], v105, s[28:31], s50 offen offset:0 sc1
    buffer_load_dwordx4 v[48:51], v105, s[28:31], s51 offen offset:0 sc1
    v_lshlrev_b32 v64, 16, v88
    v_and_b32 v65, 0xffff0000, v88
    v_lshlrev_b32 v66, 16, v89
    v_and_b32 v67, 0xffff0000, v89
    v_lshlrev_b32 v68, 16, v90
    v_and_b32 v69, 0xffff0000, v90
    v_lshlrev_b32 v70, 16, v91
    v_and_b32 v71, 0xffff0000, v91
    s_waitcnt lgkmcnt(3)
    v_mul_f32 v64, v64, v104
    v_mul_f32 v65, v65, v104
    v_mul_f32 v66, v66, v104
    v_mul_f32 v67, v67, v104
    v_mul_f32 v68, v68, v104
    v_mul_f32 v69, v69, v104
    v_mul_f32 v70, v70, v104
    v_mul_f32 v71, v71, v104
    s_waitcnt lgkmcnt(2)
    v_lshlrev_b32 v72, 16, v52
    v_and_b32 v52, 0xffff0000, v52
    v_add_f32 v64, v64, v72
    v_add_f32 v65, v65, v52
    v_lshlrev_b32 v72, 16, v53
    v_and_b32 v53, 0xffff0000, v53
    v_add_f32 v66, v66, v72
    v_add_f32 v67, v67, v53
    v_lshlrev_b32 v72, 16, v54
    v_and_b32 v54, 0xffff0000, v54
    v_add_f32 v68, v68, v72
    v_add_f32 v69, v69, v54
    v_lshlrev_b32 v72, 16, v55
    v_and_b32 v55, 0xffff0000, v55
    v_add_f32 v70, v70, v72
    v_add_f32 v71, v71, v55
    s_waitcnt vmcnt(11)
    v_lshlrev_b32 v72, 16, v4
    v_and_b32 v4, 0xffff0000, v4
    v_add_f32 v64, v64, v72
    v_add_f32 v65, v65, v4
    v_lshlrev_b32 v72, 16, v5
    v_and_b32 v5, 0xffff0000, v5
    v_add_f32 v66, v66, v72
    v_add_f32 v67, v67, v5
    v_lshlrev_b32 v72, 16, v6
    v_and_b32 v6, 0xffff0000, v6
    v_add_f32 v68, v68, v72
    v_add_f32 v69, v69, v6
    v_lshlrev_b32 v72, 16, v7
    v_and_b32 v7, 0xffff0000, v7
    v_add_f32 v70, v70, v72
    v_add_f32 v71, v71, v7
    s_waitcnt vmcnt(10)
    v_lshlrev_b32 v72, 16, v8
    v_and_b32 v8, 0xffff0000, v8
    v_add_f32 v64, v64, v72
    v_add_f32 v65, v65, v8
    v_lshlrev_b32 v72, 16, v9
    v_and_b32 v9, 0xffff0000, v9
    v_add_f32 v66, v66, v72
    v_add_f32 v67, v67, v9
    v_lshlrev_b32 v72, 16, v10
    v_and_b32 v10, 0xffff0000, v10
    v_add_f32 v68, v68, v72
    v_add_f32 v69, v69, v10
    v_lshlrev_b32 v72, 16, v11
    v_and_b32 v11, 0xffff0000, v11
    v_add_f32 v70, v70, v72
    v_add_f32 v71, v71, v11
    s_waitcnt vmcnt(9)
    v_lshlrev_b32 v72, 16, v12
    v_and_b32 v12, 0xffff0000, v12
    v_add_f32 v64, v64, v72
    v_add_f32 v65, v65, v12
    v_lshlrev_b32 v72, 16, v13
    v_and_b32 v13, 0xffff0000, v13
    v_add_f32 v66, v66, v72
    v_add_f32 v67, v67, v13
    v_lshlrev_b32 v72, 16, v14
    v_and_b32 v14, 0xffff0000, v14
    v_add_f32 v68, v68, v72
    v_add_f32 v69, v69, v14
    v_lshlrev_b32 v72, 16, v15
    v_and_b32 v15, 0xffff0000, v15
    v_add_f32 v70, v70, v72
    v_add_f32 v71, v71, v15
    s_waitcnt vmcnt(8)
    v_lshlrev_b32 v72, 16, v16
    v_and_b32 v16, 0xffff0000, v16
    v_add_f32 v64, v64, v72
    v_add_f32 v65, v65, v16
    v_lshlrev_b32 v72, 16, v17
    v_and_b32 v17, 0xffff0000, v17
    v_add_f32 v66, v66, v72
    v_add_f32 v67, v67, v17
    v_lshlrev_b32 v72, 16, v18
    v_and_b32 v18, 0xffff0000, v18
    v_add_f32 v68, v68, v72
    v_add_f32 v69, v69, v18
    v_lshlrev_b32 v72, 16, v19
    v_and_b32 v19, 0xffff0000, v19
    v_add_f32 v70, v70, v72
    v_add_f32 v71, v71, v19
    v_cvt_pk_bf16_f32 v76, v64, v65
    v_cvt_pk_bf16_f32 v77, v66, v67
    v_cvt_pk_bf16_f32 v78, v68, v69
    v_cvt_pk_bf16_f32 v79, v70, v71
    s_nop 0
    v_permlane32_swap_b32 v76, v78
    v_permlane32_swap_b32 v77, v79
    buffer_store_dwordx4 v[76:79], v112, s[20:23], s52 offen offset:0
    v_lshlrev_b32 v64, 16, v92
    v_and_b32 v65, 0xffff0000, v92
    v_lshlrev_b32 v66, 16, v93
    v_and_b32 v67, 0xffff0000, v93
    v_lshlrev_b32 v68, 16, v94
    v_and_b32 v69, 0xffff0000, v94
    v_lshlrev_b32 v70, 16, v95
    v_and_b32 v71, 0xffff0000, v95
    v_mul_f32 v64, v64, v104
    v_mul_f32 v65, v65, v104
    v_mul_f32 v66, v66, v104
    v_mul_f32 v67, v67, v104
    v_mul_f32 v68, v68, v104
    v_mul_f32 v69, v69, v104
    v_mul_f32 v70, v70, v104
    v_mul_f32 v71, v71, v104
    s_waitcnt lgkmcnt(1)
    v_lshlrev_b32 v72, 16, v56
    v_and_b32 v56, 0xffff0000, v56
    v_add_f32 v64, v64, v72
    v_add_f32 v65, v65, v56
    v_lshlrev_b32 v72, 16, v57
    v_and_b32 v57, 0xffff0000, v57
    v_add_f32 v66, v66, v72
    v_add_f32 v67, v67, v57
    v_lshlrev_b32 v72, 16, v58
    v_and_b32 v58, 0xffff0000, v58
    v_add_f32 v68, v68, v72
    v_add_f32 v69, v69, v58
    v_lshlrev_b32 v72, 16, v59
    v_and_b32 v59, 0xffff0000, v59
    v_add_f32 v70, v70, v72
    v_add_f32 v71, v71, v59
    s_waitcnt vmcnt(8)
    v_lshlrev_b32 v72, 16, v20
    v_and_b32 v20, 0xffff0000, v20
    v_add_f32 v64, v64, v72
    v_add_f32 v65, v65, v20
    v_lshlrev_b32 v72, 16, v21
    v_and_b32 v21, 0xffff0000, v21
    v_add_f32 v66, v66, v72
    v_add_f32 v67, v67, v21
    v_lshlrev_b32 v72, 16, v22
    v_and_b32 v22, 0xffff0000, v22
    v_add_f32 v68, v68, v72
    v_add_f32 v69, v69, v22
    v_lshlrev_b32 v72, 16, v23
    v_and_b32 v23, 0xffff0000, v23
    v_add_f32 v70, v70, v72
    v_add_f32 v71, v71, v23
    s_waitcnt vmcnt(7)
    v_lshlrev_b32 v72, 16, v24
    v_and_b32 v24, 0xffff0000, v24
    v_add_f32 v64, v64, v72
    v_add_f32 v65, v65, v24
    v_lshlrev_b32 v72, 16, v25
    v_and_b32 v25, 0xffff0000, v25
    v_add_f32 v66, v66, v72
    v_add_f32 v67, v67, v25
    v_lshlrev_b32 v72, 16, v26
    v_and_b32 v26, 0xffff0000, v26
    v_add_f32 v68, v68, v72
    v_add_f32 v69, v69, v26
    v_lshlrev_b32 v72, 16, v27
    v_and_b32 v27, 0xffff0000, v27
    v_add_f32 v70, v70, v72
    v_add_f32 v71, v71, v27
    s_waitcnt vmcnt(6)
    v_lshlrev_b32 v72, 16, v28
    v_and_b32 v28, 0xffff0000, v28
    v_add_f32 v64, v64, v72
    v_add_f32 v65, v65, v28
    v_lshlrev_b32 v72, 16, v29
    v_and_b32 v29, 0xffff0000, v29
    v_add_f32 v66, v66, v72
    v_add_f32 v67, v67, v29
    v_lshlrev_b32 v72, 16, v30
    v_and_b32 v30, 0xffff0000, v30
    v_add_f32 v68, v68, v72
    v_add_f32 v69, v69, v30
    v_lshlrev_b32 v72, 16, v31
    v_and_b32 v31, 0xffff0000, v31
    v_add_f32 v70, v70, v72
    v_add_f32 v71, v71, v31
    s_waitcnt vmcnt(5)
    v_lshlrev_b32 v72, 16, v32
    v_and_b32 v32, 0xffff0000, v32
    v_add_f32 v64, v64, v72
    v_add_f32 v65, v65, v32
    v_lshlrev_b32 v72, 16, v33
    v_and_b32 v33, 0xffff0000, v33
    v_add_f32 v66, v66, v72
    v_add_f32 v67, v67, v33
    v_lshlrev_b32 v72, 16, v34
    v_and_b32 v34, 0xffff0000, v34
    v_add_f32 v68, v68, v72
    v_add_f32 v69, v69, v34
    v_lshlrev_b32 v72, 16, v35
    v_and_b32 v35, 0xffff0000, v35
    v_add_f32 v70, v70, v72
    v_add_f32 v71, v71, v35
    v_cvt_pk_bf16_f32 v80, v64, v65
    v_cvt_pk_bf16_f32 v81, v66, v67
    v_cvt_pk_bf16_f32 v82, v68, v69
    v_cvt_pk_bf16_f32 v83, v70, v71
    s_nop 0
    v_permlane32_swap_b32 v80, v82
    v_permlane32_swap_b32 v81, v83
    buffer_store_dwordx4 v[80:83], v112, s[20:23], s52 offen offset:64
    v_lshlrev_b32 v64, 16, v96
    v_and_b32 v65, 0xffff0000, v96
    v_lshlrev_b32 v66, 16, v97
    v_and_b32 v67, 0xffff0000, v97
    v_lshlrev_b32 v68, 16, v98
    v_and_b32 v69, 0xffff0000, v98
    v_lshlrev_b32 v70, 16, v99
    v_and_b32 v71, 0xffff0000, v99
    v_mul_f32 v64, v64, v104
    v_mul_f32 v65, v65, v104
    v_mul_f32 v66, v66, v104
    v_mul_f32 v67, v67, v104
    v_mul_f32 v68, v68, v104
    v_mul_f32 v69, v69, v104
    v_mul_f32 v70, v70, v104
    v_mul_f32 v71, v71, v104
    s_waitcnt lgkmcnt(0)
    v_lshlrev_b32 v72, 16, v60
    v_and_b32 v60, 0xffff0000, v60
    v_add_f32 v64, v64, v72
    v_add_f32 v65, v65, v60
    v_lshlrev_b32 v72, 16, v61
    v_and_b32 v61, 0xffff0000, v61
    v_add_f32 v66, v66, v72
    v_add_f32 v67, v67, v61
    v_lshlrev_b32 v72, 16, v62
    v_and_b32 v62, 0xffff0000, v62
    v_add_f32 v68, v68, v72
    v_add_f32 v69, v69, v62
    v_lshlrev_b32 v72, 16, v63
    v_and_b32 v63, 0xffff0000, v63
    v_add_f32 v70, v70, v72
    v_add_f32 v71, v71, v63
    s_waitcnt vmcnt(5)
    v_lshlrev_b32 v72, 16, v36
    v_and_b32 v36, 0xffff0000, v36
    v_add_f32 v64, v64, v72
    v_add_f32 v65, v65, v36
    v_lshlrev_b32 v72, 16, v37
    v_and_b32 v37, 0xffff0000, v37
    v_add_f32 v66, v66, v72
    v_add_f32 v67, v67, v37
    v_lshlrev_b32 v72, 16, v38
    v_and_b32 v38, 0xffff0000, v38
    v_add_f32 v68, v68, v72
    v_add_f32 v69, v69, v38
    v_lshlrev_b32 v72, 16, v39
    v_and_b32 v39, 0xffff0000, v39
    v_add_f32 v70, v70, v72
    v_add_f32 v71, v71, v39
    s_waitcnt vmcnt(4)
    v_lshlrev_b32 v72, 16, v40
    v_and_b32 v40, 0xffff0000, v40
    v_add_f32 v64, v64, v72
    v_add_f32 v65, v65, v40
    v_lshlrev_b32 v72, 16, v41
    v_and_b32 v41, 0xffff0000, v41
    v_add_f32 v66, v66, v72
    v_add_f32 v67, v67, v41
    v_lshlrev_b32 v72, 16, v42
    v_and_b32 v42, 0xffff0000, v42
    v_add_f32 v68, v68, v72
    v_add_f32 v69, v69, v42
    v_lshlrev_b32 v72, 16, v43
    v_and_b32 v43, 0xffff0000, v43
    v_add_f32 v70, v70, v72
    v_add_f32 v71, v71, v43
    s_waitcnt vmcnt(3)
    v_lshlrev_b32 v72, 16, v44
    v_and_b32 v44, 0xffff0000, v44
    v_add_f32 v64, v64, v72
    v_add_f32 v65, v65, v44
    v_lshlrev_b32 v72, 16, v45
    v_and_b32 v45, 0xffff0000, v45
    v_add_f32 v66, v66, v72
    v_add_f32 v67, v67, v45
    v_lshlrev_b32 v72, 16, v46
    v_and_b32 v46, 0xffff0000, v46
    v_add_f32 v68, v68, v72
    v_add_f32 v69, v69, v46
    v_lshlrev_b32 v72, 16, v47
    v_and_b32 v47, 0xffff0000, v47
    v_add_f32 v70, v70, v72
    v_add_f32 v71, v71, v47
    s_waitcnt vmcnt(2)
    v_lshlrev_b32 v72, 16, v48
    v_and_b32 v48, 0xffff0000, v48
    v_add_f32 v64, v64, v72
    v_add_f32 v65, v65, v48
    v_lshlrev_b32 v72, 16, v49
    v_and_b32 v49, 0xffff0000, v49
    v_add_f32 v66, v66, v72
    v_add_f32 v67, v67, v49
    v_lshlrev_b32 v72, 16, v50
    v_and_b32 v50, 0xffff0000, v50
    v_add_f32 v68, v68, v72
    v_add_f32 v69, v69, v50
    v_lshlrev_b32 v72, 16, v51
    v_and_b32 v51, 0xffff0000, v51
    v_add_f32 v70, v70, v72
    v_add_f32 v71, v71, v51
    v_cvt_pk_bf16_f32 v84, v64, v65
    v_cvt_pk_bf16_f32 v85, v66, v67
    v_cvt_pk_bf16_f32 v86, v68, v69
    v_cvt_pk_bf16_f32 v87, v70, v71
    s_nop 0
    v_permlane32_swap_b32 v84, v86
    v_permlane32_swap_b32 v85, v87
    buffer_store_dwordx4 v[84:87], v112, s[20:23], s53 offen offset:0
    s_endpgm
mk_end:
    s_endpgm
all_code_end:
.section .rodata,"a"
.p2align 6
.amdhsa_kernel gated_mix__sliding_block__mixer_channel_mlp__prompt_kernel
  .amdhsa_next_free_vgpr 256
  .amdhsa_next_free_sgpr 102
  .amdhsa_accum_offset 256
  .amdhsa_group_segment_fixed_size 0
  .amdhsa_kernarg_size 96
  .amdhsa_user_sgpr_count 2
  .amdhsa_user_sgpr_kernarg_segment_ptr 1
  .amdhsa_system_sgpr_workgroup_id_x 1
.end_amdhsa_kernel
```
